```python
import torch

def _softmax(x, axis=-1):
    return torch.softmax(x, dim=axis)
def _gelu(x):
    return torch.nn.functional.gelu(x, approximate="tanh")
def _silu(x):
    return torch.nn.functional.silu(x)
def _sigmoid(x):
    return torch.sigmoid(x)
def _layernorm(x, axis=-1, eps=1e-5):
    m = x.mean(dim=axis, keepdim=True)
    v = x.var(dim=axis, keepdim=True, unbiased=False)
    return (x - m) / torch.sqrt(v + eps)
def _scatter_add(tgt, idx, src, axis=0):
    return tgt.clone().index_add_(axis, idx, src)
def _segment_sum(src, seg, n):
    out = torch.zeros((n,) + src.shape[1:], dtype=src.dtype)
    return out.index_add_(0, seg, src)
def _pad(x, pw):
    flat = tuple(v for pair in reversed(pw) for v in pair)
    return torch.nn.functional.pad(x, flat)

kernel_name = 'recurrent_scan__compressed_kv_cla__dense_activation_silu__prompt'

def setup_inputs():

    _w = (lambda a: (lambda t: t.to(torch.bfloat16) if t.is_floating_point() else t)(torch.as_tensor(a)))
    def _A_setup():
        B, H, Sq, Sk, D, M = 1, 32, 2048, 2048, 128, 640
        Dc = 4 * D
        return {
            "x": _w((lambda *s: torch.randn(*s, dtype=torch.bfloat16) * 0.05)(B, Sq, M)),
            "c_kv": _w((lambda *s: torch.randn(*s, dtype=torch.bfloat16) * 0.8)(B, Sk, Dc)),
            "w_q": _w((lambda *s: torch.randn(*s, dtype=torch.bfloat16) * 1.6)(M, H, D) * (M ** -0.5)),
            "w_uk": _w((lambda *s: torch.randn(*s, dtype=torch.bfloat16) * 1.6)(Dc, H, D) * (Dc ** -0.5)),
            "w_uv": _w((lambda *s: torch.randn(*s, dtype=torch.bfloat16) * 0.8)(Dc, H, D) * (Dc ** -0.5)),
            "w_o": _w((lambda *s: torch.randn(*s, dtype=torch.bfloat16) * 0.8)(H, D, M) * ((H * D) ** -0.5)),
        }
    _A_in = _A_setup()

    def _B_setup():
        B, S, D, F = 1, 2048, 640, 1728
        return {
            "x": _w((lambda *s: torch.randn(*s, dtype=torch.bfloat16) * 0.05)(B, S, D)),
            "w1": _w((lambda *s: torch.randn(*s, dtype=torch.bfloat16) * 0.8)(D, F) * (D ** -0.5)),
            "w2": _w((lambda *s: torch.randn(*s, dtype=torch.bfloat16) * 0.2)(F, D) * (F ** -0.5)),
        }
    _B_in = _B_setup()

    return {
        "A_x": _A_in["x"],
        "A_c_kv": _A_in["c_kv"],
        "A_w_q": _A_in["w_q"],
        "A_w_uk": _A_in["w_uk"],
        "A_w_uv": _A_in["w_uv"],
        "A_w_o": _A_in["w_o"],
        "B_x": _B_in["x"],
        "B_w1": _B_in["w1"],
        "B_w2": _B_in["w2"],
    }

def reference(A_x, A_c_kv, A_w_q, A_w_uk, A_w_uv, A_w_o, B_x, B_w1, B_w2):
    def _A_ref(x, c_kv, w_q, w_uk, w_uv, w_o):
        B, Sq, M = x.shape[0], x.shape[1], x.shape[2]
        Sk = c_kv.shape[1]
        H, D = w_q.shape[1], w_q.shape[2]
        q = torch.einsum("bqm,mhd->bhqd", x, w_q)
        k = torch.einsum("bkc,chd->bhkd", c_kv, w_uk)
        v = torch.einsum("bkc,chd->bhkd", c_kv, w_uv)
        scores = torch.einsum("bhqd,bhkd->bhqk", q, k) * (D ** -0.5)
        off = Sk - Sq
        qi = torch.arange(Sq)[:, None]
        kj = torch.arange(Sk)[None, :]
        cmask = kj <= (qi + off)
        scores = torch.where(cmask[None, None], scores, -1e9)
        p = _softmax(scores, axis=-1)
        ctx = torch.einsum("bhqk,bhkd->bhqd", p, v)
        return torch.einsum("bhqd,hdm->bqm", ctx, w_o)

    def _B_ref(x, w1, w2):
        h = torch.einsum("bsd,df->bsf", x, w1)
        h = _silu(h)
        out = torch.einsum("bsf,fd->bsd", h, w2)
        return out

    x = A_x
    xn = _layernorm(x, axis=-1)
    s = _A_ref(xn, A_c_kv, A_w_q, A_w_uk, A_w_uv, A_w_o)
    g = _silu(_B_ref(xn, B_w1, B_w2))
    return x + s * g
```

```asm
; @launch grid=(256,1,1) block=(256,1,1) lds=163840
.amdgcn_target "amdgcn-amd-amdhsa--gfx950"
.text
.globl recurrent_scan__compressed_kv_cla__dense_activation_silu__prompt_kernel
.p2align 8
.type recurrent_scan__compressed_kv_cla__dense_activation_silu__prompt_kernel,@function
recurrent_scan__compressed_kv_cla__dense_activation_silu__prompt_kernel:
  s_cmp_ge_u32 s2, 256
  s_cbranch_scc1 recurrent_scan__compressed_kv_cla__dense_activation_silu__prompt_kernel_end
  s_getpc_b64 s[4:5]
recurrent_scan__compressed_kv_cla__dense_activation_silu__prompt_kernel_pc0:
  v_lshrrev_b32 v1, 2, v0
  v_lshlrev_b32 v1, 7, v1
  global_load_dword v2, v1, s[4:5]
  s_lshr_b32 s3, s2, 3
  s_lshl_b32 s3, s3, 12
  v_lshrrev_b32 v1, 3, v0
  v_lshlrev_b32 v1, 7, v1
  v_add_u32 v1, s3, v1
  v_min_u32 v1, recurrent_scan__compressed_kv_cla__dense_activation_silu__prompt_kernel_last-recurrent_scan__compressed_kv_cla__dense_activation_silu__prompt_kernel_pc0, v1
  global_load_dword v3, v1, s[4:5]
  s_load_dwordx2 s[76:77], s[0:1], 8
  s_load_dwordx2 s[78:79], s[0:1], 24
  s_load_dwordx2 s[80:81], s[0:1], 0
  s_load_dwordx2 s[82:83], s[0:1], 32
  s_load_dwordx2 s[84:85], s[0:1], 88
  s_load_dwordx2 s[72:73], s[0:1], 80
  s_load_dwordx2 s[32:33], s[0:1], 16
  s_load_dwordx2 s[34:35], s[0:1], 56
  s_load_dwordx2 s[36:37], s[0:1], 40
  s_load_dwordx2 s[40:41], s[0:1], 64
  v_lshrrev_b32 v250, 6, v0
  v_and_b32 v249, 63, v0
  v_readfirstlane_b32 s3, v250
  v_cmp_eq_u32 vcc, 0, v0
  v_mov_b32 v255, 0x10000000
  v_lshlrev_b32 v248, 4, v249
  v_cndmask_b32 v255, v255, v0, vcc
  s_and_b32 s47, s2, 7
  s_bfe_u32 s46, s2, 0x20003
  s_lshl_b32 s44, s47, 2
  s_add_u32 s44, s44, s46
  s_lshr_b32 s45, s2, 5
  s_mov_b32 s64, 4096
  s_mov_b32 s65, 8192
  s_mov_b32 s66, 12288
  s_mov_b32 s67, 16384
  s_lshl_b32 s50, s3, 12
  s_lshl_b32 s60, s3, 13
  s_add_u32 s60, s60, 73728
  s_lshl_b32 s61, s3, 11
  s_lshl_b32 s62, s3, 17
  s_and_b32 s58, s3, 1
  s_lshl_b32 s58, s58, 18
  v_lshrrev_b32 v250, 4, v249
  v_and_b32 v251, 15, v249
  s_lshl_b32 s48, s3, 4
  v_add_u32 v252, s48, v250
  v_lshlrev_b32 v252, 13, v252
  v_lshlrev_b32 v253, 1, v250
  v_xor_b32 v253, v253, v251
  v_lshl_add_u32 v240, v253, 4, v252
  v_add_u32 v241, 31744, v240
  v_xor_b32 v242, 128, v240
  v_add_u32 v243, 95232, v242
  v_add_u32 v242, 63488, v242
  v_lshrrev_b32 v252, 3, v249
  v_lshlrev_b32 v251, 10, v252
  v_and_b32 v254, 7, v249
  v_xor_b32 v253, v250, v254
  v_lshl_add_u32 v238, v253, 4, v251
  v_xor_b32 v239, 64, v238
  v_add_u32 v239, 7168, v239
  v_lshlrev_b32 v252, 13, v252
  v_and_b32 v251, 1, v250
  v_lshlrev_b32 v251, 1, v251
  v_xor_b32 v253, v251, v254
  v_lshl_add_u32 v244, v253, 4, v252
  v_xor_b32 v245, 64, v244
  v_add_u32 v246, 129024, v244
  v_add_u32 v247, 193536, v245
  v_add_u32 v245, 64512, v245
  v_and_b32 v251, 1, v249
  v_lshrrev_b32 v252, 1, v249
  v_mul_u32_u24 v253, 1280, v251
  v_lshl_add_u32 v172, v252, 4, v253
  v_cmp_gt_u32 s[86:87], 32, v249
  v_mov_b32 v253, 0x10000000
  s_lshl_b32 s48, s3, 5
  s_add_u32 s48, s48, 139264
  v_cndmask_b32 v173, v253, v172, s[86:87]
  v_lshlrev_b32 v251, 4, v251
  v_lshl_add_u32 v251, v252, 7, v251
  v_add_u32 v174, s48, v251
  s_mul_i32 s54, s47, 1
  s_add_u32 s54, s54, s45
  s_and_b32 s54, s54, 7
  s_lshr_b32 s55, s3, 1
  s_add_u32 s55, s55, s54
  v_lshrrev_b32 v251, 3, v249
  v_lshlrev_b32 v251, 8, v251
  v_lshl_add_u32 v251, v254, 4, v251
  s_mul_i32 s48, s3, 6144
  v_add_u32 v188, s48, v251
  s_mul_i32 s48, s3, 3072
  s_add_u32 s48, s48, 139264
  v_add_u32 v189, s48, v248
  v_bfe_u32 v251, v249, 2, 2
  v_and_b32 v252, 3, v249
  v_lshlrev_b32 v252, 3, v252
  v_lshl_add_u32 v253, v250, 3, v251
  v_and_b32 v254, 1, v250
  v_lshl_add_u32 v232, v254, 2, v251
  v_lshl_add_u32 v233, v253, 8, v252
  v_xor_b32 v224, 0, v232
  v_lshl_add_u32 v224, v224, 5, v233
  v_xor_b32 v225, 1, v232
  v_lshl_add_u32 v225, v225, 5, v233
  v_xor_b32 v226, 2, v232
  v_lshl_add_u32 v226, v226, 5, v233
  v_xor_b32 v227, 3, v232
  v_lshl_add_u32 v227, v227, 5, v233
  v_xor_b32 v228, 4, v232
  v_lshl_add_u32 v228, v228, 5, v233
  v_xor_b32 v229, 5, v232
  v_lshl_add_u32 v229, v229, 5, v233
  v_xor_b32 v230, 6, v232
  v_lshl_add_u32 v230, v230, 5, v233
  v_xor_b32 v231, 7, v232
  v_lshl_add_u32 v231, v231, 5, v233
  v_lshrrev_b32 v251, 1, v251
  v_lshl_add_u32 v251, v254, 1, v251
  v_lshl_add_u32 v252, v253, 7, v252
  v_add_u32 v252, 16384, v252
  v_xor_b32 v232, 0, v251
  v_lshl_add_u32 v232, v232, 5, v252
  v_xor_b32 v233, 1, v251
  v_lshl_add_u32 v233, v233, 5, v252
  v_xor_b32 v234, 2, v251
  v_lshl_add_u32 v234, v234, 5, v252
  v_xor_b32 v235, 3, v251
  v_lshl_add_u32 v235, v235, 5, v252
  v_and_b32 v251, 15, v249
  v_lshrrev_b32 v252, 1, v251
  v_xor_b32 v252, v252, v250
  v_lshlrev_b32 v252, 4, v252
  v_lshl_add_u32 v252, v251, 7, v252
  v_add_u32 v236, s60, v252
  v_xor_b32 v237, 64, v236
  s_waitcnt lgkmcnt(0)
  s_lshl_b32 s48, s2, 3
  s_lshl_b32 s49, s3, 1
  s_add_u32 s48, s48, s49
  s_mul_i32 s49, s48, 1280
  s_add_u32 s24, s80, s49
  s_addc_u32 s25, s81, 0
  s_mov_b32 s26, 2560
  s_mov_b32 s27, 0x20000
  buffer_load_dwordx4 v[136:139], v172, s[24:27], 0 offen offset:0
  buffer_load_dwordx4 v[140:143], v172, s[24:27], 0 offen offset:512
  buffer_load_dwordx4 v[144:147], v173, s[24:27], 0 offen offset:1024
  s_lshl_b32 s48, s45, 18
  s_lshl_b32 s49, s3, 16
  s_add_u32 s48, s48, s49
  s_add_u32 s4, s76, s48
  s_addc_u32 s5, s77, 0
  s_mov_b32 s6, 65536
  s_mov_b32 s7, 0x20000
  s_lshl_b32 s48, s44, 8
  s_sub_u32 s49, 4194304, s48
  s_add_u32 s8, s78, s48
  s_addc_u32 s9, s79, 0
  s_mov_b32 s10, s49
  s_mov_b32 s11, 0x20000
  s_add_u32 s12, s82, s48
  s_addc_u32 s13, s83, 0
  s_mov_b32 s14, s49
  s_mov_b32 s15, 0x20000
  s_add_u32 m0, s50, 0
  s_add_u32 s51, s54, 0
  s_and_b32 s51, s51, 7
  s_lshl_b32 s51, s51, 19
  buffer_load_dwordx4 v240, s[8:11], s51 offen offset:0 lds
  buffer_load_dwordx4 v241, s[8:11], s51 offen offset:1024 lds
  buffer_load_dwordx4 v242, s[8:11], s51 offen offset:2048 lds
  buffer_load_dwordx4 v243, s[8:11], s51 offen offset:3072 lds
  s_add_u32 m0, s61, 49152
  s_add_u32 s51, s51, s62
  buffer_load_dwordx4 v244, s[12:15], s51 offen offset:0 lds
  buffer_load_dwordx4 v245, s[12:15], s51 offen offset:1024 lds
  s_add_u32 s52, s54, 0
  s_and_b32 s52, s52, 7
  s_lshl_b32 s52, s52, 7
  s_add_u32 s68, s84, 100663296
  s_addc_u32 s69, s85, 0
  s_mov_b32 s70, 20480
  s_mov_b32 s71, 0x20000
  s_lshr_b32 s49, s2, 1
  s_mul_i32 s49, s49, 20480
  s_and_b32 s48, s2, 1
  s_lshl_b32 s48, s48, 7
  s_add_u32 s49, s49, s48
  s_add_u32 s76, s84, s49
  s_addc_u32 s77, s85, 0
  s_mov_b32 s78, 20352
  s_mov_b32 s79, 0x20000
  s_lshl_b32 s48, s44, 20
  s_lshl_b32 s49, s45, 16
  s_add_u32 s48, s48, s49
  s_lshl_b32 s49, s3, 14
  s_add_u32 s48, s48, s49
  s_add_u32 s16, s84, s48
  s_addc_u32 s17, s85, 0
  s_add_u32 s16, s16, 3145728
  s_addc_u32 s17, s17, 0
  s_mov_b32 s18, 16384
  s_mov_b32 s19, 0x20000
  s_add_u32 s20, s84, s48
  s_addc_u32 s21, s85, 0
  s_add_u32 s20, s20, 3670016
  s_addc_u32 s21, s21, 0
  s_mov_b32 s22, 16384
  s_mov_b32 s23, 0x20000
  s_mov_b32 s74, 256
  s_mov_b32 s75, 0x20000
  s_lshl_b32 s48, s44, 8
  s_sub_u32 s56, 5242880, s48
  s_add_u32 s24, s32, s48
  s_addc_u32 s25, s33, 0
  s_mov_b32 s26, s56
  s_mov_b32 s27, 0x20000
  s_lshl_b32 s48, s44, 7
  s_sub_u32 s56, 2213888, s48
  s_cmp_lt_u32 s44, 27
  s_cselect_b32 s56, s56, 0
  s_sub_u32 s34, s34, 2048
  s_subb_u32 s35, s35, 0
  s_add_u32 s28, s34, s48
  s_addc_u32 s29, s35, 0
  s_mov_b32 s30, s56
  s_mov_b32 s31, 0x20000
  s_add_u32 m0, s60, 0
  s_nop 0
  buffer_load_dwordx4 v238, s[4:7], s52 offen offset:0 lds
  buffer_load_dwordx4 v239, s[4:7], s52 offen offset:1024 lds
  s_add_u32 s52, s52, 16384
  s_add_u32 m0, s60, 2048
  s_nop 0
  buffer_load_dwordx4 v238, s[4:7], s52 offen offset:0 lds
  buffer_load_dwordx4 v239, s[4:7], s52 offen offset:1024 lds
  s_add_u32 s52, s52, 16384
  s_add_u32 m0, s60, 4096
  s_nop 0
  buffer_load_dwordx4 v238, s[4:7], s52 offen offset:0 lds
  buffer_load_dwordx4 v239, s[4:7], s52 offen offset:1024 lds
  s_add_u32 s52, s52, 16384
  s_add_u32 m0, s60, 6144
  s_nop 0
  buffer_load_dwordx4 v238, s[4:7], s52 offen offset:0 lds
  buffer_load_dwordx4 v239, s[4:7], s52 offen offset:1024 lds
  s_waitcnt vmcnt(14)
  v_lshlrev_b32 v148, 16, v136
  v_and_b32 v149, 0xffff0000, v136
  v_lshlrev_b32 v150, 16, v137
  v_and_b32 v151, 0xffff0000, v137
  v_lshlrev_b32 v152, 16, v138
  v_and_b32 v153, 0xffff0000, v138
  v_lshlrev_b32 v154, 16, v139
  v_and_b32 v155, 0xffff0000, v139
  v_lshlrev_b32 v156, 16, v140
  v_and_b32 v157, 0xffff0000, v140
  v_lshlrev_b32 v158, 16, v141
  v_and_b32 v159, 0xffff0000, v141
  v_lshlrev_b32 v160, 16, v142
  v_and_b32 v161, 0xffff0000, v142
  v_lshlrev_b32 v162, 16, v143
  v_and_b32 v163, 0xffff0000, v143
  v_lshlrev_b32 v164, 16, v144
  v_and_b32 v165, 0xffff0000, v144
  v_lshlrev_b32 v166, 16, v145
  v_and_b32 v167, 0xffff0000, v145
  v_lshlrev_b32 v168, 16, v146
  v_and_b32 v169, 0xffff0000, v146
  v_lshlrev_b32 v170, 16, v147
  v_and_b32 v171, 0xffff0000, v147
  v_pk_add_f32 v[136:137], v[148:149], v[150:151]
  v_pk_add_f32 v[138:139], v[152:153], v[154:155]
  v_pk_add_f32 v[136:137], v[136:137], v[156:157]
  v_pk_add_f32 v[138:139], v[138:139], v[158:159]
  v_pk_add_f32 v[136:137], v[136:137], v[160:161]
  v_pk_add_f32 v[138:139], v[138:139], v[162:163]
  v_pk_add_f32 v[136:137], v[136:137], v[164:165]
  v_pk_add_f32 v[138:139], v[138:139], v[166:167]
  v_pk_add_f32 v[136:137], v[136:137], v[168:169]
  v_pk_add_f32 v[138:139], v[138:139], v[170:171]
  v_pk_add_f32 v[136:137], v[136:137], v[138:139]
  v_add_f32 v134, v136, v137
  s_nop 1
  v_add_f32_dpp v134, v134, v134 row_ror:2 row_mask:0xf bank_mask:0xf
  s_nop 1
  v_add_f32_dpp v134, v134, v134 row_ror:4 row_mask:0xf bank_mask:0xf
  s_nop 1
  v_add_f32_dpp v134, v134, v134 row_ror:8 row_mask:0xf bank_mask:0xf
  v_mov_b32 v135, v134
  s_nop 1
  v_permlane16_swap_b32 v135, v134
  v_add_f32 v134, v134, v135
  v_mov_b32 v135, v134
  s_nop 1
  v_permlane32_swap_b32 v135, v134
  v_add_f32 v134, v134, v135
  v_mul_f32 v136, 0xbacccccd, v134
  v_cndmask_b32 v137, 0, v136, s[86:87]
  v_pk_add_f32 v[148:149], v[148:149], v[136:137] op_sel_hi:[1,0]
  v_pk_add_f32 v[150:151], v[150:151], v[136:137] op_sel_hi:[1,0]
  v_pk_add_f32 v[152:153], v[152:153], v[136:137] op_sel_hi:[1,0]
  v_pk_add_f32 v[154:155], v[154:155], v[136:137] op_sel_hi:[1,0]
  v_pk_add_f32 v[156:157], v[156:157], v[136:137] op_sel_hi:[1,0]
  v_pk_add_f32 v[158:159], v[158:159], v[136:137] op_sel_hi:[1,0]
  v_pk_add_f32 v[160:161], v[160:161], v[136:137] op_sel_hi:[1,0]
  v_pk_add_f32 v[162:163], v[162:163], v[136:137] op_sel_hi:[1,0]
  v_pk_add_f32 v[164:165], v[164:165], v[136:137] op_sel:[0,1] op_sel_hi:[1,1]
  v_pk_add_f32 v[166:167], v[166:167], v[136:137] op_sel:[0,1] op_sel_hi:[1,1]
  v_pk_add_f32 v[168:169], v[168:169], v[136:137] op_sel:[0,1] op_sel_hi:[1,1]
  v_pk_add_f32 v[170:171], v[170:171], v[136:137] op_sel:[0,1] op_sel_hi:[1,1]
  v_pk_mul_f32 v[138:139], v[148:149], v[148:149]
  v_pk_mul_f32 v[140:141], v[150:151], v[150:151]
  v_pk_fma_f32 v[138:139], v[152:153], v[152:153], v[138:139]
  v_pk_fma_f32 v[140:141], v[154:155], v[154:155], v[140:141]
  v_pk_fma_f32 v[138:139], v[156:157], v[156:157], v[138:139]
  v_pk_fma_f32 v[140:141], v[158:159], v[158:159], v[140:141]
  v_pk_fma_f32 v[138:139], v[160:161], v[160:161], v[138:139]
  v_pk_fma_f32 v[140:141], v[162:163], v[162:163], v[140:141]
  v_pk_fma_f32 v[138:139], v[164:165], v[164:165], v[138:139]
  v_pk_fma_f32 v[140:141], v[166:167], v[166:167], v[140:141]
  v_pk_fma_f32 v[138:139], v[168:169], v[168:169], v[138:139]
  v_pk_fma_f32 v[140:141], v[170:171], v[170:171], v[140:141]
  v_pk_add_f32 v[138:139], v[138:139], v[140:141]
  v_add_f32 v134, v138, v139
  s_nop 1
  v_add_f32_dpp v134, v134, v134 row_ror:2 row_mask:0xf bank_mask:0xf
  s_nop 1
  v_add_f32_dpp v134, v134, v134 row_ror:4 row_mask:0xf bank_mask:0xf
  s_nop 1
  v_add_f32_dpp v134, v134, v134 row_ror:8 row_mask:0xf bank_mask:0xf
  v_mov_b32 v135, v134
  s_nop 1
  v_permlane16_swap_b32 v135, v134
  v_add_f32 v134, v134, v135
  v_mov_b32 v135, v134
  s_nop 1
  v_permlane32_swap_b32 v135, v134
  v_add_f32 v134, v134, v135
  v_mov_b32 v135, 0x3727c5ac
  v_fmac_f32 v135, 0x3acccccd, v134
  v_rsq_f32 v135, v135
  s_nop 0
  v_mul_f32 v136, 0x3e0293ee, v135
  v_pk_mul_f32 v[148:149], v[148:149], v[136:137] op_sel_hi:[1,0]
  v_pk_mul_f32 v[150:151], v[150:151], v[136:137] op_sel_hi:[1,0]
  v_pk_mul_f32 v[152:153], v[152:153], v[136:137] op_sel_hi:[1,0]
  v_pk_mul_f32 v[154:155], v[154:155], v[136:137] op_sel_hi:[1,0]
  v_pk_mul_f32 v[156:157], v[156:157], v[136:137] op_sel_hi:[1,0]
  v_pk_mul_f32 v[158:159], v[158:159], v[136:137] op_sel_hi:[1,0]
  v_pk_mul_f32 v[160:161], v[160:161], v[136:137] op_sel_hi:[1,0]
  v_pk_mul_f32 v[162:163], v[162:163], v[136:137] op_sel_hi:[1,0]
  v_pk_mul_f32 v[164:165], v[164:165], v[136:137] op_sel_hi:[1,0]
  v_pk_mul_f32 v[166:167], v[166:167], v[136:137] op_sel_hi:[1,0]
  v_pk_mul_f32 v[168:169], v[168:169], v[136:137] op_sel_hi:[1,0]
  v_pk_mul_f32 v[170:171], v[170:171], v[136:137] op_sel_hi:[1,0]
  v_cvt_pk_bf16_f32 v136, v148, v149
  v_cvt_pk_bf16_f32 v137, v150, v151
  v_cvt_pk_bf16_f32 v138, v152, v153
  v_cvt_pk_bf16_f32 v139, v154, v155
  v_cvt_pk_bf16_f32 v140, v156, v157
  v_cvt_pk_bf16_f32 v141, v158, v159
  v_cvt_pk_bf16_f32 v142, v160, v161
  v_cvt_pk_bf16_f32 v143, v162, v163
  v_cvt_pk_bf16_f32 v144, v164, v165
  v_cvt_pk_bf16_f32 v145, v166, v167
  v_cvt_pk_bf16_f32 v146, v168, v169
  v_cvt_pk_bf16_f32 v147, v170, v171
  ds_write_b128 v174, v[136:139] offset:0
  ds_write_b128 v174, v[140:143] offset:4096
  ds_write_b128 v174, v[144:147] offset:8192
  s_add_u32 m0, s50, 16384
  s_add_u32 s51, s54, 1
  s_and_b32 s51, s51, 7
  s_lshl_b32 s51, s51, 19
  buffer_load_dwordx4 v240, s[8:11], s51 offen offset:0 lds
  buffer_load_dwordx4 v241, s[8:11], s51 offen offset:1024 lds
  buffer_load_dwordx4 v242, s[8:11], s51 offen offset:2048 lds
  buffer_load_dwordx4 v243, s[8:11], s51 offen offset:3072 lds
  s_add_u32 m0, s61, 57344
  s_add_u32 s51, s51, s62
  buffer_load_dwordx4 v244, s[12:15], s51 offen offset:0 lds
  buffer_load_dwordx4 v245, s[12:15], s51 offen offset:1024 lds
  s_add_u32 s52, s54, 1
  s_and_b32 s52, s52, 7
  s_lshl_b32 s52, s52, 7
  s_add_u32 m0, s60, 32768
  s_nop 0
  buffer_load_dwordx4 v238, s[4:7], s52 offen offset:0 lds
  buffer_load_dwordx4 v239, s[4:7], s52 offen offset:1024 lds
  s_add_u32 s52, s52, 16384
  s_add_u32 m0, s60, 34816
  s_nop 0
  buffer_load_dwordx4 v238, s[4:7], s52 offen offset:0 lds
  buffer_load_dwordx4 v239, s[4:7], s52 offen offset:1024 lds
  s_add_u32 s52, s52, 16384
  s_add_u32 m0, s60, 36864
  s_nop 0
  buffer_load_dwordx4 v238, s[4:7], s52 offen offset:0 lds
  buffer_load_dwordx4 v239, s[4:7], s52 offen offset:1024 lds
  s_add_u32 s52, s52, 16384
  s_add_u32 m0, s60, 38912
  s_nop 0
  buffer_load_dwordx4 v238, s[4:7], s52 offen offset:0 lds
  buffer_load_dwordx4 v239, s[4:7], s52 offen offset:1024 lds
  s_waitcnt vmcnt(14)
  s_waitcnt lgkmcnt(0)
  s_barrier
  ds_read_b64_tr_b16 v[192:193], v224 offset:0
  ds_read_b64_tr_b16 v[194:195], v224 offset:1024
  ds_read_b64_tr_b16 v[196:197], v224 offset:8192
  ds_read_b64_tr_b16 v[198:199], v224 offset:9216
  ds_read_b128 a[0:3], v236 offset:0
  ds_read_b128 a[4:7], v236 offset:2048
  ds_read_b128 a[8:11], v236 offset:4096
  ds_read_b128 a[12:15], v236 offset:6144
  ds_read_b128 a[16:19], v237 offset:0
  ds_read_b128 a[20:23], v237 offset:2048
  ds_read_b128 a[24:27], v237 offset:4096
  ds_read_b128 a[28:31], v237 offset:6144
  s_waitcnt lgkmcnt(0)
  v_mfma_f32_16x16x32_bf16 v[0:3], v[192:195], a[0:3], 0
  s_add_u32 m0, s50, 32768
  ds_read_b64_tr_b16 v[200:201], v225 offset:0
  s_add_u32 s51, s54, 2
  v_mfma_f32_16x16x32_bf16 v[0:3], v[196:199], a[16:19], v[0:3]
  s_and_b32 s51, s51, 7
  ds_read_b64_tr_b16 v[202:203], v225 offset:1024
  s_lshl_b32 s51, s51, 19
  v_mfma_f32_16x16x32_bf16 v[32:35], v[196:199], a[20:23], 0
  ds_read_b64_tr_b16 v[204:205], v225 offset:8192
  v_mfma_f32_16x16x32_bf16 v[32:35], v[192:195], a[4:7], v[32:35]
  ds_read_b64_tr_b16 v[206:207], v225 offset:9216
  v_mfma_f32_16x16x32_bf16 v[64:67], v[192:195], a[8:11], 0
  ds_read_b64_tr_b16 v[208:209], v226 offset:0
  v_mfma_f32_16x16x32_bf16 v[64:67], v[196:199], a[24:27], v[64:67]
  ds_read_b64_tr_b16 v[210:211], v226 offset:1024
  v_mfma_f32_16x16x32_bf16 v[96:99], v[196:199], a[28:31], 0
  ds_read_b64_tr_b16 v[212:213], v226 offset:8192
  v_mfma_f32_16x16x32_bf16 v[96:99], v[192:195], a[12:15], v[96:99]
  s_waitcnt lgkmcnt(3)
  ds_read_b64_tr_b16 v[214:215], v226 offset:9216
  v_mfma_f32_16x16x32_bf16 v[4:7], v[200:203], a[0:3], 0
  buffer_load_dwordx4 v240, s[8:11], s51 offen offset:0 lds
  v_mfma_f32_16x16x32_bf16 v[4:7], v[204:207], a[16:19], v[4:7]
  ds_read_b128 v[176:179], v189 offset:0
  v_mfma_f32_16x16x32_bf16 v[36:39], v[204:207], a[20:23], 0
  buffer_load_dwordx4 v241, s[8:11], s51 offen offset:1024 lds
  v_mfma_f32_16x16x32_bf16 v[36:39], v[200:203], a[4:7], v[36:39]
  buffer_load_dwordx4 v242, s[8:11], s51 offen offset:2048 lds
  v_mfma_f32_16x16x32_bf16 v[68:71], v[200:203], a[8:11], 0
  ds_read_b64_tr_b16 v[216:217], v227 offset:0
  v_mfma_f32_16x16x32_bf16 v[68:71], v[204:207], a[24:27], v[68:71]
  ds_read_b64_tr_b16 v[218:219], v227 offset:1024
  v_mfma_f32_16x16x32_bf16 v[100:103], v[204:207], a[28:31], 0
  ds_read_b128 v[180:183], v189 offset:1024
  v_mfma_f32_16x16x32_bf16 v[100:103], v[200:203], a[12:15], v[100:103]
  s_waitcnt lgkmcnt(4)
  buffer_load_dwordx4 v243, s[8:11], s51 offen offset:3072 lds
  s_add_u32 m0, s61, 65536
  v_mfma_f32_16x16x32_bf16 v[8:11], v[208:211], a[0:3], 0
  s_add_u32 s51, s51, s62
  ds_read_b64_tr_b16 v[220:221], v227 offset:8192
  v_mfma_f32_16x16x32_bf16 v[8:11], v[212:215], a[16:19], v[8:11]
  ds_read_b64_tr_b16 v[222:223], v227 offset:9216
  v_mfma_f32_16x16x32_bf16 v[40:43], v[212:215], a[20:23], 0
  ds_read_b128 v[184:187], v189 offset:2048
  v_mfma_f32_16x16x32_bf16 v[40:43], v[208:211], a[4:7], v[40:43]
  buffer_load_dwordx4 v244, s[12:15], s51 offen offset:0 lds
  v_mfma_f32_16x16x32_bf16 v[72:75], v[208:211], a[8:11], 0
  buffer_load_dwordx4 v245, s[12:15], s51 offen offset:1024 lds
  s_add_u32 s52, s54, 2
  v_mfma_f32_16x16x32_bf16 v[72:75], v[212:215], a[24:27], v[72:75]
  s_and_b32 s52, s52, 7
  ds_read_b64_tr_b16 v[192:193], v228 offset:0
  s_lshl_b32 s52, s52, 7
  s_add_u32 m0, s60, 0
  v_mfma_f32_16x16x32_bf16 v[104:107], v[212:215], a[28:31], 0
  ds_read_b64_tr_b16 v[194:195], v228 offset:1024
  v_mfma_f32_16x16x32_bf16 v[104:107], v[208:211], a[12:15], v[104:107]
  s_waitcnt lgkmcnt(3)
  ds_read_b64_tr_b16 v[196:197], v228 offset:8192
  v_mfma_f32_16x16x32_bf16 v[12:15], v[216:219], a[0:3], 0
  ds_read_b64_tr_b16 v[198:199], v228 offset:9216
  v_mfma_f32_16x16x32_bf16 v[12:15], v[220:223], a[16:19], v[12:15]
  buffer_load_dwordx4 v238, s[4:7], s52 offen offset:0 lds
  v_mfma_f32_16x16x32_bf16 v[44:47], v[220:223], a[20:23], 0
  buffer_load_dwordx4 v239, s[4:7], s52 offen offset:1024 lds
  s_add_u32 s52, s52, 16384
  v_mfma_f32_16x16x32_bf16 v[44:47], v[216:219], a[4:7], v[44:47]
  s_add_u32 m0, s60, 2048
  ds_read_b64_tr_b16 v[200:201], v229 offset:0
  v_mfma_f32_16x16x32_bf16 v[76:79], v[216:219], a[8:11], 0
  ds_read_b64_tr_b16 v[202:203], v229 offset:1024
  v_mfma_f32_16x16x32_bf16 v[76:79], v[220:223], a[24:27], v[76:79]
  buffer_load_dwordx4 v238, s[4:7], s52 offen offset:0 lds
  v_mfma_f32_16x16x32_bf16 v[108:111], v[220:223], a[28:31], 0
  ds_read_b64_tr_b16 v[204:205], v229 offset:8192
  v_mfma_f32_16x16x32_bf16 v[108:111], v[216:219], a[12:15], v[108:111]
  s_waitcnt lgkmcnt(3)
  ds_read_b64_tr_b16 v[206:207], v229 offset:9216
  v_mfma_f32_16x16x32_bf16 v[16:19], v[192:195], a[0:3], 0
  buffer_load_dwordx4 v239, s[4:7], s52 offen offset:1024 lds
  s_add_u32 s52, s52, 16384
  v_mfma_f32_16x16x32_bf16 v[16:19], v[196:199], a[16:19], v[16:19]
  s_add_u32 m0, s60, 4096
  ds_read_b64_tr_b16 v[208:209], v230 offset:0
  v_mfma_f32_16x16x32_bf16 v[48:51], v[196:199], a[20:23], 0
  buffer_load_dwordx4 v238, s[4:7], s52 offen offset:0 lds
  v_mfma_f32_16x16x32_bf16 v[48:51], v[192:195], a[4:7], v[48:51]
  ds_read_b64_tr_b16 v[210:211], v230 offset:1024
  v_mfma_f32_16x16x32_bf16 v[80:83], v[192:195], a[8:11], 0
  buffer_load_dwordx4 v239, s[4:7], s52 offen offset:1024 lds
  s_add_u32 s52, s52, 16384
  v_mfma_f32_16x16x32_bf16 v[80:83], v[196:199], a[24:27], v[80:83]
  s_add_u32 m0, s60, 6144
  ds_read_b64_tr_b16 v[212:213], v230 offset:8192
  v_mfma_f32_16x16x32_bf16 v[112:115], v[196:199], a[28:31], 0
  ds_read_b64_tr_b16 v[214:215], v230 offset:9216
  v_mfma_f32_16x16x32_bf16 v[112:115], v[192:195], a[12:15], v[112:115]
  s_waitcnt lgkmcnt(4)
  buffer_load_dwordx4 v238, s[4:7], s52 offen offset:0 lds
  v_mfma_f32_16x16x32_bf16 v[20:23], v[200:203], a[0:3], 0
  buffer_load_dwordx4 v239, s[4:7], s52 offen offset:1024 lds
  v_mfma_f32_16x16x32_bf16 v[20:23], v[204:207], a[16:19], v[20:23]
  ds_read_b64_tr_b16 v[216:217], v231 offset:0
  v_mov_b32 v253, 0
  v_mfma_f32_16x16x32_bf16 v[52:55], v[204:207], a[20:23], 0
  ds_read_b64_tr_b16 v[218:219], v231 offset:1024
  v_lshlrev_b32 v252, 22, v249
  v_mfma_f32_16x16x32_bf16 v[52:55], v[200:203], a[4:7], v[52:55]
  s_lshl_b32 s53, s44, 5
  ds_read_b64_tr_b16 v[220:221], v231 offset:8192
  s_add_u32 s53, s53, s45
  v_mfma_f32_16x16x32_bf16 v[84:87], v[200:203], a[8:11], 0
  s_lshl_b32 s53, s53, 2
  ds_read_b64_tr_b16 v[222:223], v231 offset:9216
  v_mfma_f32_16x16x32_bf16 v[84:87], v[204:207], a[24:27], v[84:87]
  buffer_store_dword v253, v255, s[68:71], s53 offen sc1
  v_mfma_f32_16x16x32_bf16 v[116:119], v[204:207], a[28:31], 0
  s_lshl_b32 s53, s45, 5
  s_add_u32 s53, s53, s44
  s_lshl_b32 s53, s53, 2
  v_mfma_f32_16x16x32_bf16 v[116:119], v[200:203], a[12:15], v[116:119]
  s_waitcnt lgkmcnt(4)
  ds_read_b64_tr_b16 v[192:193], v232 offset:32768
  s_add_u32 s53, s53, 0x1000
  v_mfma_f32_16x16x32_bf16 v[24:27], v[208:211], a[0:3], 0
  ds_read_b64_tr_b16 v[194:195], v232 offset:33280
  v_mfma_f32_16x16x32_bf16 v[24:27], v[212:215], a[16:19], v[24:27]
  buffer_store_dword v253, v255, s[68:71], s53 offen sc1
  v_mfma_f32_16x16x32_bf16 v[56:59], v[212:215], a[20:23], 0
  s_lshl_b32 s53, s47, 3
  ds_read_b64_tr_b16 v[196:197], v232 offset:36864
  s_add_u32 s53, s53, s45
  v_mfma_f32_16x16x32_bf16 v[56:59], v[208:211], a[4:7], v[56:59]
  s_lshl_b32 s53, s53, 5
  ds_read_b64_tr_b16 v[198:199], v232 offset:37376
  s_add_u32 s53, s53, s46
  v_mfma_f32_16x16x32_bf16 v[88:91], v[208:211], a[8:11], 0
  s_lshl_b32 s53, s53, 2
  s_waitcnt vmcnt(16)
  ds_read_b128 a[32:35], v236 offset:32768
  v_mfma_f32_16x16x32_bf16 v[88:91], v[212:215], a[24:27], v[88:91]
  s_add_u32 s53, s53, 8192
  v_mfma_f32_16x16x32_bf16 v[120:123], v[212:215], a[28:31], 0
  buffer_store_dword v253, v255, s[68:71], s53 offen sc1
  v_mfma_f32_16x16x32_bf16 v[120:123], v[208:211], a[12:15], v[120:123]
  s_waitcnt lgkmcnt(5)
  ds_read_b64_tr_b16 v[200:201], v233 offset:32768
  s_lshl_b32 s53, s47, 3
  v_mfma_f32_16x16x32_bf16 v[28:31], v[216:219], a[0:3], 0
  s_add_u32 s53, s53, s45
  ds_read_b64_tr_b16 v[202:203], v233 offset:33280
  s_lshl_b32 s53, s53, 5
  v_mfma_f32_16x16x32_bf16 v[28:31], v[220:223], a[16:19], v[28:31]
  s_lshl_b32 s49, s46, 2
  ds_read_b64_tr_b16 v[204:205], v233 offset:36864
  s_add_u32 s53, s53, s49
  v_mfma_f32_16x16x32_bf16 v[60:63], v[220:223], a[20:23], 0
  s_add_u32 s53, s53, s3
  ds_read_b64_tr_b16 v[206:207], v233 offset:37376
  s_lshl_b32 s53, s53, 2
  v_mfma_f32_16x16x32_bf16 v[60:63], v[216:219], a[4:7], v[60:63]
  s_add_u32 s53, s53, 8256
  ds_read_b128 a[36:39], v236 offset:34816
  v_mfma_f32_16x16x32_bf16 v[92:95], v[216:219], a[8:11], 0
  ds_read_b128 a[40:43], v236 offset:36864
  v_mfma_f32_16x16x32_bf16 v[92:95], v[220:223], a[24:27], v[92:95]
  buffer_store_dwordx4 v[176:179], v188, s[76:79], 0 offen offset:0 sc1
  v_mfma_f32_16x16x32_bf16 v[124:127], v[220:223], a[28:31], 0
  ds_read_b64_tr_b16 v[208:209], v234 offset:32768
  v_mfma_f32_16x16x32_bf16 v[124:127], v[216:219], a[12:15], v[124:127]
  s_waitcnt lgkmcnt(8)
  ds_read_b64_tr_b16 v[210:211], v234 offset:33280
  v_mfma_f32_16x16x32_bf16 v[128:131], a[0:3], v[192:195], 0
  buffer_store_dword v253, v252, s[68:71], s53 offen sc1
  v_mfma_f32_16x16x32_bf16 v[128:131], a[16:19], v[196:199], v[128:131]
  s_lshl_b32 s53, s45, 2
  ds_read_b64_tr_b16 v[212:213], v234 offset:36864
  s_add_u32 s53, s53, s46
  v_mfma_f32_16x16x32_bf16 v[132:135], a[20:23], v[196:199], 0
  s_lshl_b32 s53, s53, 5
  ds_read_b64_tr_b16 v[214:215], v234 offset:37376
  s_add_u32 s53, s53, s47
  v_mfma_f32_16x16x32_bf16 v[132:135], a[4:7], v[192:195], v[132:135]
  s_lshl_b32 s53, s53, 2
  ds_read_b128 a[44:47], v236 offset:38912
  s_add_u32 s53, s53, 16384
  v_mfma_f32_16x16x32_bf16 v[136:139], a[8:11], v[192:195], 0
  buffer_store_dwordx4 v[180:183], v188, s[76:79], 0 offen offset:2048 sc1
  v_mfma_f32_16x16x32_bf16 v[136:139], a[24:27], v[196:199], v[136:139]
  ds_read_b128 a[48:51], v237 offset:32768
  v_mfma_f32_16x16x32_bf16 v[140:143], a[28:31], v[196:199], 0
  buffer_store_dword v253, v255, s[68:71], s53 offen sc1
  v_mfma_f32_16x16x32_bf16 v[140:143], a[12:15], v[192:195], v[140:143]
  s_waitcnt lgkmcnt(8)
  ds_read_b64_tr_b16 v[216:217], v235 offset:32768
  s_lshl_b32 s53, s45, 2
  v_mfma_f32_16x16x32_bf16 v[144:147], a[0:3], v[200:203], 0
  s_add_u32 s53, s53, s46
  ds_read_b64_tr_b16 v[218:219], v235 offset:33280
  s_lshl_b32 s53, s53, 5
  v_mfma_f32_16x16x32_bf16 v[144:147], a[16:19], v[204:207], v[144:147]
  s_add_u32 s53, s53, s47
  buffer_store_dwordx4 v[184:187], v188, s[76:79], s64 offen offset:0 sc1
  v_mfma_f32_16x16x32_bf16 v[148:151], a[20:23], v[204:207], 0
  s_lshl_b32 s53, s53, 2
  ds_read_b64_tr_b16 v[220:221], v235 offset:36864
  s_add_u32 s53, s53, 16384
  v_mfma_f32_16x16x32_bf16 v[148:151], a[4:7], v[200:203], v[148:151]
  s_add_u32 s53, s53, 64
  ds_read_b64_tr_b16 v[222:223], v235 offset:37376
  v_mfma_f32_16x16x32_bf16 v[152:155], a[8:11], v[200:203], 0
  ds_read_b128 a[52:55], v237 offset:34816
  v_mfma_f32_16x16x32_bf16 v[152:155], a[24:27], v[204:207], v[152:155]
  ds_read_b128 a[56:59], v237 offset:36864
  v_mfma_f32_16x16x32_bf16 v[156:159], a[28:31], v[204:207], 0
  buffer_store_dword v253, v255, s[68:71], s53 offen sc1
  v_mfma_f32_16x16x32_bf16 v[156:159], a[12:15], v[200:203], v[156:159]
  s_waitcnt lgkmcnt(8)
  v_mfma_f32_16x16x32_bf16 v[160:163], a[0:3], v[208:211], 0
  ds_read_b128 a[60:63], v237 offset:38912
  v_mfma_f32_16x16x32_bf16 v[160:163], a[16:19], v[212:215], v[160:163]
  v_mfma_f32_16x16x32_bf16 v[164:167], a[20:23], v[212:215], 0
  v_mfma_f32_16x16x32_bf16 v[164:167], a[4:7], v[208:211], v[164:167]
  s_waitcnt lgkmcnt(0)
  s_barrier
  v_mfma_f32_16x16x32_bf16 v[168:171], a[8:11], v[208:211], 0
  s_add_u32 m0, s50, 0
  ds_read_b64_tr_b16 v[192:193], v224 offset:16384
  s_add_u32 s51, s54, 3
  v_mfma_f32_16x16x32_bf16 v[168:171], a[24:27], v[212:215], v[168:171]
  s_and_b32 s51, s51, 7
  ds_read_b64_tr_b16 v[194:195], v224 offset:17408
  s_lshl_b32 s51, s51, 19
  v_mfma_f32_16x16x32_bf16 v[172:175], a[28:31], v[212:215], 0
  ds_read_b64_tr_b16 v[196:197], v224 offset:24576
  v_mfma_f32_16x16x32_bf16 v[172:175], a[12:15], v[208:211], v[172:175]
  ds_read_b64_tr_b16 v[198:199], v224 offset:25600
  v_mfma_f32_16x16x32_bf16 v[176:179], a[0:3], v[216:219], 0
  ds_read_b64_tr_b16 v[200:201], v225 offset:16384
  v_mfma_f32_16x16x32_bf16 v[176:179], a[16:19], v[220:223], v[176:179]
  ds_read_b64_tr_b16 v[202:203], v225 offset:17408
  v_mfma_f32_16x16x32_bf16 v[180:183], a[20:23], v[220:223], 0
  ds_read_b64_tr_b16 v[204:205], v225 offset:24576
  v_mfma_f32_16x16x32_bf16 v[180:183], a[4:7], v[216:219], v[180:183]
  ds_read_b64_tr_b16 v[206:207], v225 offset:25600
  v_mfma_f32_16x16x32_bf16 v[184:187], a[8:11], v[216:219], 0
  buffer_load_dwordx4 v240, s[8:11], s51 offen offset:0 lds
  v_mfma_f32_16x16x32_bf16 v[184:187], a[24:27], v[220:223], v[184:187]
  v_mfma_f32_16x16x32_bf16 v[188:191], a[28:31], v[220:223], 0
  buffer_load_dwordx4 v241, s[8:11], s51 offen offset:1024 lds
  v_mfma_f32_16x16x32_bf16 v[188:191], a[12:15], v[216:219], v[188:191]
  s_waitcnt lgkmcnt(4)
  ds_read_b64_tr_b16 v[208:209], v226 offset:16384
  v_mfma_f32_16x16x32_bf16 v[0:3], v[192:195], a[32:35], v[0:3]
  ds_read_b64_tr_b16 v[210:211], v226 offset:17408
  v_mfma_f32_16x16x32_bf16 v[0:3], v[196:199], a[48:51], v[0:3]
  ds_read_b64_tr_b16 v[212:213], v226 offset:24576
  v_mfma_f32_16x16x32_bf16 v[32:35], v[196:199], a[52:55], v[32:35]
  ds_read_b64_tr_b16 v[214:215], v226 offset:25600
  v_mfma_f32_16x16x32_bf16 v[32:35], v[192:195], a[36:39], v[32:35]
recurrent_scan__compressed_kv_cla__dense_activation_silu__prompt_kernel_g0:
  buffer_load_dwordx4 v242, s[8:11], s51 offen offset:2048 lds
  v_mfma_f32_16x16x32_bf16 v[64:67], v[192:195], a[40:43], v[64:67]
  v_mfma_f32_16x16x32_bf16 v[64:67], v[196:199], a[56:59], v[64:67]
  v_mfma_f32_16x16x32_bf16 v[96:99], v[196:199], a[60:63], v[96:99]
  buffer_load_dwordx4 v243, s[8:11], s51 offen offset:3072 lds
  v_mfma_f32_16x16x32_bf16 v[96:99], v[192:195], a[44:47], v[96:99]
  s_waitcnt lgkmcnt(4)
  ds_read_b64_tr_b16 v[216:217], v227 offset:16384
  s_add_u32 m0, s61, 49152
  v_mfma_f32_16x16x32_bf16 v[4:7], v[200:203], a[32:35], v[4:7]
  s_add_u32 s51, s51, s62
  ds_read_b64_tr_b16 v[218:219], v227 offset:17408
  v_mfma_f32_16x16x32_bf16 v[4:7], v[204:207], a[48:51], v[4:7]
  ds_read_b64_tr_b16 v[220:221], v227 offset:24576
  v_mfma_f32_16x16x32_bf16 v[36:39], v[204:207], a[52:55], v[36:39]
  ds_read_b64_tr_b16 v[222:223], v227 offset:25600
  v_mfma_f32_16x16x32_bf16 v[36:39], v[200:203], a[36:39], v[36:39]
  v_mfma_f32_16x16x32_bf16 v[68:71], v[200:203], a[40:43], v[68:71]
  v_mfma_f32_16x16x32_bf16 v[68:71], v[204:207], a[56:59], v[68:71]
  buffer_load_dwordx4 v244, s[12:15], s51 offen offset:0 lds
  v_mfma_f32_16x16x32_bf16 v[100:103], v[204:207], a[60:63], v[100:103]
  ds_read_b64_tr_b16 v[192:193], v228 offset:16384
  v_mfma_f32_16x16x32_bf16 v[100:103], v[200:203], a[44:47], v[100:103]
  s_waitcnt lgkmcnt(5)
  ds_read_b64_tr_b16 v[194:195], v228 offset:17408
  v_mfma_f32_16x16x32_bf16 v[8:11], v[208:211], a[32:35], v[8:11]
  ds_read_b64_tr_b16 v[196:197], v228 offset:24576
  v_mfma_f32_16x16x32_bf16 v[8:11], v[212:215], a[48:51], v[8:11]
  ds_read_b64_tr_b16 v[198:199], v228 offset:25600
  v_mfma_f32_16x16x32_bf16 v[40:43], v[212:215], a[52:55], v[40:43]
  buffer_load_dwordx4 v245, s[12:15], s51 offen offset:1024 lds
  v_mfma_f32_16x16x32_bf16 v[40:43], v[208:211], a[36:39], v[40:43]
  s_add_u32 s52, s54, 3
  s_and_b32 s52, s52, 7
  s_lshl_b32 s52, s52, 7
  v_mfma_f32_16x16x32_bf16 v[72:75], v[208:211], a[40:43], v[72:75]
  s_add_u32 m0, s60, 32768
  v_mfma_f32_16x16x32_bf16 v[72:75], v[212:215], a[56:59], v[72:75]
  v_mfma_f32_16x16x32_bf16 v[104:107], v[212:215], a[60:63], v[104:107]
  ds_read_b64_tr_b16 v[200:201], v229 offset:16384
  v_mfma_f32_16x16x32_bf16 v[104:107], v[208:211], a[44:47], v[104:107]
  s_waitcnt lgkmcnt(5)
  ds_read_b64_tr_b16 v[202:203], v229 offset:17408
  v_mfma_f32_16x16x32_bf16 v[12:15], v[216:219], a[32:35], v[12:15]
  ds_read_b64_tr_b16 v[204:205], v229 offset:24576
  v_mfma_f32_16x16x32_bf16 v[12:15], v[220:223], a[48:51], v[12:15]
  ds_read_b64_tr_b16 v[206:207], v229 offset:25600
  v_mfma_f32_16x16x32_bf16 v[44:47], v[220:223], a[52:55], v[44:47]
  v_mfma_f32_16x16x32_bf16 v[44:47], v[216:219], a[36:39], v[44:47]
  v_mfma_f32_16x16x32_bf16 v[76:79], v[216:219], a[40:43], v[76:79]
  buffer_load_dwordx4 v238, s[4:7], s52 offen offset:0 lds
  v_mfma_f32_16x16x32_bf16 v[76:79], v[220:223], a[56:59], v[76:79]
  v_mfma_f32_16x16x32_bf16 v[108:111], v[220:223], a[60:63], v[108:111]
  ds_read_b64_tr_b16 v[208:209], v230 offset:16384
  v_mfma_f32_16x16x32_bf16 v[108:111], v[216:219], a[44:47], v[108:111]
  s_waitcnt lgkmcnt(5)
  ds_read_b64_tr_b16 v[210:211], v230 offset:17408
  v_mfma_f32_16x16x32_bf16 v[16:19], v[192:195], a[32:35], v[16:19]
  buffer_load_dwordx4 v239, s[4:7], s52 offen offset:1024 lds
  v_mfma_f32_16x16x32_bf16 v[16:19], v[196:199], a[48:51], v[16:19]
  s_add_u32 s52, s52, 16384
  ds_read_b64_tr_b16 v[212:213], v230 offset:24576
  s_add_u32 m0, s60, 34816
  v_mfma_f32_16x16x32_bf16 v[48:51], v[196:199], a[52:55], v[48:51]
  ds_read_b64_tr_b16 v[214:215], v230 offset:25600
  v_mfma_f32_16x16x32_bf16 v[48:51], v[192:195], a[36:39], v[48:51]
  v_mfma_f32_16x16x32_bf16 v[80:83], v[192:195], a[40:43], v[80:83]
  v_mfma_f32_16x16x32_bf16 v[80:83], v[196:199], a[56:59], v[80:83]
  v_mfma_f32_16x16x32_bf16 v[112:115], v[196:199], a[60:63], v[112:115]
  buffer_load_dwordx4 v238, s[4:7], s52 offen offset:0 lds
  v_mfma_f32_16x16x32_bf16 v[112:115], v[192:195], a[44:47], v[112:115]
  s_waitcnt lgkmcnt(4)
  ds_read_b64_tr_b16 v[216:217], v231 offset:16384
  v_mfma_f32_16x16x32_bf16 v[20:23], v[200:203], a[32:35], v[20:23]
  ds_read_b64_tr_b16 v[218:219], v231 offset:17408
  v_mfma_f32_16x16x32_bf16 v[20:23], v[204:207], a[48:51], v[20:23]
  ds_read_b64_tr_b16 v[220:221], v231 offset:24576
  v_mfma_f32_16x16x32_bf16 v[52:55], v[204:207], a[52:55], v[52:55]
  ds_read_b64_tr_b16 v[222:223], v231 offset:25600
  v_mfma_f32_16x16x32_bf16 v[52:55], v[200:203], a[36:39], v[52:55]
  buffer_load_dwordx4 v239, s[4:7], s52 offen offset:1024 lds
  v_mfma_f32_16x16x32_bf16 v[84:87], v[200:203], a[40:43], v[84:87]
  s_add_u32 s52, s52, 16384
  s_add_u32 m0, s60, 36864
  v_mfma_f32_16x16x32_bf16 v[84:87], v[204:207], a[56:59], v[84:87]
  v_mfma_f32_16x16x32_bf16 v[116:119], v[204:207], a[60:63], v[116:119]
  ds_read_b64_tr_b16 v[192:193], v232 offset:40960
  v_mfma_f32_16x16x32_bf16 v[116:119], v[200:203], a[44:47], v[116:119]
  s_waitcnt lgkmcnt(5)
  ds_read_b64_tr_b16 v[194:195], v232 offset:41472
  v_mfma_f32_16x16x32_bf16 v[24:27], v[208:211], a[32:35], v[24:27]
  ds_read_b64_tr_b16 v[196:197], v232 offset:45056
  v_mfma_f32_16x16x32_bf16 v[24:27], v[212:215], a[48:51], v[24:27]
  ds_read_b64_tr_b16 v[198:199], v232 offset:45568
  v_mfma_f32_16x16x32_bf16 v[56:59], v[212:215], a[52:55], v[56:59]
  buffer_load_dwordx4 v238, s[4:7], s52 offen offset:0 lds
  v_mfma_f32_16x16x32_bf16 v[56:59], v[208:211], a[36:39], v[56:59]
  v_mfma_f32_16x16x32_bf16 v[88:91], v[208:211], a[40:43], v[88:91]
  s_waitcnt vmcnt(20)
  ds_read_b128 a[64:67], v236 offset:0
  v_mfma_f32_16x16x32_bf16 v[88:91], v[212:215], a[56:59], v[88:91]
  buffer_load_dwordx4 v239, s[4:7], s52 offen offset:1024 lds
  v_mfma_f32_16x16x32_bf16 v[120:123], v[212:215], a[60:63], v[120:123]
  s_add_u32 s52, s52, 16384
  ds_read_b64_tr_b16 v[200:201], v233 offset:40960
  s_add_u32 m0, s60, 38912
  v_mfma_f32_16x16x32_bf16 v[120:123], v[208:211], a[44:47], v[120:123]
  s_waitcnt lgkmcnt(6)
  ds_read_b64_tr_b16 v[202:203], v233 offset:41472
  v_mfma_f32_16x16x32_bf16 v[28:31], v[216:219], a[32:35], v[28:31]
  ds_read_b64_tr_b16 v[204:205], v233 offset:45056
  v_mfma_f32_16x16x32_bf16 v[28:31], v[220:223], a[48:51], v[28:31]
  ds_read_b64_tr_b16 v[206:207], v233 offset:45568
  v_mfma_f32_16x16x32_bf16 v[60:63], v[220:223], a[52:55], v[60:63]
  ds_read_b128 a[68:71], v236 offset:2048
  v_mfma_f32_16x16x32_bf16 v[60:63], v[216:219], a[36:39], v[60:63]
  v_mfma_f32_16x16x32_bf16 v[92:95], v[216:219], a[40:43], v[92:95]
  buffer_load_dwordx4 v238, s[4:7], s52 offen offset:0 lds
  v_mfma_f32_16x16x32_bf16 v[92:95], v[220:223], a[56:59], v[92:95]
  ds_read_b128 a[72:75], v236 offset:4096
  v_mfma_f32_16x16x32_bf16 v[124:127], v[220:223], a[60:63], v[124:127]
  ds_read_b64_tr_b16 v[208:209], v234 offset:40960
  v_mfma_f32_16x16x32_bf16 v[124:127], v[216:219], a[44:47], v[124:127]
  s_waitcnt lgkmcnt(8)
  ds_read_b64_tr_b16 v[210:211], v234 offset:41472
  v_mfma_f32_16x16x32_bf16 v[128:131], a[32:35], v[192:195], v[128:131]
  buffer_load_dwordx4 v239, s[4:7], s52 offen offset:1024 lds
  v_mfma_f32_16x16x32_bf16 v[128:131], a[48:51], v[196:199], v[128:131]
  ds_read_b64_tr_b16 v[212:213], v234 offset:45056
  v_mfma_f32_16x16x32_bf16 v[132:135], a[52:55], v[196:199], v[132:135]
  ds_read_b64_tr_b16 v[214:215], v234 offset:45568
  v_mfma_f32_16x16x32_bf16 v[132:135], a[36:39], v[192:195], v[132:135]
  ds_read_b128 a[76:79], v236 offset:6144
  v_mfma_f32_16x16x32_bf16 v[136:139], a[40:43], v[192:195], v[136:139]
  ds_read_b128 a[80:83], v237 offset:0
  v_mfma_f32_16x16x32_bf16 v[136:139], a[56:59], v[196:199], v[136:139]
  v_mfma_f32_16x16x32_bf16 v[140:143], a[60:63], v[196:199], v[140:143]
  ds_read_b64_tr_b16 v[216:217], v235 offset:40960
  v_mfma_f32_16x16x32_bf16 v[140:143], a[44:47], v[192:195], v[140:143]
  s_waitcnt lgkmcnt(9)
  ds_read_b64_tr_b16 v[218:219], v235 offset:41472
  v_mfma_f32_16x16x32_bf16 v[144:147], a[32:35], v[200:203], v[144:147]
  ds_read_b64_tr_b16 v[220:221], v235 offset:45056
  v_mfma_f32_16x16x32_bf16 v[144:147], a[48:51], v[204:207], v[144:147]
  ds_read_b64_tr_b16 v[222:223], v235 offset:45568
  v_mfma_f32_16x16x32_bf16 v[148:151], a[52:55], v[204:207], v[148:151]
  ds_read_b128 a[84:87], v237 offset:2048
  v_mfma_f32_16x16x32_bf16 v[148:151], a[36:39], v[200:203], v[148:151]
  v_mfma_f32_16x16x32_bf16 v[152:155], a[40:43], v[200:203], v[152:155]
  ds_read_b128 a[88:91], v237 offset:4096
  v_mfma_f32_16x16x32_bf16 v[152:155], a[56:59], v[204:207], v[152:155]
  v_mfma_f32_16x16x32_bf16 v[156:159], a[60:63], v[204:207], v[156:159]
  v_mfma_f32_16x16x32_bf16 v[156:159], a[44:47], v[200:203], v[156:159]
  s_waitcnt lgkmcnt(8)
  v_mfma_f32_16x16x32_bf16 v[160:163], a[32:35], v[208:211], v[160:163]
  ds_read_b128 a[92:95], v237 offset:6144
  v_mfma_f32_16x16x32_bf16 v[160:163], a[48:51], v[212:215], v[160:163]
  v_mfma_f32_16x16x32_bf16 v[164:167], a[52:55], v[212:215], v[164:167]
  v_mfma_f32_16x16x32_bf16 v[164:167], a[36:39], v[208:211], v[164:167]
  s_waitcnt lgkmcnt(0)
  s_barrier
  v_mfma_f32_16x16x32_bf16 v[168:171], a[40:43], v[208:211], v[168:171]
  s_add_u32 m0, s50, 16384
  ds_read_b64_tr_b16 v[192:193], v224 offset:32768
  s_add_u32 s51, s54, 4
  v_mfma_f32_16x16x32_bf16 v[168:171], a[56:59], v[212:215], v[168:171]
  s_and_b32 s51, s51, 7
  ds_read_b64_tr_b16 v[194:195], v224 offset:33792
  s_lshl_b32 s51, s51, 19
  v_mfma_f32_16x16x32_bf16 v[172:175], a[60:63], v[212:215], v[172:175]
  ds_read_b64_tr_b16 v[196:197], v224 offset:40960
  v_mfma_f32_16x16x32_bf16 v[172:175], a[44:47], v[208:211], v[172:175]
  ds_read_b64_tr_b16 v[198:199], v224 offset:41984
  v_mfma_f32_16x16x32_bf16 v[176:179], a[32:35], v[216:219], v[176:179]
  ds_read_b64_tr_b16 v[200:201], v225 offset:32768
  v_mfma_f32_16x16x32_bf16 v[176:179], a[48:51], v[220:223], v[176:179]
  ds_read_b64_tr_b16 v[202:203], v225 offset:33792
  v_mfma_f32_16x16x32_bf16 v[180:183], a[52:55], v[220:223], v[180:183]
  ds_read_b64_tr_b16 v[204:205], v225 offset:40960
  v_mfma_f32_16x16x32_bf16 v[180:183], a[36:39], v[216:219], v[180:183]
  ds_read_b64_tr_b16 v[206:207], v225 offset:41984
  v_mfma_f32_16x16x32_bf16 v[184:187], a[40:43], v[216:219], v[184:187]
  buffer_load_dwordx4 v240, s[8:11], s51 offen offset:0 lds
  v_mfma_f32_16x16x32_bf16 v[184:187], a[56:59], v[220:223], v[184:187]
  buffer_load_dwordx4 v241, s[8:11], s51 offen offset:1024 lds
  v_mfma_f32_16x16x32_bf16 v[188:191], a[60:63], v[220:223], v[188:191]
  ds_read_b64_tr_b16 v[208:209], v226 offset:32768
  v_mfma_f32_16x16x32_bf16 v[188:191], a[44:47], v[216:219], v[188:191]
  s_waitcnt lgkmcnt(5)
  ds_read_b64_tr_b16 v[210:211], v226 offset:33792
  v_mfma_f32_16x16x32_bf16 v[0:3], v[192:195], a[64:67], v[0:3]
  buffer_load_dwordx4 v242, s[8:11], s51 offen offset:2048 lds
  v_mfma_f32_16x16x32_bf16 v[0:3], v[196:199], a[80:83], v[0:3]
  ds_read_b64_tr_b16 v[212:213], v226 offset:40960
  v_mfma_f32_16x16x32_bf16 v[32:35], v[196:199], a[84:87], v[32:35]
  ds_read_b64_tr_b16 v[214:215], v226 offset:41984
  v_mfma_f32_16x16x32_bf16 v[32:35], v[192:195], a[68:71], v[32:35]
  buffer_load_dwordx4 v243, s[8:11], s51 offen offset:3072 lds
  v_mfma_f32_16x16x32_bf16 v[64:67], v[192:195], a[72:75], v[64:67]
  s_add_u32 m0, s61, 57344
  s_add_u32 s51, s51, s62
  v_mfma_f32_16x16x32_bf16 v[64:67], v[196:199], a[88:91], v[64:67]
  v_mfma_f32_16x16x32_bf16 v[96:99], v[196:199], a[92:95], v[96:99]
  ds_read_b64_tr_b16 v[216:217], v227 offset:32768
  v_mfma_f32_16x16x32_bf16 v[96:99], v[192:195], a[76:79], v[96:99]
  s_waitcnt lgkmcnt(5)
  ds_read_b64_tr_b16 v[218:219], v227 offset:33792
  v_mfma_f32_16x16x32_bf16 v[4:7], v[200:203], a[64:67], v[4:7]
  buffer_load_dwordx4 v244, s[12:15], s51 offen offset:0 lds
  v_mfma_f32_16x16x32_bf16 v[4:7], v[204:207], a[80:83], v[4:7]
  ds_read_b64_tr_b16 v[220:221], v227 offset:40960
  v_mfma_f32_16x16x32_bf16 v[36:39], v[204:207], a[84:87], v[36:39]
  ds_read_b64_tr_b16 v[222:223], v227 offset:41984
  v_mfma_f32_16x16x32_bf16 v[36:39], v[200:203], a[68:71], v[36:39]
  buffer_load_dwordx4 v245, s[12:15], s51 offen offset:1024 lds
  v_mfma_f32_16x16x32_bf16 v[68:71], v[200:203], a[72:75], v[68:71]
  s_add_u32 s52, s54, 4
  s_and_b32 s52, s52, 7
  s_lshl_b32 s52, s52, 7
  v_mfma_f32_16x16x32_bf16 v[68:71], v[204:207], a[88:91], v[68:71]
  s_add_u32 m0, s60, 0
  v_mfma_f32_16x16x32_bf16 v[100:103], v[204:207], a[92:95], v[100:103]
  ds_read_b64_tr_b16 v[192:193], v228 offset:32768
  v_mfma_f32_16x16x32_bf16 v[100:103], v[200:203], a[76:79], v[100:103]
  s_waitcnt lgkmcnt(5)
  ds_read_b64_tr_b16 v[194:195], v228 offset:33792
  v_mfma_f32_16x16x32_bf16 v[8:11], v[208:211], a[64:67], v[8:11]
  ds_read_b64_tr_b16 v[196:197], v228 offset:40960
  v_mfma_f32_16x16x32_bf16 v[8:11], v[212:215], a[80:83], v[8:11]
  ds_read_b64_tr_b16 v[198:199], v228 offset:41984
  v_mfma_f32_16x16x32_bf16 v[40:43], v[212:215], a[84:87], v[40:43]
  v_mfma_f32_16x16x32_bf16 v[40:43], v[208:211], a[68:71], v[40:43]
  v_mfma_f32_16x16x32_bf16 v[72:75], v[208:211], a[72:75], v[72:75]
  buffer_load_dwordx4 v238, s[4:7], s52 offen offset:0 lds
  v_mfma_f32_16x16x32_bf16 v[72:75], v[212:215], a[88:91], v[72:75]
  v_mfma_f32_16x16x32_bf16 v[104:107], v[212:215], a[92:95], v[104:107]
  buffer_load_dwordx4 v239, s[4:7], s52 offen offset:1024 lds
  v_mfma_f32_16x16x32_bf16 v[104:107], v[208:211], a[76:79], v[104:107]
  s_waitcnt lgkmcnt(4)
  ds_read_b64_tr_b16 v[200:201], v229 offset:32768
  s_add_u32 s52, s52, 16384
  v_mfma_f32_16x16x32_bf16 v[12:15], v[216:219], a[64:67], v[12:15]
  s_add_u32 m0, s60, 2048
  ds_read_b64_tr_b16 v[202:203], v229 offset:33792
  v_mfma_f32_16x16x32_bf16 v[12:15], v[220:223], a[80:83], v[12:15]
  ds_read_b64_tr_b16 v[204:205], v229 offset:40960
  v_mfma_f32_16x16x32_bf16 v[44:47], v[220:223], a[84:87], v[44:47]
  ds_read_b64_tr_b16 v[206:207], v229 offset:41984
  v_mfma_f32_16x16x32_bf16 v[44:47], v[216:219], a[68:71], v[44:47]
  v_mfma_f32_16x16x32_bf16 v[76:79], v[216:219], a[72:75], v[76:79]
  buffer_load_dwordx4 v238, s[4:7], s52 offen offset:0 lds
  v_mfma_f32_16x16x32_bf16 v[76:79], v[220:223], a[88:91], v[76:79]
  v_mfma_f32_16x16x32_bf16 v[108:111], v[220:223], a[92:95], v[108:111]
  ds_read_b64_tr_b16 v[208:209], v230 offset:32768
  v_mfma_f32_16x16x32_bf16 v[108:111], v[216:219], a[76:79], v[108:111]
  s_waitcnt lgkmcnt(5)
  ds_read_b64_tr_b16 v[210:211], v230 offset:33792
  v_mfma_f32_16x16x32_bf16 v[16:19], v[192:195], a[64:67], v[16:19]
  buffer_load_dwordx4 v239, s[4:7], s52 offen offset:1024 lds
  v_mfma_f32_16x16x32_bf16 v[16:19], v[196:199], a[80:83], v[16:19]
  s_add_u32 s52, s52, 16384
  ds_read_b64_tr_b16 v[212:213], v230 offset:40960
  s_add_u32 m0, s60, 4096
  v_mfma_f32_16x16x32_bf16 v[48:51], v[196:199], a[84:87], v[48:51]
  ds_read_b64_tr_b16 v[214:215], v230 offset:41984
  v_mfma_f32_16x16x32_bf16 v[48:51], v[192:195], a[68:71], v[48:51]
  v_mfma_f32_16x16x32_bf16 v[80:83], v[192:195], a[72:75], v[80:83]
  v_mfma_f32_16x16x32_bf16 v[80:83], v[196:199], a[88:91], v[80:83]
  buffer_load_dwordx4 v238, s[4:7], s52 offen offset:0 lds
  v_mfma_f32_16x16x32_bf16 v[112:115], v[196:199], a[92:95], v[112:115]
  ds_read_b64_tr_b16 v[216:217], v231 offset:32768
  v_mfma_f32_16x16x32_bf16 v[112:115], v[192:195], a[76:79], v[112:115]
  s_waitcnt lgkmcnt(5)
  ds_read_b64_tr_b16 v[218:219], v231 offset:33792
  v_mfma_f32_16x16x32_bf16 v[20:23], v[200:203], a[64:67], v[20:23]
  buffer_load_dwordx4 v239, s[4:7], s52 offen offset:1024 lds
  v_mfma_f32_16x16x32_bf16 v[20:23], v[204:207], a[80:83], v[20:23]
  s_add_u32 s52, s52, 16384
  ds_read_b64_tr_b16 v[220:221], v231 offset:40960
  s_add_u32 m0, s60, 6144
  v_mfma_f32_16x16x32_bf16 v[52:55], v[204:207], a[84:87], v[52:55]
  ds_read_b64_tr_b16 v[222:223], v231 offset:41984
  v_mfma_f32_16x16x32_bf16 v[52:55], v[200:203], a[68:71], v[52:55]
  v_mfma_f32_16x16x32_bf16 v[84:87], v[200:203], a[72:75], v[84:87]
  v_mfma_f32_16x16x32_bf16 v[84:87], v[204:207], a[88:91], v[84:87]
  v_mfma_f32_16x16x32_bf16 v[116:119], v[204:207], a[92:95], v[116:119]
  buffer_load_dwordx4 v238, s[4:7], s52 offen offset:0 lds
  v_mfma_f32_16x16x32_bf16 v[116:119], v[200:203], a[76:79], v[116:119]
  s_waitcnt lgkmcnt(4)
  ds_read_b64_tr_b16 v[192:193], v232 offset:49152
  v_mfma_f32_16x16x32_bf16 v[24:27], v[208:211], a[64:67], v[24:27]
  ds_read_b64_tr_b16 v[194:195], v232 offset:49664
  v_mfma_f32_16x16x32_bf16 v[24:27], v[212:215], a[80:83], v[24:27]
  ds_read_b64_tr_b16 v[196:197], v232 offset:53248
  v_mfma_f32_16x16x32_bf16 v[56:59], v[212:215], a[84:87], v[56:59]
  ds_read_b64_tr_b16 v[198:199], v232 offset:53760
  v_mfma_f32_16x16x32_bf16 v[56:59], v[208:211], a[68:71], v[56:59]
  buffer_load_dwordx4 v239, s[4:7], s52 offen offset:1024 lds
  v_mfma_f32_16x16x32_bf16 v[88:91], v[208:211], a[72:75], v[88:91]
  s_mul_i32 s48, s45, 80
  s_waitcnt vmcnt(14)
  ds_read_b128 a[96:99], v236 offset:32768
  v_mfma_f32_16x16x32_bf16 v[88:91], v[212:215], a[88:91], v[88:91]
  s_mul_i32 s49, s3, 20
  s_add_u32 s48, s48, s49
  v_mfma_f32_16x16x32_bf16 v[120:123], v[212:215], a[92:95], v[120:123]
  ds_read_b64_tr_b16 v[200:201], v233 offset:49152
  v_mfma_f32_16x16x32_bf16 v[120:123], v[208:211], a[76:79], v[120:123]
  s_waitcnt lgkmcnt(6)
  ds_read_b64_tr_b16 v[202:203], v233 offset:49664
  v_mfma_f32_16x16x32_bf16 v[28:31], v[216:219], a[64:67], v[28:31]
  ds_read_b64_tr_b16 v[204:205], v233 offset:53248
  v_lshrrev_b32 v251, 1, v249
  v_mfma_f32_16x16x32_bf16 v[28:31], v[220:223], a[80:83], v[28:31]
  ds_read_b64_tr_b16 v[206:207], v233 offset:53760
  v_min_u32 v251, 19, v251
  v_mfma_f32_16x16x32_bf16 v[60:63], v[220:223], a[84:87], v[60:63]
  ds_read_b128 a[100:103], v236 offset:34816
  v_mfma_f32_16x16x32_bf16 v[60:63], v[216:219], a[68:71], v[60:63]
  v_add_u32 v251, s48, v251
  v_mfma_f32_16x16x32_bf16 v[92:95], v[216:219], a[72:75], v[92:95]
  ds_read_b128 a[104:107], v236 offset:36864
  v_and_b32 v252, 1, v249
  v_mfma_f32_16x16x32_bf16 v[92:95], v[220:223], a[88:91], v[92:95]
  v_mfma_f32_16x16x32_bf16 v[124:127], v[220:223], a[92:95], v[124:127]
  ds_read_b64_tr_b16 v[208:209], v234 offset:49152
  v_lshlrev_b32 v252, 7, v252
  v_mfma_f32_16x16x32_bf16 v[124:127], v[216:219], a[76:79], v[124:127]
  s_waitcnt lgkmcnt(8)
  ds_read_b64_tr_b16 v[210:211], v234 offset:49664
  v_lshl_add_u32 v252, v251, 13, v252
  v_mfma_f32_16x16x32_bf16 v[128:131], a[64:67], v[192:195], v[128:131]
  ds_read_b64_tr_b16 v[212:213], v234 offset:53248
  v_mfma_f32_16x16x32_bf16 v[128:131], a[80:83], v[196:199], v[128:131]
  ds_read_b64_tr_b16 v[214:215], v234 offset:53760
  v_mfma_f32_16x16x32_bf16 v[132:135], a[84:87], v[196:199], v[132:135]
  ds_read_b128 a[108:111], v236 offset:38912
  v_mfma_f32_16x16x32_bf16 v[132:135], a[68:71], v[192:195], v[132:135]
  buffer_load_dword v250, v252, s[24:27], 0 offen
  v_mfma_f32_16x16x32_bf16 v[136:139], a[72:75], v[192:195], v[136:139]
  ds_read_b128 a[112:115], v237 offset:32768
  v_mfma_f32_16x16x32_bf16 v[136:139], a[88:91], v[196:199], v[136:139]
  v_mfma_f32_16x16x32_bf16 v[140:143], a[92:95], v[196:199], v[140:143]
  ds_read_b64_tr_b16 v[216:217], v235 offset:49152
  v_mfma_f32_16x16x32_bf16 v[140:143], a[76:79], v[192:195], v[140:143]
  s_waitcnt lgkmcnt(9)
  ds_read_b64_tr_b16 v[218:219], v235 offset:49664
  v_mfma_f32_16x16x32_bf16 v[144:147], a[64:67], v[200:203], v[144:147]
  ds_read_b64_tr_b16 v[220:221], v235 offset:53248
  v_mfma_f32_16x16x32_bf16 v[144:147], a[80:83], v[204:207], v[144:147]
  ds_read_b64_tr_b16 v[222:223], v235 offset:53760
  v_mfma_f32_16x16x32_bf16 v[148:151], a[84:87], v[204:207], v[148:151]
  ds_read_b128 a[116:119], v237 offset:34816
  v_mfma_f32_16x16x32_bf16 v[148:151], a[68:71], v[200:203], v[148:151]
  v_mfma_f32_16x16x32_bf16 v[152:155], a[72:75], v[200:203], v[152:155]
  ds_read_b128 a[120:123], v237 offset:36864
  v_mfma_f32_16x16x32_bf16 v[152:155], a[88:91], v[204:207], v[152:155]
  v_mfma_f32_16x16x32_bf16 v[156:159], a[92:95], v[204:207], v[156:159]
  v_mfma_f32_16x16x32_bf16 v[156:159], a[76:79], v[200:203], v[156:159]
  s_waitcnt lgkmcnt(8)
  v_mfma_f32_16x16x32_bf16 v[160:163], a[64:67], v[208:211], v[160:163]
  ds_read_b128 a[124:127], v237 offset:38912
  v_mfma_f32_16x16x32_bf16 v[160:163], a[80:83], v[212:215], v[160:163]
  v_mfma_f32_16x16x32_bf16 v[164:167], a[84:87], v[212:215], v[164:167]
  v_mfma_f32_16x16x32_bf16 v[164:167], a[68:71], v[208:211], v[164:167]
  s_waitcnt lgkmcnt(0)
  s_barrier
  v_mfma_f32_16x16x32_bf16 v[168:171], a[72:75], v[208:211], v[168:171]
  s_add_u32 m0, s50, 32768
  ds_read_b64_tr_b16 v[192:193], v224 offset:0
  s_add_u32 s51, s54, 5
  v_mfma_f32_16x16x32_bf16 v[168:171], a[88:91], v[212:215], v[168:171]
  s_and_b32 s51, s51, 7
  ds_read_b64_tr_b16 v[194:195], v224 offset:1024
  s_lshl_b32 s51, s51, 19
  v_mfma_f32_16x16x32_bf16 v[172:175], a[92:95], v[212:215], v[172:175]
  ds_read_b64_tr_b16 v[196:197], v224 offset:8192
  v_mfma_f32_16x16x32_bf16 v[172:175], a[76:79], v[208:211], v[172:175]
  ds_read_b64_tr_b16 v[198:199], v224 offset:9216
  v_mfma_f32_16x16x32_bf16 v[176:179], a[64:67], v[216:219], v[176:179]
  ds_read_b64_tr_b16 v[200:201], v225 offset:0
  v_mfma_f32_16x16x32_bf16 v[176:179], a[80:83], v[220:223], v[176:179]
  ds_read_b64_tr_b16 v[202:203], v225 offset:1024
  v_mfma_f32_16x16x32_bf16 v[180:183], a[84:87], v[220:223], v[180:183]
  ds_read_b64_tr_b16 v[204:205], v225 offset:8192
  v_mfma_f32_16x16x32_bf16 v[180:183], a[68:71], v[216:219], v[180:183]
  ds_read_b64_tr_b16 v[206:207], v225 offset:9216
  v_mfma_f32_16x16x32_bf16 v[184:187], a[72:75], v[216:219], v[184:187]
  buffer_load_dwordx4 v240, s[8:11], s51 offen offset:0 lds
  v_mfma_f32_16x16x32_bf16 v[184:187], a[88:91], v[220:223], v[184:187]
  buffer_load_dwordx4 v241, s[8:11], s51 offen offset:1024 lds
  v_mfma_f32_16x16x32_bf16 v[188:191], a[92:95], v[220:223], v[188:191]
  ds_read_b64_tr_b16 v[208:209], v226 offset:0
  v_mfma_f32_16x16x32_bf16 v[188:191], a[76:79], v[216:219], v[188:191]
  s_waitcnt lgkmcnt(5)
  ds_read_b64_tr_b16 v[210:211], v226 offset:1024
  v_mfma_f32_16x16x32_bf16 v[0:3], v[192:195], a[96:99], v[0:3]
  buffer_load_dwordx4 v242, s[8:11], s51 offen offset:2048 lds
  v_mfma_f32_16x16x32_bf16 v[0:3], v[196:199], a[112:115], v[0:3]
  ds_read_b64_tr_b16 v[212:213], v226 offset:8192
  v_mfma_f32_16x16x32_bf16 v[32:35], v[196:199], a[116:119], v[32:35]
  ds_read_b64_tr_b16 v[214:215], v226 offset:9216
  v_mfma_f32_16x16x32_bf16 v[32:35], v[192:195], a[100:103], v[32:35]
  buffer_load_dwordx4 v243, s[8:11], s51 offen offset:3072 lds
  v_mfma_f32_16x16x32_bf16 v[64:67], v[192:195], a[104:107], v[64:67]
  s_add_u32 m0, s61, 65536
  s_add_u32 s51, s51, s62
  v_mfma_f32_16x16x32_bf16 v[64:67], v[196:199], a[120:123], v[64:67]
  v_mfma_f32_16x16x32_bf16 v[96:99], v[196:199], a[124:127], v[96:99]
  ds_read_b64_tr_b16 v[216:217], v227 offset:0
  v_mfma_f32_16x16x32_bf16 v[96:99], v[192:195], a[108:111], v[96:99]
  s_waitcnt lgkmcnt(5)
  ds_read_b64_tr_b16 v[218:219], v227 offset:1024
  v_mfma_f32_16x16x32_bf16 v[4:7], v[200:203], a[96:99], v[4:7]
  ds_read_b64_tr_b16 v[220:221], v227 offset:8192
  v_mfma_f32_16x16x32_bf16 v[4:7], v[204:207], a[112:115], v[4:7]
  ds_read_b64_tr_b16 v[222:223], v227 offset:9216
  v_mfma_f32_16x16x32_bf16 v[36:39], v[204:207], a[116:119], v[36:39]
  buffer_load_dwordx4 v244, s[12:15], s51 offen offset:0 lds
  v_mfma_f32_16x16x32_bf16 v[36:39], v[200:203], a[100:103], v[36:39]
  v_mfma_f32_16x16x32_bf16 v[68:71], v[200:203], a[104:107], v[68:71]
  buffer_load_dwordx4 v245, s[12:15], s51 offen offset:1024 lds
  v_mfma_f32_16x16x32_bf16 v[68:71], v[204:207], a[120:123], v[68:71]
  s_add_u32 s52, s54, 5
  s_and_b32 s52, s52, 7
  s_lshl_b32 s52, s52, 7
  v_mfma_f32_16x16x32_bf16 v[100:103], v[204:207], a[124:127], v[100:103]
  s_add_u32 m0, s60, 32768
  ds_read_b64_tr_b16 v[192:193], v228 offset:0
  v_mfma_f32_16x16x32_bf16 v[100:103], v[200:203], a[108:111], v[100:103]
  s_waitcnt lgkmcnt(5)
  ds_read_b64_tr_b16 v[194:195], v228 offset:1024
  v_mfma_f32_16x16x32_bf16 v[8:11], v[208:211], a[96:99], v[8:11]
  ds_read_b64_tr_b16 v[196:197], v228 offset:8192
  v_mfma_f32_16x16x32_bf16 v[8:11], v[212:215], a[112:115], v[8:11]
  ds_read_b64_tr_b16 v[198:199], v228 offset:9216
  v_mfma_f32_16x16x32_bf16 v[40:43], v[212:215], a[116:119], v[40:43]
  v_mfma_f32_16x16x32_bf16 v[40:43], v[208:211], a[100:103], v[40:43]
  v_mfma_f32_16x16x32_bf16 v[72:75], v[208:211], a[104:107], v[72:75]
  v_mfma_f32_16x16x32_bf16 v[72:75], v[212:215], a[120:123], v[72:75]
  buffer_load_dwordx4 v238, s[4:7], s52 offen offset:0 lds
  v_mfma_f32_16x16x32_bf16 v[104:107], v[212:215], a[124:127], v[104:107]
  ds_read_b64_tr_b16 v[200:201], v229 offset:0
  v_mfma_f32_16x16x32_bf16 v[104:107], v[208:211], a[108:111], v[104:107]
  s_waitcnt lgkmcnt(5)
  ds_read_b64_tr_b16 v[202:203], v229 offset:1024
  v_mfma_f32_16x16x32_bf16 v[12:15], v[216:219], a[96:99], v[12:15]
  buffer_load_dwordx4 v239, s[4:7], s52 offen offset:1024 lds
  v_mfma_f32_16x16x32_bf16 v[12:15], v[220:223], a[112:115], v[12:15]
  s_add_u32 s52, s52, 16384
  ds_read_b64_tr_b16 v[204:205], v229 offset:8192
  s_add_u32 m0, s60, 34816
  v_mfma_f32_16x16x32_bf16 v[44:47], v[220:223], a[116:119], v[44:47]
  ds_read_b64_tr_b16 v[206:207], v229 offset:9216
  v_mfma_f32_16x16x32_bf16 v[44:47], v[216:219], a[100:103], v[44:47]
  v_mfma_f32_16x16x32_bf16 v[76:79], v[216:219], a[104:107], v[76:79]
  v_mfma_f32_16x16x32_bf16 v[76:79], v[220:223], a[120:123], v[76:79]
  v_mfma_f32_16x16x32_bf16 v[108:111], v[220:223], a[124:127], v[108:111]
  ds_read_b64_tr_b16 v[208:209], v230 offset:0
  v_mfma_f32_16x16x32_bf16 v[108:111], v[216:219], a[108:111], v[108:111]
  s_waitcnt lgkmcnt(5)
  ds_read_b64_tr_b16 v[210:211], v230 offset:1024
  v_mfma_f32_16x16x32_bf16 v[16:19], v[192:195], a[96:99], v[16:19]
  buffer_load_dwordx4 v238, s[4:7], s52 offen offset:0 lds
  v_mfma_f32_16x16x32_bf16 v[16:19], v[196:199], a[112:115], v[16:19]
  ds_read_b64_tr_b16 v[212:213], v230 offset:8192
  v_mfma_f32_16x16x32_bf16 v[48:51], v[196:199], a[116:119], v[48:51]
  ds_read_b64_tr_b16 v[214:215], v230 offset:9216
  v_mfma_f32_16x16x32_bf16 v[48:51], v[192:195], a[100:103], v[48:51]
  buffer_load_dwordx4 v239, s[4:7], s52 offen offset:1024 lds
  v_mfma_f32_16x16x32_bf16 v[80:83], v[192:195], a[104:107], v[80:83]
  s_add_u32 s52, s52, 16384
  s_add_u32 m0, s60, 36864
  v_mfma_f32_16x16x32_bf16 v[80:83], v[196:199], a[120:123], v[80:83]
  v_mfma_f32_16x16x32_bf16 v[112:115], v[196:199], a[124:127], v[112:115]
  ds_read_b64_tr_b16 v[216:217], v231 offset:0
  v_mfma_f32_16x16x32_bf16 v[112:115], v[192:195], a[108:111], v[112:115]
  s_waitcnt lgkmcnt(5)
  ds_read_b64_tr_b16 v[218:219], v231 offset:1024
  v_mfma_f32_16x16x32_bf16 v[20:23], v[200:203], a[96:99], v[20:23]
  buffer_load_dwordx4 v238, s[4:7], s52 offen offset:0 lds
  v_mfma_f32_16x16x32_bf16 v[20:23], v[204:207], a[112:115], v[20:23]
  ds_read_b64_tr_b16 v[220:221], v231 offset:8192
  v_mfma_f32_16x16x32_bf16 v[52:55], v[204:207], a[116:119], v[52:55]
  ds_read_b64_tr_b16 v[222:223], v231 offset:9216
  v_mfma_f32_16x16x32_bf16 v[52:55], v[200:203], a[100:103], v[52:55]
  buffer_load_dwordx4 v239, s[4:7], s52 offen offset:1024 lds
  v_mfma_f32_16x16x32_bf16 v[84:87], v[200:203], a[104:107], v[84:87]
  s_add_u32 s52, s52, 16384
  s_add_u32 m0, s60, 38912
  v_mfma_f32_16x16x32_bf16 v[84:87], v[204:207], a[120:123], v[84:87]
  v_mfma_f32_16x16x32_bf16 v[116:119], v[204:207], a[124:127], v[116:119]
  ds_read_b64_tr_b16 v[192:193], v232 offset:32768
  v_mfma_f32_16x16x32_bf16 v[116:119], v[200:203], a[108:111], v[116:119]
  s_waitcnt lgkmcnt(5)
  ds_read_b64_tr_b16 v[194:195], v232 offset:33280
  v_mfma_f32_16x16x32_bf16 v[24:27], v[208:211], a[96:99], v[24:27]
  ds_read_b64_tr_b16 v[196:197], v232 offset:36864
  v_mfma_f32_16x16x32_bf16 v[24:27], v[212:215], a[112:115], v[24:27]
  ds_read_b64_tr_b16 v[198:199], v232 offset:37376
  v_mfma_f32_16x16x32_bf16 v[56:59], v[212:215], a[116:119], v[56:59]
  buffer_load_dwordx4 v238, s[4:7], s52 offen offset:0 lds
  v_mfma_f32_16x16x32_bf16 v[56:59], v[208:211], a[100:103], v[56:59]
  v_mfma_f32_16x16x32_bf16 v[88:91], v[208:211], a[104:107], v[88:91]
  buffer_load_dwordx4 v239, s[4:7], s52 offen offset:1024 lds
  v_mfma_f32_16x16x32_bf16 v[88:91], v[212:215], a[120:123], v[88:91]
  s_and_b32 s53, s2, 1
  s_waitcnt vmcnt(15)
  ds_read_b128 a[128:131], v236 offset:0
  v_mfma_f32_16x16x32_bf16 v[120:123], v[212:215], a[124:127], v[120:123]
  s_lshl_b32 s53, s53, 7
  ds_read_b64_tr_b16 v[200:201], v233 offset:32768
  v_mfma_f32_16x16x32_bf16 v[120:123], v[208:211], a[108:111], v[120:123]
  s_waitcnt lgkmcnt(6)
  ds_read_b64_tr_b16 v[202:203], v233 offset:33280
  v_mfma_f32_16x16x32_bf16 v[28:31], v[216:219], a[96:99], v[28:31]
  ds_read_b64_tr_b16 v[204:205], v233 offset:36864
  v_mfma_f32_16x16x32_bf16 v[28:31], v[220:223], a[112:115], v[28:31]
  ds_read_b64_tr_b16 v[206:207], v233 offset:37376
  v_mfma_f32_16x16x32_bf16 v[60:63], v[220:223], a[116:119], v[60:63]
  ds_read_b128 a[132:135], v236 offset:2048
  v_mov_b32 v254, 1
  v_mfma_f32_16x16x32_bf16 v[60:63], v[216:219], a[100:103], v[60:63]
  v_mfma_f32_16x16x32_bf16 v[92:95], v[216:219], a[104:107], v[92:95]
  buffer_atomic_add v254, v255, s[72:75], s53 offen sc1
  v_mfma_f32_16x16x32_bf16 v[92:95], v[220:223], a[120:123], v[92:95]
  ds_read_b128 a[136:139], v236 offset:4096
  v_mfma_f32_16x16x32_bf16 v[124:127], v[220:223], a[124:127], v[124:127]
  ds_read_b64_tr_b16 v[208:209], v234 offset:32768
  v_mfma_f32_16x16x32_bf16 v[124:127], v[216:219], a[108:111], v[124:127]
  s_waitcnt lgkmcnt(8)
  ds_read_b64_tr_b16 v[210:211], v234 offset:33280
  v_mul_u32_u24 v252, 3456, v251
  v_mfma_f32_16x16x32_bf16 v[128:131], a[96:99], v[192:195], v[128:131]
  buffer_load_dword v250, v252, s[28:31], 0 offen offset:2048
  v_mfma_f32_16x16x32_bf16 v[128:131], a[112:115], v[196:199], v[128:131]
  ds_read_b64_tr_b16 v[212:213], v234 offset:36864
  v_mfma_f32_16x16x32_bf16 v[132:135], a[116:119], v[196:199], v[132:135]
  ds_read_b64_tr_b16 v[214:215], v234 offset:37376
  v_mfma_f32_16x16x32_bf16 v[132:135], a[100:103], v[192:195], v[132:135]
  ds_read_b128 a[140:143], v236 offset:6144
  v_mfma_f32_16x16x32_bf16 v[136:139], a[104:107], v[192:195], v[136:139]
  ds_read_b128 a[144:147], v237 offset:0
  v_mfma_f32_16x16x32_bf16 v[136:139], a[120:123], v[196:199], v[136:139]
  v_mfma_f32_16x16x32_bf16 v[140:143], a[124:127], v[196:199], v[140:143]
  ds_read_b64_tr_b16 v[216:217], v235 offset:32768
  v_mfma_f32_16x16x32_bf16 v[140:143], a[108:111], v[192:195], v[140:143]
  s_waitcnt lgkmcnt(9)
  ds_read_b64_tr_b16 v[218:219], v235 offset:33280
  v_mfma_f32_16x16x32_bf16 v[144:147], a[96:99], v[200:203], v[144:147]
  ds_read_b64_tr_b16 v[220:221], v235 offset:36864
  v_mfma_f32_16x16x32_bf16 v[144:147], a[112:115], v[204:207], v[144:147]
  ds_read_b64_tr_b16 v[222:223], v235 offset:37376
  v_mfma_f32_16x16x32_bf16 v[148:151], a[116:119], v[204:207], v[148:151]
  ds_read_b128 a[148:151], v237 offset:2048
  v_mfma_f32_16x16x32_bf16 v[148:151], a[100:103], v[200:203], v[148:151]
  v_mfma_f32_16x16x32_bf16 v[152:155], a[104:107], v[200:203], v[152:155]
  ds_read_b128 a[152:155], v237 offset:4096
  v_mfma_f32_16x16x32_bf16 v[152:155], a[120:123], v[204:207], v[152:155]
  v_mfma_f32_16x16x32_bf16 v[156:159], a[124:127], v[204:207], v[156:159]
  v_mfma_f32_16x16x32_bf16 v[156:159], a[108:111], v[200:203], v[156:159]
  s_waitcnt lgkmcnt(8)
  v_mfma_f32_16x16x32_bf16 v[160:163], a[96:99], v[208:211], v[160:163]
  ds_read_b128 a[156:159], v237 offset:6144
  v_mfma_f32_16x16x32_bf16 v[160:163], a[112:115], v[212:215], v[160:163]
  v_mfma_f32_16x16x32_bf16 v[164:167], a[116:119], v[212:215], v[164:167]
  v_mfma_f32_16x16x32_bf16 v[164:167], a[100:103], v[208:211], v[164:167]
  s_waitcnt lgkmcnt(0)
  s_barrier
  v_mfma_f32_16x16x32_bf16 v[168:171], a[104:107], v[208:211], v[168:171]
  s_add_u32 m0, s50, 0
  ds_read_b64_tr_b16 v[192:193], v224 offset:16384
  s_add_u32 s51, s54, 6
  v_mfma_f32_16x16x32_bf16 v[168:171], a[120:123], v[212:215], v[168:171]
  s_and_b32 s51, s51, 7
  ds_read_b64_tr_b16 v[194:195], v224 offset:17408
  s_lshl_b32 s51, s51, 19
  v_mfma_f32_16x16x32_bf16 v[172:175], a[124:127], v[212:215], v[172:175]
  ds_read_b64_tr_b16 v[196:197], v224 offset:24576
  v_mfma_f32_16x16x32_bf16 v[172:175], a[108:111], v[208:211], v[172:175]
  ds_read_b64_tr_b16 v[198:199], v224 offset:25600
  v_mfma_f32_16x16x32_bf16 v[176:179], a[96:99], v[216:219], v[176:179]
  ds_read_b64_tr_b16 v[200:201], v225 offset:16384
  v_mfma_f32_16x16x32_bf16 v[176:179], a[112:115], v[220:223], v[176:179]
  ds_read_b64_tr_b16 v[202:203], v225 offset:17408
  v_mfma_f32_16x16x32_bf16 v[180:183], a[116:119], v[220:223], v[180:183]
  ds_read_b64_tr_b16 v[204:205], v225 offset:24576
  v_mfma_f32_16x16x32_bf16 v[180:183], a[100:103], v[216:219], v[180:183]
  ds_read_b64_tr_b16 v[206:207], v225 offset:25600
  v_mfma_f32_16x16x32_bf16 v[184:187], a[104:107], v[216:219], v[184:187]
  buffer_load_dwordx4 v240, s[8:11], s51 offen offset:0 lds
  v_mfma_f32_16x16x32_bf16 v[184:187], a[120:123], v[220:223], v[184:187]
  v_mfma_f32_16x16x32_bf16 v[188:191], a[124:127], v[220:223], v[188:191]
  buffer_load_dwordx4 v241, s[8:11], s51 offen offset:1024 lds
  v_mfma_f32_16x16x32_bf16 v[188:191], a[108:111], v[216:219], v[188:191]
  s_waitcnt lgkmcnt(4)
  ds_read_b64_tr_b16 v[208:209], v226 offset:16384
  v_mfma_f32_16x16x32_bf16 v[0:3], v[192:195], a[128:131], v[0:3]
  ds_read_b64_tr_b16 v[210:211], v226 offset:17408
  v_mfma_f32_16x16x32_bf16 v[0:3], v[196:199], a[144:147], v[0:3]
  ds_read_b64_tr_b16 v[212:213], v226 offset:24576
  v_mfma_f32_16x16x32_bf16 v[32:35], v[196:199], a[148:151], v[32:35]
  ds_read_b64_tr_b16 v[214:215], v226 offset:25600
  v_mfma_f32_16x16x32_bf16 v[32:35], v[192:195], a[132:135], v[32:35]
  buffer_load_dwordx4 v242, s[8:11], s51 offen offset:2048 lds
  v_mfma_f32_16x16x32_bf16 v[64:67], v[192:195], a[136:139], v[64:67]
  v_mfma_f32_16x16x32_bf16 v[64:67], v[196:199], a[152:155], v[64:67]
  v_mfma_f32_16x16x32_bf16 v[96:99], v[196:199], a[156:159], v[96:99]
  buffer_load_dwordx4 v243, s[8:11], s51 offen offset:3072 lds
  v_mfma_f32_16x16x32_bf16 v[96:99], v[192:195], a[140:143], v[96:99]
  s_waitcnt lgkmcnt(4)
  ds_read_b64_tr_b16 v[216:217], v227 offset:16384
  s_add_u32 m0, s61, 49152
  v_mfma_f32_16x16x32_bf16 v[4:7], v[200:203], a[128:131], v[4:7]
  s_add_u32 s51, s51, s62
  ds_read_b64_tr_b16 v[218:219], v227 offset:17408
  v_mfma_f32_16x16x32_bf16 v[4:7], v[204:207], a[144:147], v[4:7]
  ds_read_b64_tr_b16 v[220:221], v227 offset:24576
  v_mfma_f32_16x16x32_bf16 v[36:39], v[204:207], a[148:151], v[36:39]
  ds_read_b64_tr_b16 v[222:223], v227 offset:25600
  v_mfma_f32_16x16x32_bf16 v[36:39], v[200:203], a[132:135], v[36:39]
  v_mfma_f32_16x16x32_bf16 v[68:71], v[200:203], a[136:139], v[68:71]
  v_mfma_f32_16x16x32_bf16 v[68:71], v[204:207], a[152:155], v[68:71]
  buffer_load_dwordx4 v244, s[12:15], s51 offen offset:0 lds
  v_mfma_f32_16x16x32_bf16 v[100:103], v[204:207], a[156:159], v[100:103]
  ds_read_b64_tr_b16 v[192:193], v228 offset:16384
  v_mfma_f32_16x16x32_bf16 v[100:103], v[200:203], a[140:143], v[100:103]
  s_waitcnt lgkmcnt(5)
  ds_read_b64_tr_b16 v[194:195], v228 offset:17408
  v_mfma_f32_16x16x32_bf16 v[8:11], v[208:211], a[128:131], v[8:11]
  ds_read_b64_tr_b16 v[196:197], v228 offset:24576
  v_mfma_f32_16x16x32_bf16 v[8:11], v[212:215], a[144:147], v[8:11]
  ds_read_b64_tr_b16 v[198:199], v228 offset:25600
  v_mfma_f32_16x16x32_bf16 v[40:43], v[212:215], a[148:151], v[40:43]
  buffer_load_dwordx4 v245, s[12:15], s51 offen offset:1024 lds
  v_mfma_f32_16x16x32_bf16 v[40:43], v[208:211], a[132:135], v[40:43]
  s_add_u32 s52, s54, 6
  s_and_b32 s52, s52, 7
  s_lshl_b32 s52, s52, 7
  v_mfma_f32_16x16x32_bf16 v[72:75], v[208:211], a[136:139], v[72:75]
  s_add_u32 m0, s60, 0
  v_mfma_f32_16x16x32_bf16 v[72:75], v[212:215], a[152:155], v[72:75]
  v_mfma_f32_16x16x32_bf16 v[104:107], v[212:215], a[156:159], v[104:107]
  ds_read_b64_tr_b16 v[200:201], v229 offset:16384
  v_mfma_f32_16x16x32_bf16 v[104:107], v[208:211], a[140:143], v[104:107]
  s_waitcnt lgkmcnt(5)
  ds_read_b64_tr_b16 v[202:203], v229 offset:17408
  v_mfma_f32_16x16x32_bf16 v[12:15], v[216:219], a[128:131], v[12:15]
  ds_read_b64_tr_b16 v[204:205], v229 offset:24576
  v_mfma_f32_16x16x32_bf16 v[12:15], v[220:223], a[144:147], v[12:15]
  ds_read_b64_tr_b16 v[206:207], v229 offset:25600
  v_mfma_f32_16x16x32_bf16 v[44:47], v[220:223], a[148:151], v[44:47]
  v_mfma_f32_16x16x32_bf16 v[44:47], v[216:219], a[132:135], v[44:47]
  v_mfma_f32_16x16x32_bf16 v[76:79], v[216:219], a[136:139], v[76:79]
  buffer_load_dwordx4 v238, s[4:7], s52 offen offset:0 lds
  v_mfma_f32_16x16x32_bf16 v[76:79], v[220:223], a[152:155], v[76:79]
  v_mfma_f32_16x16x32_bf16 v[108:111], v[220:223], a[156:159], v[108:111]
  ds_read_b64_tr_b16 v[208:209], v230 offset:16384
  v_mfma_f32_16x16x32_bf16 v[108:111], v[216:219], a[140:143], v[108:111]
  s_waitcnt lgkmcnt(5)
  ds_read_b64_tr_b16 v[210:211], v230 offset:17408
  v_mfma_f32_16x16x32_bf16 v[16:19], v[192:195], a[128:131], v[16:19]
  buffer_load_dwordx4 v239, s[4:7], s52 offen offset:1024 lds
  v_mfma_f32_16x16x32_bf16 v[16:19], v[196:199], a[144:147], v[16:19]
  s_add_u32 s52, s52, 16384
  ds_read_b64_tr_b16 v[212:213], v230 offset:24576
  s_add_u32 m0, s60, 2048
  v_mfma_f32_16x16x32_bf16 v[48:51], v[196:199], a[148:151], v[48:51]
  ds_read_b64_tr_b16 v[214:215], v230 offset:25600
  v_mfma_f32_16x16x32_bf16 v[48:51], v[192:195], a[132:135], v[48:51]
  v_mfma_f32_16x16x32_bf16 v[80:83], v[192:195], a[136:139], v[80:83]
  v_mfma_f32_16x16x32_bf16 v[80:83], v[196:199], a[152:155], v[80:83]
  v_mfma_f32_16x16x32_bf16 v[112:115], v[196:199], a[156:159], v[112:115]
  buffer_load_dwordx4 v238, s[4:7], s52 offen offset:0 lds
  v_mfma_f32_16x16x32_bf16 v[112:115], v[192:195], a[140:143], v[112:115]
  s_waitcnt lgkmcnt(4)
  ds_read_b64_tr_b16 v[216:217], v231 offset:16384
  v_mfma_f32_16x16x32_bf16 v[20:23], v[200:203], a[128:131], v[20:23]
  ds_read_b64_tr_b16 v[218:219], v231 offset:17408
  v_mfma_f32_16x16x32_bf16 v[20:23], v[204:207], a[144:147], v[20:23]
  ds_read_b64_tr_b16 v[220:221], v231 offset:24576
  v_mfma_f32_16x16x32_bf16 v[52:55], v[204:207], a[148:151], v[52:55]
  ds_read_b64_tr_b16 v[222:223], v231 offset:25600
  v_mfma_f32_16x16x32_bf16 v[52:55], v[200:203], a[132:135], v[52:55]
  buffer_load_dwordx4 v239, s[4:7], s52 offen offset:1024 lds
  v_mfma_f32_16x16x32_bf16 v[84:87], v[200:203], a[136:139], v[84:87]
  s_add_u32 s52, s52, 16384
  s_add_u32 m0, s60, 4096
  v_mfma_f32_16x16x32_bf16 v[84:87], v[204:207], a[152:155], v[84:87]
  v_mfma_f32_16x16x32_bf16 v[116:119], v[204:207], a[156:159], v[116:119]
  ds_read_b64_tr_b16 v[192:193], v232 offset:40960
  v_mfma_f32_16x16x32_bf16 v[116:119], v[200:203], a[140:143], v[116:119]
  s_waitcnt lgkmcnt(5)
  ds_read_b64_tr_b16 v[194:195], v232 offset:41472
  v_mfma_f32_16x16x32_bf16 v[24:27], v[208:211], a[128:131], v[24:27]
  ds_read_b64_tr_b16 v[196:197], v232 offset:45056
  v_mfma_f32_16x16x32_bf16 v[24:27], v[212:215], a[144:147], v[24:27]
  ds_read_b64_tr_b16 v[198:199], v232 offset:45568
  v_mfma_f32_16x16x32_bf16 v[56:59], v[212:215], a[148:151], v[56:59]
  buffer_load_dwordx4 v238, s[4:7], s52 offen offset:0 lds
  v_mfma_f32_16x16x32_bf16 v[56:59], v[208:211], a[132:135], v[56:59]
  v_mfma_f32_16x16x32_bf16 v[88:91], v[208:211], a[136:139], v[88:91]
  s_waitcnt vmcnt(13)
  ds_read_b128 a[160:163], v236 offset:32768
  v_mfma_f32_16x16x32_bf16 v[88:91], v[212:215], a[152:155], v[88:91]
  buffer_load_dwordx4 v239, s[4:7], s52 offen offset:1024 lds
  v_mfma_f32_16x16x32_bf16 v[120:123], v[212:215], a[156:159], v[120:123]
  s_add_u32 s52, s52, 16384
  ds_read_b64_tr_b16 v[200:201], v233 offset:40960
  s_add_u32 m0, s60, 6144
  v_mfma_f32_16x16x32_bf16 v[120:123], v[208:211], a[140:143], v[120:123]
  s_waitcnt lgkmcnt(6)
  ds_read_b64_tr_b16 v[202:203], v233 offset:41472
  v_mfma_f32_16x16x32_bf16 v[28:31], v[216:219], a[128:131], v[28:31]
  ds_read_b64_tr_b16 v[204:205], v233 offset:45056
  v_mfma_f32_16x16x32_bf16 v[28:31], v[220:223], a[144:147], v[28:31]
  ds_read_b64_tr_b16 v[206:207], v233 offset:45568
  v_mfma_f32_16x16x32_bf16 v[60:63], v[220:223], a[148:151], v[60:63]
  ds_read_b128 a[164:167], v236 offset:34816
  v_mfma_f32_16x16x32_bf16 v[60:63], v[216:219], a[132:135], v[60:63]
  v_mfma_f32_16x16x32_bf16 v[92:95], v[216:219], a[136:139], v[92:95]
  buffer_load_dwordx4 v238, s[4:7], s52 offen offset:0 lds
  v_mfma_f32_16x16x32_bf16 v[92:95], v[220:223], a[152:155], v[92:95]
  ds_read_b128 a[168:171], v236 offset:36864
  v_mfma_f32_16x16x32_bf16 v[124:127], v[220:223], a[156:159], v[124:127]
  ds_read_b64_tr_b16 v[208:209], v234 offset:40960
  v_mfma_f32_16x16x32_bf16 v[124:127], v[216:219], a[140:143], v[124:127]
  s_waitcnt lgkmcnt(8)
  ds_read_b64_tr_b16 v[210:211], v234 offset:41472
  v_mfma_f32_16x16x32_bf16 v[128:131], a[128:131], v[192:195], v[128:131]
  buffer_load_dwordx4 v239, s[4:7], s52 offen offset:1024 lds
  v_mfma_f32_16x16x32_bf16 v[128:131], a[144:147], v[196:199], v[128:131]
  ds_read_b64_tr_b16 v[212:213], v234 offset:45056
  v_mfma_f32_16x16x32_bf16 v[132:135], a[148:151], v[196:199], v[132:135]
  ds_read_b64_tr_b16 v[214:215], v234 offset:45568
  v_mfma_f32_16x16x32_bf16 v[132:135], a[132:135], v[192:195], v[132:135]
  ds_read_b128 a[172:175], v236 offset:38912
  v_mfma_f32_16x16x32_bf16 v[136:139], a[136:139], v[192:195], v[136:139]
  ds_read_b128 a[176:179], v237 offset:32768
  v_mfma_f32_16x16x32_bf16 v[136:139], a[152:155], v[196:199], v[136:139]
  v_mfma_f32_16x16x32_bf16 v[140:143], a[156:159], v[196:199], v[140:143]
  ds_read_b64_tr_b16 v[216:217], v235 offset:40960
  v_mfma_f32_16x16x32_bf16 v[140:143], a[140:143], v[192:195], v[140:143]
  s_waitcnt lgkmcnt(9)
  ds_read_b64_tr_b16 v[218:219], v235 offset:41472
  v_mfma_f32_16x16x32_bf16 v[144:147], a[128:131], v[200:203], v[144:147]
  ds_read_b64_tr_b16 v[220:221], v235 offset:45056
  v_mfma_f32_16x16x32_bf16 v[144:147], a[144:147], v[204:207], v[144:147]
  ds_read_b64_tr_b16 v[222:223], v235 offset:45568
  v_mfma_f32_16x16x32_bf16 v[148:151], a[148:151], v[204:207], v[148:151]
  ds_read_b128 a[180:183], v237 offset:34816
  v_mfma_f32_16x16x32_bf16 v[148:151], a[132:135], v[200:203], v[148:151]
  v_mfma_f32_16x16x32_bf16 v[152:155], a[136:139], v[200:203], v[152:155]
  ds_read_b128 a[184:187], v237 offset:36864
  v_mfma_f32_16x16x32_bf16 v[152:155], a[152:155], v[204:207], v[152:155]
  v_mfma_f32_16x16x32_bf16 v[156:159], a[156:159], v[204:207], v[156:159]
  v_mfma_f32_16x16x32_bf16 v[156:159], a[140:143], v[200:203], v[156:159]
  s_waitcnt lgkmcnt(8)
  v_mfma_f32_16x16x32_bf16 v[160:163], a[128:131], v[208:211], v[160:163]
  ds_read_b128 a[188:191], v237 offset:38912
  v_mfma_f32_16x16x32_bf16 v[160:163], a[144:147], v[212:215], v[160:163]
  v_mfma_f32_16x16x32_bf16 v[164:167], a[148:151], v[212:215], v[164:167]
  v_mfma_f32_16x16x32_bf16 v[164:167], a[132:135], v[208:211], v[164:167]
  s_waitcnt lgkmcnt(0)
  s_barrier
  v_mfma_f32_16x16x32_bf16 v[168:171], a[136:139], v[208:211], v[168:171]
  s_add_u32 m0, s50, 16384
  ds_read_b64_tr_b16 v[192:193], v224 offset:32768
  s_add_u32 s51, s54, 7
  v_mfma_f32_16x16x32_bf16 v[168:171], a[152:155], v[212:215], v[168:171]
  s_and_b32 s51, s51, 7
  ds_read_b64_tr_b16 v[194:195], v224 offset:33792
  s_lshl_b32 s51, s51, 19
  v_mfma_f32_16x16x32_bf16 v[172:175], a[156:159], v[212:215], v[172:175]
  ds_read_b64_tr_b16 v[196:197], v224 offset:40960
  v_mfma_f32_16x16x32_bf16 v[172:175], a[140:143], v[208:211], v[172:175]
  ds_read_b64_tr_b16 v[198:199], v224 offset:41984
  v_mfma_f32_16x16x32_bf16 v[176:179], a[128:131], v[216:219], v[176:179]
  ds_read_b64_tr_b16 v[200:201], v225 offset:32768
  v_mfma_f32_16x16x32_bf16 v[176:179], a[144:147], v[220:223], v[176:179]
  ds_read_b64_tr_b16 v[202:203], v225 offset:33792
  v_mfma_f32_16x16x32_bf16 v[180:183], a[148:151], v[220:223], v[180:183]
  ds_read_b64_tr_b16 v[204:205], v225 offset:40960
  v_mfma_f32_16x16x32_bf16 v[180:183], a[132:135], v[216:219], v[180:183]
  ds_read_b64_tr_b16 v[206:207], v225 offset:41984
  v_mfma_f32_16x16x32_bf16 v[184:187], a[136:139], v[216:219], v[184:187]
  buffer_load_dwordx4 v240, s[8:11], s51 offen offset:0 lds
  v_mfma_f32_16x16x32_bf16 v[184:187], a[152:155], v[220:223], v[184:187]
  v_mfma_f32_16x16x32_bf16 v[188:191], a[156:159], v[220:223], v[188:191]
  buffer_load_dwordx4 v241, s[8:11], s51 offen offset:1024 lds
  v_mfma_f32_16x16x32_bf16 v[188:191], a[140:143], v[216:219], v[188:191]
  s_waitcnt lgkmcnt(4)
  ds_read_b64_tr_b16 v[208:209], v226 offset:32768
  v_mfma_f32_16x16x32_bf16 v[0:3], v[192:195], a[160:163], v[0:3]
  ds_read_b64_tr_b16 v[210:211], v226 offset:33792
  v_mfma_f32_16x16x32_bf16 v[0:3], v[196:199], a[176:179], v[0:3]
  ds_read_b64_tr_b16 v[212:213], v226 offset:40960
  v_mfma_f32_16x16x32_bf16 v[32:35], v[196:199], a[180:183], v[32:35]
  ds_read_b64_tr_b16 v[214:215], v226 offset:41984
  v_mfma_f32_16x16x32_bf16 v[32:35], v[192:195], a[164:167], v[32:35]
  buffer_load_dwordx4 v242, s[8:11], s51 offen offset:2048 lds
  v_mfma_f32_16x16x32_bf16 v[64:67], v[192:195], a[168:171], v[64:67]
  v_mfma_f32_16x16x32_bf16 v[64:67], v[196:199], a[184:187], v[64:67]
  v_mfma_f32_16x16x32_bf16 v[96:99], v[196:199], a[188:191], v[96:99]
  buffer_load_dwordx4 v243, s[8:11], s51 offen offset:3072 lds
  v_mfma_f32_16x16x32_bf16 v[96:99], v[192:195], a[172:175], v[96:99]
  s_waitcnt lgkmcnt(4)
  ds_read_b64_tr_b16 v[216:217], v227 offset:32768
  s_add_u32 m0, s61, 57344
  v_mfma_f32_16x16x32_bf16 v[4:7], v[200:203], a[160:163], v[4:7]
  s_add_u32 s51, s51, s62
  ds_read_b64_tr_b16 v[218:219], v227 offset:33792
  v_mfma_f32_16x16x32_bf16 v[4:7], v[204:207], a[176:179], v[4:7]
  ds_read_b64_tr_b16 v[220:221], v227 offset:40960
  v_mfma_f32_16x16x32_bf16 v[36:39], v[204:207], a[180:183], v[36:39]
  ds_read_b64_tr_b16 v[222:223], v227 offset:41984
  v_mfma_f32_16x16x32_bf16 v[36:39], v[200:203], a[164:167], v[36:39]
  v_mfma_f32_16x16x32_bf16 v[68:71], v[200:203], a[168:171], v[68:71]
  v_mfma_f32_16x16x32_bf16 v[68:71], v[204:207], a[184:187], v[68:71]
  buffer_load_dwordx4 v244, s[12:15], s51 offen offset:0 lds
  v_mfma_f32_16x16x32_bf16 v[100:103], v[204:207], a[188:191], v[100:103]
  ds_read_b64_tr_b16 v[192:193], v228 offset:32768
  v_mfma_f32_16x16x32_bf16 v[100:103], v[200:203], a[172:175], v[100:103]
  s_waitcnt lgkmcnt(5)
  ds_read_b64_tr_b16 v[194:195], v228 offset:33792
  v_mfma_f32_16x16x32_bf16 v[8:11], v[208:211], a[160:163], v[8:11]
  ds_read_b64_tr_b16 v[196:197], v228 offset:40960
  v_mfma_f32_16x16x32_bf16 v[8:11], v[212:215], a[176:179], v[8:11]
  ds_read_b64_tr_b16 v[198:199], v228 offset:41984
  v_mfma_f32_16x16x32_bf16 v[40:43], v[212:215], a[180:183], v[40:43]
  buffer_load_dwordx4 v245, s[12:15], s51 offen offset:1024 lds
  v_mfma_f32_16x16x32_bf16 v[40:43], v[208:211], a[164:167], v[40:43]
  s_add_u32 s52, s54, 7
  s_and_b32 s52, s52, 7
  s_lshl_b32 s52, s52, 7
  v_mfma_f32_16x16x32_bf16 v[72:75], v[208:211], a[168:171], v[72:75]
  s_add_u32 m0, s60, 32768
  v_mfma_f32_16x16x32_bf16 v[72:75], v[212:215], a[184:187], v[72:75]
  v_mfma_f32_16x16x32_bf16 v[104:107], v[212:215], a[188:191], v[104:107]
  ds_read_b64_tr_b16 v[200:201], v229 offset:32768
  v_mfma_f32_16x16x32_bf16 v[104:107], v[208:211], a[172:175], v[104:107]
  s_waitcnt lgkmcnt(5)
  ds_read_b64_tr_b16 v[202:203], v229 offset:33792
  v_mfma_f32_16x16x32_bf16 v[12:15], v[216:219], a[160:163], v[12:15]
  ds_read_b64_tr_b16 v[204:205], v229 offset:40960
  v_mfma_f32_16x16x32_bf16 v[12:15], v[220:223], a[176:179], v[12:15]
  ds_read_b64_tr_b16 v[206:207], v229 offset:41984
  v_mfma_f32_16x16x32_bf16 v[44:47], v[220:223], a[180:183], v[44:47]
  v_mfma_f32_16x16x32_bf16 v[44:47], v[216:219], a[164:167], v[44:47]
  v_mfma_f32_16x16x32_bf16 v[76:79], v[216:219], a[168:171], v[76:79]
  buffer_load_dwordx4 v238, s[4:7], s52 offen offset:0 lds
  v_mfma_f32_16x16x32_bf16 v[76:79], v[220:223], a[184:187], v[76:79]
  v_mfma_f32_16x16x32_bf16 v[108:111], v[220:223], a[188:191], v[108:111]
  ds_read_b64_tr_b16 v[208:209], v230 offset:32768
  v_mfma_f32_16x16x32_bf16 v[108:111], v[216:219], a[172:175], v[108:111]
  s_waitcnt lgkmcnt(5)
  ds_read_b64_tr_b16 v[210:211], v230 offset:33792
  v_mfma_f32_16x16x32_bf16 v[16:19], v[192:195], a[160:163], v[16:19]
  buffer_load_dwordx4 v239, s[4:7], s52 offen offset:1024 lds
  v_mfma_f32_16x16x32_bf16 v[16:19], v[196:199], a[176:179], v[16:19]
  s_add_u32 s52, s52, 16384
  ds_read_b64_tr_b16 v[212:213], v230 offset:40960
  s_add_u32 m0, s60, 34816
  v_mfma_f32_16x16x32_bf16 v[48:51], v[196:199], a[180:183], v[48:51]
  ds_read_b64_tr_b16 v[214:215], v230 offset:41984
  v_mfma_f32_16x16x32_bf16 v[48:51], v[192:195], a[164:167], v[48:51]
  v_mfma_f32_16x16x32_bf16 v[80:83], v[192:195], a[168:171], v[80:83]
  v_mfma_f32_16x16x32_bf16 v[80:83], v[196:199], a[184:187], v[80:83]
  v_mfma_f32_16x16x32_bf16 v[112:115], v[196:199], a[188:191], v[112:115]
  buffer_load_dwordx4 v238, s[4:7], s52 offen offset:0 lds
  v_mfma_f32_16x16x32_bf16 v[112:115], v[192:195], a[172:175], v[112:115]
  s_waitcnt lgkmcnt(4)
  ds_read_b64_tr_b16 v[216:217], v231 offset:32768
  v_mfma_f32_16x16x32_bf16 v[20:23], v[200:203], a[160:163], v[20:23]
  ds_read_b64_tr_b16 v[218:219], v231 offset:33792
  v_mfma_f32_16x16x32_bf16 v[20:23], v[204:207], a[176:179], v[20:23]
  ds_read_b64_tr_b16 v[220:221], v231 offset:40960
  v_mfma_f32_16x16x32_bf16 v[52:55], v[204:207], a[180:183], v[52:55]
  ds_read_b64_tr_b16 v[222:223], v231 offset:41984
  v_mfma_f32_16x16x32_bf16 v[52:55], v[200:203], a[164:167], v[52:55]
  buffer_load_dwordx4 v239, s[4:7], s52 offen offset:1024 lds
  v_mfma_f32_16x16x32_bf16 v[84:87], v[200:203], a[168:171], v[84:87]
  s_add_u32 s52, s52, 16384
  s_add_u32 m0, s60, 36864
  v_mfma_f32_16x16x32_bf16 v[84:87], v[204:207], a[184:187], v[84:87]
  v_mfma_f32_16x16x32_bf16 v[116:119], v[204:207], a[188:191], v[116:119]
  ds_read_b64_tr_b16 v[192:193], v232 offset:49152
  v_mfma_f32_16x16x32_bf16 v[116:119], v[200:203], a[172:175], v[116:119]
  s_waitcnt lgkmcnt(5)
  ds_read_b64_tr_b16 v[194:195], v232 offset:49664
  v_mfma_f32_16x16x32_bf16 v[24:27], v[208:211], a[160:163], v[24:27]
  ds_read_b64_tr_b16 v[196:197], v232 offset:53248
  v_mfma_f32_16x16x32_bf16 v[24:27], v[212:215], a[176:179], v[24:27]
  ds_read_b64_tr_b16 v[198:199], v232 offset:53760
  v_mfma_f32_16x16x32_bf16 v[56:59], v[212:215], a[180:183], v[56:59]
  buffer_load_dwordx4 v238, s[4:7], s52 offen offset:0 lds
  v_mfma_f32_16x16x32_bf16 v[56:59], v[208:211], a[164:167], v[56:59]
  v_mfma_f32_16x16x32_bf16 v[88:91], v[208:211], a[168:171], v[88:91]
  s_waitcnt vmcnt(11)
  ds_read_b128 a[192:195], v236 offset:0
  v_mfma_f32_16x16x32_bf16 v[88:91], v[212:215], a[184:187], v[88:91]
  buffer_load_dwordx4 v239, s[4:7], s52 offen offset:1024 lds
  v_mfma_f32_16x16x32_bf16 v[120:123], v[212:215], a[188:191], v[120:123]
  s_add_u32 s52, s52, 16384
  ds_read_b64_tr_b16 v[200:201], v233 offset:49152
  s_add_u32 m0, s60, 38912
  v_mfma_f32_16x16x32_bf16 v[120:123], v[208:211], a[172:175], v[120:123]
  s_waitcnt lgkmcnt(6)
  ds_read_b64_tr_b16 v[202:203], v233 offset:49664
  v_mfma_f32_16x16x32_bf16 v[28:31], v[216:219], a[160:163], v[28:31]
  ds_read_b64_tr_b16 v[204:205], v233 offset:53248
  v_mfma_f32_16x16x32_bf16 v[28:31], v[220:223], a[176:179], v[28:31]
  ds_read_b64_tr_b16 v[206:207], v233 offset:53760
  v_mfma_f32_16x16x32_bf16 v[60:63], v[220:223], a[180:183], v[60:63]
  ds_read_b128 a[196:199], v236 offset:2048
  v_mfma_f32_16x16x32_bf16 v[60:63], v[216:219], a[164:167], v[60:63]
  v_mfma_f32_16x16x32_bf16 v[92:95], v[216:219], a[168:171], v[92:95]
  buffer_load_dwordx4 v238, s[4:7], s52 offen offset:0 lds
  v_mfma_f32_16x16x32_bf16 v[92:95], v[220:223], a[184:187], v[92:95]
  ds_read_b128 a[200:203], v236 offset:4096
  v_mfma_f32_16x16x32_bf16 v[124:127], v[220:223], a[188:191], v[124:127]
  ds_read_b64_tr_b16 v[208:209], v234 offset:49152
  v_mfma_f32_16x16x32_bf16 v[124:127], v[216:219], a[172:175], v[124:127]
  s_waitcnt lgkmcnt(8)
  ds_read_b64_tr_b16 v[210:211], v234 offset:49664
  v_mfma_f32_16x16x32_bf16 v[128:131], a[160:163], v[192:195], v[128:131]
  buffer_load_dwordx4 v239, s[4:7], s52 offen offset:1024 lds
  v_mfma_f32_16x16x32_bf16 v[128:131], a[176:179], v[196:199], v[128:131]
  ds_read_b64_tr_b16 v[212:213], v234 offset:53248
  v_mfma_f32_16x16x32_bf16 v[132:135], a[180:183], v[196:199], v[132:135]
  ds_read_b64_tr_b16 v[214:215], v234 offset:53760
  v_mfma_f32_16x16x32_bf16 v[132:135], a[164:167], v[192:195], v[132:135]
  ds_read_b128 a[204:207], v236 offset:6144
  v_mfma_f32_16x16x32_bf16 v[136:139], a[168:171], v[192:195], v[136:139]
  ds_read_b128 a[208:211], v237 offset:0
  v_mfma_f32_16x16x32_bf16 v[136:139], a[184:187], v[196:199], v[136:139]
  v_mfma_f32_16x16x32_bf16 v[140:143], a[188:191], v[196:199], v[140:143]
  ds_read_b64_tr_b16 v[216:217], v235 offset:49152
  v_mfma_f32_16x16x32_bf16 v[140:143], a[172:175], v[192:195], v[140:143]
  s_waitcnt lgkmcnt(9)
  ds_read_b64_tr_b16 v[218:219], v235 offset:49664
  v_mfma_f32_16x16x32_bf16 v[144:147], a[160:163], v[200:203], v[144:147]
  ds_read_b64_tr_b16 v[220:221], v235 offset:53248
  v_mfma_f32_16x16x32_bf16 v[144:147], a[176:179], v[204:207], v[144:147]
  ds_read_b64_tr_b16 v[222:223], v235 offset:53760
  v_mfma_f32_16x16x32_bf16 v[148:151], a[180:183], v[204:207], v[148:151]
  ds_read_b128 a[212:215], v237 offset:2048
  v_mfma_f32_16x16x32_bf16 v[148:151], a[164:167], v[200:203], v[148:151]
  v_mfma_f32_16x16x32_bf16 v[152:155], a[168:171], v[200:203], v[152:155]
  ds_read_b128 a[216:219], v237 offset:4096
  v_mfma_f32_16x16x32_bf16 v[152:155], a[184:187], v[204:207], v[152:155]
  v_mfma_f32_16x16x32_bf16 v[156:159], a[188:191], v[204:207], v[156:159]
  v_mfma_f32_16x16x32_bf16 v[156:159], a[172:175], v[200:203], v[156:159]
  s_waitcnt lgkmcnt(8)
  v_mfma_f32_16x16x32_bf16 v[160:163], a[160:163], v[208:211], v[160:163]
  ds_read_b128 a[220:223], v237 offset:6144
  v_mfma_f32_16x16x32_bf16 v[160:163], a[176:179], v[212:215], v[160:163]
  v_mfma_f32_16x16x32_bf16 v[164:167], a[180:183], v[212:215], v[164:167]
  v_mfma_f32_16x16x32_bf16 v[164:167], a[164:167], v[208:211], v[164:167]
  s_waitcnt lgkmcnt(0)
  s_barrier
  v_mfma_f32_16x16x32_bf16 v[168:171], a[168:171], v[208:211], v[168:171]
  s_add_u32 m0, s50, 32768
  ds_read_b64_tr_b16 v[192:193], v224 offset:0
  s_add_u32 s51, s55, 2
  v_mfma_f32_16x16x32_bf16 v[168:171], a[184:187], v[212:215], v[168:171]
  s_and_b32 s51, s51, 7
  ds_read_b64_tr_b16 v[194:195], v224 offset:1024
  v_mfma_f32_16x16x32_bf16 v[172:175], a[188:191], v[212:215], v[172:175]
  s_lshl_b32 s51, s51, 19
  ds_read_b64_tr_b16 v[196:197], v224 offset:8192
  v_mfma_f32_16x16x32_bf16 v[172:175], a[172:175], v[208:211], v[172:175]
  ds_read_b64_tr_b16 v[198:199], v224 offset:9216
  v_mfma_f32_16x16x32_bf16 v[176:179], a[160:163], v[216:219], v[176:179]
  ds_read_b64_tr_b16 v[200:201], v225 offset:0
  v_mfma_f32_16x16x32_bf16 v[176:179], a[176:179], v[220:223], v[176:179]
  s_add_u32 s51, s51, s58
  ds_read_b64_tr_b16 v[202:203], v225 offset:1024
  v_mfma_f32_16x16x32_bf16 v[180:183], a[180:183], v[220:223], v[180:183]
  ds_read_b64_tr_b16 v[204:205], v225 offset:8192
  v_mfma_f32_16x16x32_bf16 v[180:183], a[164:167], v[216:219], v[180:183]
  ds_read_b64_tr_b16 v[206:207], v225 offset:9216
  v_mfma_f32_16x16x32_bf16 v[184:187], a[168:171], v[216:219], v[184:187]
  s_add_u32 s51, s51, 128
  v_mfma_f32_16x16x32_bf16 v[184:187], a[184:187], v[220:223], v[184:187]
  v_mfma_f32_16x16x32_bf16 v[188:191], a[188:191], v[220:223], v[188:191]
  ds_read_b64_tr_b16 v[208:209], v226 offset:0
  v_mfma_f32_16x16x32_bf16 v[188:191], a[172:175], v[216:219], v[188:191]
  s_waitcnt lgkmcnt(5)
  ds_read_b64_tr_b16 v[210:211], v226 offset:1024
  v_mfma_f32_16x16x32_bf16 v[0:3], v[192:195], a[192:195], v[0:3]
  ds_read_b64_tr_b16 v[212:213], v226 offset:8192
  v_mfma_f32_16x16x32_bf16 v[0:3], v[196:199], a[208:211], v[0:3]
  ds_read_b64_tr_b16 v[214:215], v226 offset:9216
  v_mfma_f32_16x16x32_bf16 v[32:35], v[196:199], a[212:215], v[32:35]
  v_mfma_f32_16x16x32_bf16 v[32:35], v[192:195], a[196:199], v[32:35]
  v_mfma_f32_16x16x32_bf16 v[64:67], v[192:195], a[200:203], v[64:67]
  v_mfma_f32_16x16x32_bf16 v[64:67], v[196:199], a[216:219], v[64:67]
  buffer_load_dwordx4 v244, s[12:15], s51 offen offset:0 lds
  v_mfma_f32_16x16x32_bf16 v[96:99], v[196:199], a[220:223], v[96:99]
  ds_read_b64_tr_b16 v[216:217], v227 offset:0
  v_mfma_f32_16x16x32_bf16 v[96:99], v[192:195], a[204:207], v[96:99]
  s_waitcnt lgkmcnt(5)
  ds_read_b64_tr_b16 v[218:219], v227 offset:1024
  v_mfma_f32_16x16x32_bf16 v[4:7], v[200:203], a[192:195], v[4:7]
  s_mov_b32 s32, s84
  ds_read_b64_tr_b16 v[220:221], v227 offset:8192
  v_mfma_f32_16x16x32_bf16 v[4:7], v[204:207], a[208:211], v[4:7]
  ds_read_b64_tr_b16 v[222:223], v227 offset:9216
  v_mfma_f32_16x16x32_bf16 v[36:39], v[204:207], a[212:215], v[36:39]
  s_mov_b32 s33, s85
  buffer_load_dwordx4 v245, s[12:15], s51 offen offset:1024 lds
  v_mfma_f32_16x16x32_bf16 v[36:39], v[200:203], a[196:199], v[36:39]
  v_mfma_f32_16x16x32_bf16 v[68:71], v[200:203], a[200:203], v[68:71]
  v_mfma_f32_16x16x32_bf16 v[68:71], v[204:207], a[216:219], v[68:71]
  s_mov_b32 s34, 2621440
  v_mfma_f32_16x16x32_bf16 v[100:103], v[204:207], a[220:223], v[100:103]
  ds_read_b64_tr_b16 v[192:193], v228 offset:0
  v_mfma_f32_16x16x32_bf16 v[100:103], v[200:203], a[204:207], v[100:103]
  s_waitcnt lgkmcnt(5)
  ds_read_b64_tr_b16 v[194:195], v228 offset:1024
  v_mfma_f32_16x16x32_bf16 v[8:11], v[208:211], a[192:195], v[8:11]
  s_mov_b32 s35, 0x20000
  buffer_load_dwordx4 v246, s[12:15], s51 offen offset:2048 lds
  v_mfma_f32_16x16x32_bf16 v[8:11], v[212:215], a[208:211], v[8:11]
  ds_read_b64_tr_b16 v[196:197], v228 offset:8192
  v_mfma_f32_16x16x32_bf16 v[40:43], v[212:215], a[212:215], v[40:43]
  ds_read_b64_tr_b16 v[198:199], v228 offset:9216
  v_mfma_f32_16x16x32_bf16 v[40:43], v[208:211], a[196:199], v[40:43]
  s_getpc_b64 s[80:81]
recurrent_scan__compressed_kv_cla__dense_activation_silu__prompt_kernel_cp0:
  s_add_u32 s80, s80, recurrent_scan__compressed_kv_cla__dense_activation_silu__prompt_kernel_g2-recurrent_scan__compressed_kv_cla__dense_activation_silu__prompt_kernel_cp0
  s_addc_u32 s81, s81, 0
  v_mfma_f32_16x16x32_bf16 v[72:75], v[208:211], a[200:203], v[72:75]
  v_mfma_f32_16x16x32_bf16 v[72:75], v[212:215], a[216:219], v[72:75]
  v_mfma_f32_16x16x32_bf16 v[104:107], v[212:215], a[220:223], v[104:107]
  buffer_load_dwordx4 v247, s[12:15], s51 offen offset:3072 lds
  v_mfma_f32_16x16x32_bf16 v[104:107], v[208:211], a[204:207], v[104:107]
  s_waitcnt lgkmcnt(4)
  ds_read_b64_tr_b16 v[200:201], v229 offset:0
  s_add_u32 m0, s50, 139264
  v_mfma_f32_16x16x32_bf16 v[12:15], v[216:219], a[192:195], v[12:15]
  s_add_u32 s51, s55, 0
  ds_read_b64_tr_b16 v[202:203], v229 offset:1024
  v_mfma_f32_16x16x32_bf16 v[12:15], v[220:223], a[208:211], v[12:15]
  ds_read_b64_tr_b16 v[204:205], v229 offset:8192
  v_mfma_f32_16x16x32_bf16 v[44:47], v[220:223], a[212:215], v[44:47]
  ds_read_b64_tr_b16 v[206:207], v229 offset:9216
  v_mfma_f32_16x16x32_bf16 v[44:47], v[216:219], a[196:199], v[44:47]
  s_and_b32 s51, s51, 7
  v_mfma_f32_16x16x32_bf16 v[76:79], v[216:219], a[200:203], v[76:79]
  s_lshr_b32 s48, s2, 3
  v_mfma_f32_16x16x32_bf16 v[76:79], v[220:223], a[216:219], v[76:79]
  v_mfma_f32_16x16x32_bf16 v[108:111], v[220:223], a[220:223], v[108:111]
  s_lshl_b32 s51, s51, 19
  ds_read_b64_tr_b16 v[208:209], v230 offset:0
  v_mfma_f32_16x16x32_bf16 v[108:111], v[216:219], a[204:207], v[108:111]
  s_waitcnt lgkmcnt(5)
  ds_read_b64_tr_b16 v[210:211], v230 offset:1024
  s_lshl_b32 s48, s48, 2
  v_mfma_f32_16x16x32_bf16 v[16:19], v[192:195], a[192:195], v[16:19]
  ds_read_b64_tr_b16 v[212:213], v230 offset:8192
  v_mfma_f32_16x16x32_bf16 v[16:19], v[196:199], a[208:211], v[16:19]
  s_add_u32 s51, s51, s58
  ds_read_b64_tr_b16 v[214:215], v230 offset:9216
  v_mfma_f32_16x16x32_bf16 v[48:51], v[196:199], a[212:215], v[48:51]
  s_add_u32 s48, s48, s3
  v_mfma_f32_16x16x32_bf16 v[48:51], v[192:195], a[196:199], v[48:51]
  v_mfma_f32_16x16x32_bf16 v[80:83], v[192:195], a[200:203], v[80:83]
  s_add_u32 s51, s51, 128
  v_mfma_f32_16x16x32_bf16 v[80:83], v[196:199], a[216:219], v[80:83]
  s_mul_i32 s48, s48, 256
  v_mfma_f32_16x16x32_bf16 v[112:115], v[196:199], a[220:223], v[112:115]
  ds_read_b64_tr_b16 v[216:217], v231 offset:0
  v_mfma_f32_16x16x32_bf16 v[112:115], v[192:195], a[204:207], v[112:115]
  s_waitcnt lgkmcnt(5)
  ds_read_b64_tr_b16 v[218:219], v231 offset:1024
  v_mfma_f32_16x16x32_bf16 v[20:23], v[200:203], a[192:195], v[20:23]
  ds_read_b64_tr_b16 v[220:221], v231 offset:8192
  v_mfma_f32_16x16x32_bf16 v[20:23], v[204:207], a[208:211], v[20:23]
  ds_read_b64_tr_b16 v[222:223], v231 offset:9216
  v_mfma_f32_16x16x32_bf16 v[52:55], v[204:207], a[212:215], v[52:55]
  v_mfma_f32_16x16x32_bf16 v[52:55], v[200:203], a[196:199], v[52:55]
  v_mfma_f32_16x16x32_bf16 v[84:87], v[200:203], a[200:203], v[84:87]
  v_mfma_f32_16x16x32_bf16 v[84:87], v[204:207], a[216:219], v[84:87]
  buffer_load_dwordx4 v244, s[12:15], s51 offen offset:0 lds
  v_mfma_f32_16x16x32_bf16 v[116:119], v[204:207], a[220:223], v[116:119]
  ds_read_b64_tr_b16 v[192:193], v232 offset:32768
  v_and_b32 v251, 1, v249
  v_mfma_f32_16x16x32_bf16 v[116:119], v[200:203], a[204:207], v[116:119]
  s_waitcnt lgkmcnt(5)
  ds_read_b64_tr_b16 v[194:195], v232 offset:33280
  v_mfma_f32_16x16x32_bf16 v[24:27], v[208:211], a[192:195], v[24:27]
  ds_read_b64_tr_b16 v[196:197], v232 offset:36864
  v_mfma_f32_16x16x32_bf16 v[24:27], v[212:215], a[208:211], v[24:27]
  ds_read_b64_tr_b16 v[198:199], v232 offset:37376
  v_lshlrev_b32 v251, 7, v251
  v_mfma_f32_16x16x32_bf16 v[56:59], v[212:215], a[212:215], v[56:59]
  buffer_load_dwordx4 v245, s[12:15], s51 offen offset:1024 lds
  v_mfma_f32_16x16x32_bf16 v[56:59], v[208:211], a[196:199], v[56:59]
  v_mfma_f32_16x16x32_bf16 v[88:91], v[208:211], a[200:203], v[88:91]
  s_waitcnt vmcnt(6)
  ds_read_b128 a[224:227], v236 offset:32768
  v_add_u32 v251, s48, v251
  v_mfma_f32_16x16x32_bf16 v[88:91], v[212:215], a[216:219], v[88:91]
  v_mfma_f32_16x16x32_bf16 v[120:123], v[212:215], a[220:223], v[120:123]
  ds_read_b64_tr_b16 v[200:201], v233 offset:32768
  v_mfma_f32_16x16x32_bf16 v[120:123], v[208:211], a[204:207], v[120:123]
  s_waitcnt lgkmcnt(6)
  ds_read_b64_tr_b16 v[202:203], v233 offset:33280
  v_min_u32 v251, recurrent_scan__compressed_kv_cla__dense_activation_silu__prompt_kernel_last-recurrent_scan__compressed_kv_cla__dense_activation_silu__prompt_kernel_g2, v251
  v_mfma_f32_16x16x32_bf16 v[28:31], v[216:219], a[192:195], v[28:31]
  buffer_load_dwordx4 v246, s[12:15], s51 offen offset:2048 lds
  v_mfma_f32_16x16x32_bf16 v[28:31], v[220:223], a[208:211], v[28:31]
  ds_read_b64_tr_b16 v[204:205], v233 offset:36864
  v_mfma_f32_16x16x32_bf16 v[60:63], v[220:223], a[212:215], v[60:63]
  ds_read_b64_tr_b16 v[206:207], v233 offset:37376
  v_mfma_f32_16x16x32_bf16 v[60:63], v[216:219], a[196:199], v[60:63]
  ds_read_b128 a[228:231], v236 offset:34816
  v_mfma_f32_16x16x32_bf16 v[92:95], v[216:219], a[200:203], v[92:95]
  global_load_dword v252, v251, s[80:81]
  v_mfma_f32_16x16x32_bf16 v[92:95], v[220:223], a[216:219], v[92:95]
  ds_read_b128 a[232:235], v236 offset:36864
  v_mfma_f32_16x16x32_bf16 v[124:127], v[220:223], a[220:223], v[124:127]
  buffer_load_dwordx4 v247, s[12:15], s51 offen offset:3072 lds
  v_mfma_f32_16x16x32_bf16 v[124:127], v[216:219], a[204:207], v[124:127]
  s_waitcnt lgkmcnt(7)
  ds_read_b64_tr_b16 v[208:209], v234 offset:32768
  v_mfma_f32_16x16x32_bf16 v[128:131], a[192:195], v[192:195], v[128:131]
  ds_read_b64_tr_b16 v[210:211], v234 offset:33280
  v_mfma_f32_16x16x32_bf16 v[128:131], a[208:211], v[196:199], v[128:131]
  ds_read_b64_tr_b16 v[212:213], v234 offset:36864
  v_mfma_f32_16x16x32_bf16 v[132:135], a[212:215], v[196:199], v[132:135]
  ds_read_b64_tr_b16 v[214:215], v234 offset:37376
  v_mfma_f32_16x16x32_bf16 v[132:135], a[196:199], v[192:195], v[132:135]
  ds_read_b128 a[236:239], v236 offset:38912
  v_mfma_f32_16x16x32_bf16 v[136:139], a[200:203], v[192:195], v[136:139]
  ds_read_b128 a[240:243], v237 offset:32768
  v_mfma_f32_16x16x32_bf16 v[136:139], a[216:219], v[196:199], v[136:139]
  v_mfma_f32_16x16x32_bf16 v[140:143], a[220:223], v[196:199], v[140:143]
  ds_read_b64_tr_b16 v[216:217], v235 offset:32768
  v_mfma_f32_16x16x32_bf16 v[140:143], a[204:207], v[192:195], v[140:143]
  s_waitcnt lgkmcnt(9)
  ds_read_b64_tr_b16 v[218:219], v235 offset:33280
  v_mfma_f32_16x16x32_bf16 v[144:147], a[192:195], v[200:203], v[144:147]
  ds_read_b64_tr_b16 v[220:221], v235 offset:36864
  v_mfma_f32_16x16x32_bf16 v[144:147], a[208:211], v[204:207], v[144:147]
  ds_read_b64_tr_b16 v[222:223], v235 offset:37376
  v_mfma_f32_16x16x32_bf16 v[148:151], a[212:215], v[204:207], v[148:151]
  ds_read_b128 a[244:247], v237 offset:34816
  v_mfma_f32_16x16x32_bf16 v[148:151], a[196:199], v[200:203], v[148:151]
  v_mfma_f32_16x16x32_bf16 v[152:155], a[200:203], v[200:203], v[152:155]
  ds_read_b128 a[248:251], v237 offset:36864
  v_mfma_f32_16x16x32_bf16 v[152:155], a[216:219], v[204:207], v[152:155]
  v_mfma_f32_16x16x32_bf16 v[156:159], a[220:223], v[204:207], v[156:159]
  v_mfma_f32_16x16x32_bf16 v[156:159], a[204:207], v[200:203], v[156:159]
  s_waitcnt lgkmcnt(8)
  v_mfma_f32_16x16x32_bf16 v[160:163], a[192:195], v[208:211], v[160:163]
  ds_read_b128 a[252:255], v237 offset:38912
  v_mfma_f32_16x16x32_bf16 v[160:163], a[208:211], v[212:215], v[160:163]
  v_mfma_f32_16x16x32_bf16 v[164:167], a[212:215], v[212:215], v[164:167]
  v_mfma_f32_16x16x32_bf16 v[164:167], a[196:199], v[208:211], v[164:167]
  s_waitcnt lgkmcnt(0)
  s_barrier
  v_mfma_f32_16x16x32_bf16 v[168:171], a[200:203], v[208:211], v[168:171]
  s_add_u32 m0, s50, 73728
  ds_read_b64_tr_b16 v[192:193], v224 offset:16384
  s_add_u32 s51, s55, 4
  v_mfma_f32_16x16x32_bf16 v[168:171], a[216:219], v[212:215], v[168:171]
  s_and_b32 s51, s51, 7
  ds_read_b64_tr_b16 v[194:195], v224 offset:17408
  s_lshl_b32 s51, s51, 19
  v_mfma_f32_16x16x32_bf16 v[172:175], a[220:223], v[212:215], v[172:175]
  s_add_u32 s51, s51, s58
  ds_read_b64_tr_b16 v[196:197], v224 offset:24576
  s_add_u32 s51, s51, 128
  v_mfma_f32_16x16x32_bf16 v[172:175], a[204:207], v[208:211], v[172:175]
  ds_read_b64_tr_b16 v[198:199], v224 offset:25600
  v_mfma_f32_16x16x32_bf16 v[176:179], a[192:195], v[216:219], v[176:179]
  ds_read_b64_tr_b16 v[200:201], v225 offset:16384
  v_mfma_f32_16x16x32_bf16 v[176:179], a[208:211], v[220:223], v[176:179]
  ds_read_b64_tr_b16 v[202:203], v225 offset:17408
  v_mfma_f32_16x16x32_bf16 v[180:183], a[212:215], v[220:223], v[180:183]
  ds_read_b64_tr_b16 v[204:205], v225 offset:24576
  v_mfma_f32_16x16x32_bf16 v[180:183], a[196:199], v[216:219], v[180:183]
  ds_read_b64_tr_b16 v[206:207], v225 offset:25600
  v_mfma_f32_16x16x32_bf16 v[184:187], a[200:203], v[216:219], v[184:187]
  buffer_load_dwordx4 v244, s[12:15], s51 offen offset:0 lds
  v_mfma_f32_16x16x32_bf16 v[184:187], a[216:219], v[220:223], v[184:187]
  v_mfma_f32_16x16x32_bf16 v[188:191], a[220:223], v[220:223], v[188:191]
  s_lshl_b32 s48, s45, 3
  buffer_load_dwordx4 v245, s[12:15], s51 offen offset:1024 lds
  v_mfma_f32_16x16x32_bf16 v[188:191], a[204:207], v[216:219], v[188:191]
  s_waitcnt lgkmcnt(4)
  ds_read_b64_tr_b16 v[208:209], v226 offset:16384
  s_add_u32 s88, s48, s3
  v_mfma_f32_16x16x32_bf16 v[0:3], v[192:195], a[224:227], v[0:3]
  s_sub_u32 s89, s48, s3
  ds_read_b64_tr_b16 v[210:211], v226 offset:17408
  s_add_u32 s89, s89, 7
  v_mfma_f32_16x16x32_bf16 v[0:3], v[196:199], a[240:243], v[0:3]
  s_sub_u32 s48, 120, s48
  buffer_load_dwordx4 v246, s[12:15], s51 offen offset:2048 lds
  v_mfma_f32_16x16x32_bf16 v[32:35], v[196:199], a[244:247], v[32:35]
  s_add_u32 s90, s48, s3
  ds_read_b64_tr_b16 v[212:213], v226 offset:24576
  v_mfma_f32_16x16x32_bf16 v[32:35], v[192:195], a[228:231], v[32:35]
  ds_read_b64_tr_b16 v[214:215], v226 offset:25600
  v_mfma_f32_16x16x32_bf16 v[64:67], v[192:195], a[232:235], v[64:67]
  s_sub_u32 s91, s48, s3
  buffer_load_dwordx4 v247, s[12:15], s51 offen offset:3072 lds
  v_mfma_f32_16x16x32_bf16 v[64:67], v[196:199], a[248:251], v[64:67]
  s_add_u32 m0, s50, 90112
  s_add_u32 s51, s55, 6
  s_and_b32 s51, s51, 7
  v_mfma_f32_16x16x32_bf16 v[96:99], v[196:199], a[252:255], v[96:99]
  s_lshl_b32 s51, s51, 19
  ds_read_b64_tr_b16 v[216:217], v227 offset:16384
  s_add_u32 s51, s51, s58
  v_mfma_f32_16x16x32_bf16 v[96:99], v[192:195], a[236:239], v[96:99]
  s_waitcnt lgkmcnt(5)
  ds_read_b64_tr_b16 v[218:219], v227 offset:17408
  s_add_u32 s51, s51, 128
  v_mfma_f32_16x16x32_bf16 v[4:7], v[200:203], a[224:227], v[4:7]
  s_add_u32 s91, s91, 7
  ds_read_b64_tr_b16 v[220:221], v227 offset:24576
  s_mul_i32 s62, s3, 3072
  v_mfma_f32_16x16x32_bf16 v[4:7], v[204:207], a[240:243], v[4:7]
  s_add_u32 s62, s62, 65536
  ds_read_b64_tr_b16 v[222:223], v227 offset:25600
  v_mfma_f32_16x16x32_bf16 v[36:39], v[204:207], a[244:247], v[36:39]
  v_mfma_f32_16x16x32_bf16 v[36:39], v[200:203], a[228:231], v[36:39]
  s_add_u32 s60, s50, 65536
  v_mfma_f32_16x16x32_bf16 v[68:71], v[200:203], a[232:235], v[68:71]
  v_mfma_f32_16x16x32_bf16 v[68:71], v[204:207], a[248:251], v[68:71]
  s_mul_i32 s48, s88, 20480
  buffer_load_dwordx4 v244, s[12:15], s51 offen offset:0 lds
  v_mfma_f32_16x16x32_bf16 v[100:103], v[204:207], a[252:255], v[100:103]
  ds_read_b64_tr_b16 v[192:193], v228 offset:16384
  v_mfma_f32_16x16x32_bf16 v[100:103], v[200:203], a[236:239], v[100:103]
  s_waitcnt lgkmcnt(5)
  ds_read_b64_tr_b16 v[194:195], v228 offset:17408
  v_mfma_f32_16x16x32_bf16 v[8:11], v[208:211], a[224:227], v[8:11]
  buffer_load_dwordx4 v245, s[12:15], s51 offen offset:1024 lds
  v_mfma_f32_16x16x32_bf16 v[8:11], v[212:215], a[240:243], v[8:11]
  ds_read_b64_tr_b16 v[196:197], v228 offset:24576
  v_mfma_f32_16x16x32_bf16 v[40:43], v[212:215], a[244:247], v[40:43]
  ds_read_b64_tr_b16 v[198:199], v228 offset:25600
  v_mfma_f32_16x16x32_bf16 v[40:43], v[208:211], a[228:231], v[40:43]
  buffer_load_dwordx4 v246, s[12:15], s51 offen offset:2048 lds
  v_mfma_f32_16x16x32_bf16 v[72:75], v[208:211], a[232:235], v[72:75]
  v_cvt_pk_bf16_f32 v0, v0, v1
  v_add_u32 v236, s48, v248
  v_mfma_f32_16x16x32_bf16 v[72:75], v[212:215], a[248:251], v[72:75]
  s_mul_i32 s48, s89, 20480
  buffer_load_dwordx4 v247, s[12:15], s51 offen offset:3072 lds
  v_mfma_f32_16x16x32_bf16 v[104:107], v[212:215], a[252:255], v[104:107]
  ds_read_b64_tr_b16 v[200:201], v229 offset:16384
  v_cvt_pk_bf16_f32 v1, v2, v3
  v_mfma_f32_16x16x32_bf16 v[104:107], v[208:211], a[236:239], v[104:107]
  s_waitcnt lgkmcnt(5)
  ds_read_b64_tr_b16 v[202:203], v229 offset:17408
  v_cvt_pk_bf16_f32 v2, v4, v5
  v_mfma_f32_16x16x32_bf16 v[12:15], v[216:219], a[224:227], v[12:15]
  ds_read_b64_tr_b16 v[204:205], v229 offset:24576
  v_cvt_pk_bf16_f32 v3, v6, v7
  v_mfma_f32_16x16x32_bf16 v[12:15], v[220:223], a[240:243], v[12:15]
  ds_read_b64_tr_b16 v[206:207], v229 offset:25600
  v_add_u32 v237, s48, v248
  v_mfma_f32_16x16x32_bf16 v[44:47], v[220:223], a[244:247], v[44:47]
  s_mul_i32 s48, s90, 20480
  v_cvt_pk_bf16_f32 v32, v32, v33
  v_cvt_pk_bf16_f32 v33, v34, v35
  v_mfma_f32_16x16x32_bf16 v[44:47], v[216:219], a[228:231], v[44:47]
recurrent_scan__compressed_kv_cla__dense_activation_silu__prompt_kernel_g2:
  v_cvt_pk_bf16_f32 v34, v36, v37
  v_add_u32 v238, s48, v248
  v_mfma_f32_16x16x32_bf16 v[76:79], v[216:219], a[232:235], v[76:79]
  s_mul_i32 s48, s91, 20480
  v_cvt_pk_bf16_f32 v35, v38, v39
  v_mfma_f32_16x16x32_bf16 v[76:79], v[220:223], a[248:251], v[76:79]
  v_mfma_f32_16x16x32_bf16 v[108:111], v[220:223], a[252:255], v[108:111]
  ds_read_b64_tr_b16 v[208:209], v230 offset:16384
  v_cvt_pk_bf16_f32 v64, v64, v65
  v_mfma_f32_16x16x32_bf16 v[108:111], v[216:219], a[236:239], v[108:111]
  s_waitcnt lgkmcnt(5)
  ds_read_b64_tr_b16 v[210:211], v230 offset:17408
  v_cvt_pk_bf16_f32 v65, v66, v67
  v_mfma_f32_16x16x32_bf16 v[16:19], v[192:195], a[224:227], v[16:19]
  ds_read_b64_tr_b16 v[212:213], v230 offset:24576
  v_add_u32 v239, s48, v248
  v_mfma_f32_16x16x32_bf16 v[16:19], v[196:199], a[240:243], v[16:19]
  ds_read_b64_tr_b16 v[214:215], v230 offset:25600
  v_cvt_pk_bf16_f32 v66, v68, v69
  v_mfma_f32_16x16x32_bf16 v[48:51], v[196:199], a[244:247], v[48:51]
  v_cvt_pk_bf16_f32 v67, v70, v71
  v_lshrrev_b32 v250, 4, v249
  v_mfma_f32_16x16x32_bf16 v[48:51], v[192:195], a[228:231], v[48:51]
  v_cvt_pk_bf16_f32 v96, v96, v97
  v_and_b32 v251, 15, v249
  v_mfma_f32_16x16x32_bf16 v[80:83], v[192:195], a[232:235], v[80:83]
  s_lshl_b32 s48, s3, 3
  v_and_b32 v243, 1, v249
  v_lshlrev_b32 v243, 7, v243
  v_mfma_f32_16x16x32_bf16 v[80:83], v[196:199], a[248:251], v[80:83]
  buffer_load_dword v247, v243, s[72:75], 0 offen sc1
  v_mfma_f32_16x16x32_bf16 v[112:115], v[196:199], a[252:255], v[112:115]
  v_cvt_pk_bf16_f32 v97, v98, v99
  v_cvt_pk_bf16_f32 v98, v100, v101
  v_mfma_f32_16x16x32_bf16 v[112:115], v[192:195], a[236:239], v[112:115]
  s_waitcnt lgkmcnt(4)
  ds_read_b64_tr_b16 v[216:217], v231 offset:16384
  v_cvt_pk_bf16_f32 v99, v102, v103
  v_mfma_f32_16x16x32_bf16 v[20:23], v[200:203], a[224:227], v[20:23]
  ds_read_b64_tr_b16 v[218:219], v231 offset:17408
  s_waitcnt vmcnt(10)
  v_add_u32 v252, s48, v250
  v_mfma_f32_16x16x32_bf16 v[20:23], v[204:207], a[240:243], v[20:23]
  ds_read_b64_tr_b16 v[220:221], v231 offset:24576
  v_lshlrev_b32 v252, 13, v252
  v_mfma_f32_16x16x32_bf16 v[52:55], v[204:207], a[244:247], v[52:55]
  s_and_b32 s56, s3, 1
  ds_read_b64_tr_b16 v[222:223], v231 offset:25600
  v_add_u32 v228, 114688, v232
  v_mfma_f32_16x16x32_bf16 v[52:55], v[200:203], a[228:231], v[52:55]
  s_lshl_b32 s56, s56, 3
  buffer_store_dwordx4 v[0:3], v248, s[16:19], 0 offen offset:0 sc1
  v_mfma_f32_16x16x32_bf16 v[84:87], v[200:203], a[232:235], v[84:87]
  v_add_u32 v229, 114688, v233
  v_add_u32 v230, 114688, v234
  v_mfma_f32_16x16x32_bf16 v[84:87], v[204:207], a[248:251], v[84:87]
  v_add_u32 v231, 114688, v235
  v_add_u32 v224, 49152, v232
  v_add_u32 v225, 49152, v233
  v_mfma_f32_16x16x32_bf16 v[116:119], v[204:207], a[252:255], v[116:119]
  v_add_u32 v226, 49152, v234
  v_add_u32 v227, 49152, v235
  v_cvt_pk_bf16_f32 v8, v8, v9
  v_mfma_f32_16x16x32_bf16 v[116:119], v[200:203], a[236:239], v[116:119]
  s_waitcnt lgkmcnt(4)
  v_cvt_pk_bf16_f32 v9, v10, v11
  v_cvt_pk_bf16_f32 v10, v12, v13
  v_mfma_f32_16x16x32_bf16 v[24:27], v[208:211], a[224:227], v[24:27]
  v_cvt_pk_bf16_f32 v11, v14, v15
  v_lshl_add_u32 v253, v250, 1, s56
  v_mfma_f32_16x16x32_bf16 v[24:27], v[212:215], a[240:243], v[24:27]
  ds_read_b64_tr_b16 v[192:193], v232 offset:40960
  v_cvt_pk_bf16_f32 v40, v40, v41
  v_mfma_f32_16x16x32_bf16 v[56:59], v[212:215], a[244:247], v[56:59]
  ds_read_b64_tr_b16 v[194:195], v232 offset:41472
  v_xor_b32 v253, v253, v251
  v_mfma_f32_16x16x32_bf16 v[56:59], v[208:211], a[228:231], v[56:59]
  ds_read_b64_tr_b16 v[196:197], v232 offset:45056
  v_cvt_pk_bf16_f32 v41, v42, v43
  v_lshl_add_u32 v240, v253, 4, v252
  v_mfma_f32_16x16x32_bf16 v[88:91], v[208:211], a[232:235], v[88:91]
  ds_read_b64_tr_b16 v[198:199], v232 offset:45568
  v_cvt_pk_bf16_f32 v42, v44, v45
  v_mfma_f32_16x16x32_bf16 v[88:91], v[212:215], a[248:251], v[88:91]
  buffer_store_dwordx4 v[32:35], v248, s[16:19], s64 offen offset:0 sc1
  v_cvt_pk_bf16_f32 v43, v46, v47
  v_mfma_f32_16x16x32_bf16 v[120:123], v[212:215], a[252:255], v[120:123]
  v_cvt_pk_bf16_f32 v72, v72, v73
  v_add_u32 v241, 31744, v240
  v_mfma_f32_16x16x32_bf16 v[120:123], v[208:211], a[236:239], v[120:123]
  s_waitcnt lgkmcnt(4)
  v_cvt_pk_bf16_f32 v73, v74, v75
  v_lshrrev_b32 v252, 3, v249
  v_mfma_f32_16x16x32_bf16 v[28:31], v[216:219], a[224:227], v[28:31]
  ds_read_b64_tr_b16 v[200:201], v233 offset:40960
  v_cvt_pk_bf16_f32 v74, v76, v77
  v_mfma_f32_16x16x32_bf16 v[28:31], v[220:223], a[240:243], v[28:31]
  ds_read_b64_tr_b16 v[202:203], v233 offset:41472
  v_add_u32 v252, s48, v252
  v_mfma_f32_16x16x32_bf16 v[60:63], v[220:223], a[244:247], v[60:63]
  v_cvt_pk_bf16_f32 v75, v78, v79
  v_mul_u32_u24 v252, 3456, v252
  v_mfma_f32_16x16x32_bf16 v[60:63], v[216:219], a[228:231], v[60:63]
  ds_read_b64_tr_b16 v[204:205], v233 offset:45056
  v_cvt_pk_bf16_f32 v104, v104, v105
  v_mfma_f32_16x16x32_bf16 v[92:95], v[216:219], a[232:235], v[92:95]
  ds_read_b64_tr_b16 v[206:207], v233 offset:45568
  v_and_b32 v253, 1, v250
  v_mfma_f32_16x16x32_bf16 v[92:95], v[220:223], a[248:251], v[92:95]
  s_lshr_b32 s56, s56, 1
  buffer_store_dwordx4 v[64:67], v248, s[16:19], s65 offen offset:0 sc1
  v_cvt_pk_bf16_f32 v105, v106, v107
  v_mfma_f32_16x16x32_bf16 v[124:127], v[220:223], a[252:255], v[124:127]
  v_cvt_pk_bf16_f32 v106, v108, v109
  v_cvt_pk_bf16_f32 v107, v110, v111
  v_mfma_f32_16x16x32_bf16 v[124:127], v[216:219], a[236:239], v[124:127]
  s_waitcnt lgkmcnt(4)
  ds_read_b64_tr_b16 v[208:209], v234 offset:40960
  v_lshl_add_u32 v253, v253, 1, s56
  v_mfma_f32_16x16x32_bf16 v[128:131], a[224:227], v[192:195], v[128:131]
  ds_read_b64_tr_b16 v[210:211], v234 offset:41472
  v_and_b32 v254, 7, v249
  v_mfma_f32_16x16x32_bf16 v[128:131], a[240:243], v[196:199], v[128:131]
  ds_read_b64_tr_b16 v[212:213], v234 offset:45056
  v_cvt_pk_bf16_f32 v16, v16, v17
  v_mfma_f32_16x16x32_bf16 v[132:135], a[244:247], v[196:199], v[132:135]
  ds_read_b64_tr_b16 v[214:215], v234 offset:45568
  v_xor_b32 v253, v253, v254
  v_mfma_f32_16x16x32_bf16 v[132:135], a[228:231], v[192:195], v[132:135]
  buffer_store_dwordx4 v[96:99], v248, s[16:19], s66 offen offset:0 sc1
  v_mfma_f32_16x16x32_bf16 v[136:139], a[232:235], v[192:195], v[136:139]
  v_cvt_pk_bf16_f32 v17, v18, v19
  v_cvt_pk_bf16_f32 v18, v20, v21
  v_mfma_f32_16x16x32_bf16 v[136:139], a[248:251], v[196:199], v[136:139]
  v_cvt_pk_bf16_f32 v19, v22, v23
  v_lshl_add_u32 v242, v253, 4, v252
  v_mfma_f32_16x16x32_bf16 v[140:143], a[252:255], v[196:199], v[140:143]
  ds_read_b64_tr_b16 v[216:217], v235 offset:40960
  v_cvt_pk_bf16_f32 v48, v48, v49
  v_mfma_f32_16x16x32_bf16 v[140:143], a[236:239], v[192:195], v[140:143]
  s_waitcnt lgkmcnt(5)
  ds_read_b64_tr_b16 v[218:219], v235 offset:41472
  v_cvt_pk_bf16_f32 v49, v50, v51
  v_mfma_f32_16x16x32_bf16 v[144:147], a[224:227], v[200:203], v[144:147]
  ds_read_b64_tr_b16 v[220:221], v235 offset:45056
  v_cvt_pk_bf16_f32 v50, v52, v53
  v_mfma_f32_16x16x32_bf16 v[144:147], a[240:243], v[204:207], v[144:147]
  ds_read_b64_tr_b16 v[222:223], v235 offset:45568
  v_cvt_pk_bf16_f32 v51, v54, v55
  v_mfma_f32_16x16x32_bf16 v[148:151], a[244:247], v[204:207], v[148:151]
  v_cvt_pk_bf16_f32 v80, v80, v81
  v_add_u32 v244, s50, v248
  v_mfma_f32_16x16x32_bf16 v[148:151], a[228:231], v[200:203], v[148:151]
  s_mul_i32 s58, s45, 5
  v_cvt_pk_bf16_f32 v81, v82, v83
  s_lshr_b32 s58, s58, 1
  v_mfma_f32_16x16x32_bf16 v[152:155], a[232:235], v[200:203], v[152:155]
  s_mov_b32 s59, s58
  v_cvt_pk_bf16_f32 v82, v84, v85
  v_mfma_f32_16x16x32_bf16 v[152:155], a[248:251], v[204:207], v[152:155]
  v_cvt_pk_bf16_f32 v83, v86, v87
  v_mfma_f32_16x16x32_bf16 v[156:159], a[252:255], v[204:207], v[156:159]
  v_mfma_f32_16x16x32_bf16 v[156:159], a[236:239], v[200:203], v[156:159]
  s_waitcnt lgkmcnt(4)
  v_cvt_pk_bf16_f32 v112, v112, v113
  v_mfma_f32_16x16x32_bf16 v[160:163], a[224:227], v[208:211], v[160:163]
  v_cvt_pk_bf16_f32 v113, v114, v115
  v_mfma_f32_16x16x32_bf16 v[160:163], a[240:243], v[212:215], v[160:163]
  v_cvt_pk_bf16_f32 v114, v116, v117
  v_mfma_f32_16x16x32_bf16 v[164:167], a[244:247], v[212:215], v[164:167]
  v_cvt_pk_bf16_f32 v115, v118, v119
  v_mfma_f32_16x16x32_bf16 v[164:167], a[228:231], v[208:211], v[164:167]
  s_waitcnt vmcnt(13)
  s_waitcnt lgkmcnt(0)
  s_barrier
  v_mfma_f32_16x16x32_bf16 v[168:171], a[232:235], v[208:211], v[168:171]
  ds_read_b64_tr_b16 v[192:193], v228 offset:8192
  v_mfma_f32_16x16x32_bf16 v[168:171], a[248:251], v[212:215], v[168:171]
  ds_read_b64_tr_b16 v[194:195], v228 offset:8704
  v_mfma_f32_16x16x32_bf16 v[172:175], a[252:255], v[212:215], v[172:175]
  ds_read_b64_tr_b16 v[196:197], v228 offset:12288
  v_cvt_pk_bf16_f32 v24, v24, v25
  v_mfma_f32_16x16x32_bf16 v[172:175], a[236:239], v[208:211], v[172:175]
  ds_read_b64_tr_b16 v[198:199], v228 offset:12800
  v_cvt_pk_bf16_f32 v25, v26, v27
  v_mfma_f32_16x16x32_bf16 v[176:179], a[224:227], v[216:219], v[176:179]
  s_add_u32 m0, s62, 49152
  ds_read_b64_tr_b16 v[200:201], v228 offset:16384
  v_cvt_pk_bf16_f32 v26, v28, v29
  v_mfma_f32_16x16x32_bf16 v[176:179], a[240:243], v[220:223], v[176:179]
  s_lshl_b32 s51, s58, 18
  ds_read_b64_tr_b16 v[202:203], v228 offset:16896
  v_cvt_pk_bf16_f32 v27, v30, v31
  v_mfma_f32_16x16x32_bf16 v[180:183], a[244:247], v[220:223], v[180:183]
  ds_read_b64_tr_b16 v[204:205], v228 offset:20480
  v_mfma_f32_16x16x32_bf16 v[180:183], a[228:231], v[216:219], v[180:183]
  s_mul_i32 s52, s58, 110592
  ds_read_b64_tr_b16 v[206:207], v228 offset:20992
  v_cvt_pk_bf16_f32 v56, v56, v57
  v_mfma_f32_16x16x32_bf16 v[184:187], a[232:235], v[216:219], v[184:187]
  v_cvt_pk_bf16_f32 v57, v58, v59
  v_mfma_f32_16x16x32_bf16 v[184:187], a[248:251], v[220:223], v[184:187]
  v_cvt_pk_bf16_f32 v58, v60, v61
  v_mfma_f32_16x16x32_bf16 v[188:191], a[252:255], v[220:223], v[188:191]
  ds_read_b64_tr_b16 v[208:209], v229 offset:8192
  v_cvt_pk_bf16_f32 v59, v62, v63
  v_mfma_f32_16x16x32_bf16 v[188:191], a[236:239], v[216:219], v[188:191]
  s_waitcnt lgkmcnt(1)
  ds_read_b64_tr_b16 v[210:211], v229 offset:8704
  v_mfma_f32_16x16x32_bf16 v[4:7], a[0:3], v[192:195], 0
  ds_read_b64_tr_b16 v[212:213], v229 offset:12288
  v_cvt_pk_bf16_f32 v88, v88, v89
  v_mfma_f32_16x16x32_bf16 v[4:7], a[16:19], v[196:199], v[4:7]
  ds_read_b64_tr_b16 v[214:215], v229 offset:12800
  v_cvt_pk_bf16_f32 v89, v90, v91
  v_mfma_f32_16x16x32_bf16 v[4:7], a[32:35], v[200:203], v[4:7]
  ds_read_b64_tr_b16 v[216:217], v229 offset:16384
  v_cvt_pk_bf16_f32 v90, v92, v93
  v_mfma_f32_16x16x32_bf16 v[4:7], a[48:51], v[204:207], v[4:7]
  ds_read_b64_tr_b16 v[218:219], v229 offset:16896
  v_cvt_pk_bf16_f32 v91, v94, v95
  v_mfma_f32_16x16x32_bf16 v[36:39], a[52:55], v[204:207], 0
  buffer_load_dwordx4 v240, s[24:27], s51 offen offset:0  lds
  v_mfma_f32_16x16x32_bf16 v[36:39], a[36:39], v[200:203], v[36:39]
  ds_read_b64_tr_b16 v[220:221], v229 offset:20480
  v_cvt_pk_bf16_f32 v128, v128, v129
  v_mfma_f32_16x16x32_bf16 v[36:39], a[20:23], v[196:199], v[36:39]
  ds_read_b64_tr_b16 v[222:223], v229 offset:20992
  v_cvt_pk_bf16_f32 v129, v130, v131
  v_mfma_f32_16x16x32_bf16 v[36:39], a[4:7], v[192:195], v[36:39]
  v_cvt_pk_bf16_f32 v130, v132, v133
  v_cvt_pk_bf16_f32 v131, v134, v135
  v_mfma_f32_16x16x32_bf16 v[68:71], a[8:11], v[192:195], 0
  buffer_store_dwordx4 v[128:131], v248, s[20:23], 0 offen offset:0 sc1
  v_cvt_pk_bf16_f32 v136, v136, v137
  v_mfma_f32_16x16x32_bf16 v[68:71], a[24:27], v[196:199], v[68:71]
  v_cvt_pk_bf16_f32 v120, v120, v121
  v_cvt_pk_bf16_f32 v121, v122, v123
  v_cvt_pk_bf16_f32 v137, v138, v139
  v_mfma_f32_16x16x32_bf16 v[68:71], a[40:43], v[200:203], v[68:71]
  v_cvt_pk_bf16_f32 v122, v124, v125
  v_cvt_pk_bf16_f32 v123, v126, v127
  v_mfma_f32_16x16x32_bf16 v[68:71], a[56:59], v[204:207], v[68:71]
  buffer_load_dwordx4 v241, s[24:27], s51 offen offset:1024  lds
  v_mfma_f32_16x16x32_bf16 v[100:103], a[60:63], v[204:207], 0
  v_cvt_pk_bf16_f32 v138, v140, v141
  v_mfma_f32_16x16x32_bf16 v[100:103], a[44:47], v[200:203], v[100:103]
  buffer_load_dwordx4 v242, s[28:31], s52 offen offset:2048  lds
  v_mfma_f32_16x16x32_bf16 v[100:103], a[28:31], v[196:199], v[100:103]
  s_add_u32 s58, s58, 1
  v_cvt_pk_bf16_f32 v139, v142, v143
  v_mfma_f32_16x16x32_bf16 v[100:103], a[12:15], v[192:195], v[100:103]
  s_waitcnt lgkmcnt(0)
  ds_read_b64_tr_b16 v[192:193], v230 offset:8192
  v_mfma_f32_16x16x32_bf16 v[12:15], a[0:3], v[208:211], 0
  ds_read_b64_tr_b16 v[194:195], v230 offset:8704
  s_cmp_eq_u32 s58, 20
  s_cselect_b32 s58, 0, s58
  v_mfma_f32_16x16x32_bf16 v[12:15], a[16:19], v[212:215], v[12:15]
  s_add_u32 m0, s62, 61440
  ds_read_b64_tr_b16 v[196:197], v230 offset:12288
  s_lshl_b32 s51, s58, 18
  v_mfma_f32_16x16x32_bf16 v[12:15], a[32:35], v[216:219], v[12:15]
  s_mul_i32 s52, s58, 110592
  ds_read_b64_tr_b16 v[198:199], v230 offset:12800
  v_mfma_f32_16x16x32_bf16 v[12:15], a[48:51], v[220:223], v[12:15]
  ds_read_b64_tr_b16 v[200:201], v230 offset:16384
  v_mfma_f32_16x16x32_bf16 v[44:47], a[52:55], v[220:223], 0
  ds_read_b64_tr_b16 v[202:203], v230 offset:16896
  v_mfma_f32_16x16x32_bf16 v[44:47], a[36:39], v[216:219], v[44:47]
  buffer_store_dwordx4 v[136:139], v248, s[20:23], s65 offen offset:0 sc1
  v_mfma_f32_16x16x32_bf16 v[44:47], a[20:23], v[212:215], v[44:47]
  ds_read_b64_tr_b16 v[204:205], v230 offset:20480
  v_mfma_f32_16x16x32_bf16 v[44:47], a[4:7], v[208:211], v[44:47]
  ds_read_b64_tr_b16 v[206:207], v230 offset:20992
  v_mfma_f32_16x16x32_bf16 v[76:79], a[8:11], v[208:211], 0
  v_mfma_f32_16x16x32_bf16 v[76:79], a[24:27], v[212:215], v[76:79]
  buffer_load_dwordx4 v240, s[24:27], s51 offen offset:0  lds
  v_mfma_f32_16x16x32_bf16 v[76:79], a[40:43], v[216:219], v[76:79]
  buffer_store_dwordx4 v[8:11], v248, s[16:19], 0 offen offset:1024 sc1
  v_mfma_f32_16x16x32_bf16 v[76:79], a[56:59], v[220:223], v[76:79]
  v_mfma_f32_16x16x32_bf16 v[108:111], a[60:63], v[220:223], 0
  v_mfma_f32_16x16x32_bf16 v[108:111], a[44:47], v[216:219], v[108:111]
  buffer_load_dwordx4 v241, s[24:27], s51 offen offset:1024  lds
  v_mfma_f32_16x16x32_bf16 v[108:111], a[28:31], v[212:215], v[108:111]
  v_mfma_f32_16x16x32_bf16 v[108:111], a[12:15], v[208:211], v[108:111]
  s_waitcnt lgkmcnt(0)
  ds_read_b64_tr_b16 v[208:209], v231 offset:8192
  v_mfma_f32_16x16x32_bf16 v[20:23], a[0:3], v[192:195], 0
  ds_read_b64_tr_b16 v[210:211], v231 offset:8704
  v_mfma_f32_16x16x32_bf16 v[20:23], a[16:19], v[196:199], v[20:23]
  ds_read_b64_tr_b16 v[212:213], v231 offset:12288
  v_mfma_f32_16x16x32_bf16 v[20:23], a[32:35], v[200:203], v[20:23]
  ds_read_b64_tr_b16 v[214:215], v231 offset:12800
  v_mfma_f32_16x16x32_bf16 v[20:23], a[48:51], v[204:207], v[20:23]
  buffer_load_dwordx4 v242, s[28:31], s52 offen offset:2048  lds
  v_mfma_f32_16x16x32_bf16 v[52:55], a[52:55], v[204:207], 0
  s_add_u32 s58, s58, 1
  ds_read_b64_tr_b16 v[216:217], v231 offset:16384
  v_mfma_f32_16x16x32_bf16 v[52:55], a[36:39], v[200:203], v[52:55]
  ds_read_b64_tr_b16 v[218:219], v231 offset:16896
  s_cmp_eq_u32 s58, 20
  s_cselect_b32 s58, 0, s58
  v_mfma_f32_16x16x32_bf16 v[52:55], a[20:23], v[196:199], v[52:55]
  buffer_store_dwordx4 v[40:43], v248, s[16:19], s64 offen offset:1024 sc1
  v_mfma_f32_16x16x32_bf16 v[52:55], a[4:7], v[192:195], v[52:55]
  ds_read_b64_tr_b16 v[220:221], v231 offset:20480
  v_mfma_f32_16x16x32_bf16 v[84:87], a[8:11], v[192:195], 0
  ds_read_b64_tr_b16 v[222:223], v231 offset:20992
  v_mfma_f32_16x16x32_bf16 v[84:87], a[24:27], v[196:199], v[84:87]
  v_mfma_f32_16x16x32_bf16 v[84:87], a[40:43], v[200:203], v[84:87]
  buffer_store_dwordx4 v[72:75], v248, s[16:19], s65 offen offset:1024 sc1
  v_mfma_f32_16x16x32_bf16 v[84:87], a[56:59], v[204:207], v[84:87]
  v_mfma_f32_16x16x32_bf16 v[116:119], a[60:63], v[204:207], 0
  v_mfma_f32_16x16x32_bf16 v[116:119], a[44:47], v[200:203], v[116:119]
  v_mfma_f32_16x16x32_bf16 v[116:119], a[28:31], v[196:199], v[116:119]
  v_mfma_f32_16x16x32_bf16 v[116:119], a[12:15], v[192:195], v[116:119]
  s_waitcnt lgkmcnt(0)
  v_mfma_f32_16x16x32_bf16 v[28:31], a[0:3], v[208:211], 0
  v_mfma_f32_16x16x32_bf16 v[28:31], a[16:19], v[212:215], v[28:31]
  v_mfma_f32_16x16x32_bf16 v[28:31], a[32:35], v[216:219], v[28:31]
  buffer_store_dwordx4 v[104:107], v248, s[16:19], s66 offen offset:1024 sc1
  v_mfma_f32_16x16x32_bf16 v[28:31], a[48:51], v[220:223], v[28:31]
  s_waitcnt lgkmcnt(0)
  s_barrier
  v_mfma_f32_16x16x32_bf16 v[60:63], a[52:55], v[220:223], 0
  s_add_u32 m0, s62, 73728
  ds_read_b64_tr_b16 v[192:193], v232 offset:16384
  s_lshl_b32 s51, s58, 18
  v_mfma_f32_16x16x32_bf16 v[60:63], a[36:39], v[216:219], v[60:63]
  s_mul_i32 s52, s58, 110592
  ds_read_b64_tr_b16 v[194:195], v232 offset:16896
  v_mfma_f32_16x16x32_bf16 v[60:63], a[20:23], v[212:215], v[60:63]
  ds_read_b64_tr_b16 v[196:197], v232 offset:20480
  v_mfma_f32_16x16x32_bf16 v[60:63], a[4:7], v[208:211], v[60:63]
  ds_read_b64_tr_b16 v[198:199], v232 offset:20992
  v_mfma_f32_16x16x32_bf16 v[92:95], a[8:11], v[208:211], 0
  ds_read_b64_tr_b16 v[200:201], v232 offset:24576
  v_mfma_f32_16x16x32_bf16 v[92:95], a[24:27], v[212:215], v[92:95]
  ds_read_b64_tr_b16 v[202:203], v232 offset:25088
  v_mfma_f32_16x16x32_bf16 v[92:95], a[40:43], v[216:219], v[92:95]
  ds_read_b64_tr_b16 v[204:205], v232 offset:28672
  v_mfma_f32_16x16x32_bf16 v[92:95], a[56:59], v[220:223], v[92:95]
  ds_read_b64_tr_b16 v[206:207], v232 offset:29184
  v_mfma_f32_16x16x32_bf16 v[124:127], a[60:63], v[220:223], 0
  buffer_load_dwordx4 v240, s[24:27], s51 offen offset:0  lds
  v_mfma_f32_16x16x32_bf16 v[124:127], a[44:47], v[216:219], v[124:127]
  buffer_store_dwordx4 v[16:19], v248, s[16:19], 0 offen offset:2048 sc1
  v_mfma_f32_16x16x32_bf16 v[124:127], a[28:31], v[212:215], v[124:127]
  buffer_load_dwordx4 v241, s[24:27], s51 offen offset:1024  lds
  v_mfma_f32_16x16x32_bf16 v[124:127], a[12:15], v[208:211], v[124:127]
  s_waitcnt lgkmcnt(0)
  ds_read_b64_tr_b16 v[208:209], v233 offset:16384
  v_mfma_f32_16x16x32_bf16 v[4:7], a[64:67], v[192:195], v[4:7]
  ds_read_b64_tr_b16 v[210:211], v233 offset:16896
  v_mfma_f32_16x16x32_bf16 v[4:7], a[80:83], v[196:199], v[4:7]
  ds_read_b64_tr_b16 v[212:213], v233 offset:20480
  v_mfma_f32_16x16x32_bf16 v[4:7], a[96:99], v[200:203], v[4:7]
  ds_read_b64_tr_b16 v[214:215], v233 offset:20992
  v_mfma_f32_16x16x32_bf16 v[4:7], a[112:115], v[204:207], v[4:7]
  buffer_load_dwordx4 v242, s[28:31], s52 offen offset:2048  lds
  v_mfma_f32_16x16x32_bf16 v[36:39], a[116:119], v[204:207], v[36:39]
  s_add_u32 s58, s58, 1
  ds_read_b64_tr_b16 v[216:217], v233 offset:24576
  v_mfma_f32_16x16x32_bf16 v[36:39], a[100:103], v[200:203], v[36:39]
  ds_read_b64_tr_b16 v[218:219], v233 offset:25088
  s_cmp_eq_u32 s58, 20
  s_cselect_b32 s58, 0, s58
  v_mfma_f32_16x16x32_bf16 v[36:39], a[84:87], v[196:199], v[36:39]
  s_add_u32 m0, s62, 86016
  buffer_store_dwordx4 v[48:51], v248, s[16:19], s64 offen offset:2048 sc1
  v_mfma_f32_16x16x32_bf16 v[36:39], a[68:71], v[192:195], v[36:39]
  s_lshl_b32 s51, s58, 18
  ds_read_b64_tr_b16 v[220:221], v233 offset:28672
  s_mul_i32 s52, s58, 110592
  v_mfma_f32_16x16x32_bf16 v[68:71], a[72:75], v[192:195], v[68:71]
  ds_read_b64_tr_b16 v[222:223], v233 offset:29184
  v_mfma_f32_16x16x32_bf16 v[68:71], a[88:91], v[196:199], v[68:71]
  v_mfma_f32_16x16x32_bf16 v[68:71], a[104:107], v[200:203], v[68:71]
  v_mfma_f32_16x16x32_bf16 v[68:71], a[120:123], v[204:207], v[68:71]
  buffer_store_dwordx4 v[80:83], v248, s[16:19], s65 offen offset:2048 sc1
  v_mfma_f32_16x16x32_bf16 v[100:103], a[124:127], v[204:207], v[100:103]
  v_mfma_f32_16x16x32_bf16 v[100:103], a[108:111], v[200:203], v[100:103]
  buffer_load_dwordx4 v240, s[24:27], s51 offen offset:0  lds
  v_mfma_f32_16x16x32_bf16 v[100:103], a[92:95], v[196:199], v[100:103]
  v_mfma_f32_16x16x32_bf16 v[100:103], a[76:79], v[192:195], v[100:103]
  s_waitcnt lgkmcnt(0)
  ds_read_b64_tr_b16 v[192:193], v234 offset:16384
  v_mfma_f32_16x16x32_bf16 v[12:15], a[64:67], v[208:211], v[12:15]
  ds_read_b64_tr_b16 v[194:195], v234 offset:16896
  v_mfma_f32_16x16x32_bf16 v[12:15], a[80:83], v[212:215], v[12:15]
  ds_read_b64_tr_b16 v[196:197], v234 offset:20480
  v_mfma_f32_16x16x32_bf16 v[12:15], a[96:99], v[216:219], v[12:15]
  ds_read_b64_tr_b16 v[198:199], v234 offset:20992
  v_mfma_f32_16x16x32_bf16 v[12:15], a[112:115], v[220:223], v[12:15]
  buffer_load_dwordx4 v241, s[24:27], s51 offen offset:1024  lds
  v_mfma_f32_16x16x32_bf16 v[44:47], a[116:119], v[220:223], v[44:47]
  ds_read_b64_tr_b16 v[200:201], v234 offset:24576
  v_mfma_f32_16x16x32_bf16 v[44:47], a[100:103], v[216:219], v[44:47]
  ds_read_b64_tr_b16 v[202:203], v234 offset:25088
  v_mfma_f32_16x16x32_bf16 v[44:47], a[84:87], v[212:215], v[44:47]
  buffer_store_dwordx4 v[112:115], v248, s[16:19], s66 offen offset:2048 sc1
  v_mfma_f32_16x16x32_bf16 v[44:47], a[68:71], v[208:211], v[44:47]
  ds_read_b64_tr_b16 v[204:205], v234 offset:28672
  v_mfma_f32_16x16x32_bf16 v[76:79], a[72:75], v[208:211], v[76:79]
  ds_read_b64_tr_b16 v[206:207], v234 offset:29184
  v_mfma_f32_16x16x32_bf16 v[76:79], a[88:91], v[212:215], v[76:79]
  buffer_load_dwordx4 v242, s[28:31], s52 offen offset:2048  lds
  v_mfma_f32_16x16x32_bf16 v[76:79], a[104:107], v[216:219], v[76:79]
  s_add_u32 s58, s58, 1
  s_cmp_eq_u32 s58, 20
  s_cselect_b32 s58, 0, s58
  v_mfma_f32_16x16x32_bf16 v[76:79], a[120:123], v[220:223], v[76:79]
  v_mfma_f32_16x16x32_bf16 v[108:111], a[124:127], v[220:223], v[108:111]
  v_cvt_pk_bf16_f32 v144, v144, v145
  v_mfma_f32_16x16x32_bf16 v[108:111], a[108:111], v[216:219], v[108:111]
  v_mfma_f32_16x16x32_bf16 v[108:111], a[92:95], v[212:215], v[108:111]
  s_waitcnt vmcnt(26)
  v_cmp_gt_u32 vcc, 0x80, v247
  s_cbranch_vccnz recurrent_scan__compressed_kv_cla__dense_activation_silu__prompt_kernel_spin0
recurrent_scan__compressed_kv_cla__dense_activation_silu__prompt_kernel_back0:
  v_mfma_f32_16x16x32_bf16 v[108:111], a[76:79], v[208:211], v[108:111]
  s_waitcnt lgkmcnt(0)
  ds_read_b64_tr_b16 v[208:209], v235 offset:16384
  s_lshl_b32 s57, s59, 10
  v_mfma_f32_16x16x32_bf16 v[20:23], a[64:67], v[192:195], v[20:23]
  ds_read_b64_tr_b16 v[210:211], v235 offset:16896
  v_cvt_pk_bf16_f32 v145, v146, v147
  v_mfma_f32_16x16x32_bf16 v[20:23], a[80:83], v[196:199], v[20:23]
  ds_read_b64_tr_b16 v[212:213], v235 offset:20480
  v_mfma_f32_16x16x32_bf16 v[20:23], a[96:99], v[200:203], v[20:23]
  ds_read_b64_tr_b16 v[214:215], v235 offset:20992
  v_mfma_f32_16x16x32_bf16 v[20:23], a[112:115], v[204:207], v[20:23]
  ds_read_b64_tr_b16 v[216:217], v235 offset:24576
  v_mfma_f32_16x16x32_bf16 v[52:55], a[116:119], v[204:207], v[52:55]
  ds_read_b64_tr_b16 v[218:219], v235 offset:25088
  v_cvt_pk_bf16_f32 v146, v148, v149
  v_mfma_f32_16x16x32_bf16 v[52:55], a[100:103], v[200:203], v[52:55]
  buffer_load_dwordx4 a[0:3], v236, s[32:35], s57 offen sc1
  v_mfma_f32_16x16x32_bf16 v[52:55], a[84:87], v[196:199], v[52:55]
  ds_read_b64_tr_b16 v[220:221], v235 offset:28672
  v_mfma_f32_16x16x32_bf16 v[52:55], a[68:71], v[192:195], v[52:55]
  ds_read_b64_tr_b16 v[222:223], v235 offset:29184
  v_mfma_f32_16x16x32_bf16 v[84:87], a[72:75], v[192:195], v[84:87]
  buffer_load_dwordx4 a[4:7], v237, s[32:35], s57 offen sc1
  v_mfma_f32_16x16x32_bf16 v[84:87], a[88:91], v[196:199], v[84:87]
  v_cvt_pk_bf16_f32 v147, v150, v151
  v_mfma_f32_16x16x32_bf16 v[84:87], a[104:107], v[200:203], v[84:87]
  buffer_load_dwordx4 a[8:11], v238, s[32:35], s57 offen sc1
  v_mfma_f32_16x16x32_bf16 v[84:87], a[120:123], v[204:207], v[84:87]
  v_mfma_f32_16x16x32_bf16 v[116:119], a[124:127], v[204:207], v[116:119]
  buffer_store_dwordx4 v[144:147], v248, s[20:23], 0 offen offset:1024 sc1
  v_mfma_f32_16x16x32_bf16 v[116:119], a[108:111], v[200:203], v[116:119]
  v_mfma_f32_16x16x32_bf16 v[116:119], a[92:95], v[196:199], v[116:119]
  buffer_load_dwordx4 a[12:15], v239, s[32:35], s57 offen sc1
  v_mfma_f32_16x16x32_bf16 v[116:119], a[76:79], v[192:195], v[116:119]
  s_waitcnt lgkmcnt(0)
  s_add_u32 s59, s59, 1
  v_mfma_f32_16x16x32_bf16 v[28:31], a[64:67], v[208:211], v[28:31]
  s_cmp_eq_u32 s59, 20
  s_cselect_b32 s59, 0, s59
  v_mfma_f32_16x16x32_bf16 v[28:31], a[80:83], v[212:215], v[28:31]
  v_mfma_f32_16x16x32_bf16 v[28:31], a[96:99], v[216:219], v[28:31]
  s_lshl_b32 s57, s59, 10
  v_mfma_f32_16x16x32_bf16 v[28:31], a[112:115], v[220:223], v[28:31]
  s_barrier
  ds_read_b64_tr_b16 v[192:193], v224 offset:8192
  v_mfma_f32_16x16x32_bf16 v[60:63], a[116:119], v[220:223], v[60:63]
  ds_read_b64_tr_b16 v[194:195], v224 offset:8704
  v_cvt_pk_bf16_f32 v152, v152, v153
  v_mfma_f32_16x16x32_bf16 v[60:63], a[100:103], v[216:219], v[60:63]
  ds_read_b64_tr_b16 v[196:197], v224 offset:12288
  v_mfma_f32_16x16x32_bf16 v[60:63], a[84:87], v[212:215], v[60:63]
  ds_read_b64_tr_b16 v[198:199], v224 offset:12800
  v_mfma_f32_16x16x32_bf16 v[60:63], a[68:71], v[208:211], v[60:63]
  ds_read_b64_tr_b16 v[200:201], v224 offset:16384
  v_mfma_f32_16x16x32_bf16 v[92:95], a[72:75], v[208:211], v[92:95]
  ds_read_b64_tr_b16 v[202:203], v224 offset:16896
  v_cvt_pk_bf16_f32 v153, v154, v155
  v_mfma_f32_16x16x32_bf16 v[92:95], a[88:91], v[212:215], v[92:95]
  ds_read_b64_tr_b16 v[204:205], v224 offset:20480
  v_mfma_f32_16x16x32_bf16 v[92:95], a[104:107], v[216:219], v[92:95]
  ds_read_b64_tr_b16 v[206:207], v224 offset:20992
  v_mfma_f32_16x16x32_bf16 v[92:95], a[120:123], v[220:223], v[92:95]
  buffer_load_dwordx4 a[16:19], v236, s[32:35], s57 offen sc1
  v_mfma_f32_16x16x32_bf16 v[124:127], a[124:127], v[220:223], v[124:127]
  v_cvt_pk_bf16_f32 v154, v156, v157
  v_mfma_f32_16x16x32_bf16 v[124:127], a[108:111], v[216:219], v[124:127]
  v_mfma_f32_16x16x32_bf16 v[124:127], a[92:95], v[212:215], v[124:127]
  buffer_load_dwordx4 a[20:23], v237, s[32:35], s57 offen sc1
  v_mfma_f32_16x16x32_bf16 v[124:127], a[76:79], v[208:211], v[124:127]
  s_waitcnt lgkmcnt(0)
  ds_read_b64_tr_b16 v[208:209], v225 offset:8192
  v_mfma_f32_16x16x32_bf16 v[4:7], a[128:131], v[192:195], v[4:7]
  ds_read_b64_tr_b16 v[210:211], v225 offset:8704
  v_mfma_f32_16x16x32_bf16 v[4:7], a[144:147], v[196:199], v[4:7]
  ds_read_b64_tr_b16 v[212:213], v225 offset:12288
  v_cvt_pk_bf16_f32 v155, v158, v159
  v_mfma_f32_16x16x32_bf16 v[4:7], a[160:163], v[200:203], v[4:7]
  ds_read_b64_tr_b16 v[214:215], v225 offset:12800
  v_mfma_f32_16x16x32_bf16 v[4:7], a[176:179], v[204:207], v[4:7]
  ds_read_b64_tr_b16 v[216:217], v225 offset:16384
  v_mfma_f32_16x16x32_bf16 v[36:39], a[180:183], v[204:207], v[36:39]
  ds_read_b64_tr_b16 v[218:219], v225 offset:16896
  v_mfma_f32_16x16x32_bf16 v[36:39], a[164:167], v[200:203], v[36:39]
  buffer_load_dwordx4 a[24:27], v238, s[32:35], s57 offen sc1
  v_mfma_f32_16x16x32_bf16 v[36:39], a[148:151], v[196:199], v[36:39]
  ds_read_b64_tr_b16 v[220:221], v225 offset:20480
  v_mfma_f32_16x16x32_bf16 v[36:39], a[132:135], v[192:195], v[36:39]
  ds_read_b64_tr_b16 v[222:223], v225 offset:20992
  v_mfma_f32_16x16x32_bf16 v[68:71], a[136:139], v[192:195], v[68:71]
  buffer_store_dwordx4 v[152:155], v248, s[20:23], s65 offen offset:1024 sc1
  v_mfma_f32_16x16x32_bf16 v[68:71], a[152:155], v[196:199], v[68:71]
  buffer_load_dwordx4 a[28:31], v239, s[32:35], s57 offen sc1
  v_mfma_f32_16x16x32_bf16 v[68:71], a[168:171], v[200:203], v[68:71]
  s_add_u32 s59, s59, 1
  v_bfe_u32 v251, v249, 2, 2
  v_mfma_f32_16x16x32_bf16 v[68:71], a[184:187], v[204:207], v[68:71]
  s_cmp_eq_u32 s59, 20
  s_cselect_b32 s59, 0, s59
  s_lshl_b32 s57, s59, 10
  v_mfma_f32_16x16x32_bf16 v[100:103], a[188:191], v[204:207], v[100:103]
  v_and_b32 v252, 3, v249
  v_mfma_f32_16x16x32_bf16 v[100:103], a[172:175], v[200:203], v[100:103]
  v_cvt_pk_bf16_f32 v160, v160, v161
  v_mfma_f32_16x16x32_bf16 v[100:103], a[156:159], v[196:199], v[100:103]
  v_lshlrev_b32 v252, 3, v252
  v_mfma_f32_16x16x32_bf16 v[100:103], a[140:143], v[192:195], v[100:103]
  s_waitcnt lgkmcnt(0)
  ds_read_b64_tr_b16 v[192:193], v226 offset:8192
  v_mfma_f32_16x16x32_bf16 v[12:15], a[128:131], v[208:211], v[12:15]
  ds_read_b64_tr_b16 v[194:195], v226 offset:8704
  v_mul_u32_u24 v253, 3072, v250
  v_mfma_f32_16x16x32_bf16 v[12:15], a[144:147], v[212:215], v[12:15]
  ds_read_b64_tr_b16 v[196:197], v226 offset:12288
  v_cvt_pk_bf16_f32 v161, v162, v163
  v_mfma_f32_16x16x32_bf16 v[12:15], a[160:163], v[216:219], v[12:15]
  ds_read_b64_tr_b16 v[198:199], v226 offset:12800
  v_add_u32 v253, v253, v252
  v_mfma_f32_16x16x32_bf16 v[12:15], a[176:179], v[220:223], v[12:15]
  ds_read_b64_tr_b16 v[200:201], v226 offset:16384
  v_mfma_f32_16x16x32_bf16 v[44:47], a[180:183], v[220:223], v[44:47]
  ds_read_b64_tr_b16 v[202:203], v226 offset:16896
  v_add_u32 v253, 114688, v253
  v_mfma_f32_16x16x32_bf16 v[44:47], a[164:167], v[216:219], v[44:47]
  buffer_load_dwordx4 a[32:35], v236, s[32:35], s57 offen sc1
  v_mfma_f32_16x16x32_bf16 v[44:47], a[148:151], v[212:215], v[44:47]
  ds_read_b64_tr_b16 v[204:205], v226 offset:20480
  v_cvt_pk_bf16_f32 v162, v164, v165
  v_mfma_f32_16x16x32_bf16 v[44:47], a[132:135], v[208:211], v[44:47]
  ds_read_b64_tr_b16 v[206:207], v226 offset:20992
  v_and_b32 v254, 1, v250
  v_mfma_f32_16x16x32_bf16 v[76:79], a[136:139], v[208:211], v[76:79]
  buffer_load_dwordx4 a[36:39], v237, s[32:35], s57 offen sc1
  v_mfma_f32_16x16x32_bf16 v[76:79], a[152:155], v[212:215], v[76:79]
  v_cvt_pk_bf16_f32 v163, v166, v167
  v_lshl_add_u32 v136, v254, 2, v251
  v_mfma_f32_16x16x32_bf16 v[76:79], a[168:171], v[216:219], v[76:79]
  buffer_load_dwordx4 a[40:43], v238, s[32:35], s57 offen sc1
  v_mfma_f32_16x16x32_bf16 v[76:79], a[184:187], v[220:223], v[76:79]
  v_lshl_add_u32 v137, v251, 8, v253
  v_mfma_f32_16x16x32_bf16 v[108:111], a[188:191], v[220:223], v[108:111]
  v_xor_b32 v128, 0, v136
  v_mfma_f32_16x16x32_bf16 v[108:111], a[172:175], v[216:219], v[108:111]
  buffer_store_dwordx4 v[160:163], v248, s[20:23], 0 offen offset:2048 sc1
  v_mfma_f32_16x16x32_bf16 v[108:111], a[156:159], v[212:215], v[108:111]
  buffer_load_dwordx4 a[44:47], v239, s[32:35], s57 offen sc1
  v_mfma_f32_16x16x32_bf16 v[108:111], a[140:143], v[208:211], v[108:111]
  s_waitcnt lgkmcnt(0)
  ds_read_b64_tr_b16 v[208:209], v227 offset:8192
  v_lshl_add_u32 v128, v128, 5, v137
  v_mfma_f32_16x16x32_bf16 v[20:23], a[128:131], v[192:195], v[20:23]
  s_add_u32 s59, s59, 1
  ds_read_b64_tr_b16 v[210:211], v227 offset:8704
  v_mfma_f32_16x16x32_bf16 v[20:23], a[144:147], v[196:199], v[20:23]
  ds_read_b64_tr_b16 v[212:213], v227 offset:12288
  v_xor_b32 v129, 1, v136
  v_mfma_f32_16x16x32_bf16 v[20:23], a[160:163], v[200:203], v[20:23]
  ds_read_b64_tr_b16 v[214:215], v227 offset:12800
  s_cmp_eq_u32 s59, 20
  s_cselect_b32 s59, 0, s59
  v_mfma_f32_16x16x32_bf16 v[20:23], a[176:179], v[204:207], v[20:23]
  s_lshl_b32 s57, s59, 10
  ds_read_b64_tr_b16 v[216:217], v227 offset:16384
  v_lshl_add_u32 v129, v129, 5, v137
  v_mfma_f32_16x16x32_bf16 v[52:55], a[180:183], v[204:207], v[52:55]
  ds_read_b64_tr_b16 v[218:219], v227 offset:16896
  v_mfma_f32_16x16x32_bf16 v[52:55], a[164:167], v[200:203], v[52:55]
  ds_read_b64_tr_b16 v[220:221], v227 offset:20480
  v_xor_b32 v130, 2, v136
  v_mfma_f32_16x16x32_bf16 v[52:55], a[148:151], v[196:199], v[52:55]
  ds_read_b64_tr_b16 v[222:223], v227 offset:20992
  v_cvt_pk_bf16_f32 v168, v168, v169
  v_mfma_f32_16x16x32_bf16 v[52:55], a[132:135], v[192:195], v[52:55]
  v_lshl_add_u32 v130, v130, 5, v137
  v_mfma_f32_16x16x32_bf16 v[84:87], a[136:139], v[192:195], v[84:87]
  v_mfma_f32_16x16x32_bf16 v[84:87], a[152:155], v[196:199], v[84:87]
  v_xor_b32 v131, 3, v136
  v_mfma_f32_16x16x32_bf16 v[84:87], a[168:171], v[200:203], v[84:87]
  v_cvt_pk_bf16_f32 v169, v170, v171
  v_mfma_f32_16x16x32_bf16 v[84:87], a[184:187], v[204:207], v[84:87]
  buffer_load_dwordx4 a[48:51], v236, s[32:35], s57 offen sc1
  v_mfma_f32_16x16x32_bf16 v[116:119], a[188:191], v[204:207], v[116:119]
  v_lshl_add_u32 v131, v131, 5, v137
  v_mfma_f32_16x16x32_bf16 v[116:119], a[172:175], v[200:203], v[116:119]
  v_xor_b32 v132, 4, v136
  v_mfma_f32_16x16x32_bf16 v[116:119], a[156:159], v[196:199], v[116:119]
  v_cvt_pk_bf16_f32 v170, v172, v173
  v_mfma_f32_16x16x32_bf16 v[116:119], a[140:143], v[192:195], v[116:119]
  s_waitcnt lgkmcnt(0)
  buffer_load_dwordx4 a[52:55], v237, s[32:35], s57 offen sc1
  v_mfma_f32_16x16x32_bf16 v[28:31], a[128:131], v[208:211], v[28:31]
  ds_read_b64_tr_b16 v[192:193], v224 offset:24576
  v_lshl_add_u32 v132, v132, 5, v137
  v_mfma_f32_16x16x32_bf16 v[28:31], a[144:147], v[212:215], v[28:31]
  ds_read_b64_tr_b16 v[194:195], v224 offset:25088
  v_xor_b32 v133, 5, v136
  v_mfma_f32_16x16x32_bf16 v[28:31], a[160:163], v[216:219], v[28:31]
  ds_read_b64_tr_b16 v[196:197], v224 offset:28672
  v_cvt_pk_bf16_f32 v171, v174, v175
  v_mfma_f32_16x16x32_bf16 v[28:31], a[176:179], v[220:223], v[28:31]
  ds_read_b64_tr_b16 v[198:199], v224 offset:29184
  v_mfma_f32_16x16x32_bf16 v[60:63], a[180:183], v[220:223], v[60:63]
  ds_read_b64_tr_b16 v[200:201], v224 offset:32768
  v_lshl_add_u32 v133, v133, 5, v137
  v_mfma_f32_16x16x32_bf16 v[60:63], a[164:167], v[216:219], v[60:63]
  ds_read_b64_tr_b16 v[202:203], v224 offset:33280
  v_mfma_f32_16x16x32_bf16 v[60:63], a[148:151], v[212:215], v[60:63]
  buffer_load_dwordx4 a[56:59], v238, s[32:35], s57 offen sc1
  v_mfma_f32_16x16x32_bf16 v[60:63], a[132:135], v[208:211], v[60:63]
  ds_read_b64_tr_b16 v[204:205], v224 offset:36864
  v_xor_b32 v134, 6, v136
  v_mfma_f32_16x16x32_bf16 v[92:95], a[136:139], v[208:211], v[92:95]
  ds_read_b64_tr_b16 v[206:207], v224 offset:37376
  v_lshl_add_u32 v134, v134, 5, v137
  v_mfma_f32_16x16x32_bf16 v[92:95], a[152:155], v[212:215], v[92:95]
  buffer_store_dwordx4 v[168:171], v248, s[20:23], s65 offen offset:2048 sc1
  v_mfma_f32_16x16x32_bf16 v[92:95], a[168:171], v[216:219], v[92:95]
  buffer_load_dwordx4 a[60:63], v239, s[32:35], s57 offen sc1
  v_mfma_f32_16x16x32_bf16 v[92:95], a[184:187], v[220:223], v[92:95]
  s_add_u32 s59, s59, 1
  v_xor_b32 v135, 7, v136
  v_mfma_f32_16x16x32_bf16 v[124:127], a[188:191], v[220:223], v[124:127]
  s_cmp_eq_u32 s59, 20
  s_cselect_b32 s59, 0, s59
  v_lshl_add_u32 v135, v135, 5, v137
  v_mfma_f32_16x16x32_bf16 v[124:127], a[172:175], v[216:219], v[124:127]
  v_mfma_f32_16x16x32_bf16 v[124:127], a[156:159], v[212:215], v[124:127]
  v_cvt_pk_bf16_f32 v176, v176, v177
  v_lshl_add_u32 v253, v251, 7, v253
  v_mfma_f32_16x16x32_bf16 v[124:127], a[140:143], v[208:211], v[124:127]
  s_waitcnt lgkmcnt(0)
  ds_read_b64_tr_b16 v[208:209], v225 offset:24576
  v_mfma_f32_16x16x32_bf16 v[4:7], a[192:195], v[192:195], v[4:7]
  ds_read_b64_tr_b16 v[210:211], v225 offset:25088
  v_add_u32 v253, 2048, v253
  v_mfma_f32_16x16x32_bf16 v[4:7], a[208:211], v[196:199], v[4:7]
  ds_read_b64_tr_b16 v[212:213], v225 offset:28672
  v_accvgpr_write_b32 a128, v24
  v_mfma_f32_16x16x32_bf16 v[4:7], a[224:227], v[200:203], v[4:7]
  ds_read_b64_tr_b16 v[214:215], v225 offset:29184
  v_cvt_pk_bf16_f32 v177, v178, v179
  v_mfma_f32_16x16x32_bf16 v[4:7], a[240:243], v[204:207], v[4:7]
  ds_read_b64_tr_b16 v[216:217], v225 offset:32768
  v_lshrrev_b32 v245, 1, v251
  v_mfma_f32_16x16x32_bf16 v[36:39], a[244:247], v[204:207], v[36:39]
  ds_read_b64_tr_b16 v[218:219], v225 offset:33280
  v_accvgpr_write_b32 a129, v25
  v_mfma_f32_16x16x32_bf16 v[36:39], a[228:231], v[200:203], v[36:39]
  ds_read_b64_tr_b16 v[220:221], v225 offset:36864
  v_lshl_add_u32 v254, v254, 1, v245
  v_mfma_f32_16x16x32_bf16 v[36:39], a[212:215], v[196:199], v[36:39]
  ds_read_b64_tr_b16 v[222:223], v225 offset:37376
  v_cvt_pk_bf16_f32 v178, v180, v181
  v_mfma_f32_16x16x32_bf16 v[36:39], a[196:199], v[192:195], v[36:39]
  v_accvgpr_write_b32 a130, v26
  v_xor_b32 v136, 0, v254
  v_mfma_f32_16x16x32_bf16 v[68:71], a[200:203], v[192:195], v[68:71]
  v_mfma_f32_16x16x32_bf16 v[68:71], a[216:219], v[196:199], v[68:71]
  v_lshl_add_u32 v136, v136, 5, v253
  v_mfma_f32_16x16x32_bf16 v[68:71], a[232:235], v[200:203], v[68:71]
  v_mfma_f32_16x16x32_bf16 v[68:71], a[248:251], v[204:207], v[68:71]
  v_accvgpr_write_b32 a131, v27
  v_cvt_pk_bf16_f32 v179, v182, v183
  v_mfma_f32_16x16x32_bf16 v[100:103], a[252:255], v[204:207], v[100:103]
  v_xor_b32 v137, 1, v254
  v_mfma_f32_16x16x32_bf16 v[100:103], a[236:239], v[200:203], v[100:103]
  v_lshl_add_u32 v137, v137, 5, v253
  v_mfma_f32_16x16x32_bf16 v[100:103], a[220:223], v[196:199], v[100:103]
  v_accvgpr_write_b32 a132, v56
  v_mfma_f32_16x16x32_bf16 v[100:103], a[204:207], v[192:195], v[100:103]
  s_waitcnt lgkmcnt(0)
  ds_read_b64_tr_b16 v[192:193], v226 offset:24576
  v_xor_b32 v138, 2, v254
  v_mfma_f32_16x16x32_bf16 v[12:15], a[192:195], v[208:211], v[12:15]
  ds_read_b64_tr_b16 v[194:195], v226 offset:25088
  v_mfma_f32_16x16x32_bf16 v[12:15], a[208:211], v[212:215], v[12:15]
  buffer_store_dwordx4 v[176:179], v248, s[20:23], 0 offen offset:3072 sc1
  v_mfma_f32_16x16x32_bf16 v[12:15], a[224:227], v[216:219], v[12:15]
  ds_read_b64_tr_b16 v[196:197], v226 offset:28672
  v_lshl_add_u32 v138, v138, 5, v253
  v_mfma_f32_16x16x32_bf16 v[12:15], a[240:243], v[220:223], v[12:15]
  ds_read_b64_tr_b16 v[198:199], v226 offset:29184
  v_accvgpr_write_b32 a133, v57
  v_mfma_f32_16x16x32_bf16 v[44:47], a[244:247], v[220:223], v[44:47]
  ds_read_b64_tr_b16 v[200:201], v226 offset:32768
  v_xor_b32 v139, 3, v254
  v_mfma_f32_16x16x32_bf16 v[44:47], a[228:231], v[216:219], v[44:47]
  ds_read_b64_tr_b16 v[202:203], v226 offset:33280
  v_accvgpr_write_b32 a134, v58
  v_mfma_f32_16x16x32_bf16 v[44:47], a[212:215], v[212:215], v[44:47]
  ds_read_b64_tr_b16 v[204:205], v226 offset:36864
  v_lshl_add_u32 v139, v139, 5, v253
  v_mfma_f32_16x16x32_bf16 v[44:47], a[196:199], v[208:211], v[44:47]
  s_mov_b32 s54, 0
  ds_read_b64_tr_b16 v[206:207], v226 offset:37376
  v_cvt_pk_bf16_f32 v184, v184, v185
  v_mfma_f32_16x16x32_bf16 v[76:79], a[200:203], v[208:211], v[76:79]
  s_mov_b32 s55, 0
  s_mov_b64 s[86:87], -1
  v_mfma_f32_16x16x32_bf16 v[76:79], a[216:219], v[212:215], v[76:79]
  v_accvgpr_write_b32 a135, v59
  v_mfma_f32_16x16x32_bf16 v[76:79], a[232:235], v[216:219], v[76:79]
  v_mfma_f32_16x16x32_bf16 v[76:79], a[248:251], v[220:223], v[76:79]
  v_cvt_pk_bf16_f32 v185, v186, v187
  v_mfma_f32_16x16x32_bf16 v[108:111], a[252:255], v[220:223], v[108:111]
  v_accvgpr_write_b32 a136, v88
  v_mfma_f32_16x16x32_bf16 v[108:111], a[236:239], v[216:219], v[108:111]
  v_mfma_f32_16x16x32_bf16 v[108:111], a[220:223], v[212:215], v[108:111]
  v_mfma_f32_16x16x32_bf16 v[108:111], a[204:207], v[208:211], v[108:111]
  s_waitcnt lgkmcnt(0)
  ds_read_b64_tr_b16 v[208:209], v227 offset:24576
  v_accvgpr_write_b32 a137, v89
  v_mfma_f32_16x16x32_bf16 v[20:23], a[192:195], v[192:195], v[20:23]
  ds_read_b64_tr_b16 v[210:211], v227 offset:25088
  v_cvt_pk_bf16_f32 v186, v188, v189
  v_mfma_f32_16x16x32_bf16 v[20:23], a[208:211], v[196:199], v[20:23]
  ds_read_b64_tr_b16 v[212:213], v227 offset:28672
  v_mfma_f32_16x16x32_bf16 v[20:23], a[224:227], v[200:203], v[20:23]
  ds_read_b64_tr_b16 v[214:215], v227 offset:29184
  v_mfma_f32_16x16x32_bf16 v[20:23], a[240:243], v[204:207], v[20:23]
  ds_read_b64_tr_b16 v[216:217], v227 offset:32768
  v_accvgpr_write_b32 a138, v90
  v_mfma_f32_16x16x32_bf16 v[52:55], a[244:247], v[204:207], v[52:55]
  ds_read_b64_tr_b16 v[218:219], v227 offset:33280
  v_cvt_pk_bf16_f32 v187, v190, v191
  v_mfma_f32_16x16x32_bf16 v[52:55], a[228:231], v[200:203], v[52:55]
  ds_read_b64_tr_b16 v[220:221], v227 offset:36864
  v_mfma_f32_16x16x32_bf16 v[52:55], a[212:215], v[196:199], v[52:55]
  ds_read_b64_tr_b16 v[222:223], v227 offset:37376
  v_accvgpr_write_b32 a139, v91
  v_mfma_f32_16x16x32_bf16 v[52:55], a[196:199], v[192:195], v[52:55]
  buffer_store_dwordx4 v[184:187], v248, s[20:23], s65 offen offset:3072 sc1
  v_mfma_f32_16x16x32_bf16 v[84:87], a[200:203], v[192:195], v[84:87]
  v_mfma_f32_16x16x32_bf16 v[84:87], a[216:219], v[196:199], v[84:87]
  v_mfma_f32_16x16x32_bf16 v[84:87], a[232:235], v[200:203], v[84:87]
  v_accvgpr_write_b32 a140, v120
  v_mfma_f32_16x16x32_bf16 v[84:87], a[248:251], v[204:207], v[84:87]
  v_mfma_f32_16x16x32_bf16 v[116:119], a[252:255], v[204:207], v[116:119]
  v_mfma_f32_16x16x32_bf16 v[116:119], a[236:239], v[200:203], v[116:119]
  v_accvgpr_write_b32 a141, v121
  v_mfma_f32_16x16x32_bf16 v[116:119], a[220:223], v[196:199], v[116:119]
  v_mfma_f32_16x16x32_bf16 v[116:119], a[204:207], v[192:195], v[116:119]
  s_waitcnt lgkmcnt(0)
  v_mfma_f32_16x16x32_bf16 v[28:31], a[192:195], v[208:211], v[28:31]
  v_mfma_f32_16x16x32_bf16 v[28:31], a[208:211], v[212:215], v[28:31]
  v_accvgpr_write_b32 a142, v122
  v_mfma_f32_16x16x32_bf16 v[28:31], a[224:227], v[216:219], v[28:31]
  v_mfma_f32_16x16x32_bf16 v[28:31], a[240:243], v[220:223], v[28:31]
  v_mfma_f32_16x16x32_bf16 v[60:63], a[244:247], v[220:223], v[60:63]
  v_accvgpr_write_b32 a143, v123
  v_mfma_f32_16x16x32_bf16 v[60:63], a[228:231], v[216:219], v[60:63]
  v_mfma_f32_16x16x32_bf16 v[60:63], a[212:215], v[212:215], v[60:63]
  v_mfma_f32_16x16x32_bf16 v[60:63], a[196:199], v[208:211], v[60:63]
  v_mfma_f32_16x16x32_bf16 v[92:95], a[200:203], v[208:211], v[92:95]
  v_mfma_f32_16x16x32_bf16 v[92:95], a[216:219], v[212:215], v[92:95]
  v_mfma_f32_16x16x32_bf16 v[92:95], a[232:235], v[216:219], v[92:95]
  v_mfma_f32_16x16x32_bf16 v[92:95], a[248:251], v[220:223], v[92:95]
  v_mfma_f32_16x16x32_bf16 v[124:127], a[252:255], v[220:223], v[124:127]
  v_mfma_f32_16x16x32_bf16 v[124:127], a[236:239], v[216:219], v[124:127]
  v_mfma_f32_16x16x32_bf16 v[124:127], a[220:223], v[212:215], v[124:127]
  v_mfma_f32_16x16x32_bf16 v[124:127], a[204:207], v[208:211], v[124:127]
  s_waitcnt vmcnt(22)
  s_barrier
  ds_read_b64_tr_b16 a[64:65], v136 offset:0
  ds_read_b64_tr_b16 a[66:67], v136 offset:512
  ds_read_b64_tr_b16 a[68:69], v136 offset:12288
  ds_read_b64_tr_b16 a[70:71], v136 offset:12800
  ds_read_b64_tr_b16 a[72:73], v136 offset:24576
  ds_read_b64_tr_b16 a[74:75], v136 offset:25088
  ds_read_b64_tr_b16 a[76:77], v136 offset:36864
  ds_read_b64_tr_b16 a[78:79], v136 offset:37376
  s_waitcnt vmcnt(6) lgkmcnt(0)
  v_mfma_f32_16x16x32_bf16 v[144:147], a[64:67], a[0:3], 0
  s_add_u32 m0, s62, 0
  ds_read_b64_tr_b16 a[80:81], v137 offset:0
  v_cvt_pk_bf16_f32 v224, v20, v21
  v_mfma_f32_16x16x32_bf16 v[144:147], a[68:71], a[16:19], v[144:147]
  s_lshl_b32 s51, s58, 18
  ds_read_b64_tr_b16 a[82:83], v137 offset:512
  v_cvt_pk_bf16_f32 v225, v22, v23
  v_mfma_f32_16x16x32_bf16 v[144:147], a[72:75], a[32:35], v[144:147]
  s_mul_i32 s52, s58, 110592
  ds_read_b64_tr_b16 a[84:85], v137 offset:12288
  v_cvt_pk_bf16_f32 v226, v52, v53
  v_mfma_f32_16x16x32_bf16 v[144:147], a[76:79], a[48:51], v[144:147]
  s_waitcnt vmcnt(5)
  ds_read_b64_tr_b16 a[86:87], v137 offset:12800
  v_cvt_pk_bf16_f32 v227, v54, v55
  v_mfma_f32_16x16x32_bf16 v[160:163], a[76:79], a[52:55], 0
  ds_read_b64_tr_b16 a[88:89], v137 offset:24576
  v_mfma_f32_16x16x32_bf16 v[160:163], a[72:75], a[36:39], v[160:163]
  ds_read_b64_tr_b16 a[90:91], v137 offset:25088
  v_cvt_pk_bf16_f32 v228, v84, v85
  v_mfma_f32_16x16x32_bf16 v[160:163], a[68:71], a[20:23], v[160:163]
  ds_read_b64_tr_b16 a[92:93], v137 offset:36864
  v_cvt_pk_bf16_f32 v229, v86, v87
  v_mfma_f32_16x16x32_bf16 v[160:163], a[64:67], a[4:7], v[160:163]
  s_waitcnt vmcnt(4)
  ds_read_b64_tr_b16 a[94:95], v137 offset:37376
  v_cvt_pk_bf16_f32 v230, v116, v117
  v_mfma_f32_16x16x32_bf16 v[176:179], a[64:67], a[8:11], 0
  buffer_load_dwordx4 v240, s[24:27], s51 offen offset:0  lds
  v_mfma_f32_16x16x32_bf16 v[176:179], a[68:71], a[24:27], v[176:179]
  buffer_load_dwordx4 v241, s[24:27], s51 offen offset:1024  lds
  v_mfma_f32_16x16x32_bf16 v[176:179], a[72:75], a[40:43], v[176:179]
  buffer_load_dwordx4 v242, s[28:31], s52 offen offset:2048  lds
  v_mfma_f32_16x16x32_bf16 v[176:179], a[76:79], a[56:59], v[176:179]
  s_waitcnt vmcnt(5)
  ds_read_b64_tr_b16 a[96:97], v138 offset:0
  v_cvt_pk_bf16_f32 v231, v118, v119
  v_mfma_f32_16x16x32_bf16 v[192:195], a[76:79], a[60:63], 0
  s_add_u32 s58, s58, 1
  ds_read_b64_tr_b16 a[98:99], v138 offset:512
  v_cvt_pk_bf16_f32 v232, v28, v29
  v_mfma_f32_16x16x32_bf16 v[192:195], a[72:75], a[44:47], v[192:195]
  ds_read_b64_tr_b16 a[100:101], v138 offset:12288
  v_cvt_pk_bf16_f32 v233, v30, v31
  v_mfma_f32_16x16x32_bf16 v[192:195], a[68:71], a[28:31], v[192:195]
  ds_read_b64_tr_b16 a[102:103], v138 offset:12800
  s_cmp_eq_u32 s58, 20
  s_cselect_b32 s58, 0, s58
  v_mfma_f32_16x16x32_bf16 v[192:195], a[64:67], a[12:15], v[192:195]
  s_waitcnt lgkmcnt(4)
  ds_read_b64_tr_b16 a[104:105], v138 offset:24576
  v_cvt_pk_bf16_f32 v234, v60, v61
  v_mfma_f32_16x16x32_bf16 v[148:151], a[80:83], a[0:3], 0
  s_add_u32 m0, s62, 12288
  ds_read_b64_tr_b16 a[106:107], v138 offset:25088
  v_cvt_pk_bf16_f32 v235, v62, v63
  v_mfma_f32_16x16x32_bf16 v[148:151], a[84:87], a[16:19], v[148:151]
  s_lshl_b32 s51, s58, 18
  ds_read_b64_tr_b16 a[108:109], v138 offset:36864
  v_cvt_pk_bf16_f32 v140, v92, v93
  v_mfma_f32_16x16x32_bf16 v[148:151], a[88:91], a[32:35], v[148:151]
  s_mul_i32 s52, s58, 110592
  ds_read_b64_tr_b16 a[110:111], v138 offset:37376
  v_cvt_pk_bf16_f32 v141, v94, v95
  v_mfma_f32_16x16x32_bf16 v[148:151], a[92:95], a[48:51], v[148:151]
  v_cvt_pk_bf16_f32 v142, v124, v125
  v_cvt_pk_bf16_f32 v143, v126, v127
  v_mfma_f32_16x16x32_bf16 v[164:167], a[92:95], a[52:55], 0
  buffer_load_dwordx4 v240, s[24:27], s51 offen offset:0  lds
  v_mfma_f32_16x16x32_bf16 v[164:167], a[88:91], a[36:39], v[164:167]
  buffer_load_dwordx4 v241, s[24:27], s51 offen offset:1024  lds
  v_mfma_f32_16x16x32_bf16 v[164:167], a[84:87], a[20:23], v[164:167]
  v_cvt_pk_bf16_f32 v208, v4, v5
  v_cvt_pk_bf16_f32 v209, v6, v7
  v_mfma_f32_16x16x32_bf16 v[164:167], a[80:83], a[4:7], v[164:167]
  v_cvt_pk_bf16_f32 v210, v36, v37
  v_cvt_pk_bf16_f32 v211, v38, v39
  v_mfma_f32_16x16x32_bf16 v[180:183], a[80:83], a[8:11], 0
  buffer_load_dwordx4 v242, s[28:31], s52 offen offset:2048  lds
  v_mfma_f32_16x16x32_bf16 v[180:183], a[84:87], a[24:27], v[180:183]
  s_add_u32 s58, s58, 1
  ds_read_b64_tr_b16 a[64:65], v139 offset:0
  v_cvt_pk_bf16_f32 v212, v68, v69
  v_mfma_f32_16x16x32_bf16 v[180:183], a[88:91], a[40:43], v[180:183]
  ds_read_b64_tr_b16 a[66:67], v139 offset:512
  s_cmp_eq_u32 s58, 20
  s_cselect_b32 s58, 0, s58
  v_mfma_f32_16x16x32_bf16 v[180:183], a[92:95], a[56:59], v[180:183]
  s_lshl_b32 s57, s59, 10
  ds_read_b64_tr_b16 a[68:69], v139 offset:12288
  v_cvt_pk_bf16_f32 v213, v70, v71
  v_mfma_f32_16x16x32_bf16 v[196:199], a[92:95], a[60:63], 0
  ds_read_b64_tr_b16 a[70:71], v139 offset:12800
  v_cvt_pk_bf16_f32 v214, v100, v101
  v_mfma_f32_16x16x32_bf16 v[196:199], a[88:91], a[44:47], v[196:199]
  ds_read_b64_tr_b16 a[72:73], v139 offset:24576
  v_cvt_pk_bf16_f32 v215, v102, v103
  v_mfma_f32_16x16x32_bf16 v[196:199], a[84:87], a[28:31], v[196:199]
  ds_read_b64_tr_b16 a[74:75], v139 offset:25088
  v_cvt_pk_bf16_f32 v216, v12, v13
  v_mfma_f32_16x16x32_bf16 v[196:199], a[80:83], a[12:15], v[196:199]
  s_waitcnt lgkmcnt(6)
  buffer_load_dwordx4 a[192:195], v236, s[32:35], s57 offen sc1
  v_mfma_f32_16x16x32_bf16 v[152:155], a[96:99], a[0:3], 0
  ds_read_b64_tr_b16 a[76:77], v139 offset:36864
  v_cvt_pk_bf16_f32 v217, v14, v15
  v_mfma_f32_16x16x32_bf16 v[152:155], a[100:103], a[16:19], v[152:155]
  ds_read_b64_tr_b16 a[78:79], v139 offset:37376
  v_cvt_pk_bf16_f32 v218, v44, v45
  v_mfma_f32_16x16x32_bf16 v[152:155], a[104:107], a[32:35], v[152:155]
  buffer_load_dwordx4 a[196:199], v237, s[32:35], s57 offen sc1
  v_mfma_f32_16x16x32_bf16 v[152:155], a[108:111], a[48:51], v[152:155]
  v_cvt_pk_bf16_f32 v219, v46, v47
  v_cvt_pk_bf16_f32 v220, v76, v77
  v_mfma_f32_16x16x32_bf16 v[168:171], a[108:111], a[52:55], 0
  buffer_load_dwordx4 a[200:203], v238, s[32:35], s57 offen sc1
  v_mfma_f32_16x16x32_bf16 v[168:171], a[104:107], a[36:39], v[168:171]
  v_cvt_pk_bf16_f32 v221, v78, v79
  v_cvt_pk_bf16_f32 v222, v108, v109
  v_mfma_f32_16x16x32_bf16 v[168:171], a[100:103], a[20:23], v[168:171]
  buffer_load_dwordx4 a[204:207], v239, s[32:35], s57 offen sc1
  v_mfma_f32_16x16x32_bf16 v[168:171], a[96:99], a[4:7], v[168:171]
  s_add_u32 s59, s59, 1
  v_cvt_pk_bf16_f32 v223, v110, v111
  v_mfma_f32_16x16x32_bf16 v[184:187], a[96:99], a[8:11], 0
  ds_read_b64_tr_b16 a[80:81], v132 offset:0
  s_cmp_eq_u32 s59, 20
  s_cselect_b32 s59, 0, s59
  s_add_u32 m0, s62, 24576
  v_mfma_f32_16x16x32_bf16 v[184:187], a[100:103], a[24:27], v[184:187]
  s_lshl_b32 s51, s58, 18
  ds_read_b64_tr_b16 a[82:83], v132 offset:1024
  s_mul_i32 s52, s58, 110592
  v_mfma_f32_16x16x32_bf16 v[184:187], a[104:107], a[40:43], v[184:187]
  buffer_load_dwordx4 v240, s[24:27], s51 offen offset:0  lds
  v_mfma_f32_16x16x32_bf16 v[184:187], a[108:111], a[56:59], v[184:187]
  buffer_load_dwordx4 v241, s[24:27], s51 offen offset:1024  lds
  v_mfma_f32_16x16x32_bf16 v[200:203], a[108:111], a[60:63], 0
  ds_read_b64_tr_b16 a[84:85], v132 offset:12288
  v_mfma_f32_16x16x32_bf16 v[200:203], a[104:107], a[44:47], v[200:203]
  ds_read_b64_tr_b16 a[86:87], v132 offset:13312
  v_mfma_f32_16x16x32_bf16 v[200:203], a[100:103], a[28:31], v[200:203]
  buffer_load_dwordx4 v242, s[28:31], s52 offen offset:2048  lds
  v_mfma_f32_16x16x32_bf16 v[200:203], a[96:99], a[12:15], v[200:203]
  s_waitcnt lgkmcnt(4)
  ds_read_b64_tr_b16 a[88:89], v132 offset:24576
  s_add_u32 s58, s58, 1
  v_mfma_f32_16x16x32_bf16 v[156:159], a[64:67], a[0:3], 0
  ds_read_b64_tr_b16 a[90:91], v132 offset:25600
  s_cmp_eq_u32 s58, 20
  s_cselect_b32 s58, 0, s58
  v_mfma_f32_16x16x32_bf16 v[156:159], a[68:71], a[16:19], v[156:159]
  s_add_u32 m0, s62, 36864
  ds_read_b64_tr_b16 a[92:93], v132 offset:36864
  s_lshl_b32 s51, s58, 18
  v_mfma_f32_16x16x32_bf16 v[156:159], a[72:75], a[32:35], v[156:159]
  s_mul_i32 s52, s58, 110592
  ds_read_b64_tr_b16 a[94:95], v132 offset:37888
  v_mfma_f32_16x16x32_bf16 v[156:159], a[76:79], a[48:51], v[156:159]
  buffer_load_dwordx4 v240, s[24:27], s51 offen offset:0  lds
  v_mfma_f32_16x16x32_bf16 v[172:175], a[76:79], a[52:55], 0
  v_mfma_f32_16x16x32_bf16 v[172:175], a[72:75], a[36:39], v[172:175]
  buffer_load_dwordx4 v241, s[24:27], s51 offen offset:1024  lds
  v_mfma_f32_16x16x32_bf16 v[172:175], a[68:71], a[20:23], v[172:175]
  v_mfma_f32_16x16x32_bf16 v[172:175], a[64:67], a[4:7], v[172:175]
  buffer_load_dwordx4 v242, s[28:31], s52 offen offset:2048  lds
  v_mfma_f32_16x16x32_bf16 v[188:191], a[64:67], a[8:11], 0
  s_add_u32 s58, s58, 1
  ds_read_b64_tr_b16 a[96:97], v133 offset:0
  v_mfma_f32_16x16x32_bf16 v[188:191], a[68:71], a[24:27], v[188:191]
  ds_read_b64_tr_b16 a[98:99], v133 offset:1024
  s_cmp_eq_u32 s58, 20
  s_cselect_b32 s58, 0, s58
  v_mfma_f32_16x16x32_bf16 v[188:191], a[72:75], a[40:43], v[188:191]
  s_lshl_b32 s57, s59, 10
  ds_read_b64_tr_b16 a[100:101], v133 offset:12288
  v_mfma_f32_16x16x32_bf16 v[188:191], a[76:79], a[56:59], v[188:191]
  ds_read_b64_tr_b16 a[102:103], v133 offset:13312
  v_mfma_f32_16x16x32_bf16 v[204:207], a[76:79], a[60:63], 0
  ds_read_b64_tr_b16 a[104:105], v133 offset:24576
  v_mfma_f32_16x16x32_bf16 v[204:207], a[72:75], a[44:47], v[204:207]
  ds_read_b64_tr_b16 a[106:107], v133 offset:25600
  v_mfma_f32_16x16x32_bf16 v[204:207], a[68:71], a[28:31], v[204:207]
  buffer_load_dwordx4 a[208:211], v236, s[32:35], s57 offen sc1
  v_mfma_f32_16x16x32_bf16 v[204:207], a[64:67], a[12:15], v[204:207]
  s_waitcnt lgkmcnt(6)
  ds_read_b64_tr_b16 a[108:109], v133 offset:36864
  v_mfma_f32_16x16x32_bf16 v[16:19], a[80:83], a[0:3], 0
  ds_read_b64_tr_b16 a[110:111], v133 offset:37888
  v_mfma_f32_16x16x32_bf16 v[16:19], a[84:87], a[16:19], v[16:19]
  buffer_load_dwordx4 a[212:215], v237, s[32:35], s57 offen sc1
  v_mfma_f32_16x16x32_bf16 v[16:19], a[88:91], a[32:35], v[16:19]
  buffer_load_dwordx4 a[216:219], v238, s[32:35], s57 offen sc1
  v_mfma_f32_16x16x32_bf16 v[16:19], a[92:95], a[48:51], v[16:19]
  buffer_load_dwordx4 a[220:223], v239, s[32:35], s57 offen sc1
  v_mfma_f32_16x16x32_bf16 v[48:51], a[92:95], a[52:55], 0
  s_add_u32 s59, s59, 1
  s_cmp_eq_u32 s59, 20
  s_cselect_b32 s59, 0, s59
  v_mfma_f32_16x16x32_bf16 v[48:51], a[88:91], a[36:39], v[48:51]
  v_mfma_f32_16x16x32_bf16 v[48:51], a[84:87], a[20:23], v[48:51]
  v_mfma_f32_16x16x32_bf16 v[48:51], a[80:83], a[4:7], v[48:51]
  v_mfma_f32_16x16x32_bf16 v[80:83], a[80:83], a[8:11], 0
  buffer_store_dwordx4 a[128:131], v248, s[16:19], 0 offen offset:3072 sc1
  v_mfma_f32_16x16x32_bf16 v[80:83], a[84:87], a[24:27], v[80:83]
  ds_read_b64_tr_b16 a[64:65], v134 offset:0
  v_mfma_f32_16x16x32_bf16 v[80:83], a[88:91], a[40:43], v[80:83]
  ds_read_b64_tr_b16 a[66:67], v134 offset:1024
  v_mfma_f32_16x16x32_bf16 v[80:83], a[92:95], a[56:59], v[80:83]
  buffer_store_dwordx4 a[132:135], v248, s[16:19], s64 offen offset:3072 sc1
  v_mfma_f32_16x16x32_bf16 v[112:115], a[92:95], a[60:63], 0
  ds_read_b64_tr_b16 a[68:69], v134 offset:12288
  v_mfma_f32_16x16x32_bf16 v[112:115], a[88:91], a[44:47], v[112:115]
  ds_read_b64_tr_b16 a[70:71], v134 offset:13312
  v_mfma_f32_16x16x32_bf16 v[112:115], a[84:87], a[28:31], v[112:115]
  buffer_store_dwordx4 a[136:139], v248, s[16:19], s65 offen offset:3072 sc1
  v_mfma_f32_16x16x32_bf16 v[112:115], a[80:83], a[12:15], v[112:115]
  s_waitcnt lgkmcnt(4)
  ds_read_b64_tr_b16 a[72:73], v134 offset:24576
  v_mfma_f32_16x16x32_bf16 v[20:23], a[96:99], a[0:3], 0
  ds_read_b64_tr_b16 a[74:75], v134 offset:25600
  v_mfma_f32_16x16x32_bf16 v[20:23], a[100:103], a[16:19], v[20:23]
  buffer_store_dwordx4 a[140:143], v248, s[16:19], s66 offen offset:3072 sc1
  v_mfma_f32_16x16x32_bf16 v[20:23], a[104:107], a[32:35], v[20:23]
  ds_read_b64_tr_b16 a[76:77], v134 offset:36864
  v_mfma_f32_16x16x32_bf16 v[20:23], a[108:111], a[48:51], v[20:23]
  ds_read_b64_tr_b16 a[78:79], v134 offset:37888
  v_mfma_f32_16x16x32_bf16 v[52:55], a[108:111], a[52:55], 0
  v_mfma_f32_16x16x32_bf16 v[52:55], a[104:107], a[36:39], v[52:55]
  v_mfma_f32_16x16x32_bf16 v[52:55], a[100:103], a[20:23], v[52:55]
  v_mfma_f32_16x16x32_bf16 v[52:55], a[96:99], a[4:7], v[52:55]
  v_mfma_f32_16x16x32_bf16 v[84:87], a[96:99], a[8:11], 0
  ds_read_b64_tr_b16 a[80:81], v135 offset:0
  v_mfma_f32_16x16x32_bf16 v[84:87], a[100:103], a[24:27], v[84:87]
  ds_read_b64_tr_b16 a[82:83], v135 offset:1024
  v_mfma_f32_16x16x32_bf16 v[84:87], a[104:107], a[40:43], v[84:87]
  ds_read_b64_tr_b16 a[84:85], v135 offset:12288
  v_mfma_f32_16x16x32_bf16 v[84:87], a[108:111], a[56:59], v[84:87]
  ds_read_b64_tr_b16 a[86:87], v135 offset:13312
  v_mfma_f32_16x16x32_bf16 v[116:119], a[108:111], a[60:63], 0
  ds_read_b64_tr_b16 a[88:89], v135 offset:24576
  v_mfma_f32_16x16x32_bf16 v[116:119], a[104:107], a[44:47], v[116:119]
  ds_read_b64_tr_b16 a[90:91], v135 offset:25600
  v_mfma_f32_16x16x32_bf16 v[116:119], a[100:103], a[28:31], v[116:119]
  ds_read_b64_tr_b16 a[92:93], v135 offset:36864
  v_mfma_f32_16x16x32_bf16 v[116:119], a[96:99], a[12:15], v[116:119]
  s_waitcnt lgkmcnt(7)
  ds_read_b64_tr_b16 a[94:95], v135 offset:37888
  s_lshl_b32 s57, s59, 10
  v_mfma_f32_16x16x32_bf16 v[24:27], a[64:67], a[0:3], 0
  buffer_load_dwordx4 a[224:227], v236, s[32:35], s57 offen sc1
  v_mfma_f32_16x16x32_bf16 v[24:27], a[68:71], a[16:19], v[24:27]
  buffer_load_dwordx4 a[228:231], v237, s[32:35], s57 offen sc1
  v_mfma_f32_16x16x32_bf16 v[24:27], a[72:75], a[32:35], v[24:27]
  v_mfma_f32_16x16x32_bf16 v[24:27], a[76:79], a[48:51], v[24:27]
  v_mfma_f32_16x16x32_bf16 v[56:59], a[76:79], a[52:55], 0
  v_mfma_f32_16x16x32_bf16 v[56:59], a[72:75], a[36:39], v[56:59]
  v_mfma_f32_16x16x32_bf16 v[56:59], a[68:71], a[20:23], v[56:59]
  buffer_load_dwordx4 a[236:239], v238, s[32:35], s57 offen sc1
  v_mfma_f32_16x16x32_bf16 v[56:59], a[64:67], a[4:7], v[56:59]
  v_mfma_f32_16x16x32_bf16 v[88:91], a[64:67], a[8:11], 0
  ds_read_b64_tr_b16 a[96:97], v128 offset:0
  v_mfma_f32_16x16x32_bf16 v[88:91], a[68:71], a[24:27], v[88:91]
  ds_read_b64_tr_b16 a[98:99], v128 offset:1024
  v_mfma_f32_16x16x32_bf16 v[88:91], a[72:75], a[40:43], v[88:91]
  ds_read_b64_tr_b16 a[100:101], v128 offset:12288
  v_mfma_f32_16x16x32_bf16 v[88:91], a[76:79], a[56:59], v[88:91]
  ds_read_b64_tr_b16 a[102:103], v128 offset:13312
  v_mfma_f32_16x16x32_bf16 v[120:123], a[76:79], a[60:63], 0
  ds_read_b64_tr_b16 a[104:105], v128 offset:24576
  v_mfma_f32_16x16x32_bf16 v[120:123], a[72:75], a[44:47], v[120:123]
  ds_read_b64_tr_b16 a[106:107], v128 offset:25600
  v_mfma_f32_16x16x32_bf16 v[120:123], a[68:71], a[28:31], v[120:123]
  buffer_load_dwordx4 a[240:243], v239, s[32:35], s57 offen sc1
  v_mfma_f32_16x16x32_bf16 v[120:123], a[64:67], a[12:15], v[120:123]
  s_waitcnt lgkmcnt(6)
  ds_read_b64_tr_b16 a[108:109], v128 offset:36864
  s_add_u32 s59, s59, 1
  v_mfma_f32_16x16x32_bf16 v[28:31], a[80:83], a[0:3], 0
  ds_read_b64_tr_b16 a[110:111], v128 offset:37888
  v_mfma_f32_16x16x32_bf16 v[28:31], a[84:87], a[16:19], v[28:31]
  v_mfma_f32_16x16x32_bf16 v[28:31], a[88:91], a[32:35], v[28:31]
  s_cmp_eq_u32 s59, 20
  s_cselect_b32 s59, 0, s59
  v_mfma_f32_16x16x32_bf16 v[28:31], a[92:95], a[48:51], v[28:31]
  v_mfma_f32_16x16x32_bf16 v[60:63], a[92:95], a[52:55], 0
  v_mfma_f32_16x16x32_bf16 v[60:63], a[88:91], a[36:39], v[60:63]
  v_mfma_f32_16x16x32_bf16 v[60:63], a[84:87], a[20:23], v[60:63]
  v_mfma_f32_16x16x32_bf16 v[60:63], a[80:83], a[4:7], v[60:63]
  v_mfma_f32_16x16x32_bf16 v[92:95], a[80:83], a[8:11], 0
  ds_read_b64_tr_b16 a[64:65], v129 offset:0
  v_mfma_f32_16x16x32_bf16 v[92:95], a[84:87], a[24:27], v[92:95]
  ds_read_b64_tr_b16 a[66:67], v129 offset:1024
  v_mfma_f32_16x16x32_bf16 v[92:95], a[88:91], a[40:43], v[92:95]
  ds_read_b64_tr_b16 a[68:69], v129 offset:12288
  v_mfma_f32_16x16x32_bf16 v[92:95], a[92:95], a[56:59], v[92:95]
  ds_read_b64_tr_b16 a[70:71], v129 offset:13312
  v_mfma_f32_16x16x32_bf16 v[124:127], a[92:95], a[60:63], 0
  ds_read_b64_tr_b16 a[72:73], v129 offset:24576
  v_mfma_f32_16x16x32_bf16 v[124:127], a[88:91], a[44:47], v[124:127]
  ds_read_b64_tr_b16 a[74:75], v129 offset:25600
  v_mfma_f32_16x16x32_bf16 v[124:127], a[84:87], a[28:31], v[124:127]
  ds_read_b64_tr_b16 a[76:77], v129 offset:36864
  v_mfma_f32_16x16x32_bf16 v[124:127], a[80:83], a[12:15], v[124:127]
  s_waitcnt lgkmcnt(7)
  ds_read_b64_tr_b16 a[78:79], v129 offset:37888
  v_mfma_f32_16x16x32_bf16 v[0:3], a[96:99], a[0:3], 0
  v_mfma_f32_16x16x32_bf16 v[0:3], a[100:103], a[16:19], v[0:3]
  v_mfma_f32_16x16x32_bf16 v[0:3], a[104:107], a[32:35], v[0:3]
  v_mfma_f32_16x16x32_bf16 v[0:3], a[108:111], a[48:51], v[0:3]
  v_mfma_f32_16x16x32_bf16 v[32:35], a[108:111], a[52:55], 0
  v_mfma_f32_16x16x32_bf16 v[32:35], a[104:107], a[36:39], v[32:35]
  v_mfma_f32_16x16x32_bf16 v[32:35], a[100:103], a[20:23], v[32:35]
  v_mfma_f32_16x16x32_bf16 v[32:35], a[96:99], a[4:7], v[32:35]
  v_mfma_f32_16x16x32_bf16 v[64:67], a[96:99], a[8:11], 0
  ds_read_b64_tr_b16 a[80:81], v130 offset:0
  v_mfma_f32_16x16x32_bf16 v[64:67], a[100:103], a[24:27], v[64:67]
  ds_read_b64_tr_b16 a[82:83], v130 offset:1024
  v_mfma_f32_16x16x32_bf16 v[64:67], a[104:107], a[40:43], v[64:67]
  ds_read_b64_tr_b16 a[84:85], v130 offset:12288
  v_mfma_f32_16x16x32_bf16 v[64:67], a[108:111], a[56:59], v[64:67]
  ds_read_b64_tr_b16 a[86:87], v130 offset:13312
  v_mfma_f32_16x16x32_bf16 v[96:99], a[108:111], a[60:63], 0
  ds_read_b64_tr_b16 a[88:89], v130 offset:24576
  v_mfma_f32_16x16x32_bf16 v[96:99], a[104:107], a[44:47], v[96:99]
  ds_read_b64_tr_b16 a[90:91], v130 offset:25600
  v_mfma_f32_16x16x32_bf16 v[96:99], a[100:103], a[28:31], v[96:99]
  ds_read_b64_tr_b16 a[92:93], v130 offset:36864
  v_mfma_f32_16x16x32_bf16 v[96:99], a[96:99], a[12:15], v[96:99]
  s_waitcnt lgkmcnt(7)
  ds_read_b64_tr_b16 a[94:95], v130 offset:37888
  s_lshl_b32 s57, s59, 10
  v_mfma_f32_16x16x32_bf16 v[4:7], a[64:67], a[0:3], 0
  buffer_load_dwordx4 a[112:115], v236, s[32:35], s57 offen sc1
  v_mfma_f32_16x16x32_bf16 v[4:7], a[68:71], a[16:19], v[4:7]
  buffer_load_dwordx4 a[116:119], v237, s[32:35], s57 offen sc1
  v_mfma_f32_16x16x32_bf16 v[4:7], a[72:75], a[32:35], v[4:7]
  buffer_load_dwordx4 a[120:123], v238, s[32:35], s57 offen sc1
  v_mfma_f32_16x16x32_bf16 v[4:7], a[76:79], a[48:51], v[4:7]
  buffer_load_dwordx4 a[124:127], v239, s[32:35], s57 offen sc1
  v_mfma_f32_16x16x32_bf16 v[36:39], a[76:79], a[52:55], 0
  s_add_u32 s59, s59, 1
  s_cmp_eq_u32 s59, 20
  s_cselect_b32 s59, 0, s59
  v_mfma_f32_16x16x32_bf16 v[36:39], a[72:75], a[36:39], v[36:39]
  v_mfma_f32_16x16x32_bf16 v[36:39], a[68:71], a[20:23], v[36:39]
  v_mfma_f32_16x16x32_bf16 v[36:39], a[64:67], a[4:7], v[36:39]
  v_mfma_f32_16x16x32_bf16 v[68:71], a[64:67], a[8:11], 0
  ds_read_b64_tr_b16 a[96:97], v131 offset:0
  v_mfma_f32_16x16x32_bf16 v[68:71], a[68:71], a[24:27], v[68:71]
  ds_read_b64_tr_b16 a[98:99], v131 offset:1024
  v_mfma_f32_16x16x32_bf16 v[68:71], a[72:75], a[40:43], v[68:71]
  ds_read_b64_tr_b16 a[100:101], v131 offset:12288
  v_mfma_f32_16x16x32_bf16 v[68:71], a[76:79], a[56:59], v[68:71]
  ds_read_b64_tr_b16 a[102:103], v131 offset:13312
  v_mfma_f32_16x16x32_bf16 v[100:103], a[76:79], a[60:63], 0
  ds_read_b64_tr_b16 a[104:105], v131 offset:24576
  v_mfma_f32_16x16x32_bf16 v[100:103], a[72:75], a[44:47], v[100:103]
  ds_read_b64_tr_b16 a[106:107], v131 offset:25600
  v_mfma_f32_16x16x32_bf16 v[100:103], a[68:71], a[28:31], v[100:103]
  buffer_store_dwordx4 v[208:211], v248, s[20:23], s64 offen offset:0 sc1
  v_mfma_f32_16x16x32_bf16 v[100:103], a[64:67], a[12:15], v[100:103]
  s_waitcnt lgkmcnt(6)
  ds_read_b64_tr_b16 a[108:109], v131 offset:36864
  v_mfma_f32_16x16x32_bf16 v[8:11], a[80:83], a[0:3], 0
  ds_read_b64_tr_b16 a[110:111], v131 offset:37888
  v_mfma_f32_16x16x32_bf16 v[8:11], a[84:87], a[16:19], v[8:11]
  v_mfma_f32_16x16x32_bf16 v[8:11], a[88:91], a[32:35], v[8:11]
  buffer_store_dwordx4 v[212:215], v248, s[20:23], s66 offen offset:0 sc1
  v_mfma_f32_16x16x32_bf16 v[8:11], a[92:95], a[48:51], v[8:11]
  v_subrev_u32 v128, 49152, v128
  v_subrev_u32 v129, 49152, v129
  v_mfma_f32_16x16x32_bf16 v[40:43], a[92:95], a[52:55], 0
  v_subrev_u32 v130, 49152, v130
  v_mfma_f32_16x16x32_bf16 v[40:43], a[88:91], a[36:39], v[40:43]
  v_subrev_u32 v131, 49152, v131
  v_mfma_f32_16x16x32_bf16 v[40:43], a[84:87], a[20:23], v[40:43]
  v_subrev_u32 v132, 49152, v132
  v_mfma_f32_16x16x32_bf16 v[40:43], a[80:83], a[4:7], v[40:43]
  buffer_store_dwordx4 v[216:219], v248, s[20:23], s64 offen offset:1024 sc1
  v_mfma_f32_16x16x32_bf16 v[72:75], a[80:83], a[8:11], 0
  v_subrev_u32 v133, 49152, v133
  v_subrev_u32 v134, 49152, v134
  v_mfma_f32_16x16x32_bf16 v[72:75], a[84:87], a[24:27], v[72:75]
  v_subrev_u32 v135, 49152, v135
  v_mfma_f32_16x16x32_bf16 v[72:75], a[88:91], a[40:43], v[72:75]
  v_subrev_u32 v136, 49152, v136
  v_mfma_f32_16x16x32_bf16 v[72:75], a[92:95], a[56:59], v[72:75]
  buffer_store_dwordx4 v[220:223], v248, s[20:23], s66 offen offset:1024 sc1
  v_mfma_f32_16x16x32_bf16 v[104:107], a[92:95], a[60:63], 0
  v_subrev_u32 v137, 49152, v137
  v_subrev_u32 v138, 49152, v138
  v_mfma_f32_16x16x32_bf16 v[104:107], a[88:91], a[44:47], v[104:107]
  v_subrev_u32 v139, 49152, v139
  v_mfma_f32_16x16x32_bf16 v[104:107], a[84:87], a[28:31], v[104:107]
  v_mfma_f32_16x16x32_bf16 v[104:107], a[80:83], a[12:15], v[104:107]
  s_waitcnt vmcnt(20)
  s_waitcnt lgkmcnt(0)
  s_barrier
  v_mfma_f32_16x16x32_bf16 v[12:15], a[96:99], a[0:3], 0
  ds_read_b64_tr_b16 a[64:65], v128 offset:0
  v_mfma_f32_16x16x32_bf16 v[12:15], a[100:103], a[16:19], v[12:15]
  ds_read_b64_tr_b16 a[66:67], v128 offset:1024
  v_mfma_f32_16x16x32_bf16 v[12:15], a[104:107], a[32:35], v[12:15]
  ds_read_b64_tr_b16 a[68:69], v128 offset:12288
  v_mfma_f32_16x16x32_bf16 v[12:15], a[108:111], a[48:51], v[12:15]
  s_add_u32 m0, s62, 49152
  ds_read_b64_tr_b16 a[70:71], v128 offset:13312
  s_lshl_b32 s51, s58, 18
  v_mfma_f32_16x16x32_bf16 v[44:47], a[108:111], a[52:55], 0
  s_mul_i32 s52, s58, 110592
  ds_read_b64_tr_b16 a[72:73], v128 offset:24576
  v_mfma_f32_16x16x32_bf16 v[44:47], a[104:107], a[36:39], v[44:47]
  ds_read_b64_tr_b16 a[74:75], v128 offset:25600
  v_mfma_f32_16x16x32_bf16 v[44:47], a[100:103], a[20:23], v[44:47]
  ds_read_b64_tr_b16 a[76:77], v128 offset:36864
  v_mfma_f32_16x16x32_bf16 v[44:47], a[96:99], a[4:7], v[44:47]
  ds_read_b64_tr_b16 a[78:79], v128 offset:37888
  v_mfma_f32_16x16x32_bf16 v[76:79], a[96:99], a[8:11], 0
  buffer_load_dwordx4 v240, s[24:27], s51 offen offset:0  lds
  v_mfma_f32_16x16x32_bf16 v[76:79], a[100:103], a[24:27], v[76:79]
  ds_read_b64_tr_b16 a[80:81], v129 offset:0
  v_mfma_f32_16x16x32_bf16 v[76:79], a[104:107], a[40:43], v[76:79]
  ds_read_b64_tr_b16 a[82:83], v129 offset:1024
  v_mfma_f32_16x16x32_bf16 v[76:79], a[108:111], a[56:59], v[76:79]
  buffer_load_dwordx4 v241, s[24:27], s51 offen offset:1024  lds
  v_mfma_f32_16x16x32_bf16 v[108:111], a[108:111], a[60:63], 0
  ds_read_b64_tr_b16 a[84:85], v129 offset:12288
  v_mfma_f32_16x16x32_bf16 v[108:111], a[104:107], a[44:47], v[108:111]
  ds_read_b64_tr_b16 a[86:87], v129 offset:13312
  v_mfma_f32_16x16x32_bf16 v[108:111], a[100:103], a[28:31], v[108:111]
  buffer_load_dwordx4 v242, s[28:31], s52 offen offset:2048  lds
  v_mfma_f32_16x16x32_bf16 v[108:111], a[96:99], a[12:15], v[108:111]
  s_waitcnt vmcnt(10) lgkmcnt(4)
  ds_read_b64_tr_b16 a[88:89], v129 offset:24576
  s_add_u32 s58, s58, 1
  v_mfma_f32_16x16x32_bf16 v[0:3], a[64:67], a[192:195], v[0:3]
  ds_read_b64_tr_b16 a[90:91], v129 offset:25600
  s_cmp_eq_u32 s58, 20
  s_cselect_b32 s58, 0, s58
  v_mfma_f32_16x16x32_bf16 v[0:3], a[68:71], a[208:211], v[0:3]
  s_add_u32 m0, s62, 61440
  ds_read_b64_tr_b16 a[92:93], v129 offset:36864
  s_lshl_b32 s51, s58, 18
  v_mfma_f32_16x16x32_bf16 v[0:3], a[72:75], a[224:227], v[0:3]
  s_mul_i32 s52, s58, 110592
  ds_read_b64_tr_b16 a[94:95], v129 offset:37888
  v_mfma_f32_16x16x32_bf16 v[0:3], a[76:79], a[112:115], v[0:3]
  s_waitcnt vmcnt(9)
  v_mfma_f32_16x16x32_bf16 v[32:35], a[76:79], a[116:119], v[32:35]
  v_mfma_f32_16x16x32_bf16 v[32:35], a[72:75], a[228:231], v[32:35]
  v_mfma_f32_16x16x32_bf16 v[32:35], a[68:71], a[212:215], v[32:35]
  buffer_load_dwordx4 v240, s[24:27], s51 offen offset:0  lds
  v_mfma_f32_16x16x32_bf16 v[32:35], a[64:67], a[196:199], v[32:35]
  s_waitcnt vmcnt(9)
  v_mfma_f32_16x16x32_bf16 v[64:67], a[64:67], a[200:203], v[64:67]
  buffer_load_dwordx4 v241, s[24:27], s51 offen offset:1024  lds
  v_mfma_f32_16x16x32_bf16 v[64:67], a[68:71], a[216:219], v[64:67]
  ds_read_b64_tr_b16 a[96:97], v130 offset:0
  v_mfma_f32_16x16x32_bf16 v[64:67], a[72:75], a[236:239], v[64:67]
  ds_read_b64_tr_b16 a[98:99], v130 offset:1024
  v_mfma_f32_16x16x32_bf16 v[64:67], a[76:79], a[120:123], v[64:67]
  s_waitcnt vmcnt(9)
  ds_read_b64_tr_b16 a[100:101], v130 offset:12288
  v_mfma_f32_16x16x32_bf16 v[96:99], a[76:79], a[124:127], v[96:99]
  ds_read_b64_tr_b16 a[102:103], v130 offset:13312
  v_mfma_f32_16x16x32_bf16 v[96:99], a[72:75], a[240:243], v[96:99]
  buffer_load_dwordx4 v242, s[28:31], s52 offen offset:2048  lds
  v_mfma_f32_16x16x32_bf16 v[96:99], a[68:71], a[220:223], v[96:99]
  s_add_u32 s58, s58, 1
  ds_read_b64_tr_b16 a[104:105], v130 offset:24576
  v_mfma_f32_16x16x32_bf16 v[96:99], a[64:67], a[204:207], v[96:99]
  s_waitcnt lgkmcnt(5)
  ds_read_b64_tr_b16 a[106:107], v130 offset:25600
  v_mfma_f32_16x16x32_bf16 v[4:7], a[80:83], a[192:195], v[4:7]
  ds_read_b64_tr_b16 a[108:109], v130 offset:36864
  s_cmp_eq_u32 s58, 20
  s_cselect_b32 s58, 0, s58
  v_mfma_f32_16x16x32_bf16 v[4:7], a[84:87], a[208:211], v[4:7]
  s_lshl_b32 s57, s59, 10
  ds_read_b64_tr_b16 a[110:111], v130 offset:37888
  v_mfma_f32_16x16x32_bf16 v[4:7], a[88:91], a[224:227], v[4:7]
  buffer_load_dwordx4 a[0:3], v236, s[32:35], s57 offen sc1
  v_mfma_f32_16x16x32_bf16 v[4:7], a[92:95], a[112:115], v[4:7]
  v_mfma_f32_16x16x32_bf16 v[36:39], a[92:95], a[116:119], v[36:39]
  v_mfma_f32_16x16x32_bf16 v[36:39], a[88:91], a[228:231], v[36:39]
  buffer_load_dwordx4 a[4:7], v237, s[32:35], s57 offen sc1
  v_mfma_f32_16x16x32_bf16 v[36:39], a[84:87], a[212:215], v[36:39]
  v_mfma_f32_16x16x32_bf16 v[36:39], a[80:83], a[196:199], v[36:39]
  buffer_load_dwordx4 a[8:11], v238, s[32:35], s57 offen sc1
  v_mfma_f32_16x16x32_bf16 v[68:71], a[80:83], a[200:203], v[68:71]
  ds_read_b64_tr_b16 a[64:65], v131 offset:0
  v_mfma_f32_16x16x32_bf16 v[68:71], a[84:87], a[216:219], v[68:71]
  ds_read_b64_tr_b16 a[66:67], v131 offset:1024
  v_mfma_f32_16x16x32_bf16 v[68:71], a[88:91], a[236:239], v[68:71]
  buffer_load_dwordx4 a[12:15], v239, s[32:35], s57 offen sc1
  v_mfma_f32_16x16x32_bf16 v[68:71], a[92:95], a[120:123], v[68:71]
  s_add_u32 s59, s59, 1
  ds_read_b64_tr_b16 a[68:69], v131 offset:12288
  v_mfma_f32_16x16x32_bf16 v[100:103], a[92:95], a[124:127], v[100:103]
  ds_read_b64_tr_b16 a[70:71], v131 offset:13312
  s_cmp_eq_u32 s59, 20
  s_cselect_b32 s59, 0, s59
  v_mfma_f32_16x16x32_bf16 v[100:103], a[88:91], a[240:243], v[100:103]
  ds_read_b64_tr_b16 a[72:73], v131 offset:24576
  v_mfma_f32_16x16x32_bf16 v[100:103], a[84:87], a[220:223], v[100:103]
  ds_read_b64_tr_b16 a[74:75], v131 offset:25600
  v_mfma_f32_16x16x32_bf16 v[100:103], a[80:83], a[204:207], v[100:103]
  s_waitcnt lgkmcnt(6)
  ds_read_b64_tr_b16 a[76:77], v131 offset:36864
  v_mfma_f32_16x16x32_bf16 v[8:11], a[96:99], a[192:195], v[8:11]
  ds_read_b64_tr_b16 a[78:79], v131 offset:37888
  v_mfma_f32_16x16x32_bf16 v[8:11], a[100:103], a[208:211], v[8:11]
  v_mfma_f32_16x16x32_bf16 v[8:11], a[104:107], a[224:227], v[8:11]
  v_mfma_f32_16x16x32_bf16 v[8:11], a[108:111], a[112:115], v[8:11]
  s_add_u32 m0, s62, 73728
  s_lshl_b32 s51, s58, 18
  s_mul_i32 s52, s58, 110592
  v_mfma_f32_16x16x32_bf16 v[40:43], a[108:111], a[116:119], v[40:43]
  v_mfma_f32_16x16x32_bf16 v[40:43], a[104:107], a[228:231], v[40:43]
  v_mfma_f32_16x16x32_bf16 v[40:43], a[100:103], a[212:215], v[40:43]
  v_mfma_f32_16x16x32_bf16 v[40:43], a[96:99], a[196:199], v[40:43]
  buffer_load_dwordx4 v240, s[24:27], s51 offen offset:0  lds
  v_mfma_f32_16x16x32_bf16 v[72:75], a[96:99], a[200:203], v[72:75]
  ds_read_b64_tr_b16 a[80:81], v132 offset:0
  v_mfma_f32_16x16x32_bf16 v[72:75], a[100:103], a[216:219], v[72:75]
  ds_read_b64_tr_b16 a[82:83], v132 offset:1024
  v_mfma_f32_16x16x32_bf16 v[72:75], a[104:107], a[236:239], v[72:75]
  buffer_load_dwordx4 v241, s[24:27], s51 offen offset:1024  lds
  v_mfma_f32_16x16x32_bf16 v[72:75], a[108:111], a[120:123], v[72:75]
  ds_read_b64_tr_b16 a[84:85], v132 offset:12288
  v_mfma_f32_16x16x32_bf16 v[104:107], a[108:111], a[124:127], v[104:107]
  ds_read_b64_tr_b16 a[86:87], v132 offset:13312
  v_mfma_f32_16x16x32_bf16 v[104:107], a[104:107], a[240:243], v[104:107]
  buffer_load_dwordx4 v242, s[28:31], s52 offen offset:2048  lds
  v_mfma_f32_16x16x32_bf16 v[104:107], a[100:103], a[220:223], v[104:107]
  s_add_u32 s58, s58, 1
  ds_read_b64_tr_b16 a[88:89], v132 offset:24576
  v_mfma_f32_16x16x32_bf16 v[104:107], a[96:99], a[204:207], v[104:107]
  s_waitcnt lgkmcnt(5)
  ds_read_b64_tr_b16 a[90:91], v132 offset:25600
  v_mfma_f32_16x16x32_bf16 v[12:15], a[64:67], a[192:195], v[12:15]
  ds_read_b64_tr_b16 a[92:93], v132 offset:36864
  s_cmp_eq_u32 s58, 20
  s_cselect_b32 s58, 0, s58
  v_mfma_f32_16x16x32_bf16 v[12:15], a[68:71], a[208:211], v[12:15]
  s_add_u32 m0, s62, 86016
  ds_read_b64_tr_b16 a[94:95], v132 offset:37888
  s_lshl_b32 s51, s58, 18
  v_mfma_f32_16x16x32_bf16 v[12:15], a[72:75], a[224:227], v[12:15]
  s_mul_i32 s52, s58, 110592
  v_mfma_f32_16x16x32_bf16 v[12:15], a[76:79], a[112:115], v[12:15]
  buffer_load_dwordx4 v240, s[24:27], s51 offen offset:0  lds
  v_mfma_f32_16x16x32_bf16 v[44:47], a[76:79], a[116:119], v[44:47]
  v_mfma_f32_16x16x32_bf16 v[44:47], a[72:75], a[228:231], v[44:47]
  buffer_load_dwordx4 v241, s[24:27], s51 offen offset:1024  lds
  v_mfma_f32_16x16x32_bf16 v[44:47], a[68:71], a[212:215], v[44:47]
  v_mfma_f32_16x16x32_bf16 v[44:47], a[64:67], a[196:199], v[44:47]
  buffer_load_dwordx4 v242, s[28:31], s52 offen offset:2048  lds
  v_mfma_f32_16x16x32_bf16 v[76:79], a[64:67], a[200:203], v[76:79]
  s_add_u32 s58, s58, 1
  ds_read_b64_tr_b16 a[96:97], v133 offset:0
  v_mfma_f32_16x16x32_bf16 v[76:79], a[68:71], a[216:219], v[76:79]
  ds_read_b64_tr_b16 a[98:99], v133 offset:1024
  s_cmp_eq_u32 s58, 20
  s_cselect_b32 s58, 0, s58
  v_mfma_f32_16x16x32_bf16 v[76:79], a[72:75], a[236:239], v[76:79]
  s_lshl_b32 s57, s59, 10
  ds_read_b64_tr_b16 a[100:101], v133 offset:12288
  v_mfma_f32_16x16x32_bf16 v[76:79], a[76:79], a[120:123], v[76:79]
  ds_read_b64_tr_b16 a[102:103], v133 offset:13312
  v_mfma_f32_16x16x32_bf16 v[108:111], a[76:79], a[124:127], v[108:111]
  ds_read_b64_tr_b16 a[104:105], v133 offset:24576
  v_mfma_f32_16x16x32_bf16 v[108:111], a[72:75], a[240:243], v[108:111]
  ds_read_b64_tr_b16 a[106:107], v133 offset:25600
  v_mfma_f32_16x16x32_bf16 v[108:111], a[68:71], a[220:223], v[108:111]
  buffer_load_dwordx4 a[16:19], v236, s[32:35], s57 offen sc1
  v_mfma_f32_16x16x32_bf16 v[108:111], a[64:67], a[204:207], v[108:111]
  s_waitcnt lgkmcnt(6)
  ds_read_b64_tr_b16 a[108:109], v133 offset:36864
  v_mfma_f32_16x16x32_bf16 v[16:19], a[80:83], a[192:195], v[16:19]
  ds_read_b64_tr_b16 a[110:111], v133 offset:37888
  v_mfma_f32_16x16x32_bf16 v[16:19], a[84:87], a[208:211], v[16:19]
  buffer_load_dwordx4 a[20:23], v237, s[32:35], s57 offen sc1
  v_mfma_f32_16x16x32_bf16 v[16:19], a[88:91], a[224:227], v[16:19]
  buffer_load_dwordx4 a[24:27], v238, s[32:35], s57 offen sc1
  v_mfma_f32_16x16x32_bf16 v[16:19], a[92:95], a[112:115], v[16:19]
  buffer_load_dwordx4 a[28:31], v239, s[32:35], s57 offen sc1
  v_mfma_f32_16x16x32_bf16 v[48:51], a[92:95], a[116:119], v[48:51]
  s_add_u32 s59, s59, 1
  s_cmp_eq_u32 s59, 20
  s_cselect_b32 s59, 0, s59
  v_mfma_f32_16x16x32_bf16 v[48:51], a[88:91], a[228:231], v[48:51]
  v_mfma_f32_16x16x32_bf16 v[48:51], a[84:87], a[212:215], v[48:51]
  v_mfma_f32_16x16x32_bf16 v[48:51], a[80:83], a[196:199], v[48:51]
  v_mfma_f32_16x16x32_bf16 v[80:83], a[80:83], a[200:203], v[80:83]
  buffer_store_dwordx4 v[224:227], v248, s[20:23], s64 offen offset:2048 sc1
  v_mfma_f32_16x16x32_bf16 v[80:83], a[84:87], a[216:219], v[80:83]
  ds_read_b64_tr_b16 a[64:65], v134 offset:0
  v_mfma_f32_16x16x32_bf16 v[80:83], a[88:91], a[236:239], v[80:83]
  ds_read_b64_tr_b16 a[66:67], v134 offset:1024
  v_mfma_f32_16x16x32_bf16 v[80:83], a[92:95], a[120:123], v[80:83]
  buffer_store_dwordx4 v[228:231], v248, s[20:23], s66 offen offset:2048 sc1
  v_mfma_f32_16x16x32_bf16 v[112:115], a[92:95], a[124:127], v[112:115]
  ds_read_b64_tr_b16 a[68:69], v134 offset:12288
  v_mfma_f32_16x16x32_bf16 v[112:115], a[88:91], a[240:243], v[112:115]
  ds_read_b64_tr_b16 a[70:71], v134 offset:13312
  v_mfma_f32_16x16x32_bf16 v[112:115], a[84:87], a[220:223], v[112:115]
  buffer_store_dwordx4 v[232:235], v248, s[20:23], s64 offen offset:3072 sc1
  v_mfma_f32_16x16x32_bf16 v[112:115], a[80:83], a[204:207], v[112:115]
  s_waitcnt lgkmcnt(4)
  ds_read_b64_tr_b16 a[72:73], v134 offset:24576
  v_mfma_f32_16x16x32_bf16 v[20:23], a[96:99], a[192:195], v[20:23]
  ds_read_b64_tr_b16 a[74:75], v134 offset:25600
  v_mfma_f32_16x16x32_bf16 v[20:23], a[100:103], a[208:211], v[20:23]
  buffer_store_dwordx4 v[140:143], v248, s[20:23], s66 offen offset:3072 sc1
  v_mfma_f32_16x16x32_bf16 v[20:23], a[104:107], a[224:227], v[20:23]
  ds_read_b64_tr_b16 a[76:77], v134 offset:36864
  v_mfma_f32_16x16x32_bf16 v[20:23], a[108:111], a[112:115], v[20:23]
  ds_read_b64_tr_b16 a[78:79], v134 offset:37888
  v_mfma_f32_16x16x32_bf16 v[52:55], a[108:111], a[116:119], v[52:55]
  s_lshl_b32 s56, s44, 20
  s_sub_u32 s49, 16, s45
  s_lshl_b32 s49, s49, 15
  v_mfma_f32_16x16x32_bf16 v[52:55], a[104:107], a[228:231], v[52:55]
  s_add_u32 s8, s84, s56
  s_addc_u32 s9, s85, 0
  v_mfma_f32_16x16x32_bf16 v[52:55], a[100:103], a[212:215], v[52:55]
  v_mfma_f32_16x16x32_bf16 v[52:55], a[96:99], a[196:199], v[52:55]
  v_mfma_f32_16x16x32_bf16 v[84:87], a[96:99], a[200:203], v[84:87]
  ds_read_b64_tr_b16 a[80:81], v135 offset:0
  s_add_u32 s8, s8, 3145728
  s_addc_u32 s9, s9, 0
  v_mfma_f32_16x16x32_bf16 v[84:87], a[100:103], a[216:219], v[84:87]
  ds_read_b64_tr_b16 a[82:83], v135 offset:1024
  v_mfma_f32_16x16x32_bf16 v[84:87], a[104:107], a[236:239], v[84:87]
  ds_read_b64_tr_b16 a[84:85], v135 offset:12288
  v_mfma_f32_16x16x32_bf16 v[84:87], a[108:111], a[120:123], v[84:87]
  ds_read_b64_tr_b16 a[86:87], v135 offset:13312
  v_mfma_f32_16x16x32_bf16 v[116:119], a[108:111], a[124:127], v[116:119]
  s_mov_b32 s10, s49
  ds_read_b64_tr_b16 a[88:89], v135 offset:24576
  v_mfma_f32_16x16x32_bf16 v[116:119], a[104:107], a[240:243], v[116:119]
  ds_read_b64_tr_b16 a[90:91], v135 offset:25600
  v_mfma_f32_16x16x32_bf16 v[116:119], a[100:103], a[220:223], v[116:119]
  s_mov_b32 s11, 0x20000
  ds_read_b64_tr_b16 a[92:93], v135 offset:36864
  v_mfma_f32_16x16x32_bf16 v[116:119], a[96:99], a[204:207], v[116:119]
  s_waitcnt lgkmcnt(7)
  ds_read_b64_tr_b16 a[94:95], v135 offset:37888
  s_lshl_b32 s57, s59, 10
  v_mfma_f32_16x16x32_bf16 v[24:27], a[64:67], a[192:195], v[24:27]
  buffer_load_dwordx4 a[32:35], v236, s[32:35], s57 offen sc1
  v_mfma_f32_16x16x32_bf16 v[24:27], a[68:71], a[208:211], v[24:27]
  buffer_load_dwordx4 a[36:39], v237, s[32:35], s57 offen sc1
  v_mfma_f32_16x16x32_bf16 v[24:27], a[72:75], a[224:227], v[24:27]
  v_mov_b32 v250, 0x3f803f80
  v_accvgpr_write_b32 a232, v250
  v_mfma_f32_16x16x32_bf16 v[24:27], a[76:79], a[112:115], v[24:27]
  s_add_u32 s12, s84, s56
  s_addc_u32 s13, s85, 0
  v_mfma_f32_16x16x32_bf16 v[56:59], a[76:79], a[116:119], v[56:59]
  s_add_u32 s12, s12, 3670016
  s_addc_u32 s13, s13, 0
  v_accvgpr_write_b32 a233, v250
  v_mfma_f32_16x16x32_bf16 v[56:59], a[72:75], a[228:231], v[56:59]
  v_mfma_f32_16x16x32_bf16 v[56:59], a[68:71], a[212:215], v[56:59]
  buffer_load_dwordx4 a[40:43], v238, s[32:35], s57 offen sc1
  v_mfma_f32_16x16x32_bf16 v[56:59], a[64:67], a[196:199], v[56:59]
  v_accvgpr_write_b32 a234, v250
  v_mfma_f32_16x16x32_bf16 v[88:91], a[64:67], a[200:203], v[88:91]
  ds_read_b64_tr_b16 a[96:97], v136 offset:0
  v_accvgpr_write_b32 a235, v250
  v_mfma_f32_16x16x32_bf16 v[88:91], a[68:71], a[216:219], v[88:91]
  s_mov_b32 s14, s49
  ds_read_b64_tr_b16 a[98:99], v136 offset:512
  v_mfma_f32_16x16x32_bf16 v[88:91], a[72:75], a[236:239], v[88:91]
  ds_read_b64_tr_b16 a[100:101], v136 offset:12288
  v_mfma_f32_16x16x32_bf16 v[88:91], a[76:79], a[120:123], v[88:91]
  s_mov_b32 s15, 0x20000
  ds_read_b64_tr_b16 a[102:103], v136 offset:12800
  v_mfma_f32_16x16x32_bf16 v[120:123], a[76:79], a[124:127], v[120:123]
  ds_read_b64_tr_b16 a[104:105], v136 offset:24576
  v_mfma_f32_16x16x32_bf16 v[120:123], a[72:75], a[240:243], v[120:123]
  s_lshl_b32 s56, s44, 11
  ds_read_b64_tr_b16 a[106:107], v136 offset:25088
  v_mfma_f32_16x16x32_bf16 v[120:123], a[68:71], a[220:223], v[120:123]
  buffer_load_dwordx4 a[44:47], v239, s[32:35], s57 offen sc1
  v_mfma_f32_16x16x32_bf16 v[120:123], a[64:67], a[204:207], v[120:123]
  s_waitcnt lgkmcnt(6)
  ds_read_b64_tr_b16 a[108:109], v136 offset:36864
  s_add_u32 s59, s59, 1
  v_mfma_f32_16x16x32_bf16 v[28:31], a[80:83], a[192:195], v[28:31]
  s_sub_u32 s49, 7077888, s56
  ds_read_b64_tr_b16 a[110:111], v136 offset:37376
  v_mfma_f32_16x16x32_bf16 v[28:31], a[84:87], a[208:211], v[28:31]
  s_cmp_lt_u32 s44, 27
  s_cselect_b32 s49, s49, 0
  v_mfma_f32_16x16x32_bf16 v[28:31], a[88:91], a[224:227], v[28:31]
  s_cmp_eq_u32 s59, 20
  s_cselect_b32 s59, 0, s59
  v_mfma_f32_16x16x32_bf16 v[28:31], a[92:95], a[112:115], v[28:31]
  v_mfma_f32_16x16x32_bf16 v[60:63], a[92:95], a[116:119], v[60:63]
  v_mfma_f32_16x16x32_bf16 v[60:63], a[88:91], a[228:231], v[60:63]
  s_add_u32 s76, s84, s56
  s_addc_u32 s77, s85, 0
  v_mfma_f32_16x16x32_bf16 v[60:63], a[84:87], a[212:215], v[60:63]
  v_mfma_f32_16x16x32_bf16 v[60:63], a[80:83], a[196:199], v[60:63]
  v_mfma_f32_16x16x32_bf16 v[92:95], a[80:83], a[200:203], v[92:95]
  ds_read_b64_tr_b16 a[64:65], v137 offset:0
  v_mfma_f32_16x16x32_bf16 v[92:95], a[84:87], a[216:219], v[92:95]
  ds_read_b64_tr_b16 a[66:67], v137 offset:512
  s_add_u32 s76, s76, 53477376
  s_addc_u32 s77, s77, 0
  v_mfma_f32_16x16x32_bf16 v[92:95], a[88:91], a[236:239], v[92:95]
  ds_read_b64_tr_b16 a[68:69], v137 offset:12288
  v_mfma_f32_16x16x32_bf16 v[92:95], a[92:95], a[120:123], v[92:95]
  ds_read_b64_tr_b16 a[70:71], v137 offset:12800
  v_mfma_f32_16x16x32_bf16 v[124:127], a[92:95], a[124:127], v[124:127]
  ds_read_b64_tr_b16 a[72:73], v137 offset:24576
  v_mfma_f32_16x16x32_bf16 v[124:127], a[88:91], a[240:243], v[124:127]
  ds_read_b64_tr_b16 a[74:75], v137 offset:25088
  v_mfma_f32_16x16x32_bf16 v[124:127], a[84:87], a[220:223], v[124:127]
  s_mov_b32 s78, s49
  ds_read_b64_tr_b16 a[76:77], v137 offset:36864
  v_mfma_f32_16x16x32_bf16 v[124:127], a[80:83], a[204:207], v[124:127]
  s_waitcnt lgkmcnt(7)
  ds_read_b64_tr_b16 a[78:79], v137 offset:37376
  v_mfma_f32_16x16x32_bf16 v[144:147], a[96:99], a[192:195], v[144:147]
  s_mov_b32 s79, 0x20000
  v_mfma_f32_16x16x32_bf16 v[144:147], a[100:103], a[208:211], v[144:147]
  v_mfma_f32_16x16x32_bf16 v[144:147], a[104:107], a[224:227], v[144:147]
  s_lshl_b32 s56, s44, 12
  v_mfma_f32_16x16x32_bf16 v[144:147], a[108:111], a[112:115], v[144:147]
  v_mfma_f32_16x16x32_bf16 v[160:163], a[108:111], a[116:119], v[160:163]
  s_sub_u32 s49, 16777216, s56
  v_mfma_f32_16x16x32_bf16 v[160:163], a[104:107], a[228:231], v[160:163]
  v_mfma_f32_16x16x32_bf16 v[160:163], a[100:103], a[212:215], v[160:163]
  s_add_u32 s16, s84, s56
  s_addc_u32 s17, s85, 0
  v_mfma_f32_16x16x32_bf16 v[160:163], a[96:99], a[196:199], v[160:163]
  v_mfma_f32_16x16x32_bf16 v[176:179], a[96:99], a[200:203], v[176:179]
  ds_read_b64_tr_b16 a[80:81], v138 offset:0
  v_mfma_f32_16x16x32_bf16 v[176:179], a[100:103], a[216:219], v[176:179]
  ds_read_b64_tr_b16 a[82:83], v138 offset:512
  v_mfma_f32_16x16x32_bf16 v[176:179], a[104:107], a[236:239], v[176:179]
  ds_read_b64_tr_b16 a[84:85], v138 offset:12288
  s_add_u32 s16, s16, 36700160
  s_addc_u32 s17, s17, 0
  v_mfma_f32_16x16x32_bf16 v[176:179], a[108:111], a[120:123], v[176:179]
  ds_read_b64_tr_b16 a[86:87], v138 offset:12800
  v_mfma_f32_16x16x32_bf16 v[192:195], a[108:111], a[124:127], v[192:195]
  ds_read_b64_tr_b16 a[88:89], v138 offset:24576
  v_mfma_f32_16x16x32_bf16 v[192:195], a[104:107], a[240:243], v[192:195]
  ds_read_b64_tr_b16 a[90:91], v138 offset:25088
  v_mfma_f32_16x16x32_bf16 v[192:195], a[100:103], a[220:223], v[192:195]
  s_mov_b32 s18, s49
  ds_read_b64_tr_b16 a[92:93], v138 offset:36864
  v_mfma_f32_16x16x32_bf16 v[192:195], a[96:99], a[204:207], v[192:195]
  s_waitcnt lgkmcnt(7)
  ds_read_b64_tr_b16 a[94:95], v138 offset:37376
  s_lshl_b32 s57, s59, 10
  v_mfma_f32_16x16x32_bf16 v[148:151], a[64:67], a[192:195], v[148:151]
  s_mov_b32 s19, 0x20000
  buffer_load_dwordx4 a[48:51], v236, s[32:35], s57 offen sc1
  v_mfma_f32_16x16x32_bf16 v[148:151], a[68:71], a[208:211], v[148:151]
  buffer_load_dwordx4 a[52:55], v237, s[32:35], s57 offen sc1
  v_mfma_f32_16x16x32_bf16 v[148:151], a[72:75], a[224:227], v[148:151]
  s_getpc_b64 s[80:81]
recurrent_scan__compressed_kv_cla__dense_activation_silu__prompt_kernel_cp1:
  s_add_u32 s80, s80, recurrent_scan__compressed_kv_cla__dense_activation_silu__prompt_kernel_s14-recurrent_scan__compressed_kv_cla__dense_activation_silu__prompt_kernel_cp1
  s_addc_u32 s81, s81, 0
  v_mfma_f32_16x16x32_bf16 v[148:151], a[76:79], a[112:115], v[148:151]
  v_mfma_f32_16x16x32_bf16 v[164:167], a[76:79], a[116:119], v[164:167]
  v_mfma_f32_16x16x32_bf16 v[164:167], a[72:75], a[228:231], v[164:167]
  v_mfma_f32_16x16x32_bf16 v[164:167], a[68:71], a[212:215], v[164:167]
  buffer_load_dwordx4 a[56:59], v238, s[32:35], s57 offen sc1
  v_mfma_f32_16x16x32_bf16 v[164:167], a[64:67], a[196:199], v[164:167]
  v_mfma_f32_16x16x32_bf16 v[180:183], a[64:67], a[200:203], v[180:183]
  ds_read_b64_tr_b16 a[96:97], v139 offset:0
  v_mfma_f32_16x16x32_bf16 v[180:183], a[68:71], a[216:219], v[180:183]
  s_lshr_b32 s56, s2, 3
  ds_read_b64_tr_b16 a[98:99], v139 offset:512
  v_mfma_f32_16x16x32_bf16 v[180:183], a[72:75], a[236:239], v[180:183]
  ds_read_b64_tr_b16 a[100:101], v139 offset:12288
  v_mfma_f32_16x16x32_bf16 v[180:183], a[76:79], a[120:123], v[180:183]
  s_lshl_b32 s56, s56, 2
  ds_read_b64_tr_b16 a[102:103], v139 offset:12800
  v_mfma_f32_16x16x32_bf16 v[196:199], a[76:79], a[124:127], v[196:199]
  ds_read_b64_tr_b16 a[104:105], v139 offset:24576
  v_mfma_f32_16x16x32_bf16 v[196:199], a[72:75], a[240:243], v[196:199]
  s_add_u32 s56, s56, s3
  ds_read_b64_tr_b16 a[106:107], v139 offset:25088
  v_mfma_f32_16x16x32_bf16 v[196:199], a[68:71], a[220:223], v[196:199]
  buffer_load_dwordx4 a[60:63], v239, s[32:35], s57 offen sc1
  v_mfma_f32_16x16x32_bf16 v[196:199], a[64:67], a[204:207], v[196:199]
  s_waitcnt lgkmcnt(6)
  ds_read_b64_tr_b16 a[108:109], v139 offset:36864
  s_add_u32 s59, s59, 1
  v_mfma_f32_16x16x32_bf16 v[152:155], a[80:83], a[192:195], v[152:155]
  s_mul_i32 s56, s56, 1024
  ds_read_b64_tr_b16 a[110:111], v139 offset:37376
  v_mfma_f32_16x16x32_bf16 v[152:155], a[84:87], a[208:211], v[152:155]
  v_mfma_f32_16x16x32_bf16 v[152:155], a[88:91], a[224:227], v[152:155]
  s_cmp_eq_u32 s59, 20
  s_cselect_b32 s59, 0, s59
  v_add_u32 v128, 49152, v128
  v_mfma_f32_16x16x32_bf16 v[152:155], a[92:95], a[112:115], v[152:155]
  v_add_u32 v129, 49152, v129
  v_mfma_f32_16x16x32_bf16 v[168:171], a[92:95], a[116:119], v[168:171]
  v_add_u32 v130, 49152, v130
  v_mfma_f32_16x16x32_bf16 v[168:171], a[88:91], a[228:231], v[168:171]
  v_add_u32 v131, 49152, v131
  v_mfma_f32_16x16x32_bf16 v[168:171], a[84:87], a[212:215], v[168:171]
  v_add_u32 v132, 49152, v132
  v_mfma_f32_16x16x32_bf16 v[168:171], a[80:83], a[196:199], v[168:171]
  v_add_u32 v133, 49152, v133
  v_and_b32 v253, 7, v249
  v_mfma_f32_16x16x32_bf16 v[184:187], a[80:83], a[200:203], v[184:187]
  v_add_u32 v134, 49152, v134
  v_mfma_f32_16x16x32_bf16 v[184:187], a[84:87], a[216:219], v[184:187]
  v_add_u32 v135, 49152, v135
  v_lshlrev_b32 v253, 7, v253
  v_mfma_f32_16x16x32_bf16 v[184:187], a[88:91], a[236:239], v[184:187]
  v_add_u32 v136, 49152, v136
  v_mfma_f32_16x16x32_bf16 v[184:187], a[92:95], a[120:123], v[184:187]
  v_add_u32 v137, 49152, v137
  v_add_u32 v253, s56, v253
  v_mfma_f32_16x16x32_bf16 v[200:203], a[92:95], a[124:127], v[200:203]
  v_add_u32 v138, 49152, v138
  v_mfma_f32_16x16x32_bf16 v[200:203], a[88:91], a[240:243], v[200:203]
  v_add_u32 v139, 49152, v139
  v_min_u32 v253, recurrent_scan__compressed_kv_cla__dense_activation_silu__prompt_kernel_last-recurrent_scan__compressed_kv_cla__dense_activation_silu__prompt_kernel_s14, v253
  v_mfma_f32_16x16x32_bf16 v[200:203], a[84:87], a[220:223], v[200:203]
  v_mfma_f32_16x16x32_bf16 v[200:203], a[80:83], a[204:207], v[200:203]
  s_waitcnt vmcnt(8)
  s_waitcnt lgkmcnt(0)
  s_barrier
  v_mfma_f32_16x16x32_bf16 v[156:159], a[96:99], a[192:195], v[156:159]
  ds_read_b64_tr_b16 a[64:65], v128 offset:0
  v_mfma_f32_16x16x32_bf16 v[156:159], a[100:103], a[208:211], v[156:159]
  ds_read_b64_tr_b16 a[66:67], v128 offset:1024
  v_mfma_f32_16x16x32_bf16 v[156:159], a[104:107], a[224:227], v[156:159]
  ds_read_b64_tr_b16 a[68:69], v128 offset:12288
  v_mfma_f32_16x16x32_bf16 v[156:159], a[108:111], a[112:115], v[156:159]
  s_lshl_b32 s53, s44, 5
  ds_read_b64_tr_b16 a[70:71], v128 offset:13312
  s_add_u32 s53, s53, s45
  v_mfma_f32_16x16x32_bf16 v[172:175], a[108:111], a[116:119], v[172:175]
  s_lshl_b32 s53, s53, 2
  ds_read_b64_tr_b16 a[72:73], v128 offset:24576
  v_mfma_f32_16x16x32_bf16 v[172:175], a[104:107], a[228:231], v[172:175]
  ds_read_b64_tr_b16 a[74:75], v128 offset:25600
  v_mfma_f32_16x16x32_bf16 v[172:175], a[100:103], a[212:215], v[172:175]
  ds_read_b64_tr_b16 a[76:77], v128 offset:36864
  v_mfma_f32_16x16x32_bf16 v[172:175], a[96:99], a[196:199], v[172:175]
  ds_read_b64_tr_b16 a[78:79], v128 offset:37888
  v_mov_b32 v254, 1
  v_mfma_f32_16x16x32_bf16 v[188:191], a[96:99], a[200:203], v[188:191]
  global_load_dword v253, v253, s[80:81]
  v_mfma_f32_16x16x32_bf16 v[188:191], a[100:103], a[216:219], v[188:191]
  buffer_store_dword v254, v255, s[68:71], s53 offen sc1
  v_mfma_f32_16x16x32_bf16 v[188:191], a[104:107], a[236:239], v[188:191]
  s_add_u32 m0, s62, 0
  ds_read_b64_tr_b16 a[80:81], v129 offset:0
  s_lshl_b32 s51, s58, 18
  v_mfma_f32_16x16x32_bf16 v[188:191], a[108:111], a[120:123], v[188:191]
  s_mul_i32 s52, s58, 110592
  ds_read_b64_tr_b16 a[82:83], v129 offset:1024
  v_mfma_f32_16x16x32_bf16 v[204:207], a[108:111], a[124:127], v[204:207]
  ds_read_b64_tr_b16 a[84:85], v129 offset:12288
  v_mfma_f32_16x16x32_bf16 v[204:207], a[104:107], a[240:243], v[204:207]
  ds_read_b64_tr_b16 a[86:87], v129 offset:13312
  v_mfma_f32_16x16x32_bf16 v[204:207], a[100:103], a[220:223], v[204:207]
  ds_read_b64_tr_b16 a[88:89], v129 offset:24576
  v_mfma_f32_16x16x32_bf16 v[204:207], a[96:99], a[204:207], v[204:207]
  s_waitcnt vmcnt(5) lgkmcnt(5)
  ds_read_b64_tr_b16 a[90:91], v129 offset:25600
  v_mfma_f32_16x16x32_bf16 v[0:3], a[64:67], a[0:3], v[0:3]
  buffer_load_dwordx4 v240, s[24:27], s51 offen offset:0  lds
  v_mfma_f32_16x16x32_bf16 v[0:3], a[68:71], a[16:19], v[0:3]
  ds_read_b64_tr_b16 a[92:93], v129 offset:36864
  v_mfma_f32_16x16x32_bf16 v[0:3], a[72:75], a[32:35], v[0:3]
  ds_read_b64_tr_b16 a[94:95], v129 offset:37888
  v_mfma_f32_16x16x32_bf16 v[0:3], a[76:79], a[48:51], v[0:3]
  s_waitcnt vmcnt(5)
  buffer_load_dwordx4 v241, s[24:27], s51 offen offset:1024  lds
  v_mfma_f32_16x16x32_bf16 v[32:35], a[76:79], a[52:55], v[32:35]
  buffer_load_dwordx4 v242, s[28:31], s52 offen offset:2048  lds
  v_mfma_f32_16x16x32_bf16 v[32:35], a[72:75], a[36:39], v[32:35]
  s_add_u32 s58, s58, 1
  s_cmp_eq_u32 s58, 20
  s_cselect_b32 s58, 0, s58
  v_mfma_f32_16x16x32_bf16 v[32:35], a[68:71], a[20:23], v[32:35]
  s_add_u32 m0, s62, 12288
  s_lshl_b32 s51, s58, 18
  s_mul_i32 s52, s58, 110592
  v_mfma_f32_16x16x32_bf16 v[32:35], a[64:67], a[4:7], v[32:35]
  s_waitcnt vmcnt(6)
  v_mfma_f32_16x16x32_bf16 v[64:67], a[64:67], a[8:11], v[64:67]
  ds_read_b64_tr_b16 a[96:97], v130 offset:0
  v_mfma_f32_16x16x32_bf16 v[64:67], a[68:71], a[24:27], v[64:67]
  ds_read_b64_tr_b16 a[98:99], v130 offset:1024
  v_mfma_f32_16x16x32_bf16 v[64:67], a[72:75], a[40:43], v[64:67]
  buffer_load_dwordx4 v240, s[24:27], s51 offen offset:0  lds
  v_mfma_f32_16x16x32_bf16 v[64:67], a[76:79], a[56:59], v[64:67]
  s_waitcnt vmcnt(6)
  ds_read_b64_tr_b16 a[100:101], v130 offset:12288
  v_mfma_f32_16x16x32_bf16 v[96:99], a[76:79], a[60:63], v[96:99]
  ds_read_b64_tr_b16 a[102:103], v130 offset:13312
  v_mfma_f32_16x16x32_bf16 v[96:99], a[72:75], a[44:47], v[96:99]
  buffer_load_dwordx4 v241, s[24:27], s51 offen offset:1024  lds
  v_mfma_f32_16x16x32_bf16 v[96:99], a[68:71], a[28:31], v[96:99]
  ds_read_b64_tr_b16 a[104:105], v130 offset:24576
  v_mfma_f32_16x16x32_bf16 v[96:99], a[64:67], a[12:15], v[96:99]
  s_waitcnt lgkmcnt(5)
  ds_read_b64_tr_b16 a[106:107], v130 offset:25600
  v_mfma_f32_16x16x32_bf16 v[4:7], a[80:83], a[0:3], v[4:7]
  buffer_load_dwordx4 v242, s[28:31], s52 offen offset:2048  lds
  v_mfma_f32_16x16x32_bf16 v[4:7], a[84:87], a[16:19], v[4:7]
  s_add_u32 s58, s58, 1
  ds_read_b64_tr_b16 a[108:109], v130 offset:36864
  v_mfma_f32_16x16x32_bf16 v[4:7], a[88:91], a[32:35], v[4:7]
  ds_read_b64_tr_b16 a[110:111], v130 offset:37888
  s_cmp_eq_u32 s58, 20
  s_cselect_b32 s58, 0, s58
  v_mfma_f32_16x16x32_bf16 v[4:7], a[92:95], a[48:51], v[4:7]
  s_lshl_b32 s57, s59, 10
  v_mfma_f32_16x16x32_bf16 v[36:39], a[92:95], a[52:55], v[36:39]
  buffer_load_dwordx4 a[192:195], v236, s[32:35], s57 offen sc1
  v_mfma_f32_16x16x32_bf16 v[36:39], a[88:91], a[36:39], v[36:39]
  v_mfma_f32_16x16x32_bf16 v[36:39], a[84:87], a[20:23], v[36:39]
  buffer_load_dwordx4 a[196:199], v237, s[32:35], s57 offen sc1
  v_mfma_f32_16x16x32_bf16 v[36:39], a[80:83], a[4:7], v[36:39]
  v_mfma_f32_16x16x32_bf16 v[68:71], a[80:83], a[8:11], v[68:71]
  buffer_load_dwordx4 a[200:203], v238, s[32:35], s57 offen sc1
  v_mfma_f32_16x16x32_bf16 v[68:71], a[84:87], a[24:27], v[68:71]
  ds_read_b64_tr_b16 a[64:65], v131 offset:0
  v_mfma_f32_16x16x32_bf16 v[68:71], a[88:91], a[40:43], v[68:71]
  ds_read_b64_tr_b16 a[66:67], v131 offset:1024
  v_mfma_f32_16x16x32_bf16 v[68:71], a[92:95], a[56:59], v[68:71]
  buffer_load_dwordx4 a[204:207], v239, s[32:35], s57 offen sc1
  v_mfma_f32_16x16x32_bf16 v[100:103], a[92:95], a[60:63], v[100:103]
  s_add_u32 s59, s59, 1
  ds_read_b64_tr_b16 a[68:69], v131 offset:12288
  v_mfma_f32_16x16x32_bf16 v[100:103], a[88:91], a[44:47], v[100:103]
  ds_read_b64_tr_b16 a[70:71], v131 offset:13312
  s_cmp_eq_u32 s59, 20
  s_cselect_b32 s59, 0, s59
  v_mfma_f32_16x16x32_bf16 v[100:103], a[84:87], a[28:31], v[100:103]
  ds_read_b64_tr_b16 a[72:73], v131 offset:24576
  v_mfma_f32_16x16x32_bf16 v[100:103], a[80:83], a[12:15], v[100:103]
  s_waitcnt lgkmcnt(5)
  ds_read_b64_tr_b16 a[74:75], v131 offset:25600
  v_mfma_f32_16x16x32_bf16 v[8:11], a[96:99], a[0:3], v[8:11]
  ds_read_b64_tr_b16 a[76:77], v131 offset:36864
  v_mfma_f32_16x16x32_bf16 v[8:11], a[100:103], a[16:19], v[8:11]
  ds_read_b64_tr_b16 a[78:79], v131 offset:37888
  v_mfma_f32_16x16x32_bf16 v[8:11], a[104:107], a[32:35], v[8:11]
  v_mfma_f32_16x16x32_bf16 v[8:11], a[108:111], a[48:51], v[8:11]
  s_add_u32 m0, s62, 24576
  s_lshl_b32 s51, s58, 18
  s_mul_i32 s52, s58, 110592
  v_mfma_f32_16x16x32_bf16 v[40:43], a[108:111], a[52:55], v[40:43]
  s_add_u32 s53, s3, 0
  s_and_b32 s53, s53, 3
  s_lshl_b32 s56, s47, 3
  v_mfma_f32_16x16x32_bf16 v[40:43], a[104:107], a[36:39], v[40:43]
  v_mfma_f32_16x16x32_bf16 v[40:43], a[100:103], a[20:23], v[40:43]
  v_mfma_f32_16x16x32_bf16 v[40:43], a[96:99], a[4:7], v[40:43]
  s_sub_u32 s49, 118, s56
  buffer_load_dwordx4 v240, s[24:27], s51 offen offset:0  lds
  v_mfma_f32_16x16x32_bf16 v[72:75], a[96:99], a[8:11], v[72:75]
  ds_read_b64_tr_b16 a[80:81], v132 offset:0
  v_mfma_f32_16x16x32_bf16 v[72:75], a[100:103], a[24:27], v[72:75]
  ds_read_b64_tr_b16 a[82:83], v132 offset:1024
  v_mfma_f32_16x16x32_bf16 v[72:75], a[104:107], a[40:43], v[72:75]
  buffer_load_dwordx4 v241, s[24:27], s51 offen offset:1024  lds
  v_mfma_f32_16x16x32_bf16 v[72:75], a[108:111], a[56:59], v[72:75]
  ds_read_b64_tr_b16 a[84:85], v132 offset:12288
  s_cmp_lt_u32 s53, 2
  s_cselect_b32 s56, s56, s49
  v_mfma_f32_16x16x32_bf16 v[104:107], a[108:111], a[60:63], v[104:107]
  ds_read_b64_tr_b16 a[86:87], v132 offset:13312
  v_mfma_f32_16x16x32_bf16 v[104:107], a[104:107], a[44:47], v[104:107]
  buffer_load_dwordx4 v242, s[28:31], s52 offen offset:2048  lds
  v_mfma_f32_16x16x32_bf16 v[104:107], a[100:103], a[28:31], v[104:107]
  s_add_u32 s58, s58, 1
  ds_read_b64_tr_b16 a[88:89], v132 offset:24576
  v_mfma_f32_16x16x32_bf16 v[104:107], a[96:99], a[12:15], v[104:107]
  s_waitcnt lgkmcnt(5)
  ds_read_b64_tr_b16 a[90:91], v132 offset:25600
  v_mfma_f32_16x16x32_bf16 v[12:15], a[64:67], a[0:3], v[12:15]
  ds_read_b64_tr_b16 a[92:93], v132 offset:36864
  s_cmp_eq_u32 s58, 20
  s_cselect_b32 s58, 0, s58
  v_mfma_f32_16x16x32_bf16 v[12:15], a[68:71], a[16:19], v[12:15]
  s_add_u32 m0, s62, 36864
  ds_read_b64_tr_b16 a[94:95], v132 offset:37888
  s_lshl_b32 s51, s58, 18
  v_mfma_f32_16x16x32_bf16 v[12:15], a[72:75], a[32:35], v[12:15]
  s_mul_i32 s52, s58, 110592
  s_add_u32 s56, s56, s53
  v_mfma_f32_16x16x32_bf16 v[12:15], a[76:79], a[48:51], v[12:15]
  s_lshl_b32 s49, s46, 1
  v_mfma_f32_16x16x32_bf16 v[44:47], a[76:79], a[52:55], v[44:47]
  v_mfma_f32_16x16x32_bf16 v[44:47], a[72:75], a[36:39], v[44:47]
  v_mfma_f32_16x16x32_bf16 v[44:47], a[68:71], a[20:23], v[44:47]
  s_add_u32 s56, s56, s49
  buffer_load_dwordx4 v240, s[24:27], s51 offen offset:0  lds
  v_mfma_f32_16x16x32_bf16 v[44:47], a[64:67], a[4:7], v[44:47]
  v_mfma_f32_16x16x32_bf16 v[76:79], a[64:67], a[8:11], v[76:79]
  buffer_load_dwordx4 v241, s[24:27], s51 offen offset:1024  lds
  v_mfma_f32_16x16x32_bf16 v[76:79], a[68:71], a[24:27], v[76:79]
  s_mul_i32 s56, s56, 55296
  ds_read_b64_tr_b16 a[96:97], v133 offset:0
  v_mfma_f32_16x16x32_bf16 v[76:79], a[72:75], a[40:43], v[76:79]
  ds_read_b64_tr_b16 a[98:99], v133 offset:1024
  v_mfma_f32_16x16x32_bf16 v[76:79], a[76:79], a[56:59], v[76:79]
  ds_read_b64_tr_b16 a[100:101], v133 offset:12288
  v_mfma_f32_16x16x32_bf16 v[108:111], a[76:79], a[60:63], v[108:111]
  ds_read_b64_tr_b16 a[102:103], v133 offset:13312
  s_add_u32 s4, s84, s56
  s_addc_u32 s5, s85, 0
  v_mfma_f32_16x16x32_bf16 v[108:111], a[72:75], a[44:47], v[108:111]
  buffer_load_dwordx4 v242, s[28:31], s52 offen offset:2048  lds
  v_mfma_f32_16x16x32_bf16 v[108:111], a[68:71], a[28:31], v[108:111]
  s_add_u32 s58, s58, 1
  ds_read_b64_tr_b16 a[104:105], v133 offset:24576
  v_mfma_f32_16x16x32_bf16 v[108:111], a[64:67], a[12:15], v[108:111]
  s_waitcnt lgkmcnt(5)
  ds_read_b64_tr_b16 a[106:107], v133 offset:25600
  v_mfma_f32_16x16x32_bf16 v[16:19], a[80:83], a[0:3], v[16:19]
  ds_read_b64_tr_b16 a[108:109], v133 offset:36864
  s_cmp_eq_u32 s58, 20
  s_cselect_b32 s58, 0, s58
  v_mfma_f32_16x16x32_bf16 v[16:19], a[84:87], a[16:19], v[16:19]
  s_lshl_b32 s57, s59, 10
  ds_read_b64_tr_b16 a[110:111], v133 offset:37888
  v_mfma_f32_16x16x32_bf16 v[16:19], a[88:91], a[32:35], v[16:19]
  buffer_load_dwordx4 a[208:211], v236, s[32:35], s57 offen sc1
  v_mfma_f32_16x16x32_bf16 v[16:19], a[92:95], a[48:51], v[16:19]
  s_add_u32 s4, s4, 53477376
  s_addc_u32 s5, s5, 0
  v_mfma_f32_16x16x32_bf16 v[48:51], a[92:95], a[52:55], v[48:51]
  v_mfma_f32_16x16x32_bf16 v[48:51], a[88:91], a[36:39], v[48:51]
  buffer_load_dwordx4 a[212:215], v237, s[32:35], s57 offen sc1
  v_mfma_f32_16x16x32_bf16 v[48:51], a[84:87], a[20:23], v[48:51]
  v_mfma_f32_16x16x32_bf16 v[48:51], a[80:83], a[4:7], v[48:51]
  buffer_load_dwordx4 a[216:219], v238, s[32:35], s57 offen sc1
  v_mfma_f32_16x16x32_bf16 v[80:83], a[80:83], a[8:11], v[80:83]
  s_mov_b32 s6, 55296
  ds_read_b64_tr_b16 a[64:65], v134 offset:0
  v_mfma_f32_16x16x32_bf16 v[80:83], a[84:87], a[24:27], v[80:83]
  ds_read_b64_tr_b16 a[66:67], v134 offset:1024
  v_mfma_f32_16x16x32_bf16 v[80:83], a[88:91], a[40:43], v[80:83]
  buffer_load_dwordx4 a[220:223], v239, s[32:35], s57 offen sc1
  v_mfma_f32_16x16x32_bf16 v[80:83], a[92:95], a[56:59], v[80:83]
  s_add_u32 s59, s59, 1
  ds_read_b64_tr_b16 a[68:69], v134 offset:12288
  s_mov_b32 s7, 0x20000
  v_mfma_f32_16x16x32_bf16 v[112:115], a[92:95], a[60:63], v[112:115]
  ds_read_b64_tr_b16 a[70:71], v134 offset:13312
  s_cmp_eq_u32 s59, 20
  s_cselect_b32 s59, 0, s59
  v_mfma_f32_16x16x32_bf16 v[112:115], a[88:91], a[44:47], v[112:115]
  ds_read_b64_tr_b16 a[72:73], v134 offset:24576
  v_mfma_f32_16x16x32_bf16 v[112:115], a[84:87], a[28:31], v[112:115]
  s_add_u32 s53, s3, 1
  ds_read_b64_tr_b16 a[74:75], v134 offset:25600
  v_mfma_f32_16x16x32_bf16 v[112:115], a[80:83], a[12:15], v[112:115]
  s_waitcnt lgkmcnt(6)
  ds_read_b64_tr_b16 a[76:77], v134 offset:36864
  v_mfma_f32_16x16x32_bf16 v[20:23], a[96:99], a[0:3], v[20:23]
  ds_read_b64_tr_b16 a[78:79], v134 offset:37888
  v_mfma_f32_16x16x32_bf16 v[20:23], a[100:103], a[16:19], v[20:23]
  s_and_b32 s53, s53, 3
  v_mfma_f32_16x16x32_bf16 v[20:23], a[104:107], a[32:35], v[20:23]
  v_mfma_f32_16x16x32_bf16 v[20:23], a[108:111], a[48:51], v[20:23]
  v_mfma_f32_16x16x32_bf16 v[52:55], a[108:111], a[52:55], v[52:55]
  s_lshl_b32 s56, s47, 3
  v_mfma_f32_16x16x32_bf16 v[52:55], a[104:107], a[36:39], v[52:55]
  v_mfma_f32_16x16x32_bf16 v[52:55], a[100:103], a[20:23], v[52:55]
  v_mfma_f32_16x16x32_bf16 v[52:55], a[96:99], a[4:7], v[52:55]
  s_sub_u32 s49, 118, s56
  v_mfma_f32_16x16x32_bf16 v[84:87], a[96:99], a[8:11], v[84:87]
  ds_read_b64_tr_b16 a[80:81], v135 offset:0
  v_mfma_f32_16x16x32_bf16 v[84:87], a[100:103], a[24:27], v[84:87]
  ds_read_b64_tr_b16 a[82:83], v135 offset:1024
  v_mfma_f32_16x16x32_bf16 v[84:87], a[104:107], a[40:43], v[84:87]
  ds_read_b64_tr_b16 a[84:85], v135 offset:12288
  s_cmp_lt_u32 s53, 2
  s_cselect_b32 s56, s56, s49
  v_mfma_f32_16x16x32_bf16 v[84:87], a[108:111], a[56:59], v[84:87]
  ds_read_b64_tr_b16 a[86:87], v135 offset:13312
  v_mfma_f32_16x16x32_bf16 v[116:119], a[108:111], a[60:63], v[116:119]
  ds_read_b64_tr_b16 a[88:89], v135 offset:24576
  v_mfma_f32_16x16x32_bf16 v[116:119], a[104:107], a[44:47], v[116:119]
  ds_read_b64_tr_b16 a[90:91], v135 offset:25600
  v_mfma_f32_16x16x32_bf16 v[116:119], a[100:103], a[28:31], v[116:119]
  ds_read_b64_tr_b16 a[92:93], v135 offset:36864
  v_mfma_f32_16x16x32_bf16 v[116:119], a[96:99], a[12:15], v[116:119]
  s_waitcnt lgkmcnt(7)
  ds_read_b64_tr_b16 a[94:95], v135 offset:37888
  s_lshl_b32 s57, s59, 10
  v_mfma_f32_16x16x32_bf16 v[24:27], a[64:67], a[0:3], v[24:27]
  s_add_u32 s56, s56, s53
  buffer_load_dwordx4 a[224:227], v236, s[32:35], s57 offen sc1
  v_mfma_f32_16x16x32_bf16 v[24:27], a[68:71], a[16:19], v[24:27]
  buffer_load_dwordx4 a[228:231], v237, s[32:35], s57 offen sc1
  v_mfma_f32_16x16x32_bf16 v[24:27], a[72:75], a[32:35], v[24:27]
  v_mfma_f32_16x16x32_bf16 v[24:27], a[76:79], a[48:51], v[24:27]
  s_lshl_b32 s49, s46, 1
  v_mfma_f32_16x16x32_bf16 v[56:59], a[76:79], a[52:55], v[56:59]
  v_mfma_f32_16x16x32_bf16 v[56:59], a[72:75], a[36:39], v[56:59]
  v_mfma_f32_16x16x32_bf16 v[56:59], a[68:71], a[20:23], v[56:59]
  s_add_u32 s56, s56, s49
  buffer_load_dwordx4 a[236:239], v238, s[32:35], s57 offen sc1
  v_mfma_f32_16x16x32_bf16 v[56:59], a[64:67], a[4:7], v[56:59]
  v_mfma_f32_16x16x32_bf16 v[88:91], a[64:67], a[8:11], v[88:91]
  ds_read_b64_tr_b16 a[96:97], v136 offset:0
  v_mfma_f32_16x16x32_bf16 v[88:91], a[68:71], a[24:27], v[88:91]
  s_mul_i32 s56, s56, 55296
  ds_read_b64_tr_b16 a[98:99], v136 offset:512
  v_mfma_f32_16x16x32_bf16 v[88:91], a[72:75], a[40:43], v[88:91]
  ds_read_b64_tr_b16 a[100:101], v136 offset:12288
  v_mfma_f32_16x16x32_bf16 v[88:91], a[76:79], a[56:59], v[88:91]
  ds_read_b64_tr_b16 a[102:103], v136 offset:12800
  v_mfma_f32_16x16x32_bf16 v[120:123], a[76:79], a[60:63], v[120:123]
  ds_read_b64_tr_b16 a[104:105], v136 offset:24576
  s_add_u32 s20, s84, s56
  s_addc_u32 s21, s85, 0
  v_mfma_f32_16x16x32_bf16 v[120:123], a[72:75], a[44:47], v[120:123]
  ds_read_b64_tr_b16 a[106:107], v136 offset:25088
  v_mfma_f32_16x16x32_bf16 v[120:123], a[68:71], a[28:31], v[120:123]
  buffer_load_dwordx4 a[240:243], v239, s[32:35], s57 offen sc1
  v_mfma_f32_16x16x32_bf16 v[120:123], a[64:67], a[12:15], v[120:123]
  s_waitcnt lgkmcnt(6)
  ds_read_b64_tr_b16 a[108:109], v136 offset:36864
  s_add_u32 s59, s59, 1
  v_mfma_f32_16x16x32_bf16 v[28:31], a[80:83], a[0:3], v[28:31]
  ds_read_b64_tr_b16 a[110:111], v136 offset:37376
  v_mfma_f32_16x16x32_bf16 v[28:31], a[84:87], a[16:19], v[28:31]
  v_mfma_f32_16x16x32_bf16 v[28:31], a[88:91], a[32:35], v[28:31]
  s_cmp_eq_u32 s59, 20
  s_cselect_b32 s59, 0, s59
  v_mfma_f32_16x16x32_bf16 v[28:31], a[92:95], a[48:51], v[28:31]
  s_add_u32 s20, s20, 53477376
  s_addc_u32 s21, s21, 0
  v_mfma_f32_16x16x32_bf16 v[60:63], a[92:95], a[52:55], v[60:63]
  v_mfma_f32_16x16x32_bf16 v[60:63], a[88:91], a[36:39], v[60:63]
  v_mfma_f32_16x16x32_bf16 v[60:63], a[84:87], a[20:23], v[60:63]
  v_mfma_f32_16x16x32_bf16 v[60:63], a[80:83], a[4:7], v[60:63]
  v_mfma_f32_16x16x32_bf16 v[92:95], a[80:83], a[8:11], v[92:95]
  s_mov_b32 s22, 55296
  ds_read_b64_tr_b16 a[64:65], v137 offset:0
  v_mfma_f32_16x16x32_bf16 v[92:95], a[84:87], a[24:27], v[92:95]
  ds_read_b64_tr_b16 a[66:67], v137 offset:512
  v_mfma_f32_16x16x32_bf16 v[92:95], a[88:91], a[40:43], v[92:95]
  ds_read_b64_tr_b16 a[68:69], v137 offset:12288
  v_mfma_f32_16x16x32_bf16 v[92:95], a[92:95], a[56:59], v[92:95]
  s_mov_b32 s23, 0x20000
  ds_read_b64_tr_b16 a[70:71], v137 offset:12800
  s_mul_i32 s56, s3, 20480
  v_add_u32 v251, 0, v249
  v_mfma_f32_16x16x32_bf16 v[124:127], a[92:95], a[60:63], v[124:127]
  v_mul_u32_u24 v252, 3277, v251
  v_lshrrev_b32 v252, 16, v252
  s_waitcnt vmcnt(25)
  v_mul_u32_u24 v253, 20, v252
  v_mfma_f32_16x16x32_bf16 v[124:127], a[88:91], a[44:47], v[124:127]
  v_sub_u32 v251, v251, v253
  v_bfe_u32 v253, v252, 2, 1
  v_lshlrev_b32 v253, 1, v253
  v_mfma_f32_16x16x32_bf16 v[124:127], a[84:87], a[28:31], v[124:127]
  v_xor_b32 v251, v251, v253
  v_mul_u32_u24 v252, 1280, v252
  v_lshl_add_u32 v251, v251, 4, v252
  v_mfma_f32_16x16x32_bf16 v[124:127], a[80:83], a[12:15], v[124:127]
  s_waitcnt lgkmcnt(4)
  v_add_u32 v251, s56, v251
  v_subrev_u32 v232, 0, v251
  v_add_u32 v251, 64, v249
  v_mfma_f32_16x16x32_bf16 v[144:147], a[96:99], a[0:3], v[144:147]
  v_mul_u32_u24 v252, 3277, v251
  v_lshrrev_b32 v252, 16, v252
  v_mul_u32_u24 v253, 20, v252
  v_mfma_f32_16x16x32_bf16 v[144:147], a[100:103], a[16:19], v[144:147]
  v_sub_u32 v251, v251, v253
  v_bfe_u32 v253, v252, 2, 1
  v_lshlrev_b32 v253, 1, v253
  v_mfma_f32_16x16x32_bf16 v[144:147], a[104:107], a[32:35], v[144:147]
  v_xor_b32 v251, v251, v253
  v_mul_u32_u24 v252, 1280, v252
  v_lshl_add_u32 v251, v251, 4, v252
  v_mfma_f32_16x16x32_bf16 v[144:147], a[108:111], a[48:51], v[144:147]
  ds_read_b64_tr_b16 a[72:73], v137 offset:24576
  v_add_u32 v251, s56, v251
  v_subrev_u32 v233, 1024, v251
  v_mfma_f32_16x16x32_bf16 v[160:163], a[108:111], a[52:55], v[160:163]
  ds_read_b64_tr_b16 a[74:75], v137 offset:25088
  v_add_u32 v251, 128, v249
  v_mfma_f32_16x16x32_bf16 v[160:163], a[104:107], a[36:39], v[160:163]
  ds_read_b64_tr_b16 a[76:77], v137 offset:36864
  v_mul_u32_u24 v252, 3277, v251
  v_mfma_f32_16x16x32_bf16 v[160:163], a[100:103], a[20:23], v[160:163]
  ds_read_b64_tr_b16 a[78:79], v137 offset:37376
  v_mfma_f32_16x16x32_bf16 v[160:163], a[96:99], a[4:7], v[160:163]
  v_lshrrev_b32 v252, 16, v252
  v_mfma_f32_16x16x32_bf16 v[176:179], a[96:99], a[8:11], v[176:179]
  ds_read_b64_tr_b16 a[80:81], v138 offset:0
  v_mfma_f32_16x16x32_bf16 v[176:179], a[100:103], a[24:27], v[176:179]
  ds_read_b64_tr_b16 a[82:83], v138 offset:512
  v_mfma_f32_16x16x32_bf16 v[176:179], a[104:107], a[40:43], v[176:179]
  ds_read_b64_tr_b16 a[84:85], v138 offset:12288
  v_mul_u32_u24 v253, 20, v252
  v_mfma_f32_16x16x32_bf16 v[176:179], a[108:111], a[56:59], v[176:179]
  ds_read_b64_tr_b16 a[86:87], v138 offset:12800
  v_mfma_f32_16x16x32_bf16 v[192:195], a[108:111], a[60:63], v[192:195]
  ds_read_b64_tr_b16 a[88:89], v138 offset:24576
  v_sub_u32 v251, v251, v253
  v_mfma_f32_16x16x32_bf16 v[192:195], a[104:107], a[44:47], v[192:195]
  ds_read_b64_tr_b16 a[90:91], v138 offset:25088
  v_mfma_f32_16x16x32_bf16 v[192:195], a[100:103], a[28:31], v[192:195]
  ds_read_b64_tr_b16 a[92:93], v138 offset:36864
  v_mfma_f32_16x16x32_bf16 v[192:195], a[96:99], a[12:15], v[192:195]
  s_waitcnt lgkmcnt(7)
  ds_read_b64_tr_b16 a[94:95], v138 offset:37376
  s_lshl_b32 s57, s59, 10
  v_mfma_f32_16x16x32_bf16 v[148:151], a[64:67], a[0:3], v[148:151]
  buffer_load_dwordx4 a[112:115], v236, s[32:35], s57 offen sc1
  v_mfma_f32_16x16x32_bf16 v[148:151], a[68:71], a[16:19], v[148:151]
  buffer_load_dwordx4 a[116:119], v237, s[32:35], s57 offen sc1
  v_mfma_f32_16x16x32_bf16 v[148:151], a[72:75], a[32:35], v[148:151]
  v_bfe_u32 v253, v252, 2, 1
  v_lshlrev_b32 v253, 1, v253
  v_mfma_f32_16x16x32_bf16 v[148:151], a[76:79], a[48:51], v[148:151]
  buffer_load_dwordx4 a[120:123], v238, s[32:35], s57 offen sc1
  v_mfma_f32_16x16x32_bf16 v[164:167], a[76:79], a[52:55], v[164:167]
  v_xor_b32 v251, v251, v253
  v_mfma_f32_16x16x32_bf16 v[164:167], a[72:75], a[36:39], v[164:167]
  v_mfma_f32_16x16x32_bf16 v[164:167], a[68:71], a[20:23], v[164:167]
  buffer_load_dwordx4 a[124:127], v239, s[32:35], s57 offen sc1
  v_mfma_f32_16x16x32_bf16 v[164:167], a[64:67], a[4:7], v[164:167]
  s_add_u32 s59, s59, 1
  v_mul_u32_u24 v252, 1280, v252
  v_mfma_f32_16x16x32_bf16 v[180:183], a[64:67], a[8:11], v[180:183]
  ds_read_b64_tr_b16 a[96:97], v139 offset:0
  s_cmp_eq_u32 s59, 20
  s_cselect_b32 s59, 0, s59
  v_mfma_f32_16x16x32_bf16 v[180:183], a[68:71], a[24:27], v[180:183]
  ds_read_b64_tr_b16 a[98:99], v139 offset:512
  v_lshl_add_u32 v251, v251, 4, v252
  v_mfma_f32_16x16x32_bf16 v[180:183], a[72:75], a[40:43], v[180:183]
  ds_read_b64_tr_b16 a[100:101], v139 offset:12288
  v_mfma_f32_16x16x32_bf16 v[180:183], a[76:79], a[56:59], v[180:183]
  ds_read_b64_tr_b16 a[102:103], v139 offset:12800
  v_mfma_f32_16x16x32_bf16 v[196:199], a[76:79], a[60:63], v[196:199]
  ds_read_b64_tr_b16 a[104:105], v139 offset:24576
  v_add_u32 v251, s56, v251
  v_mfma_f32_16x16x32_bf16 v[196:199], a[72:75], a[44:47], v[196:199]
  s_lshl_b32 s53, s44, 7
  ds_read_b64_tr_b16 a[106:107], v139 offset:25088
  v_mfma_f32_16x16x32_bf16 v[196:199], a[68:71], a[28:31], v[196:199]
  ds_read_b64_tr_b16 a[108:109], v139 offset:36864
  v_subrev_u32 v234, 2048, v251
  v_mfma_f32_16x16x32_bf16 v[196:199], a[64:67], a[12:15], v[196:199]
  s_waitcnt lgkmcnt(7)
  ds_read_b64_tr_b16 a[110:111], v139 offset:37376
  v_mfma_f32_16x16x32_bf16 v[152:155], a[80:83], a[0:3], v[152:155]
  v_mfma_f32_16x16x32_bf16 v[152:155], a[84:87], a[16:19], v[152:155]
  v_add_u32 v251, 192, v249
  v_mfma_f32_16x16x32_bf16 v[152:155], a[88:91], a[32:35], v[152:155]
  v_subrev_u32 v128, 49152, v128
  v_mfma_f32_16x16x32_bf16 v[152:155], a[92:95], a[48:51], v[152:155]
  v_subrev_u32 v129, 49152, v129
  v_mfma_f32_16x16x32_bf16 v[168:171], a[92:95], a[52:55], v[168:171]
  v_subrev_u32 v130, 49152, v130
  v_mul_u32_u24 v252, 3277, v251
  v_mfma_f32_16x16x32_bf16 v[168:171], a[88:91], a[36:39], v[168:171]
  v_and_b32 v243, 7, v249
  v_subrev_u32 v131, 49152, v131
  v_mfma_f32_16x16x32_bf16 v[168:171], a[84:87], a[20:23], v[168:171]
  v_subrev_u32 v132, 49152, v132
  v_lshrrev_b32 v252, 16, v252
  v_mfma_f32_16x16x32_bf16 v[168:171], a[80:83], a[4:7], v[168:171]
  v_subrev_u32 v133, 49152, v133
  v_mfma_f32_16x16x32_bf16 v[184:187], a[80:83], a[8:11], v[184:187]
  v_lshlrev_b32 v243, 2, v243
  v_subrev_u32 v134, 49152, v134
  v_mfma_f32_16x16x32_bf16 v[184:187], a[84:87], a[24:27], v[184:187]
  v_subrev_u32 v135, 49152, v135
  v_mul_u32_u24 v253, 20, v252
  v_mfma_f32_16x16x32_bf16 v[184:187], a[88:91], a[40:43], v[184:187]
  buffer_load_dword v247, v243, s[68:71], s53 offen sc1
  v_mfma_f32_16x16x32_bf16 v[184:187], a[92:95], a[56:59], v[184:187]
  v_subrev_u32 v136, 49152, v136
  v_subrev_u32 v137, 49152, v137
  v_mfma_f32_16x16x32_bf16 v[200:203], a[92:95], a[60:63], v[200:203]
  v_subrev_u32 v138, 49152, v138
  v_sub_u32 v251, v251, v253
  v_mfma_f32_16x16x32_bf16 v[200:203], a[88:91], a[44:47], v[200:203]
  v_subrev_u32 v139, 49152, v139
  v_mfma_f32_16x16x32_bf16 v[200:203], a[84:87], a[28:31], v[200:203]
  v_bfe_u32 v253, v252, 2, 1
  v_mfma_f32_16x16x32_bf16 v[200:203], a[80:83], a[12:15], v[200:203]
  s_waitcnt vmcnt(13)
  s_waitcnt lgkmcnt(0)
  s_barrier
  v_mfma_f32_16x16x32_bf16 v[156:159], a[96:99], a[0:3], v[156:159]
  ds_read_b64_tr_b16 a[64:65], v128 offset:0
  v_lshlrev_b32 v253, 1, v253
  v_mfma_f32_16x16x32_bf16 v[156:159], a[100:103], a[16:19], v[156:159]
  ds_read_b64_tr_b16 a[66:67], v128 offset:1024
  v_mfma_f32_16x16x32_bf16 v[156:159], a[104:107], a[32:35], v[156:159]
  ds_read_b64_tr_b16 a[68:69], v128 offset:12288
  v_mfma_f32_16x16x32_bf16 v[156:159], a[108:111], a[48:51], v[156:159]
  s_add_u32 m0, s62, 49152
  ds_read_b64_tr_b16 a[70:71], v128 offset:13312
  v_xor_b32 v251, v251, v253
  v_mfma_f32_16x16x32_bf16 v[172:175], a[108:111], a[52:55], v[172:175]
  s_lshl_b32 s51, s58, 18
  ds_read_b64_tr_b16 a[72:73], v128 offset:24576
  s_mul_i32 s52, s58, 110592
  v_mfma_f32_16x16x32_bf16 v[172:175], a[104:107], a[36:39], v[172:175]
  ds_read_b64_tr_b16 a[74:75], v128 offset:25600
  v_mfma_f32_16x16x32_bf16 v[172:175], a[100:103], a[20:23], v[172:175]
  ds_read_b64_tr_b16 a[76:77], v128 offset:36864
  v_mul_u32_u24 v252, 1280, v252
  v_mfma_f32_16x16x32_bf16 v[172:175], a[96:99], a[4:7], v[172:175]
  ds_read_b64_tr_b16 a[78:79], v128 offset:37888
  v_mfma_f32_16x16x32_bf16 v[188:191], a[96:99], a[8:11], v[188:191]
  buffer_load_dwordx4 v240, s[24:27], s51 offen offset:0  lds
  v_mfma_f32_16x16x32_bf16 v[188:191], a[100:103], a[24:27], v[188:191]
  ds_read_b64_tr_b16 a[80:81], v129 offset:0
  v_lshl_add_u32 v251, v251, 4, v252
  v_mfma_f32_16x16x32_bf16 v[188:191], a[104:107], a[40:43], v[188:191]
  ds_read_b64_tr_b16 a[82:83], v129 offset:1024
  v_mfma_f32_16x16x32_bf16 v[188:191], a[108:111], a[56:59], v[188:191]
  buffer_load_dwordx4 v241, s[24:27], s51 offen offset:1024  lds
  v_mfma_f32_16x16x32_bf16 v[204:207], a[108:111], a[60:63], v[204:207]
  ds_read_b64_tr_b16 a[84:85], v129 offset:12288
  v_add_u32 v251, s56, v251
  v_mfma_f32_16x16x32_bf16 v[204:207], a[104:107], a[44:47], v[204:207]
  ds_read_b64_tr_b16 a[86:87], v129 offset:13312
  v_subrev_u32 v235, 3072, v251
  v_mfma_f32_16x16x32_bf16 v[204:207], a[100:103], a[28:31], v[204:207]
  buffer_load_dwordx4 v242, s[28:31], s52 offen offset:2048  lds
  v_mfma_f32_16x16x32_bf16 v[204:207], a[96:99], a[12:15], v[204:207]
  s_waitcnt vmcnt(7) lgkmcnt(4)
  ds_read_b64_tr_b16 a[88:89], v129 offset:24576
  s_add_u32 s58, s58, 1
  v_mfma_f32_16x16x32_bf16 v[0:3], a[64:67], a[192:195], v[0:3]
  ds_read_b64_tr_b16 a[90:91], v129 offset:25600
  s_cmp_eq_u32 s58, 20
  s_cselect_b32 s58, 0, s58
  v_mfma_f32_16x16x32_bf16 v[0:3], a[68:71], a[208:211], v[0:3]
  s_add_u32 m0, s62, 61440
  ds_read_b64_tr_b16 a[92:93], v129 offset:36864
  v_add_u32 v251, 256, v249
  v_mfma_f32_16x16x32_bf16 v[0:3], a[72:75], a[224:227], v[0:3]
  s_lshl_b32 s51, s58, 18
  ds_read_b64_tr_b16 a[94:95], v129 offset:37888
  v_accvgpr_write_b32 a0, 0
  v_mfma_f32_16x16x32_bf16 v[0:3], a[76:79], a[112:115], v[0:3]
  s_waitcnt vmcnt(6)
  v_mul_u32_u24 v252, 3277, v251
  v_accvgpr_write_b32 a1, 0
  v_mfma_f32_16x16x32_bf16 v[32:35], a[76:79], a[116:119], v[32:35]
  s_mul_i32 s52, s58, 110592
  v_accvgpr_write_b32 a2, 0
  v_accvgpr_write_b32 a3, 0
  v_mfma_f32_16x16x32_bf16 v[32:35], a[72:75], a[228:231], v[32:35]
  buffer_load_dwordx4 v240, s[24:27], s51 offen offset:0  lds
  v_mfma_f32_16x16x32_bf16 v[32:35], a[68:71], a[212:215], v[32:35]
  v_lshrrev_b32 v252, 16, v252
  v_accvgpr_write_b32 a4, 0
  v_mfma_f32_16x16x32_bf16 v[32:35], a[64:67], a[196:199], v[32:35]
  s_waitcnt vmcnt(6)
  buffer_load_dwordx4 v241, s[24:27], s51 offen offset:1024  lds
  v_mfma_f32_16x16x32_bf16 v[64:67], a[64:67], a[200:203], v[64:67]
  ds_read_b64_tr_b16 a[96:97], v130 offset:0
  v_accvgpr_write_b32 a5, 0
  v_mfma_f32_16x16x32_bf16 v[64:67], a[68:71], a[216:219], v[64:67]
  ds_read_b64_tr_b16 a[98:99], v130 offset:1024
  v_mul_u32_u24 v253, 20, v252
  v_mfma_f32_16x16x32_bf16 v[64:67], a[72:75], a[236:239], v[64:67]
  ds_read_b64_tr_b16 a[100:101], v130 offset:12288
  v_accvgpr_write_b32 a6, 0
  v_mfma_f32_16x16x32_bf16 v[64:67], a[76:79], a[120:123], v[64:67]
  s_waitcnt vmcnt(6)
  buffer_load_dwordx4 v242, s[28:31], s52 offen offset:2048  lds
  v_mfma_f32_16x16x32_bf16 v[96:99], a[76:79], a[124:127], v[96:99]
  s_add_u32 s58, s58, 1
  ds_read_b64_tr_b16 a[102:103], v130 offset:13312
  v_sub_u32 v251, v251, v253
  v_mfma_f32_16x16x32_bf16 v[96:99], a[72:75], a[240:243], v[96:99]
  ds_read_b64_tr_b16 a[104:105], v130 offset:24576
  v_accvgpr_write_b32 a7, 0
  v_mfma_f32_16x16x32_bf16 v[96:99], a[68:71], a[220:223], v[96:99]
  ds_read_b64_tr_b16 a[106:107], v130 offset:25600
  v_accvgpr_write_b32 a8, 0
  v_mfma_f32_16x16x32_bf16 v[96:99], a[64:67], a[204:207], v[96:99]
  s_waitcnt lgkmcnt(6)
  s_cmp_eq_u32 s58, 20
  s_cselect_b32 s58, 0, s58
  v_mfma_f32_16x16x32_bf16 v[4:7], a[80:83], a[192:195], v[4:7]
  s_lshl_b32 s57, s59, 10
  v_bfe_u32 v253, v252, 2, 1
  v_accvgpr_write_b32 a9, 0
  v_mfma_f32_16x16x32_bf16 v[4:7], a[84:87], a[208:211], v[4:7]
  ds_read_b64_tr_b16 a[108:109], v130 offset:36864
  v_lshlrev_b32 v253, 1, v253
  v_mfma_f32_16x16x32_bf16 v[4:7], a[88:91], a[224:227], v[4:7]
  ds_read_b64_tr_b16 a[110:111], v130 offset:37888
  v_accvgpr_write_b32 a10, 0
  v_mfma_f32_16x16x32_bf16 v[4:7], a[92:95], a[112:115], v[4:7]
  buffer_load_dwordx4 a[128:131], v236, s[32:35], s57 offen sc1
  v_accvgpr_write_b32 a11, 0
  v_mfma_f32_16x16x32_bf16 v[36:39], a[92:95], a[116:119], v[36:39]
  v_xor_b32 v251, v251, v253
  v_accvgpr_write_b32 a12, 0
  v_mfma_f32_16x16x32_bf16 v[36:39], a[88:91], a[228:231], v[36:39]
  buffer_load_dwordx4 a[132:135], v237, s[32:35], s57 offen sc1
  v_mfma_f32_16x16x32_bf16 v[36:39], a[84:87], a[212:215], v[36:39]
  v_mul_u32_u24 v252, 1280, v252
  v_accvgpr_write_b32 a13, 0
  v_mfma_f32_16x16x32_bf16 v[36:39], a[80:83], a[196:199], v[36:39]
  buffer_load_dwordx4 a[136:139], v238, s[32:35], s57 offen sc1
  v_mfma_f32_16x16x32_bf16 v[68:71], a[80:83], a[200:203], v[68:71]
  v_accvgpr_write_b32 a14, 0
  v_accvgpr_write_b32 a15, 0
  v_mfma_f32_16x16x32_bf16 v[68:71], a[84:87], a[216:219], v[68:71]
  buffer_load_dwordx4 a[140:143], v239, s[32:35], s57 offen sc1
  v_mfma_f32_16x16x32_bf16 v[68:71], a[88:91], a[236:239], v[68:71]
  s_add_u32 s59, s59, 1
  ds_read_b64_tr_b16 a[64:65], v131 offset:0
  v_lshl_add_u32 v251, v251, 4, v252
  v_mfma_f32_16x16x32_bf16 v[68:71], a[92:95], a[120:123], v[68:71]
  ds_read_b64_tr_b16 a[66:67], v131 offset:1024
  v_accvgpr_write_b32 a16, 0
  v_mfma_f32_16x16x32_bf16 v[100:103], a[92:95], a[124:127], v[100:103]
  ds_read_b64_tr_b16 a[68:69], v131 offset:12288
  v_accvgpr_write_b32 a17, 0
  v_mfma_f32_16x16x32_bf16 v[100:103], a[88:91], a[240:243], v[100:103]
  ds_read_b64_tr_b16 a[70:71], v131 offset:13312
  v_add_u32 v251, s56, v251
  v_mfma_f32_16x16x32_bf16 v[100:103], a[84:87], a[220:223], v[100:103]
  s_cmp_eq_u32 s59, 20
  s_cselect_b32 s59, 0, s59
  v_accvgpr_write_b32 a18, 0
  v_mfma_f32_16x16x32_bf16 v[100:103], a[80:83], a[204:207], v[100:103]
  s_waitcnt lgkmcnt(4)
  ds_read_b64_tr_b16 a[72:73], v131 offset:24576
  v_subrev_u32 v246, 0, v251
  v_accvgpr_write_b32 a19, 0
  v_mfma_f32_16x16x32_bf16 v[8:11], a[96:99], a[192:195], v[8:11]
  ds_read_b64_tr_b16 a[74:75], v131 offset:25600
  v_accvgpr_write_b32 a20, 0
  v_mfma_f32_16x16x32_bf16 v[8:11], a[100:103], a[208:211], v[8:11]
  ds_read_b64_tr_b16 a[76:77], v131 offset:36864
  s_waitcnt vmcnt(10)
  v_cmp_ne_u32 vcc, 1, v247
  s_cbranch_vccnz recurrent_scan__compressed_kv_cla__dense_activation_silu__prompt_kernel_spin1
recurrent_scan__compressed_kv_cla__dense_activation_silu__prompt_kernel_back1:
  v_mfma_f32_16x16x32_bf16 v[8:11], a[104:107], a[224:227], v[8:11]
  ds_read_b64_tr_b16 a[78:79], v131 offset:37888
  v_accvgpr_write_b32 a248, v232
  v_accvgpr_write_b32 a21, 0
  v_mfma_f32_16x16x32_bf16 v[8:11], a[108:111], a[112:115], v[8:11]
  s_add_u32 m0, s62, 73728
  v_accvgpr_write_b32 a249, v233
  v_accvgpr_write_b32 a22, 0
  v_mfma_f32_16x16x32_bf16 v[40:43], a[108:111], a[116:119], v[40:43]
  s_lshl_b32 s51, s58, 18
  v_accvgpr_write_b32 a250, v234
  v_accvgpr_write_b32 a23, 0
  v_mfma_f32_16x16x32_bf16 v[40:43], a[104:107], a[228:231], v[40:43]
  s_mul_i32 s52, s58, 110592
  v_accvgpr_write_b32 a24, 0
  v_accvgpr_write_b32 a25, 0
  v_mfma_f32_16x16x32_bf16 v[40:43], a[100:103], a[212:215], v[40:43]
  buffer_load_dwordx4 v240, s[24:27], s51 offen offset:0  lds
  v_mfma_f32_16x16x32_bf16 v[40:43], a[96:99], a[196:199], v[40:43]
  v_accvgpr_write_b32 a251, v235
  v_accvgpr_write_b32 a26, 0
  v_mfma_f32_16x16x32_bf16 v[72:75], a[96:99], a[200:203], v[72:75]
  buffer_load_dwordx4 v241, s[24:27], s51 offen offset:1024  lds
  v_mfma_f32_16x16x32_bf16 v[72:75], a[100:103], a[216:219], v[72:75]
  ds_read_b64_tr_b16 a[80:81], v132 offset:0
  v_accvgpr_write_b32 a27, 0
  v_mfma_f32_16x16x32_bf16 v[72:75], a[104:107], a[236:239], v[72:75]
  ds_read_b64_tr_b16 a[82:83], v132 offset:1024
  v_accvgpr_write_b32 a252, v246
  v_mfma_f32_16x16x32_bf16 v[72:75], a[108:111], a[120:123], v[72:75]
  buffer_load_dwordx4 v242, s[28:31], s52 offen offset:2048  lds
  v_mfma_f32_16x16x32_bf16 v[104:107], a[108:111], a[124:127], v[104:107]
  s_add_u32 s58, s58, 1
  ds_read_b64_tr_b16 a[84:85], v132 offset:12288
  v_accvgpr_write_b32 a28, 0
  v_mfma_f32_16x16x32_bf16 v[104:107], a[104:107], a[240:243], v[104:107]
  ds_read_b64_tr_b16 a[86:87], v132 offset:13312
  v_accvgpr_write_b32 a29, 0
  v_mfma_f32_16x16x32_bf16 v[104:107], a[100:103], a[220:223], v[104:107]
  ds_read_b64_tr_b16 a[88:89], v132 offset:24576
  v_add_u32 v251, 0, v249
  v_mfma_f32_16x16x32_bf16 v[104:107], a[96:99], a[204:207], v[104:107]
  s_waitcnt lgkmcnt(5)
  ds_read_b64_tr_b16 a[90:91], v132 offset:25600
  v_accvgpr_write_b32 a30, 0
  v_mfma_f32_16x16x32_bf16 v[12:15], a[64:67], a[192:195], v[12:15]
  ds_read_b64_tr_b16 a[92:93], v132 offset:36864
  s_cmp_eq_u32 s58, 20
  s_cselect_b32 s58, 0, s58
  v_mfma_f32_16x16x32_bf16 v[12:15], a[68:71], a[208:211], v[12:15]
  s_add_u32 m0, s62, 86016
  ds_read_b64_tr_b16 a[94:95], v132 offset:37888
  v_mul_u32_u24 v252, 5462, v251
  v_accvgpr_write_b32 a31, 0
  v_mfma_f32_16x16x32_bf16 v[12:15], a[72:75], a[224:227], v[12:15]
  s_lshl_b32 s51, s58, 18
  s_mul_i32 s52, s58, 110592
  v_accvgpr_write_b32 a32, 0
  v_mfma_f32_16x16x32_bf16 v[12:15], a[76:79], a[112:115], v[12:15]
  v_lshrrev_b32 v252, 16, v252
  v_accvgpr_write_b32 a33, 0
  v_mfma_f32_16x16x32_bf16 v[44:47], a[76:79], a[116:119], v[44:47]
  buffer_load_dwordx4 v240, s[24:27], s51 offen offset:0  lds
  v_mfma_f32_16x16x32_bf16 v[44:47], a[72:75], a[228:231], v[44:47]
  buffer_load_dwordx4 v241, s[24:27], s51 offen offset:1024  lds
  v_mfma_f32_16x16x32_bf16 v[44:47], a[68:71], a[212:215], v[44:47]
  v_mul_u32_u24 v253, 12, v252
  v_accvgpr_write_b32 a34, 0
  v_mfma_f32_16x16x32_bf16 v[44:47], a[64:67], a[196:199], v[44:47]
  v_sub_u32 v251, v251, v253
  v_accvgpr_write_b32 a35, 0
  v_mfma_f32_16x16x32_bf16 v[76:79], a[64:67], a[200:203], v[76:79]
  buffer_load_dwordx4 v242, s[28:31], s52 offen offset:2048  lds
  v_mfma_f32_16x16x32_bf16 v[76:79], a[68:71], a[216:219], v[76:79]
  s_add_u32 s58, s58, 1
  v_accvgpr_write_b32 a36, 0
  v_accvgpr_write_b32 a37, 0
  v_mfma_f32_16x16x32_bf16 v[76:79], a[72:75], a[236:239], v[76:79]
  ds_read_b64_tr_b16 a[96:97], v133 offset:0
  s_cmp_eq_u32 s58, 20
  s_cselect_b32 s58, 0, s58
  v_mfma_f32_16x16x32_bf16 v[76:79], a[76:79], a[120:123], v[76:79]
  s_lshl_b32 s57, s59, 10
  ds_read_b64_tr_b16 a[98:99], v133 offset:1024
  v_bfe_u32 v253, v252, 2, 1
  v_mfma_f32_16x16x32_bf16 v[108:111], a[76:79], a[124:127], v[108:111]
  ds_read_b64_tr_b16 a[100:101], v133 offset:12288
  v_accvgpr_write_b32 a38, 0
  v_mfma_f32_16x16x32_bf16 v[108:111], a[72:75], a[240:243], v[108:111]
  ds_read_b64_tr_b16 a[102:103], v133 offset:13312
  v_accvgpr_write_b32 a39, 0
  v_mfma_f32_16x16x32_bf16 v[108:111], a[68:71], a[220:223], v[108:111]
  buffer_load_dwordx4 a[144:147], v236, s[32:35], s57 offen sc1
  v_lshlrev_b32 v253, 1, v253
  v_mfma_f32_16x16x32_bf16 v[108:111], a[64:67], a[204:207], v[108:111]
  s_waitcnt lgkmcnt(4)
  ds_read_b64_tr_b16 a[104:105], v133 offset:24576
  v_accvgpr_write_b32 a40, 0
  v_mfma_f32_16x16x32_bf16 v[16:19], a[80:83], a[192:195], v[16:19]
  ds_read_b64_tr_b16 a[106:107], v133 offset:25600
  v_accvgpr_write_b32 a41, 0
  v_mfma_f32_16x16x32_bf16 v[16:19], a[84:87], a[208:211], v[16:19]
  buffer_load_dwordx4 a[148:151], v237, s[32:35], s57 offen sc1
  v_xor_b32 v251, v251, v253
  v_mfma_f32_16x16x32_bf16 v[16:19], a[88:91], a[224:227], v[16:19]
  ds_read_b64_tr_b16 a[108:109], v133 offset:36864
  v_accvgpr_write_b32 a42, 0
  v_mfma_f32_16x16x32_bf16 v[16:19], a[92:95], a[112:115], v[16:19]
  ds_read_b64_tr_b16 a[110:111], v133 offset:37888
  v_accvgpr_write_b32 a43, 0
  v_mfma_f32_16x16x32_bf16 v[48:51], a[92:95], a[116:119], v[48:51]
  buffer_load_dwordx4 a[152:155], v238, s[32:35], s57 offen sc1
  v_mul_u32_u24 v252, 1280, v252
  v_mfma_f32_16x16x32_bf16 v[48:51], a[88:91], a[228:231], v[48:51]
  buffer_load_dwordx4 a[156:159], v239, s[32:35], s57 offen sc1
  s_add_u32 s59, s59, 1
  v_mfma_f32_16x16x32_bf16 v[48:51], a[84:87], a[212:215], v[48:51]
  s_cmp_eq_u32 s59, 20
  s_cselect_b32 s59, 0, s59
  v_lshl_add_u32 v251, v251, 4, v252
  v_accvgpr_write_b32 a44, 0
  v_mfma_f32_16x16x32_bf16 v[48:51], a[80:83], a[196:199], v[48:51]
  s_and_b32 s48, s54, 0xffff
  v_accvgpr_write_b32 a45, 0
  v_accvgpr_write_b32 a46, 0
  v_mfma_f32_16x16x32_bf16 v[80:83], a[80:83], a[200:203], v[80:83]
  s_add_u32 m0, s48, s50
  v_subrev_u32 v232, 0, v251
  v_accvgpr_write_b32 a47, 0
  v_mfma_f32_16x16x32_bf16 v[80:83], a[84:87], a[216:219], v[80:83]
  buffer_load_dwordx4 v244, s[8:11], s54 offen offset:0 sc1 lds
  v_mfma_f32_16x16x32_bf16 v[80:83], a[88:91], a[236:239], v[80:83]
  ds_read_b64_tr_b16 a[64:65], v134 offset:0
  v_add_u32 v251, 64, v249
  v_mfma_f32_16x16x32_bf16 v[80:83], a[92:95], a[120:123], v[80:83]
  ds_read_b64_tr_b16 a[66:67], v134 offset:1024
  v_accvgpr_write_b32 a48, 0
  v_mfma_f32_16x16x32_bf16 v[112:115], a[92:95], a[124:127], v[112:115]
  buffer_load_dwordx4 v244, s[8:11], s54 offen offset:1024 sc1 lds
  v_accvgpr_write_b32 a49, 0
  v_mfma_f32_16x16x32_bf16 v[112:115], a[88:91], a[240:243], v[112:115]
  ds_read_b64_tr_b16 a[68:69], v134 offset:12288
  v_mul_u32_u24 v252, 5462, v251
  v_mfma_f32_16x16x32_bf16 v[112:115], a[84:87], a[220:223], v[112:115]
  ds_read_b64_tr_b16 a[70:71], v134 offset:13312
  v_accvgpr_write_b32 a50, 0
  v_mfma_f32_16x16x32_bf16 v[112:115], a[80:83], a[204:207], v[112:115]
  s_waitcnt lgkmcnt(4)
  buffer_load_dwordx4 v244, s[8:11], s54 offen offset:2048 sc1 lds
  v_accvgpr_write_b32 a51, 0
  v_mfma_f32_16x16x32_bf16 v[20:23], a[96:99], a[192:195], v[20:23]
  ds_read_b64_tr_b16 a[72:73], v134 offset:24576
  v_lshrrev_b32 v252, 16, v252
  v_mfma_f32_16x16x32_bf16 v[20:23], a[100:103], a[208:211], v[20:23]
  ds_read_b64_tr_b16 a[74:75], v134 offset:25600
  v_accvgpr_write_b32 a52, 0
  v_mfma_f32_16x16x32_bf16 v[20:23], a[104:107], a[224:227], v[20:23]
  buffer_load_dwordx4 v244, s[8:11], s54 offen offset:3072 sc1 lds
  s_add_u32 s54, s54, 16384
  v_mfma_f32_16x16x32_bf16 v[20:23], a[108:111], a[112:115], v[20:23]
  ds_read_b64_tr_b16 a[76:77], v134 offset:36864
  v_mul_u32_u24 v253, 12, v252
  v_accvgpr_write_b32 a53, 0
  v_mfma_f32_16x16x32_bf16 v[52:55], a[108:111], a[116:119], v[52:55]
  ds_read_b64_tr_b16 a[78:79], v134 offset:37888
  v_accvgpr_write_b32 a54, 0
  v_mfma_f32_16x16x32_bf16 v[52:55], a[104:107], a[228:231], v[52:55]
  v_sub_u32 v251, v251, v253
  v_accvgpr_write_b32 a55, 0
  v_mfma_f32_16x16x32_bf16 v[52:55], a[100:103], a[212:215], v[52:55]
  v_bfe_u32 v253, v252, 2, 1
  v_accvgpr_write_b32 a56, 0
  v_mfma_f32_16x16x32_bf16 v[52:55], a[96:99], a[196:199], v[52:55]
  v_accvgpr_write_b32 a57, 0
  v_accvgpr_write_b32 a58, 0
  v_mfma_f32_16x16x32_bf16 v[84:87], a[96:99], a[200:203], v[84:87]
  ds_read_b64_tr_b16 a[80:81], v135 offset:0
  v_lshlrev_b32 v253, 1, v253
  v_mfma_f32_16x16x32_bf16 v[84:87], a[100:103], a[216:219], v[84:87]
  ds_read_b64_tr_b16 a[82:83], v135 offset:1024
  v_accvgpr_write_b32 a59, 0
  v_mfma_f32_16x16x32_bf16 v[84:87], a[104:107], a[236:239], v[84:87]
  ds_read_b64_tr_b16 a[84:85], v135 offset:12288
  v_xor_b32 v251, v251, v253
  v_mfma_f32_16x16x32_bf16 v[84:87], a[108:111], a[120:123], v[84:87]
  ds_read_b64_tr_b16 a[86:87], v135 offset:13312
  v_accvgpr_write_b32 a60, 0
  v_mfma_f32_16x16x32_bf16 v[116:119], a[108:111], a[124:127], v[116:119]
  ds_read_b64_tr_b16 a[88:89], v135 offset:24576
  v_accvgpr_write_b32 a61, 0
  v_mfma_f32_16x16x32_bf16 v[116:119], a[104:107], a[240:243], v[116:119]
  ds_read_b64_tr_b16 a[90:91], v135 offset:25600
  v_mul_u32_u24 v252, 1280, v252
  v_mfma_f32_16x16x32_bf16 v[116:119], a[100:103], a[220:223], v[116:119]
  ds_read_b64_tr_b16 a[92:93], v135 offset:36864
  v_accvgpr_write_b32 a62, 0
  v_mfma_f32_16x16x32_bf16 v[116:119], a[96:99], a[204:207], v[116:119]
  s_waitcnt lgkmcnt(7)
recurrent_scan__compressed_kv_cla__dense_activation_silu__prompt_kernel_s14:
  ds_read_b64_tr_b16 a[94:95], v135 offset:37888
  v_accvgpr_write_b32 a63, 0
  v_mfma_f32_16x16x32_bf16 v[24:27], a[64:67], a[192:195], v[24:27]
  s_lshl_b32 s57, s59, 10
  buffer_load_dwordx4 a[160:163], v236, s[32:35], s57 offen sc1
  v_mfma_f32_16x16x32_bf16 v[24:27], a[68:71], a[208:211], v[24:27]
  buffer_load_dwordx4 a[164:167], v237, s[32:35], s57 offen sc1
  v_mfma_f32_16x16x32_bf16 v[24:27], a[72:75], a[224:227], v[24:27]
  buffer_load_dwordx4 a[168:171], v238, s[32:35], s57 offen sc1
  v_lshl_add_u32 v251, v251, 4, v252
  v_mfma_f32_16x16x32_bf16 v[24:27], a[76:79], a[112:115], v[24:27]
  buffer_load_dwordx4 a[172:175], v239, s[32:35], s57 offen sc1
  v_mfma_f32_16x16x32_bf16 v[56:59], a[76:79], a[116:119], v[56:59]
  s_add_u32 s59, s59, 1
  v_subrev_u32 v233, 1024, v251
  v_mfma_f32_16x16x32_bf16 v[56:59], a[72:75], a[228:231], v[56:59]
  s_cmp_eq_u32 s59, 20
  s_cselect_b32 s59, 0, s59
  v_add_u32 v251, 128, v249
  v_mfma_f32_16x16x32_bf16 v[56:59], a[68:71], a[212:215], v[56:59]
  s_and_b32 s48, s54, 0xffff
  s_add_u32 m0, s48, s50
  v_mfma_f32_16x16x32_bf16 v[56:59], a[64:67], a[196:199], v[56:59]
  v_mul_u32_u24 v252, 5462, v251
  v_mfma_f32_16x16x32_bf16 v[88:91], a[64:67], a[200:203], v[88:91]
  ds_read_b64_tr_b16 a[96:97], v136 offset:0
  v_mfma_f32_16x16x32_bf16 v[88:91], a[68:71], a[216:219], v[88:91]
  ds_read_b64_tr_b16 a[98:99], v136 offset:512
  v_mfma_f32_16x16x32_bf16 v[88:91], a[72:75], a[236:239], v[88:91]
  ds_read_b64_tr_b16 a[100:101], v136 offset:12288
  v_lshrrev_b32 v252, 16, v252
  v_mfma_f32_16x16x32_bf16 v[88:91], a[76:79], a[120:123], v[88:91]
  ds_read_b64_tr_b16 a[102:103], v136 offset:12800
  v_mfma_f32_16x16x32_bf16 v[120:123], a[76:79], a[124:127], v[120:123]
  ds_read_b64_tr_b16 a[104:105], v136 offset:24576
  v_mul_u32_u24 v253, 12, v252
  v_mfma_f32_16x16x32_bf16 v[120:123], a[72:75], a[240:243], v[120:123]
  ds_read_b64_tr_b16 a[106:107], v136 offset:25088
  v_mfma_f32_16x16x32_bf16 v[120:123], a[68:71], a[220:223], v[120:123]
  buffer_load_dwordx4 v244, s[8:11], s54 offen offset:0 sc1 lds
  v_mfma_f32_16x16x32_bf16 v[120:123], a[64:67], a[204:207], v[120:123]
  s_waitcnt lgkmcnt(6)
  ds_read_b64_tr_b16 a[108:109], v136 offset:36864
  v_sub_u32 v251, v251, v253
  v_mfma_f32_16x16x32_bf16 v[28:31], a[80:83], a[192:195], v[28:31]
  ds_read_b64_tr_b16 a[110:111], v136 offset:37376
  v_mfma_f32_16x16x32_bf16 v[28:31], a[84:87], a[208:211], v[28:31]
  v_mfma_f32_16x16x32_bf16 v[28:31], a[88:91], a[224:227], v[28:31]
  buffer_load_dwordx4 v244, s[8:11], s54 offen offset:1024 sc1 lds
  v_mfma_f32_16x16x32_bf16 v[28:31], a[92:95], a[112:115], v[28:31]
  v_bfe_u32 v253, v252, 2, 1
  v_mfma_f32_16x16x32_bf16 v[60:63], a[92:95], a[116:119], v[60:63]
  v_lshlrev_b32 v253, 1, v253
  v_mfma_f32_16x16x32_bf16 v[60:63], a[88:91], a[228:231], v[60:63]
  v_mfma_f32_16x16x32_bf16 v[60:63], a[84:87], a[212:215], v[60:63]
  buffer_load_dwordx4 v244, s[8:11], s54 offen offset:2048 sc1 lds
  v_mfma_f32_16x16x32_bf16 v[60:63], a[80:83], a[196:199], v[60:63]
  v_xor_b32 v251, v251, v253
  v_mfma_f32_16x16x32_bf16 v[92:95], a[80:83], a[200:203], v[92:95]
  ds_read_b64_tr_b16 a[64:65], v137 offset:0
  v_mfma_f32_16x16x32_bf16 v[92:95], a[84:87], a[216:219], v[92:95]
  ds_read_b64_tr_b16 a[66:67], v137 offset:512
  v_mul_u32_u24 v252, 1280, v252
  v_mfma_f32_16x16x32_bf16 v[92:95], a[88:91], a[236:239], v[92:95]
  buffer_load_dwordx4 v244, s[8:11], s54 offen offset:3072 sc1 lds
  v_mfma_f32_16x16x32_bf16 v[92:95], a[92:95], a[120:123], v[92:95]
  s_add_u32 s54, s54, 16384
  ds_read_b64_tr_b16 a[68:69], v137 offset:12288
  v_mfma_f32_16x16x32_bf16 v[124:127], a[92:95], a[124:127], v[124:127]
  ds_read_b64_tr_b16 a[70:71], v137 offset:12800
  v_lshl_add_u32 v251, v251, 4, v252
  v_mfma_f32_16x16x32_bf16 v[124:127], a[88:91], a[240:243], v[124:127]
  ds_read_b64_tr_b16 a[72:73], v137 offset:24576
  v_mfma_f32_16x16x32_bf16 v[124:127], a[84:87], a[220:223], v[124:127]
  ds_read_b64_tr_b16 a[74:75], v137 offset:25088
  v_subrev_u32 v234, 2048, v251
  v_mfma_f32_16x16x32_bf16 v[124:127], a[80:83], a[204:207], v[124:127]
  s_waitcnt lgkmcnt(6)
  ds_read_b64_tr_b16 a[76:77], v137 offset:36864
  v_mfma_f32_16x16x32_bf16 v[144:147], a[96:99], a[192:195], v[144:147]
  ds_read_b64_tr_b16 a[78:79], v137 offset:37376
  v_mfma_f32_16x16x32_bf16 v[144:147], a[100:103], a[208:211], v[144:147]
  v_lshrrev_b32 v253, 4, v249
  v_mfma_f32_16x16x32_bf16 v[144:147], a[104:107], a[224:227], v[144:147]
  v_mfma_f32_16x16x32_bf16 v[144:147], a[108:111], a[112:115], v[144:147]
  v_mfma_f32_16x16x32_bf16 v[160:163], a[108:111], a[116:119], v[160:163]
  v_bfe_u32 v251, v249, 2, 2
  v_mfma_f32_16x16x32_bf16 v[160:163], a[104:107], a[228:231], v[160:163]
  v_mfma_f32_16x16x32_bf16 v[160:163], a[100:103], a[212:215], v[160:163]
  v_lshl_add_u32 v251, v253, 2, v251
  v_mfma_f32_16x16x32_bf16 v[160:163], a[96:99], a[196:199], v[160:163]
  v_mfma_f32_16x16x32_bf16 v[176:179], a[96:99], a[200:203], v[176:179]
  ds_read_b64_tr_b16 a[80:81], v138 offset:0
  v_mfma_f32_16x16x32_bf16 v[176:179], a[100:103], a[216:219], v[176:179]
  ds_read_b64_tr_b16 a[82:83], v138 offset:512
  v_mul_u32_u24 v251, 192, v251
  v_mfma_f32_16x16x32_bf16 v[176:179], a[104:107], a[236:239], v[176:179]
  ds_read_b64_tr_b16 a[84:85], v138 offset:12288
  v_mfma_f32_16x16x32_bf16 v[176:179], a[108:111], a[120:123], v[176:179]
  ds_read_b64_tr_b16 a[86:87], v138 offset:12800
  v_and_b32 v252, 3, v249
  v_mfma_f32_16x16x32_bf16 v[192:195], a[108:111], a[124:127], v[192:195]
  ds_read_b64_tr_b16 a[88:89], v138 offset:24576
  v_mfma_f32_16x16x32_bf16 v[192:195], a[104:107], a[240:243], v[192:195]
  ds_read_b64_tr_b16 a[90:91], v138 offset:25088
  v_mfma_f32_16x16x32_bf16 v[192:195], a[100:103], a[220:223], v[192:195]
  ds_read_b64_tr_b16 a[92:93], v138 offset:36864
  v_lshl_add_u32 v251, v252, 3, v251
  v_mfma_f32_16x16x32_bf16 v[192:195], a[96:99], a[204:207], v[192:195]
  s_waitcnt lgkmcnt(7)
  ds_read_b64_tr_b16 a[94:95], v138 offset:37376
  s_lshl_b32 s57, s59, 10
  v_mfma_f32_16x16x32_bf16 v[148:151], a[64:67], a[192:195], v[148:151]
  s_and_b32 s56, s45, 1
  buffer_load_dwordx4 a[176:179], v236, s[32:35], s57 offen sc1
  v_mfma_f32_16x16x32_bf16 v[148:151], a[68:71], a[208:211], v[148:151]
  s_lshl_b32 s56, s56, 5
  buffer_load_dwordx4 a[180:183], v237, s[32:35], s57 offen sc1
  v_mfma_f32_16x16x32_bf16 v[148:151], a[72:75], a[224:227], v[148:151]
  buffer_load_dwordx4 a[184:187], v238, s[32:35], s57 offen sc1
  v_mfma_f32_16x16x32_bf16 v[148:151], a[76:79], a[112:115], v[148:151]
  buffer_load_dwordx4 a[188:191], v239, s[32:35], s57 offen sc1
  v_mfma_f32_16x16x32_bf16 v[164:167], a[76:79], a[116:119], v[164:167]
  s_add_u32 s59, s59, 1
  s_cmp_eq_u32 s59, 20
  s_cselect_b32 s59, 0, s59
  v_mfma_f32_16x16x32_bf16 v[164:167], a[72:75], a[228:231], v[164:167]
  s_and_b32 s48, s54, 0xffff
  v_mfma_f32_16x16x32_bf16 v[164:167], a[68:71], a[212:215], v[164:167]
  s_add_u32 m0, s48, s50
  v_and_b32 v253, 1, v253
  v_mfma_f32_16x16x32_bf16 v[164:167], a[64:67], a[196:199], v[164:167]
  v_mfma_f32_16x16x32_bf16 v[180:183], a[64:67], a[200:203], v[180:183]
  ds_read_b64_tr_b16 a[96:97], v139 offset:0
  v_lshlrev_b32 v253, 5, v253
  v_mfma_f32_16x16x32_bf16 v[180:183], a[68:71], a[216:219], v[180:183]
  ds_read_b64_tr_b16 a[98:99], v139 offset:512
  v_mfma_f32_16x16x32_bf16 v[180:183], a[72:75], a[236:239], v[180:183]
  ds_read_b64_tr_b16 a[100:101], v139 offset:12288
  v_mfma_f32_16x16x32_bf16 v[180:183], a[76:79], a[120:123], v[180:183]
  ds_read_b64_tr_b16 a[102:103], v139 offset:12800
  v_xor_b32 v253, s56, v253
  v_mfma_f32_16x16x32_bf16 v[196:199], a[76:79], a[124:127], v[196:199]
  ds_read_b64_tr_b16 a[104:105], v139 offset:24576
  v_mfma_f32_16x16x32_bf16 v[196:199], a[72:75], a[240:243], v[196:199]
  ds_read_b64_tr_b16 a[106:107], v139 offset:25088
  v_subrev_u32 v253, s56, v253
  v_mfma_f32_16x16x32_bf16 v[196:199], a[68:71], a[220:223], v[196:199]
  s_mul_i32 s61, s3, 6144
  buffer_load_dwordx4 v244, s[8:11], s54 offen offset:0 sc1 lds
  v_mfma_f32_16x16x32_bf16 v[196:199], a[64:67], a[204:207], v[196:199]
  s_waitcnt lgkmcnt(6)
  ds_read_b64_tr_b16 a[108:109], v139 offset:36864
  s_add_u32 s61, s61, 131072
  v_mfma_f32_16x16x32_bf16 v[152:155], a[80:83], a[192:195], v[152:155]
  s_add_u32 s56, s56, s61
  ds_read_b64_tr_b16 a[110:111], v139 offset:37376
  v_mfma_f32_16x16x32_bf16 v[152:155], a[84:87], a[208:211], v[152:155]
  v_mfma_f32_16x16x32_bf16 v[152:155], a[88:91], a[224:227], v[152:155]
  buffer_load_dwordx4 v244, s[8:11], s54 offen offset:1024 sc1 lds
  v_mfma_f32_16x16x32_bf16 v[152:155], a[92:95], a[112:115], v[152:155]
  v_add_u32 v128, 49152, v128
  v_add_u32 v129, 49152, v129
  v_mfma_f32_16x16x32_bf16 v[168:171], a[92:95], a[116:119], v[168:171]
  v_add_u32 v130, 49152, v130
  v_mfma_f32_16x16x32_bf16 v[168:171], a[88:91], a[228:231], v[168:171]
  v_add_u32 v131, 49152, v131
  v_mfma_f32_16x16x32_bf16 v[168:171], a[84:87], a[212:215], v[168:171]
  buffer_load_dwordx4 v244, s[8:11], s54 offen offset:2048 sc1 lds
  v_mfma_f32_16x16x32_bf16 v[168:171], a[80:83], a[196:199], v[168:171]
  v_add_u32 v132, 49152, v132
  v_add_u32 v133, 49152, v133
  v_mfma_f32_16x16x32_bf16 v[184:187], a[80:83], a[200:203], v[184:187]
  v_add_u32 v134, 49152, v134
  v_add_u32 v251, s56, v251
  v_mfma_f32_16x16x32_bf16 v[184:187], a[84:87], a[216:219], v[184:187]
  v_add_u32 v135, 49152, v135
  v_mfma_f32_16x16x32_bf16 v[184:187], a[88:91], a[236:239], v[184:187]
  buffer_load_dwordx4 v244, s[8:11], s54 offen offset:3072 sc1 lds
  v_mfma_f32_16x16x32_bf16 v[184:187], a[92:95], a[120:123], v[184:187]
  s_add_u32 s54, s54, 16384
  v_add_u32 v136, 49152, v136
  v_add_u32 v235, v251, v253
  v_mfma_f32_16x16x32_bf16 v[200:203], a[92:95], a[124:127], v[200:203]
  v_add_u32 v137, 49152, v137
  v_add_u32 v138, 49152, v138
  v_mfma_f32_16x16x32_bf16 v[200:203], a[88:91], a[240:243], v[200:203]
  v_add_u32 v139, 49152, v139
  v_sub_u32 v246, v251, v253
  v_mfma_f32_16x16x32_bf16 v[200:203], a[84:87], a[220:223], v[200:203]
  v_mfma_f32_16x16x32_bf16 v[200:203], a[80:83], a[204:207], v[200:203]
  s_waitcnt vmcnt(24)
  s_waitcnt lgkmcnt(0)
  s_barrier
  v_mfma_f32_16x16x32_bf16 v[156:159], a[96:99], a[192:195], v[156:159]
  ds_read_b64_tr_b16 a[64:65], v136 offset:0
  v_mfma_f32_16x16x32_bf16 v[156:159], a[100:103], a[208:211], v[156:159]
  ds_read_b64_tr_b16 a[66:67], v136 offset:512
  v_mfma_f32_16x16x32_bf16 v[156:159], a[104:107], a[224:227], v[156:159]
  ds_read_b64_tr_b16 a[68:69], v136 offset:12288
  v_mfma_f32_16x16x32_bf16 v[156:159], a[108:111], a[112:115], v[156:159]
  ds_read_b64_tr_b16 a[70:71], v136 offset:12800
  v_mfma_f32_16x16x32_bf16 v[172:175], a[108:111], a[116:119], v[172:175]
  ds_read_b64_tr_b16 a[72:73], v136 offset:24576
  v_mfma_f32_16x16x32_bf16 v[172:175], a[104:107], a[228:231], v[172:175]
  ds_read_b64_tr_b16 a[74:75], v136 offset:25088
  v_mfma_f32_16x16x32_bf16 v[172:175], a[100:103], a[212:215], v[172:175]
  s_mul_i32 s49, s88, 55296
  ds_read_b64_tr_b16 a[76:77], v136 offset:36864
  v_add_u32 v236, s49, v248
  v_mfma_f32_16x16x32_bf16 v[172:175], a[96:99], a[196:199], v[172:175]
  s_mul_i32 s49, s89, 55296
  ds_read_b64_tr_b16 a[78:79], v136 offset:37376
  v_add_u32 v237, s49, v248
  v_mfma_f32_16x16x32_bf16 v[188:191], a[96:99], a[200:203], v[188:191]
  s_mul_i32 s49, s90, 55296
  v_add_u32 v238, s49, v248
  s_mul_i32 s49, s91, 55296
  v_mfma_f32_16x16x32_bf16 v[188:191], a[100:103], a[216:219], v[188:191]
  ds_read_b64_tr_b16 a[80:81], v137 offset:0
  v_add_u32 v239, s49, v248
  v_mfma_f32_16x16x32_bf16 v[188:191], a[104:107], a[236:239], v[188:191]
  ds_read_b64_tr_b16 a[82:83], v137 offset:512
  v_mfma_f32_16x16x32_bf16 v[188:191], a[108:111], a[120:123], v[188:191]
  ds_read_b64_tr_b16 a[84:85], v137 offset:12288
  v_mfma_f32_16x16x32_bf16 v[204:207], a[108:111], a[124:127], v[204:207]
  ds_read_b64_tr_b16 a[86:87], v137 offset:12800
  v_mfma_f32_16x16x32_bf16 v[204:207], a[104:107], a[240:243], v[204:207]
  ds_read_b64_tr_b16 a[88:89], v137 offset:24576
  v_mfma_f32_16x16x32_bf16 v[204:207], a[100:103], a[220:223], v[204:207]
  ds_read_b64_tr_b16 a[90:91], v137 offset:25088
  v_mfma_f32_16x16x32_bf16 v[204:207], a[96:99], a[204:207], v[204:207]
  s_waitcnt vmcnt(7) lgkmcnt(6)
  ds_read_b64_tr_b16 a[92:93], v137 offset:36864
  s_and_b32 s48, s54, 0xffff
  v_mfma_f32_16x16x32_bf16 v[144:147], a[64:67], a[128:131], v[144:147]
  s_add_u32 m0, s48, s50
  ds_read_b64_tr_b16 a[94:95], v137 offset:37376
  v_accvgpr_write_b32 a192, 0
  v_mfma_f32_16x16x32_bf16 v[144:147], a[68:71], a[144:147], v[144:147]
  buffer_load_dwordx4 v244, s[8:11], s54 offen offset:0 sc1 lds
  v_mfma_f32_16x16x32_bf16 v[144:147], a[72:75], a[160:163], v[144:147]
  v_mfma_f32_16x16x32_bf16 v[144:147], a[76:79], a[176:179], v[144:147]
  s_waitcnt vmcnt(7)
  v_accvgpr_write_b32 a193, 0
  v_mfma_f32_16x16x32_bf16 v[160:163], a[76:79], a[180:183], v[160:163]
  buffer_load_dwordx4 v244, s[8:11], s54 offen offset:1024 sc1 lds
  v_mfma_f32_16x16x32_bf16 v[160:163], a[72:75], a[164:167], v[160:163]
  v_mfma_f32_16x16x32_bf16 v[160:163], a[68:71], a[148:151], v[160:163]
  v_accvgpr_write_b32 a194, 0
  v_mfma_f32_16x16x32_bf16 v[160:163], a[64:67], a[132:135], v[160:163]
  s_waitcnt vmcnt(7)
  v_mfma_f32_16x16x32_bf16 v[176:179], a[64:67], a[136:139], v[176:179]
  ds_read_b64_tr_b16 a[96:97], v138 offset:0
  v_mfma_f32_16x16x32_bf16 v[176:179], a[68:71], a[152:155], v[176:179]
  ds_read_b64_tr_b16 a[98:99], v138 offset:512
  v_accvgpr_write_b32 a195, 0
  v_mfma_f32_16x16x32_bf16 v[176:179], a[72:75], a[168:171], v[176:179]
  ds_read_b64_tr_b16 a[100:101], v138 offset:12288
  v_mfma_f32_16x16x32_bf16 v[176:179], a[76:79], a[184:187], v[176:179]
  s_waitcnt vmcnt(6)
  ds_read_b64_tr_b16 a[102:103], v138 offset:12800
  v_mfma_f32_16x16x32_bf16 v[192:195], a[76:79], a[188:191], v[192:195]
  s_mul_i32 s56, s2, 8640
  buffer_load_dwordx4 v244, s[8:11], s54 offen offset:2048 sc1 lds
  v_mfma_f32_16x16x32_bf16 v[192:195], a[72:75], a[172:175], v[192:195]
  s_mul_i32 s49, s3, 2176
  ds_read_b64_tr_b16 a[104:105], v138 offset:24576
  v_accvgpr_write_b32 a196, 0
  v_mfma_f32_16x16x32_bf16 v[192:195], a[68:71], a[156:159], v[192:195]
  s_add_u32 s56, s56, s49
  ds_read_b64_tr_b16 a[106:107], v138 offset:25088
  v_min_u32 v252, 16, v249
  v_mfma_f32_16x16x32_bf16 v[192:195], a[64:67], a[140:143], v[192:195]
  s_waitcnt lgkmcnt(6)
  ds_read_b64_tr_b16 a[108:109], v138 offset:36864
  v_lshlrev_b32 v252, 7, v252
  v_mfma_f32_16x16x32_bf16 v[148:151], a[80:83], a[128:131], v[148:151]
  ds_read_b64_tr_b16 a[110:111], v138 offset:37376
  v_accvgpr_write_b32 a197, 0
  v_mfma_f32_16x16x32_bf16 v[148:151], a[84:87], a[144:147], v[148:151]
  v_add_u32 v252, s56, v252
  v_min_u32 v252, 2211836, v252
  v_mfma_f32_16x16x32_bf16 v[148:151], a[88:91], a[160:163], v[148:151]
  global_load_dword v251, v252, s[40:41]
  v_mfma_f32_16x16x32_bf16 v[148:151], a[92:95], a[176:179], v[148:151]
  s_mul_i32 s56, s47, 655360
  s_mul_i32 s49, s46, 320
  v_accvgpr_write_b32 a198, 0
  v_mfma_f32_16x16x32_bf16 v[164:167], a[92:95], a[180:183], v[164:167]
  s_add_u32 s56, s56, s49
  buffer_load_dwordx4 v244, s[8:11], s54 offen offset:3072 sc1 lds
  v_mfma_f32_16x16x32_bf16 v[164:167], a[88:91], a[164:167], v[164:167]
  s_sub_u32 s49, 5242880, s56
  v_accvgpr_write_b32 a199, 0
  v_mfma_f32_16x16x32_bf16 v[164:167], a[84:87], a[148:151], v[164:167]
  s_add_u32 s24, s36, s56
  s_addc_u32 s25, s37, 0
  s_mov_b32 s26, s49
  v_mfma_f32_16x16x32_bf16 v[164:167], a[80:83], a[132:135], v[164:167]
  s_add_u32 s54, s54, 16384
  s_mov_b32 s27, 0x20000
  s_mul_i32 s58, s3, 14
  v_mfma_f32_16x16x32_bf16 v[180:183], a[80:83], a[136:139], v[180:183]
  ds_read_b64_tr_b16 a[64:65], v139 offset:0
  v_accvgpr_write_b32 a200, 0
  v_mfma_f32_16x16x32_bf16 v[180:183], a[84:87], a[152:155], v[180:183]
  ds_read_b64_tr_b16 a[66:67], v139 offset:512
  s_cmp_eq_u32 s3, 3
  s_cselect_b32 s56, 1, 0
  v_mfma_f32_16x16x32_bf16 v[180:183], a[88:91], a[168:171], v[180:183]
  s_sub_u32 s58, s58, s56
  ds_read_b64_tr_b16 a[68:69], v139 offset:12288
  s_lshr_b32 s56, s3, 1
  v_mfma_f32_16x16x32_bf16 v[180:183], a[92:95], a[184:187], v[180:183]
  s_sub_u32 s49, s58, s56
  ds_read_b64_tr_b16 a[70:71], v139 offset:12800
  v_accvgpr_write_b32 a201, 0
  v_mfma_f32_16x16x32_bf16 v[196:199], a[92:95], a[188:191], v[196:199]
  s_add_u32 s49, s49, 14
  ds_read_b64_tr_b16 a[72:73], v139 offset:24576
  s_mul_i32 s49, s49, 40960
  v_mfma_f32_16x16x32_bf16 v[196:199], a[88:91], a[172:175], v[196:199]
  s_mul_i32 s56, s45, 160
  ds_read_b64_tr_b16 a[74:75], v139 offset:25088
  s_andn2_b32 s56, s56, 63
  v_mfma_f32_16x16x32_bf16 v[196:199], a[84:87], a[156:159], v[196:199]
  s_sub_u32 s49, s49, s56
  ds_read_b64_tr_b16 a[76:77], v139 offset:36864
  v_accvgpr_write_b32 a202, 0
  v_mfma_f32_16x16x32_bf16 v[196:199], a[80:83], a[140:143], v[196:199]
  s_waitcnt lgkmcnt(7)
  ds_read_b64_tr_b16 a[78:79], v139 offset:37376
  v_mfma_f32_16x16x32_bf16 v[152:155], a[96:99], a[128:131], v[152:155]
  s_add_u32 s28, s40, s56
  s_addc_u32 s29, s41, 0
  s_mov_b32 s30, s49
  v_mfma_f32_16x16x32_bf16 v[152:155], a[100:103], a[144:147], v[152:155]
  s_mov_b32 s31, 0x20000
  s_lshl_b32 s59, s58, 10
  v_accvgpr_write_b32 a203, 0
  v_mfma_f32_16x16x32_bf16 v[152:155], a[104:107], a[160:163], v[152:155]
  s_mul_i32 s58, s58, 40960
  s_mov_b32 s62, s61
  s_mul_i32 s61, s3, 5120
  v_mfma_f32_16x16x32_bf16 v[152:155], a[108:111], a[176:179], v[152:155]
  s_lshl_b32 s56, s47, 14
  s_sub_u32 s49, 16777216, s56
  v_mfma_f32_16x16x32_bf16 v[168:171], a[108:111], a[180:183], v[168:171]
  s_add_u32 s32, s84, s56
  s_addc_u32 s33, s85, 0
  v_accvgpr_write_b32 a204, 0
  v_mfma_f32_16x16x32_bf16 v[168:171], a[104:107], a[164:167], v[168:171]
  v_mfma_f32_16x16x32_bf16 v[168:171], a[100:103], a[148:151], v[168:171]
  s_add_u32 s32, s32, 36700160
  s_addc_u32 s33, s33, 0
  v_mfma_f32_16x16x32_bf16 v[168:171], a[96:99], a[132:135], v[168:171]
  s_mov_b32 s34, s49
  v_accvgpr_write_b32 a205, 0
  v_mfma_f32_16x16x32_bf16 v[184:187], a[96:99], a[136:139], v[184:187]
  s_mov_b32 s35, 0x20000
  ds_read_b64_tr_b16 a[80:81], v128 offset:0
  v_mfma_f32_16x16x32_bf16 v[184:187], a[100:103], a[152:155], v[184:187]
  s_add_u32 s53, s3, 2
  ds_read_b64_tr_b16 a[82:83], v128 offset:1024
  v_mfma_f32_16x16x32_bf16 v[184:187], a[104:107], a[168:171], v[184:187]
  s_and_b32 s53, s53, 3
  ds_read_b64_tr_b16 a[84:85], v128 offset:12288
  v_accvgpr_write_b32 a206, 0
  v_mfma_f32_16x16x32_bf16 v[184:187], a[108:111], a[184:187], v[184:187]
  s_lshl_b32 s56, s47, 3
  ds_read_b64_tr_b16 a[86:87], v128 offset:13312
  v_mfma_f32_16x16x32_bf16 v[200:203], a[108:111], a[188:191], v[200:203]
  s_sub_u32 s49, 118, s56
  ds_read_b64_tr_b16 a[88:89], v128 offset:24576
  v_mfma_f32_16x16x32_bf16 v[200:203], a[104:107], a[172:175], v[200:203]
  ds_read_b64_tr_b16 a[90:91], v128 offset:25600
  v_accvgpr_write_b32 a207, 0
  v_mfma_f32_16x16x32_bf16 v[200:203], a[100:103], a[156:159], v[200:203]
  ds_read_b64_tr_b16 a[92:93], v128 offset:36864
  s_cmp_lt_u32 s53, 2
  s_cselect_b32 s56, s56, s49
  v_mfma_f32_16x16x32_bf16 v[200:203], a[96:99], a[140:143], v[200:203]
  s_waitcnt lgkmcnt(7)
  ds_read_b64_tr_b16 a[94:95], v128 offset:37888
  s_and_b32 s48, s55, 0xffff
  v_mfma_f32_16x16x32_bf16 v[156:159], a[64:67], a[128:131], v[156:159]
  s_add_u32 m0, s48, s60
  s_add_u32 s56, s56, s53
  s_lshl_b32 s49, s46, 1
  v_mfma_f32_16x16x32_bf16 v[156:159], a[68:71], a[144:147], v[156:159]
  s_add_u32 s56, s56, s49
  buffer_load_dwordx4 v244, s[12:15], s55 offen offset:0 sc1 lds
  v_mfma_f32_16x16x32_bf16 v[156:159], a[72:75], a[160:163], v[156:159]
  s_mul_i32 s56, s56, 55296
  s_add_u32 s36, s84, s56
  s_addc_u32 s37, s85, 0
  v_mfma_f32_16x16x32_bf16 v[156:159], a[76:79], a[176:179], v[156:159]
  s_add_u32 s36, s36, 53477376
  s_addc_u32 s37, s37, 0
  v_mfma_f32_16x16x32_bf16 v[172:175], a[76:79], a[180:183], v[172:175]
  s_mov_b32 s38, 55296
  buffer_load_dwordx4 v244, s[12:15], s55 offen offset:1024 sc1 lds
  v_mfma_f32_16x16x32_bf16 v[172:175], a[72:75], a[164:167], v[172:175]
  s_mov_b32 s39, 0x20000
  v_mfma_f32_16x16x32_bf16 v[172:175], a[68:71], a[148:151], v[172:175]
  s_add_u32 s53, s3, 3
  v_mfma_f32_16x16x32_bf16 v[172:175], a[64:67], a[132:135], v[172:175]
  s_and_b32 s53, s53, 3
  v_mfma_f32_16x16x32_bf16 v[188:191], a[64:67], a[136:139], v[188:191]
  s_lshl_b32 s56, s47, 3
  ds_read_b64_tr_b16 a[96:97], v129 offset:0
  s_sub_u32 s49, 118, s56
  v_mfma_f32_16x16x32_bf16 v[188:191], a[68:71], a[152:155], v[188:191]
  ds_read_b64_tr_b16 a[98:99], v129 offset:1024
  s_cmp_lt_u32 s53, 2
  s_cselect_b32 s56, s56, s49
  v_mfma_f32_16x16x32_bf16 v[188:191], a[72:75], a[168:171], v[188:191]
  ds_read_b64_tr_b16 a[100:101], v129 offset:12288
  v_mfma_f32_16x16x32_bf16 v[188:191], a[76:79], a[184:187], v[188:191]
  s_add_u32 s56, s56, s53
  ds_read_b64_tr_b16 a[102:103], v129 offset:13312
  v_mfma_f32_16x16x32_bf16 v[204:207], a[76:79], a[188:191], v[204:207]
  s_lshl_b32 s49, s46, 1
  buffer_load_dwordx4 v244, s[12:15], s55 offen offset:2048 sc1 lds
  v_mfma_f32_16x16x32_bf16 v[204:207], a[72:75], a[172:175], v[204:207]
  s_add_u32 s56, s56, s49
  ds_read_b64_tr_b16 a[104:105], v129 offset:24576
  s_mul_i32 s56, s56, 55296
  v_mfma_f32_16x16x32_bf16 v[204:207], a[68:71], a[156:159], v[204:207]
  ds_read_b64_tr_b16 a[106:107], v129 offset:25600
  s_add_u32 s40, s84, s56
  s_addc_u32 s41, s85, 0
  v_mfma_f32_16x16x32_bf16 v[204:207], a[64:67], a[140:143], v[204:207]
  s_waitcnt lgkmcnt(6)
  ds_read_b64_tr_b16 a[108:109], v129 offset:36864
  v_mfma_f32_16x16x32_bf16 v[0:3], a[80:83], a[128:131], v[0:3]
  ds_read_b64_tr_b16 a[110:111], v129 offset:37888
  s_add_u32 s40, s40, 53477376
  s_addc_u32 s41, s41, 0
  v_mfma_f32_16x16x32_bf16 v[0:3], a[84:87], a[144:147], v[0:3]
  s_mov_b32 s42, 55296
  v_mfma_f32_16x16x32_bf16 v[0:3], a[88:91], a[160:163], v[0:3]
  s_mov_b32 s43, 0x20000
  v_mfma_f32_16x16x32_bf16 v[0:3], a[92:95], a[176:179], v[0:3]
  v_mul_f32 v208, 0xc13504f3, v144
  v_mul_f32 v209, 0xc13504f3, v145
  v_mfma_f32_16x16x32_bf16 v[32:35], a[92:95], a[180:183], v[32:35]
  v_mul_f32 v210, 0xc13504f3, v146
  v_mul_f32 v211, 0xc13504f3, v147
  v_mfma_f32_16x16x32_bf16 v[32:35], a[88:91], a[164:167], v[32:35]
  v_mul_f32 v212, 0xc13504f3, v148
  v_mul_f32 v213, 0xc13504f3, v149
  v_mfma_f32_16x16x32_bf16 v[32:35], a[84:87], a[148:151], v[32:35]
  v_mul_f32 v214, 0xc13504f3, v150
  v_mul_f32 v215, 0xc13504f3, v151
  v_mfma_f32_16x16x32_bf16 v[32:35], a[80:83], a[132:135], v[32:35]
  v_exp_f32 v208, v208
  v_mfma_f32_16x16x32_bf16 v[64:67], a[80:83], a[136:139], v[64:67]
  v_exp_f32 v209, v209
  v_mfma_f32_16x16x32_bf16 v[64:67], a[84:87], a[152:155], v[64:67]
  v_exp_f32 v210, v210
  v_mfma_f32_16x16x32_bf16 v[64:67], a[88:91], a[168:171], v[64:67]
  v_exp_f32 v211, v211
  v_mfma_f32_16x16x32_bf16 v[64:67], a[92:95], a[184:187], v[64:67]
  ds_read_b64_tr_b16 a[64:65], v130 offset:0
  v_exp_f32 v212, v212
  v_mfma_f32_16x16x32_bf16 v[96:99], a[92:95], a[188:191], v[96:99]
  ds_read_b64_tr_b16 a[66:67], v130 offset:1024
  v_exp_f32 v213, v213
  v_mfma_f32_16x16x32_bf16 v[96:99], a[88:91], a[172:175], v[96:99]
  v_mov_b32 v240, 0xf149f2ca
  v_exp_f32 v214, v214
  v_mfma_f32_16x16x32_bf16 v[96:99], a[84:87], a[156:159], v[96:99]
  v_exp_f32 v215, v215
  v_add_f32 v208, 1.0, v208
  v_mfma_f32_16x16x32_bf16 v[96:99], a[80:83], a[140:143], v[96:99]
  s_waitcnt lgkmcnt(2)
  v_add_f32 v209, 1.0, v209
  v_add_f32 v210, 1.0, v210
  v_add_f32 v211, 1.0, v211
  v_mfma_f32_16x16x32_bf16 v[4:7], a[96:99], a[128:131], v[4:7]
  v_add_f32 v212, 1.0, v212
  v_add_f32 v213, 1.0, v213
  v_add_f32 v214, 1.0, v214
  v_mfma_f32_16x16x32_bf16 v[4:7], a[100:103], a[144:147], v[4:7]
  ds_read_b64_tr_b16 a[68:69], v130 offset:12288
  v_lshrrev_b32 v242, 4, v249
  v_add_f32 v215, 1.0, v215
  v_mfma_f32_16x16x32_bf16 v[4:7], a[104:107], a[160:163], v[4:7]
  ds_read_b64_tr_b16 a[70:71], v130 offset:13312
  v_rcp_f32 v208, v208
  v_mfma_f32_16x16x32_bf16 v[4:7], a[108:111], a[176:179], v[4:7]
  buffer_load_dwordx4 v244, s[12:15], s55 offen offset:3072 sc1 lds
  s_add_u32 s55, s55, 16384
  v_mfma_f32_16x16x32_bf16 v[36:39], a[108:111], a[180:183], v[36:39]
  v_lshlrev_b32 v242, 2, v242
  v_rcp_f32 v209, v209
  v_mfma_f32_16x16x32_bf16 v[36:39], a[104:107], a[164:167], v[36:39]
  v_and_b32 v241, 15, v249
  v_rcp_f32 v210, v210
  v_mfma_f32_16x16x32_bf16 v[36:39], a[100:103], a[148:151], v[36:39]
  ds_read_b64_tr_b16 a[72:73], v130 offset:24576
  v_rcp_f32 v211, v211
  v_mfma_f32_16x16x32_bf16 v[36:39], a[96:99], a[132:135], v[36:39]
  ds_read_b64_tr_b16 a[74:75], v130 offset:25600
  v_rcp_f32 v212, v212
  v_mfma_f32_16x16x32_bf16 v[68:71], a[96:99], a[136:139], v[68:71]
  v_sub_u32 v242, v241, v242
  v_rcp_f32 v213, v213
  v_mfma_f32_16x16x32_bf16 v[68:71], a[100:103], a[152:155], v[68:71]
  s_lshl_b32 s56, s3, 4
  ds_read_b64_tr_b16 a[76:77], v130 offset:36864
  v_rcp_f32 v214, v214
  v_mfma_f32_16x16x32_bf16 v[68:71], a[104:107], a[168:171], v[68:71]
  v_rcp_f32 v215, v215
  v_mul_f32 v144, v144, v208
  v_mfma_f32_16x16x32_bf16 v[68:71], a[108:111], a[184:187], v[68:71]
  v_mul_f32 v145, v145, v209
  v_mul_f32 v146, v146, v210
  v_mul_f32 v147, v147, v211
  v_mfma_f32_16x16x32_bf16 v[100:103], a[108:111], a[188:191], v[100:103]
  v_mul_f32 v148, v148, v212
  v_mul_f32 v149, v149, v213
  v_mul_f32 v150, v150, v214
  v_mfma_f32_16x16x32_bf16 v[100:103], a[104:107], a[172:175], v[100:103]
  ds_read_b64_tr_b16 a[78:79], v130 offset:37888
  v_mul_f32 v151, v151, v215
  v_cvt_pk_bf16_f32 v144, v144, v145
  v_mfma_f32_16x16x32_bf16 v[100:103], a[100:103], a[156:159], v[100:103]
  v_cvt_pk_bf16_f32 v145, v146, v147
  v_cvt_pk_bf16_f32 v146, v148, v149
  v_cvt_pk_bf16_f32 v147, v150, v151
  v_mfma_f32_16x16x32_bf16 v[100:103], a[96:99], a[140:143], v[100:103]
  s_waitcnt lgkmcnt(0)
  buffer_store_dwordx4 v[144:147], v236, s[76:79], 0 offen offset:0 sc1
  v_mul_f32 v216, 0xc13504f3, v152
  v_mfma_f32_16x16x32_bf16 v[8:11], a[64:67], a[128:131], v[8:11]
  s_and_b32 s48, s55, 0xffff
  v_mul_f32 v217, 0xc13504f3, v153
  v_mul_f32 v218, 0xc13504f3, v154
  v_mul_f32 v219, 0xc13504f3, v155
  v_mfma_f32_16x16x32_bf16 v[8:11], a[68:71], a[144:147], v[8:11]
  s_add_u32 m0, s48, s60
  v_mul_f32 v220, 0xc13504f3, v156
  v_mul_f32 v221, 0xc13504f3, v157
  v_mul_f32 v222, 0xc13504f3, v158
  v_mfma_f32_16x16x32_bf16 v[8:11], a[72:75], a[160:163], v[8:11]
  v_add_u32 v241, s56, v242
  s_sub_u32 s56, 48, s56
  v_mul_f32 v223, 0xc13504f3, v159
  v_mfma_f32_16x16x32_bf16 v[8:11], a[76:79], a[176:179], v[8:11]
  v_add_u32 v242, s56, v242
  v_exp_f32 v216, v216
  v_mfma_f32_16x16x32_bf16 v[40:43], a[76:79], a[180:183], v[40:43]
  s_mov_b32 s57, 0xffff
  v_mov_b32 v243, v248
  v_exp_f32 v217, v217
  v_mfma_f32_16x16x32_bf16 v[40:43], a[72:75], a[164:167], v[40:43]
  v_mov_b32 v245, 0x10000
  v_exp_f32 v218, v218
  v_mfma_f32_16x16x32_bf16 v[40:43], a[68:71], a[148:151], v[40:43]
  v_or_b32 v247, 0x10000, v248
  v_exp_f32 v219, v219
  v_mfma_f32_16x16x32_bf16 v[40:43], a[64:67], a[132:135], v[40:43]
  ds_read_b64_tr_b16 a[80:81], v131 offset:0
  v_exp_f32 v220, v220
  v_mfma_f32_16x16x32_bf16 v[72:75], a[64:67], a[136:139], v[72:75]
  ds_read_b64_tr_b16 a[82:83], v131 offset:1024
  v_exp_f32 v221, v221
  v_mfma_f32_16x16x32_bf16 v[72:75], a[68:71], a[152:155], v[72:75]
  ds_read_b64_tr_b16 a[84:85], v131 offset:12288
  v_exp_f32 v222, v222
  v_mfma_f32_16x16x32_bf16 v[72:75], a[72:75], a[168:171], v[72:75]
  v_exp_f32 v223, v223
  v_add_f32 v216, 1.0, v216
  v_mfma_f32_16x16x32_bf16 v[72:75], a[76:79], a[184:187], v[72:75]
  v_add_f32 v217, 1.0, v217
  v_add_f32 v218, 1.0, v218
  v_add_f32 v219, 1.0, v219
  v_mfma_f32_16x16x32_bf16 v[104:107], a[76:79], a[188:191], v[104:107]
  v_add_f32 v220, 1.0, v220
  v_add_f32 v221, 1.0, v221
  v_add_f32 v222, 1.0, v222
  v_mfma_f32_16x16x32_bf16 v[104:107], a[72:75], a[172:175], v[104:107]
  ds_read_b64_tr_b16 a[86:87], v131 offset:13312
  ds_read_b64_tr_b16 a[88:89], v131 offset:24576
  ds_read_b64_tr_b16 a[90:91], v131 offset:25600
  ds_read_b64_tr_b16 a[92:93], v131 offset:36864
  ds_read_b64_tr_b16 a[94:95], v131 offset:37888
  v_mfma_f32_16x16x32_bf16 v[104:107], a[68:71], a[156:159], v[104:107]
  ds_read_b64_tr_b16 a[96:97], v132 offset:0
  v_add_f32 v223, 1.0, v223
  v_mfma_f32_16x16x32_bf16 v[104:107], a[64:67], a[140:143], v[104:107]
  s_waitcnt lgkmcnt(1)
  ds_read_b64_tr_b16 a[98:99], v132 offset:1024
  v_rcp_f32 v216, v216
  v_mfma_f32_16x16x32_bf16 v[12:15], a[80:83], a[128:131], v[12:15]
  ds_read_b64_tr_b16 a[100:101], v132 offset:12288
  v_rcp_f32 v217, v217
  v_mfma_f32_16x16x32_bf16 v[12:15], a[84:87], a[144:147], v[12:15]
  ds_read_b64_tr_b16 a[102:103], v132 offset:13312
  v_rcp_f32 v218, v218
  v_mfma_f32_16x16x32_bf16 v[12:15], a[88:91], a[160:163], v[12:15]
  ds_read_b64_tr_b16 a[104:105], v132 offset:24576
  v_rcp_f32 v219, v219
  v_mfma_f32_16x16x32_bf16 v[12:15], a[92:95], a[176:179], v[12:15]
  ds_read_b64_tr_b16 a[106:107], v132 offset:25600
  v_rcp_f32 v220, v220
  v_mfma_f32_16x16x32_bf16 v[44:47], a[92:95], a[180:183], v[44:47]
  ds_read_b64_tr_b16 a[108:109], v132 offset:36864
  v_rcp_f32 v221, v221
  v_mfma_f32_16x16x32_bf16 v[44:47], a[88:91], a[164:167], v[44:47]
  ds_read_b64_tr_b16 a[110:111], v132 offset:37888
  v_rcp_f32 v222, v222
  v_mfma_f32_16x16x32_bf16 v[44:47], a[84:87], a[148:151], v[44:47]
  v_rcp_f32 v223, v223
  v_mul_f32 v152, v152, v216
  v_mfma_f32_16x16x32_bf16 v[44:47], a[80:83], a[132:135], v[44:47]
  v_mul_f32 v153, v153, v217
  v_mul_f32 v154, v154, v218
  v_mul_f32 v155, v155, v219
  v_mfma_f32_16x16x32_bf16 v[76:79], a[80:83], a[136:139], v[76:79]
  v_mul_f32 v156, v156, v220
  v_mul_f32 v157, v157, v221
  v_mul_f32 v158, v158, v222
  v_mfma_f32_16x16x32_bf16 v[76:79], a[84:87], a[152:155], v[76:79]
  v_mul_f32 v159, v159, v223
  v_cvt_pk_bf16_f32 v152, v152, v153
  v_cvt_pk_bf16_f32 v153, v154, v155
  v_mfma_f32_16x16x32_bf16 v[76:79], a[88:91], a[168:171], v[76:79]
  v_cvt_pk_bf16_f32 v154, v156, v157
  v_cvt_pk_bf16_f32 v155, v158, v159
  v_mfma_f32_16x16x32_bf16 v[76:79], a[92:95], a[184:187], v[76:79]
  buffer_store_dwordx4 v[152:155], v236, s[76:79], 0 offen offset:1024 sc1
  v_mul_f32 v224, 0xc13504f3, v160
  v_mfma_f32_16x16x32_bf16 v[108:111], a[92:95], a[188:191], v[108:111]
  v_mul_f32 v225, 0xc13504f3, v161
  v_mul_f32 v226, 0xc13504f3, v162
  v_mul_f32 v227, 0xc13504f3, v163
  v_mfma_f32_16x16x32_bf16 v[108:111], a[88:91], a[172:175], v[108:111]
  v_mul_f32 v228, 0xc13504f3, v164
  v_mul_f32 v229, 0xc13504f3, v165
  v_mul_f32 v230, 0xc13504f3, v166
  v_mfma_f32_16x16x32_bf16 v[108:111], a[84:87], a[156:159], v[108:111]
  ds_read_b64_tr_b16 a[64:65], v133 offset:0
  v_mul_f32 v231, 0xc13504f3, v167
  v_mfma_f32_16x16x32_bf16 v[108:111], a[80:83], a[140:143], v[108:111]
  s_waitcnt lgkmcnt(1)
  ds_read_b64_tr_b16 a[66:67], v133 offset:1024
  v_exp_f32 v224, v224
  v_mfma_f32_16x16x32_bf16 v[16:19], a[96:99], a[128:131], v[16:19]
  ds_read_b64_tr_b16 a[68:69], v133 offset:12288
  v_exp_f32 v225, v225
  v_mfma_f32_16x16x32_bf16 v[16:19], a[100:103], a[144:147], v[16:19]
  ds_read_b64_tr_b16 a[70:71], v133 offset:13312
  v_exp_f32 v226, v226
  v_mfma_f32_16x16x32_bf16 v[16:19], a[104:107], a[160:163], v[16:19]
  ds_read_b64_tr_b16 a[72:73], v133 offset:24576
  v_exp_f32 v227, v227
  v_mfma_f32_16x16x32_bf16 v[16:19], a[108:111], a[176:179], v[16:19]
  buffer_load_dwordx4 v244, s[12:15], s55 offen offset:0 sc1 lds
  buffer_load_dwordx4 v244, s[12:15], s55 offen offset:1024 sc1 lds
  buffer_load_dwordx4 v244, s[12:15], s55 offen offset:2048 sc1 lds
  buffer_load_dwordx4 v244, s[12:15], s55 offen offset:3072 sc1 lds
  s_add_u32 s55, s55, 16384
  v_mfma_f32_16x16x32_bf16 v[48:51], a[108:111], a[180:183], v[48:51]
  ds_read_b64_tr_b16 a[74:75], v133 offset:25600
  v_exp_f32 v228, v228
  v_mfma_f32_16x16x32_bf16 v[48:51], a[104:107], a[164:167], v[48:51]
  ds_read_b64_tr_b16 a[76:77], v133 offset:36864
  v_exp_f32 v229, v229
  v_mfma_f32_16x16x32_bf16 v[48:51], a[100:103], a[148:151], v[48:51]
  ds_read_b64_tr_b16 a[78:79], v133 offset:37888
  v_exp_f32 v230, v230
  v_mfma_f32_16x16x32_bf16 v[48:51], a[96:99], a[132:135], v[48:51]
  v_exp_f32 v231, v231
  v_add_f32 v224, 1.0, v224
  v_mfma_f32_16x16x32_bf16 v[80:83], a[96:99], a[136:139], v[80:83]
  v_add_f32 v225, 1.0, v225
  v_add_f32 v226, 1.0, v226
  v_add_f32 v227, 1.0, v227
  v_mfma_f32_16x16x32_bf16 v[80:83], a[100:103], a[152:155], v[80:83]
  v_add_f32 v228, 1.0, v228
  v_add_f32 v229, 1.0, v229
  v_add_f32 v230, 1.0, v230
  v_mfma_f32_16x16x32_bf16 v[80:83], a[104:107], a[168:171], v[80:83]
  ds_read_b64_tr_b16 a[80:81], v134 offset:0
  v_add_f32 v231, 1.0, v231
  v_mfma_f32_16x16x32_bf16 v[80:83], a[108:111], a[184:187], v[80:83]
  ds_read_b64_tr_b16 a[82:83], v134 offset:1024
  v_rcp_f32 v224, v224
  v_mfma_f32_16x16x32_bf16 v[112:115], a[108:111], a[188:191], v[112:115]
  v_rcp_f32 v225, v225
  v_mfma_f32_16x16x32_bf16 v[112:115], a[104:107], a[172:175], v[112:115]
  ds_read_b64_tr_b16 a[84:85], v134 offset:12288
  v_rcp_f32 v226, v226
  v_mfma_f32_16x16x32_bf16 v[112:115], a[100:103], a[156:159], v[112:115]
  ds_read_b64_tr_b16 a[86:87], v134 offset:13312
  v_rcp_f32 v227, v227
  v_mfma_f32_16x16x32_bf16 v[112:115], a[96:99], a[140:143], v[112:115]
  s_waitcnt lgkmcnt(4)
  ds_read_b64_tr_b16 a[88:89], v134 offset:24576
  v_rcp_f32 v228, v228
  v_mfma_f32_16x16x32_bf16 v[20:23], a[64:67], a[128:131], v[20:23]
  s_and_b32 s48, s55, 0xffff
  ds_read_b64_tr_b16 a[90:91], v134 offset:25600
  v_rcp_f32 v229, v229
  v_mfma_f32_16x16x32_bf16 v[20:23], a[68:71], a[144:147], v[20:23]
  s_add_u32 m0, s48, s60
  ds_read_b64_tr_b16 a[92:93], v134 offset:36864
  v_rcp_f32 v230, v230
  v_mfma_f32_16x16x32_bf16 v[20:23], a[72:75], a[160:163], v[20:23]
  v_rcp_f32 v231, v231
  v_mul_f32 v160, v160, v224
  v_mfma_f32_16x16x32_bf16 v[20:23], a[76:79], a[176:179], v[20:23]
  v_mul_f32 v161, v161, v225
  v_mul_f32 v162, v162, v226
  v_mul_f32 v163, v163, v227
  v_mfma_f32_16x16x32_bf16 v[52:55], a[76:79], a[180:183], v[52:55]
  v_mul_f32 v164, v164, v228
  v_mul_f32 v165, v165, v229
  v_mul_f32 v166, v166, v230
  v_mfma_f32_16x16x32_bf16 v[52:55], a[72:75], a[164:167], v[52:55]
  v_mul_f32 v167, v167, v231
  v_cvt_pk_bf16_f32 v160, v160, v161
  v_cvt_pk_bf16_f32 v161, v162, v163
  v_mfma_f32_16x16x32_bf16 v[52:55], a[68:71], a[148:151], v[52:55]
  ds_read_b64_tr_b16 a[94:95], v134 offset:37888
  v_cvt_pk_bf16_f32 v162, v164, v165
  v_cvt_pk_bf16_f32 v163, v166, v167
  v_mfma_f32_16x16x32_bf16 v[52:55], a[64:67], a[132:135], v[52:55]
  buffer_store_dwordx4 v[160:163], v237, s[76:79], 0 offen offset:0 sc1
  v_mul_f32 v208, 0xc13504f3, v168
  v_mfma_f32_16x16x32_bf16 v[84:87], a[64:67], a[136:139], v[84:87]
  v_mul_f32 v209, 0xc13504f3, v169
  v_mul_f32 v210, 0xc13504f3, v170
  v_mul_f32 v211, 0xc13504f3, v171
  v_mfma_f32_16x16x32_bf16 v[84:87], a[68:71], a[152:155], v[84:87]
  v_mul_f32 v212, 0xc13504f3, v172
  v_mul_f32 v213, 0xc13504f3, v173
  v_mul_f32 v214, 0xc13504f3, v174
  v_mfma_f32_16x16x32_bf16 v[84:87], a[72:75], a[168:171], v[84:87]
  ds_read_b64_tr_b16 a[96:97], v135 offset:0
  v_mul_f32 v215, 0xc13504f3, v175
  v_mfma_f32_16x16x32_bf16 v[84:87], a[76:79], a[184:187], v[84:87]
  ds_read_b64_tr_b16 a[98:99], v135 offset:1024
  v_exp_f32 v208, v208
  v_mfma_f32_16x16x32_bf16 v[116:119], a[76:79], a[188:191], v[116:119]
  v_exp_f32 v209, v209
  v_mfma_f32_16x16x32_bf16 v[116:119], a[72:75], a[172:175], v[116:119]
  ds_read_b64_tr_b16 a[100:101], v135 offset:12288
  v_exp_f32 v210, v210
  v_mfma_f32_16x16x32_bf16 v[116:119], a[68:71], a[156:159], v[116:119]
  ds_read_b64_tr_b16 a[102:103], v135 offset:13312
  v_exp_f32 v211, v211
  v_mfma_f32_16x16x32_bf16 v[116:119], a[64:67], a[140:143], v[116:119]
  s_waitcnt lgkmcnt(4)
  ds_read_b64_tr_b16 a[104:105], v135 offset:24576
  v_exp_f32 v212, v212
  v_mfma_f32_16x16x32_bf16 v[24:27], a[80:83], a[128:131], v[24:27]
  ds_read_b64_tr_b16 a[106:107], v135 offset:25600
  v_exp_f32 v213, v213
  v_mfma_f32_16x16x32_bf16 v[24:27], a[84:87], a[144:147], v[24:27]
  ds_read_b64_tr_b16 a[108:109], v135 offset:36864
  v_exp_f32 v214, v214
  v_mfma_f32_16x16x32_bf16 v[24:27], a[88:91], a[160:163], v[24:27]
  v_exp_f32 v215, v215
  v_add_f32 v208, 1.0, v208
  v_mfma_f32_16x16x32_bf16 v[24:27], a[92:95], a[176:179], v[24:27]
  v_add_f32 v209, 1.0, v209
  v_add_f32 v210, 1.0, v210
  v_add_f32 v211, 1.0, v211
  v_mfma_f32_16x16x32_bf16 v[56:59], a[92:95], a[180:183], v[56:59]
  v_add_f32 v212, 1.0, v212
  v_add_f32 v213, 1.0, v213
  v_add_f32 v214, 1.0, v214
  v_mfma_f32_16x16x32_bf16 v[56:59], a[88:91], a[164:167], v[56:59]
  ds_read_b64_tr_b16 a[110:111], v135 offset:37888
  v_add_f32 v215, 1.0, v215
  v_mfma_f32_16x16x32_bf16 v[56:59], a[84:87], a[148:151], v[56:59]
  v_rcp_f32 v208, v208
  v_mfma_f32_16x16x32_bf16 v[56:59], a[80:83], a[132:135], v[56:59]
  v_rcp_f32 v209, v209
  v_mfma_f32_16x16x32_bf16 v[88:91], a[80:83], a[136:139], v[88:91]
  v_rcp_f32 v210, v210
  v_mfma_f32_16x16x32_bf16 v[88:91], a[84:87], a[152:155], v[88:91]
  v_rcp_f32 v211, v211
  v_mfma_f32_16x16x32_bf16 v[88:91], a[88:91], a[168:171], v[88:91]
  v_rcp_f32 v212, v212
  v_mfma_f32_16x16x32_bf16 v[88:91], a[92:95], a[184:187], v[88:91]
  v_rcp_f32 v213, v213
  v_mfma_f32_16x16x32_bf16 v[120:123], a[92:95], a[188:191], v[120:123]
  v_rcp_f32 v214, v214
  v_mfma_f32_16x16x32_bf16 v[120:123], a[88:91], a[172:175], v[120:123]
  v_rcp_f32 v215, v215
  v_mul_f32 v168, v168, v208
  v_mfma_f32_16x16x32_bf16 v[120:123], a[84:87], a[156:159], v[120:123]
  v_mul_f32 v169, v169, v209
  v_mul_f32 v170, v170, v210
  v_mul_f32 v171, v171, v211
  v_mfma_f32_16x16x32_bf16 v[120:123], a[80:83], a[140:143], v[120:123]
  s_waitcnt lgkmcnt(0)
  v_mul_f32 v172, v172, v212
  v_mul_f32 v173, v173, v213
  v_mul_f32 v174, v174, v214
  v_mfma_f32_16x16x32_bf16 v[28:31], a[96:99], a[128:131], v[28:31]
  v_mul_f32 v175, v175, v215
  v_cvt_pk_bf16_f32 v168, v168, v169
  v_cvt_pk_bf16_f32 v169, v170, v171
  v_mfma_f32_16x16x32_bf16 v[28:31], a[100:103], a[144:147], v[28:31]
  v_cvt_pk_bf16_f32 v170, v172, v173
  v_cvt_pk_bf16_f32 v171, v174, v175
  v_mfma_f32_16x16x32_bf16 v[28:31], a[104:107], a[160:163], v[28:31]
  buffer_store_dwordx4 v[168:171], v237, s[76:79], 0 offen offset:1024 sc1
  v_mfma_f32_16x16x32_bf16 v[28:31], a[108:111], a[176:179], v[28:31]
  buffer_load_dwordx4 v244, s[12:15], s55 offen offset:0 sc1 lds
  v_mfma_f32_16x16x32_bf16 v[60:63], a[108:111], a[180:183], v[60:63]
  buffer_load_dwordx4 v244, s[12:15], s55 offen offset:1024 sc1 lds
  v_mfma_f32_16x16x32_bf16 v[60:63], a[104:107], a[164:167], v[60:63]
  buffer_load_dwordx4 v244, s[12:15], s55 offen offset:2048 sc1 lds
  v_mfma_f32_16x16x32_bf16 v[60:63], a[100:103], a[148:151], v[60:63]
  buffer_load_dwordx4 v244, s[12:15], s55 offen offset:3072 sc1 lds
  s_add_u32 s55, s55, 16384
  v_mfma_f32_16x16x32_bf16 v[60:63], a[96:99], a[132:135], v[60:63]
  v_mfma_f32_16x16x32_bf16 v[92:95], a[96:99], a[136:139], v[92:95]
  v_mfma_f32_16x16x32_bf16 v[92:95], a[100:103], a[152:155], v[92:95]
  v_mfma_f32_16x16x32_bf16 v[92:95], a[104:107], a[168:171], v[92:95]
  v_mfma_f32_16x16x32_bf16 v[92:95], a[108:111], a[184:187], v[92:95]
  v_mfma_f32_16x16x32_bf16 v[124:127], a[108:111], a[188:191], v[124:127]
  v_mfma_f32_16x16x32_bf16 v[124:127], a[104:107], a[172:175], v[124:127]
  v_mfma_f32_16x16x32_bf16 v[124:127], a[100:103], a[156:159], v[124:127]
  v_mfma_f32_16x16x32_bf16 v[124:127], a[96:99], a[140:143], v[124:127]
  v_mov_b32 v250, 0xc13504f3
  s_waitcnt vmcnt(17)
  v_mov_b32 v251, 1.0
  v_pk_mul_f32 v[216:217], v[176:177], v[250:251] op_sel_hi:[1,0]
  v_pk_mul_f32 v[218:219], v[178:179], v[250:251] op_sel_hi:[1,0]
  v_pk_mul_f32 v[220:221], v[180:181], v[250:251] op_sel_hi:[1,0]
  v_pk_mul_f32 v[222:223], v[182:183], v[250:251] op_sel_hi:[1,0]
  v_exp_f32 v216, v216
  v_exp_f32 v217, v217
  v_exp_f32 v218, v218
  v_exp_f32 v219, v219
  v_exp_f32 v220, v220
  v_exp_f32 v221, v221
  v_exp_f32 v222, v222
  v_exp_f32 v223, v223
  v_pk_add_f32 v[216:217], v[216:217], v[250:251] op_sel:[0,1] op_sel_hi:[1,1]
  v_pk_add_f32 v[218:219], v[218:219], v[250:251] op_sel:[0,1] op_sel_hi:[1,1]
  v_pk_add_f32 v[220:221], v[220:221], v[250:251] op_sel:[0,1] op_sel_hi:[1,1]
  v_pk_add_f32 v[222:223], v[222:223], v[250:251] op_sel:[0,1] op_sel_hi:[1,1]
  v_rcp_f32 v216, v216
  v_rcp_f32 v217, v217
  v_rcp_f32 v218, v218
  v_rcp_f32 v219, v219
  v_rcp_f32 v220, v220
  v_rcp_f32 v221, v221
  v_rcp_f32 v222, v222
  v_rcp_f32 v223, v223
  v_pk_mul_f32 v[176:177], v[176:177], v[216:217]
  v_pk_mul_f32 v[178:179], v[178:179], v[218:219]
  v_pk_mul_f32 v[180:181], v[180:181], v[220:221]
  v_pk_mul_f32 v[182:183], v[182:183], v[222:223]
  v_cvt_pk_bf16_f32 v176, v176, v177
  v_cvt_pk_bf16_f32 v177, v178, v179
  v_cvt_pk_bf16_f32 v178, v180, v181
  v_cvt_pk_bf16_f32 v179, v182, v183
  buffer_store_dwordx4 v[176:179], v238, s[76:79], 0 offen offset:0 sc1
  v_pk_mul_f32 v[224:225], v[184:185], v[250:251] op_sel_hi:[1,0]
  v_pk_mul_f32 v[226:227], v[186:187], v[250:251] op_sel_hi:[1,0]
  v_pk_mul_f32 v[228:229], v[188:189], v[250:251] op_sel_hi:[1,0]
  v_pk_mul_f32 v[230:231], v[190:191], v[250:251] op_sel_hi:[1,0]
  v_exp_f32 v224, v224
  v_exp_f32 v225, v225
  v_exp_f32 v226, v226
  v_exp_f32 v227, v227
  v_exp_f32 v228, v228
  v_exp_f32 v229, v229
  v_exp_f32 v230, v230
  v_exp_f32 v231, v231
  v_pk_add_f32 v[224:225], v[224:225], v[250:251] op_sel:[0,1] op_sel_hi:[1,1]
  v_pk_add_f32 v[226:227], v[226:227], v[250:251] op_sel:[0,1] op_sel_hi:[1,1]
  v_pk_add_f32 v[228:229], v[228:229], v[250:251] op_sel:[0,1] op_sel_hi:[1,1]
  v_pk_add_f32 v[230:231], v[230:231], v[250:251] op_sel:[0,1] op_sel_hi:[1,1]
  v_rcp_f32 v224, v224
  v_rcp_f32 v225, v225
  v_rcp_f32 v226, v226
  v_rcp_f32 v227, v227
  v_rcp_f32 v228, v228
  v_rcp_f32 v229, v229
  v_rcp_f32 v230, v230
  v_rcp_f32 v231, v231
  v_pk_mul_f32 v[184:185], v[184:185], v[224:225]
  v_pk_mul_f32 v[186:187], v[186:187], v[226:227]
  v_pk_mul_f32 v[188:189], v[188:189], v[228:229]
  v_pk_mul_f32 v[190:191], v[190:191], v[230:231]
  v_cvt_pk_bf16_f32 v184, v184, v185
  v_cvt_pk_bf16_f32 v185, v186, v187
  v_cvt_pk_bf16_f32 v186, v188, v189
  v_cvt_pk_bf16_f32 v187, v190, v191
  buffer_store_dwordx4 v[184:187], v238, s[76:79], 0 offen offset:1024 sc1
  v_pk_mul_f32 v[208:209], v[192:193], v[250:251] op_sel_hi:[1,0]
  v_pk_mul_f32 v[210:211], v[194:195], v[250:251] op_sel_hi:[1,0]
  v_pk_mul_f32 v[212:213], v[196:197], v[250:251] op_sel_hi:[1,0]
  v_pk_mul_f32 v[214:215], v[198:199], v[250:251] op_sel_hi:[1,0]
  v_exp_f32 v208, v208
  v_exp_f32 v209, v209
  v_exp_f32 v210, v210
  v_exp_f32 v211, v211
  v_exp_f32 v212, v212
  v_exp_f32 v213, v213
  v_exp_f32 v214, v214
  v_exp_f32 v215, v215
  v_pk_add_f32 v[208:209], v[208:209], v[250:251] op_sel:[0,1] op_sel_hi:[1,1]
  v_pk_add_f32 v[210:211], v[210:211], v[250:251] op_sel:[0,1] op_sel_hi:[1,1]
  v_pk_add_f32 v[212:213], v[212:213], v[250:251] op_sel:[0,1] op_sel_hi:[1,1]
  v_pk_add_f32 v[214:215], v[214:215], v[250:251] op_sel:[0,1] op_sel_hi:[1,1]
  v_rcp_f32 v208, v208
  v_rcp_f32 v209, v209
  v_rcp_f32 v210, v210
  v_rcp_f32 v211, v211
  v_rcp_f32 v212, v212
  v_rcp_f32 v213, v213
  v_rcp_f32 v214, v214
  v_rcp_f32 v215, v215
  v_pk_mul_f32 v[192:193], v[192:193], v[208:209]
  v_pk_mul_f32 v[194:195], v[194:195], v[210:211]
  v_pk_mul_f32 v[196:197], v[196:197], v[212:213]
  v_pk_mul_f32 v[198:199], v[198:199], v[214:215]
  v_cvt_pk_bf16_f32 v192, v192, v193
  v_cvt_pk_bf16_f32 v193, v194, v195
  v_cvt_pk_bf16_f32 v194, v196, v197
  v_cvt_pk_bf16_f32 v195, v198, v199
  buffer_store_dwordx4 v[192:195], v239, s[76:79], 0 offen offset:0 sc1
  v_pk_mul_f32 v[216:217], v[200:201], v[250:251] op_sel_hi:[1,0]
  v_pk_mul_f32 v[218:219], v[202:203], v[250:251] op_sel_hi:[1,0]
  v_pk_mul_f32 v[220:221], v[204:205], v[250:251] op_sel_hi:[1,0]
  v_pk_mul_f32 v[222:223], v[206:207], v[250:251] op_sel_hi:[1,0]
  v_exp_f32 v216, v216
  v_exp_f32 v217, v217
  v_exp_f32 v218, v218
  v_exp_f32 v219, v219
  v_exp_f32 v220, v220
  v_exp_f32 v221, v221
  v_exp_f32 v222, v222
  v_exp_f32 v223, v223
  v_pk_add_f32 v[216:217], v[216:217], v[250:251] op_sel:[0,1] op_sel_hi:[1,1]
  v_pk_add_f32 v[218:219], v[218:219], v[250:251] op_sel:[0,1] op_sel_hi:[1,1]
  v_pk_add_f32 v[220:221], v[220:221], v[250:251] op_sel:[0,1] op_sel_hi:[1,1]
  v_pk_add_f32 v[222:223], v[222:223], v[250:251] op_sel:[0,1] op_sel_hi:[1,1]
  v_rcp_f32 v216, v216
  v_rcp_f32 v217, v217
  v_rcp_f32 v218, v218
  v_rcp_f32 v219, v219
  v_rcp_f32 v220, v220
  v_rcp_f32 v221, v221
  v_rcp_f32 v222, v222
  v_rcp_f32 v223, v223
  v_pk_mul_f32 v[200:201], v[200:201], v[216:217]
  v_pk_mul_f32 v[202:203], v[202:203], v[218:219]
  v_pk_mul_f32 v[204:205], v[204:205], v[220:221]
  v_pk_mul_f32 v[206:207], v[206:207], v[222:223]
  v_cvt_pk_bf16_f32 v200, v200, v201
  v_cvt_pk_bf16_f32 v201, v202, v203
  v_cvt_pk_bf16_f32 v202, v204, v205
  v_cvt_pk_bf16_f32 v203, v206, v207
  buffer_store_dwordx4 v[200:203], v239, s[76:79], 0 offen offset:1024 sc1
  v_cvt_pk_bf16_f32 v0, v0, v1
  v_cvt_pk_bf16_f32 v1, v2, v3
  v_cvt_pk_bf16_f32 v2, v4, v5
  v_cvt_pk_bf16_f32 v3, v6, v7
  v_accvgpr_write_b32 a128, v0
  v_accvgpr_write_b32 a129, v1
  v_accvgpr_write_b32 a130, v2
  v_accvgpr_write_b32 a131, v3
  v_cvt_pk_bf16_f32 v8, v8, v9
  v_cvt_pk_bf16_f32 v9, v10, v11
  v_cvt_pk_bf16_f32 v10, v12, v13
  v_cvt_pk_bf16_f32 v11, v14, v15
  v_accvgpr_write_b32 a132, v8
  v_accvgpr_write_b32 a133, v9
  v_accvgpr_write_b32 a134, v10
  v_accvgpr_write_b32 a135, v11
  v_cvt_pk_bf16_f32 v16, v16, v17
  v_cvt_pk_bf16_f32 v17, v18, v19
  v_cvt_pk_bf16_f32 v18, v20, v21
  v_cvt_pk_bf16_f32 v19, v22, v23
  v_accvgpr_write_b32 a136, v16
  v_accvgpr_write_b32 a137, v17
  v_accvgpr_write_b32 a138, v18
  v_accvgpr_write_b32 a139, v19
  v_cvt_pk_bf16_f32 v24, v24, v25
  v_cvt_pk_bf16_f32 v25, v26, v27
  v_cvt_pk_bf16_f32 v26, v28, v29
  v_cvt_pk_bf16_f32 v27, v30, v31
  v_accvgpr_write_b32 a140, v24
  v_accvgpr_write_b32 a141, v25
  v_accvgpr_write_b32 a142, v26
  v_accvgpr_write_b32 a143, v27
  v_cvt_pk_bf16_f32 v32, v32, v33
  v_cvt_pk_bf16_f32 v33, v34, v35
  v_cvt_pk_bf16_f32 v34, v36, v37
  v_cvt_pk_bf16_f32 v35, v38, v39
  v_accvgpr_write_b32 a144, v32
  v_accvgpr_write_b32 a145, v33
  v_accvgpr_write_b32 a146, v34
  v_accvgpr_write_b32 a147, v35
  v_cvt_pk_bf16_f32 v40, v40, v41
  v_cvt_pk_bf16_f32 v41, v42, v43
  v_cvt_pk_bf16_f32 v42, v44, v45
  v_cvt_pk_bf16_f32 v43, v46, v47
  v_accvgpr_write_b32 a148, v40
  v_accvgpr_write_b32 a149, v41
  v_accvgpr_write_b32 a150, v42
  v_accvgpr_write_b32 a151, v43
  v_cvt_pk_bf16_f32 v48, v48, v49
  v_cvt_pk_bf16_f32 v49, v50, v51
  v_cvt_pk_bf16_f32 v50, v52, v53
  v_cvt_pk_bf16_f32 v51, v54, v55
  v_accvgpr_write_b32 a152, v48
  v_accvgpr_write_b32 a153, v49
  v_accvgpr_write_b32 a154, v50
  v_accvgpr_write_b32 a155, v51
  v_cvt_pk_bf16_f32 v56, v56, v57
  v_cvt_pk_bf16_f32 v57, v58, v59
  v_cvt_pk_bf16_f32 v58, v60, v61
  v_cvt_pk_bf16_f32 v59, v62, v63
  v_accvgpr_write_b32 a156, v56
  v_accvgpr_write_b32 a157, v57
  v_accvgpr_write_b32 a158, v58
  v_accvgpr_write_b32 a159, v59
  v_cvt_pk_bf16_f32 v64, v64, v65
  v_cvt_pk_bf16_f32 v65, v66, v67
  v_cvt_pk_bf16_f32 v66, v68, v69
  v_cvt_pk_bf16_f32 v67, v70, v71
  v_accvgpr_write_b32 a160, v64
  v_accvgpr_write_b32 a161, v65
  v_accvgpr_write_b32 a162, v66
  v_accvgpr_write_b32 a163, v67
  v_cvt_pk_bf16_f32 v72, v72, v73
  v_cvt_pk_bf16_f32 v73, v74, v75
  v_cvt_pk_bf16_f32 v74, v76, v77
  v_cvt_pk_bf16_f32 v75, v78, v79
  v_accvgpr_write_b32 a164, v72
  v_accvgpr_write_b32 a165, v73
  v_accvgpr_write_b32 a166, v74
  v_accvgpr_write_b32 a167, v75
  v_cvt_pk_bf16_f32 v80, v80, v81
  v_cvt_pk_bf16_f32 v81, v82, v83
  v_cvt_pk_bf16_f32 v82, v84, v85
  v_cvt_pk_bf16_f32 v83, v86, v87
  v_accvgpr_write_b32 a168, v80
  v_accvgpr_write_b32 a169, v81
  v_accvgpr_write_b32 a170, v82
  v_accvgpr_write_b32 a171, v83
  v_cvt_pk_bf16_f32 v88, v88, v89
  v_cvt_pk_bf16_f32 v89, v90, v91
  v_cvt_pk_bf16_f32 v90, v92, v93
  v_cvt_pk_bf16_f32 v91, v94, v95
  v_accvgpr_write_b32 a172, v88
  v_accvgpr_write_b32 a173, v89
  v_accvgpr_write_b32 a174, v90
  v_accvgpr_write_b32 a175, v91
  v_cvt_pk_bf16_f32 v96, v96, v97
  v_cvt_pk_bf16_f32 v97, v98, v99
  v_cvt_pk_bf16_f32 v98, v100, v101
  v_cvt_pk_bf16_f32 v99, v102, v103
  v_accvgpr_write_b32 a176, v96
  v_accvgpr_write_b32 a177, v97
  v_accvgpr_write_b32 a178, v98
  v_accvgpr_write_b32 a179, v99
  v_cvt_pk_bf16_f32 v104, v104, v105
  v_cvt_pk_bf16_f32 v105, v106, v107
  v_cvt_pk_bf16_f32 v106, v108, v109
  v_cvt_pk_bf16_f32 v107, v110, v111
  v_accvgpr_write_b32 a180, v104
  v_accvgpr_write_b32 a181, v105
  v_accvgpr_write_b32 a182, v106
  v_accvgpr_write_b32 a183, v107
  v_cvt_pk_bf16_f32 v112, v112, v113
  v_cvt_pk_bf16_f32 v113, v114, v115
  v_cvt_pk_bf16_f32 v114, v116, v117
  v_cvt_pk_bf16_f32 v115, v118, v119
  v_accvgpr_write_b32 a184, v112
  v_accvgpr_write_b32 a185, v113
  v_accvgpr_write_b32 a186, v114
  v_accvgpr_write_b32 a187, v115
  v_cvt_pk_bf16_f32 v120, v120, v121
  v_cvt_pk_bf16_f32 v121, v122, v123
  v_cvt_pk_bf16_f32 v122, v124, v125
  v_cvt_pk_bf16_f32 v123, v126, v127
  v_accvgpr_write_b32 a188, v120
  v_accvgpr_write_b32 a189, v121
  v_accvgpr_write_b32 a190, v122
  v_accvgpr_write_b32 a191, v123
  s_lshl_b32 s48, s88, 17
  v_add_u32 v236, s48, v248
  s_lshl_b32 s48, s89, 17
  v_add_u32 v237, s48, v248
  s_lshl_b32 s48, s90, 17
  v_add_u32 v238, s48, v248
  s_lshl_b32 s48, s91, 17
  v_add_u32 v239, s48, v248
  s_waitcnt vmcnt(0)
  s_barrier
  s_lshl_b32 s53, s45, 5
  s_add_u32 s53, s53, s44
  s_lshl_b32 s53, s53, 2
  s_add_u32 s53, s53, 0x1000
  v_mov_b32 v254, 1
  buffer_store_dword v254, v255, s[68:71], s53 offen sc1
  s_cmp_eq_u32 s45, 0
  s_cbranch_scc0 recurrent_scan__compressed_kv_cla__dense_activation_silu__prompt_kernel_pd
  ds_read_b128 a[96:99], v243 offset:0
  ds_read_b128 a[100:103], v243 offset:1024
  ds_read_b128 a[104:107], v243 offset:2048
  ds_read_b128 a[108:111], v243 offset:3072
  v_cmp_gt_i32 s[76:77], 0, v241
  v_cmp_gt_i32 s[78:79], 1, v241
  v_cmp_gt_i32 s[80:81], 2, v241
  v_cmp_gt_i32 s[82:83], 3, v241
  v_cndmask_b32 v224, 0, v240, s[76:77]
  v_cndmask_b32 v225, 0, v240, s[78:79]
  v_cndmask_b32 v226, 0, v240, s[80:81]
  v_cndmask_b32 v227, 0, v240, s[82:83]
  s_waitcnt lgkmcnt(0)
  s_nop 0
  v_mfma_f32_16x16x32_bf16 v[144:147], a[96:99], a[128:131], v[224:227]
  ds_read_b128 a[112:115], v243 offset:4096
  v_mfma_f32_16x16x32_bf16 v[144:147], a[100:103], a[132:135], v[144:147]
  ds_read_b128 a[116:119], v243 offset:5120
  v_mfma_f32_16x16x32_bf16 v[144:147], a[104:107], a[136:139], v[144:147]
  ds_read_b128 a[120:123], v243 offset:6144
  v_mfma_f32_16x16x32_bf16 v[144:147], a[108:111], a[140:143], v[144:147]
  ds_read_b128 a[124:127], v243 offset:7168
  v_mfma_f32_16x16x32_bf16 v[152:155], a[108:111], a[156:159], 0
  v_cmp_gt_i32 s[76:77], 16, v241
  v_cmp_gt_i32 s[78:79], 17, v241
  v_mfma_f32_16x16x32_bf16 v[152:155], a[104:107], a[152:155], v[152:155]
  v_cmp_gt_i32 s[80:81], 18, v241
  v_cmp_gt_i32 s[82:83], 19, v241
  v_mfma_f32_16x16x32_bf16 v[152:155], a[100:103], a[148:151], v[152:155]
  v_cndmask_b32 v228, 0, v240, s[76:77]
  v_cndmask_b32 v229, 0, v240, s[78:79]
  v_mfma_f32_16x16x32_bf16 v[152:155], a[96:99], a[144:147], v[152:155]
  v_cndmask_b32 v230, 0, v240, s[80:81]
  v_cndmask_b32 v231, 0, v240, s[82:83]
  v_mfma_f32_16x16x32_bf16 v[160:163], a[96:99], a[160:163], 0
  v_mfma_f32_16x16x32_bf16 v[160:163], a[100:103], a[164:167], v[160:163]
  v_mfma_f32_16x16x32_bf16 v[160:163], a[104:107], a[168:171], v[160:163]
  v_mfma_f32_16x16x32_bf16 v[160:163], a[108:111], a[172:175], v[160:163]
  v_mfma_f32_16x16x32_bf16 v[168:171], a[108:111], a[188:191], 0
  v_mfma_f32_16x16x32_bf16 v[168:171], a[104:107], a[184:187], v[168:171]
  ds_read_b128 a[64:67], v243 offset:8192
  v_mfma_f32_16x16x32_bf16 v[168:171], a[100:103], a[180:183], v[168:171]
  v_mfma_f32_16x16x32_bf16 v[168:171], a[96:99], a[176:179], v[168:171]
  s_waitcnt lgkmcnt(1)
  ds_read_b128 a[68:71], v243 offset:9216
  v_mfma_f32_16x16x32_bf16 v[148:151], a[112:115], a[128:131], v[228:231]
  v_mfma_f32_16x16x32_bf16 v[148:151], a[116:119], a[132:135], v[148:151]
  ds_read_b128 a[72:75], v243 offset:10240
  v_mfma_f32_16x16x32_bf16 v[148:151], a[120:123], a[136:139], v[148:151]
  v_mfma_f32_16x16x32_bf16 v[148:151], a[124:127], a[140:143], v[148:151]
  ds_read_b128 a[76:79], v243 offset:11264
  v_mfma_f32_16x16x32_bf16 v[156:159], a[124:127], a[156:159], 0
  v_mfma_f32_16x16x32_bf16 v[156:159], a[120:123], a[152:155], v[156:159]
  v_mfma_f32_16x16x32_bf16 v[156:159], a[116:119], a[148:151], v[156:159]
  v_mfma_f32_16x16x32_bf16 v[156:159], a[112:115], a[144:147], v[156:159]
  v_mfma_f32_16x16x32_bf16 v[164:167], a[112:115], a[160:163], 0
  v_mfma_f32_16x16x32_bf16 v[164:167], a[116:119], a[164:167], v[164:167]
  v_mfma_f32_16x16x32_bf16 v[164:167], a[120:123], a[168:171], v[164:167]
  v_mfma_f32_16x16x32_bf16 v[164:167], a[124:127], a[172:175], v[164:167]
  v_mfma_f32_16x16x32_bf16 v[172:175], a[124:127], a[188:191], 0
  v_mfma_f32_16x16x32_bf16 v[172:175], a[120:123], a[184:187], v[172:175]
  v_mfma_f32_16x16x32_bf16 v[172:175], a[116:119], a[180:183], v[172:175]
  v_mfma_f32_16x16x32_bf16 v[172:175], a[112:115], a[176:179], v[172:175]
  v_max3_f32 v250, v144, v145, v146
  v_max3_f32 v251, v152, v153, v154
  v_max3_f32 v252, v160, v161, v162
  v_max3_f32 v253, v168, v169, v170
  v_max3_f32 v250, v250, v147, v148
  v_max3_f32 v251, v251, v155, v156
  v_max3_f32 v252, v252, v163, v164
  s_nop 0
  v_max3_f32 v253, v253, v171, v172
  v_max3_f32 v250, v250, v149, v150
  v_max3_f32 v251, v251, v157, v158
  v_max3_f32 v252, v252, v165, v166
  v_max3_f32 v253, v253, v173, v174
  v_max_f32 v250, v250, v151
  v_max_f32 v251, v251, v159
  v_max_f32 v252, v252, v167
  v_max_f32 v253, v253, v175
  v_mov_b32 v224, v250
  v_mov_b32 v225, v251
  v_mov_b32 v226, v252
  v_mov_b32 v227, v253
  v_permlane16_swap_b32 v224, v250
  v_permlane16_swap_b32 v225, v251
  v_permlane16_swap_b32 v226, v252
  v_permlane16_swap_b32 v227, v253
  v_max_f32 v250, v250, v224
  v_max_f32 v251, v251, v225
  v_max_f32 v252, v252, v226
  v_max_f32 v253, v253, v227
  v_mov_b32 v224, v250
  v_mov_b32 v225, v251
  v_mov_b32 v226, v252
  v_mov_b32 v227, v253
  v_permlane32_swap_b32 v224, v250
  v_permlane32_swap_b32 v225, v251
  v_permlane32_swap_b32 v226, v252
  v_permlane32_swap_b32 v227, v253
  v_max_f32 v250, v250, v224
  v_max_f32 v251, v251, v225
  v_max_f32 v252, v252, v226
  v_max_f32 v253, v253, v227
  v_mul_f32 v208, -1.0, v250
  v_mul_f32 v209, -1.0, v250
  v_mul_f32 v212, -1.0, v251
  v_mul_f32 v213, -1.0, v251
  v_mul_f32 v216, -1.0, v252
  v_mul_f32 v217, -1.0, v252
  v_mul_f32 v220, -1.0, v253
  v_mul_f32 v221, -1.0, v253
  v_pk_mov_b32 v[210:211], v[208:209], v[208:209] op_sel:[0,1]
  v_pk_mov_b32 v[214:215], v[212:213], v[212:213] op_sel:[0,1]
  v_pk_mov_b32 v[218:219], v[216:217], v[216:217] op_sel:[0,1]
  v_pk_mov_b32 v[222:223], v[220:221], v[220:221] op_sel:[0,1]
  v_pk_add_f32 v[144:145], v[144:145], v[208:209]
  v_pk_add_f32 v[146:147], v[146:147], v[208:209]
  v_pk_add_f32 v[148:149], v[148:149], v[208:209]
  v_pk_add_f32 v[150:151], v[150:151], v[208:209]
  v_pk_add_f32 v[152:153], v[152:153], v[212:213]
  v_pk_add_f32 v[154:155], v[154:155], v[212:213]
  v_pk_add_f32 v[156:157], v[156:157], v[212:213]
  v_pk_add_f32 v[158:159], v[158:159], v[212:213]
  v_pk_add_f32 v[160:161], v[160:161], v[216:217]
  v_pk_add_f32 v[162:163], v[162:163], v[216:217]
  v_pk_add_f32 v[164:165], v[164:165], v[216:217]
  v_pk_add_f32 v[166:167], v[166:167], v[216:217]
  v_pk_add_f32 v[168:169], v[168:169], v[220:221]
  v_pk_add_f32 v[170:171], v[170:171], v[220:221]
  v_pk_add_f32 v[172:173], v[172:173], v[220:221]
  v_pk_add_f32 v[174:175], v[174:175], v[220:221]
  v_cmp_gt_i32 s[76:77], 32, v241
  v_cmp_gt_i32 s[78:79], 33, v241
  v_cmp_gt_i32 s[80:81], 34, v241
  v_cmp_gt_i32 s[82:83], 35, v241
  v_cndmask_b32 v224, v208, v240, s[76:77]
  v_cndmask_b32 v225, v209, v240, s[78:79]
  v_cndmask_b32 v226, v210, v240, s[80:81]
  v_cndmask_b32 v227, v211, v240, s[82:83]
  s_waitcnt lgkmcnt(0)
  s_nop 0
  v_mfma_f32_16x16x32_bf16 v[176:179], a[64:67], a[128:131], v[224:227]
  ds_read_b128 a[80:83], v243 offset:12288
  v_mfma_f32_16x16x32_bf16 v[176:179], a[68:71], a[132:135], v[176:179]
  v_exp_f32 v144, v144
  v_mfma_f32_16x16x32_bf16 v[176:179], a[72:75], a[136:139], v[176:179]
  v_exp_f32 v145, v145
  v_mfma_f32_16x16x32_bf16 v[176:179], a[76:79], a[140:143], v[176:179]
  v_exp_f32 v146, v146
  v_mfma_f32_16x16x32_bf16 v[184:187], a[76:79], a[156:159], v[212:215]
  ds_read_b128 a[84:87], v243 offset:13312
  v_cvt_pk_bf16_f32 v144, v144, v145
  v_mfma_f32_16x16x32_bf16 v[184:187], a[72:75], a[152:155], v[184:187]
  v_exp_f32 v147, v147
  v_mfma_f32_16x16x32_bf16 v[184:187], a[68:71], a[148:151], v[184:187]
  v_exp_f32 v148, v148
  v_mfma_f32_16x16x32_bf16 v[184:187], a[64:67], a[144:147], v[184:187]
  ds_read_b128 a[88:91], v243 offset:14336
  v_cvt_pk_bf16_f32 v145, v146, v147
  v_mfma_f32_16x16x32_bf16 v[192:195], a[64:67], a[160:163], v[216:219]
  v_exp_f32 v149, v149
  v_cmp_gt_i32 s[76:77], 48, v241
  v_mfma_f32_16x16x32_bf16 v[192:195], a[68:71], a[164:167], v[192:195]
  v_cmp_gt_i32 s[78:79], 49, v241
  v_cmp_gt_i32 s[80:81], 50, v241
  v_cmp_gt_i32 s[82:83], 51, v241
  v_mfma_f32_16x16x32_bf16 v[192:195], a[72:75], a[168:171], v[192:195]
  v_cndmask_b32 v228, v208, v240, s[76:77]
  v_cndmask_b32 v229, v209, v240, s[78:79]
  v_cndmask_b32 v230, v210, v240, s[80:81]
  v_mfma_f32_16x16x32_bf16 v[192:195], a[76:79], a[172:175], v[192:195]
  ds_read_b128 a[92:95], v243 offset:15360
  v_cvt_pk_bf16_f32 v146, v148, v149
  v_cndmask_b32 v231, v211, v240, s[82:83]
  v_mfma_f32_16x16x32_bf16 v[200:203], a[76:79], a[188:191], v[220:223]
  v_exp_f32 v150, v150
  v_mfma_f32_16x16x32_bf16 v[200:203], a[72:75], a[184:187], v[200:203]
  v_exp_f32 v151, v151
  v_mfma_f32_16x16x32_bf16 v[200:203], a[68:71], a[180:183], v[200:203]
  v_exp_f32 v152, v152
  v_cvt_pk_bf16_f32 v147, v150, v151
  v_mfma_f32_16x16x32_bf16 v[200:203], a[64:67], a[176:179], v[200:203]
  s_waitcnt lgkmcnt(0)
  v_exp_f32 v153, v153
  v_mfma_f32_16x16x32_bf16 v[180:183], a[80:83], a[128:131], v[228:231]
  v_exp_f32 v154, v154
  v_cvt_pk_bf16_f32 v152, v152, v153
  v_mfma_f32_16x16x32_bf16 v[180:183], a[84:87], a[132:135], v[180:183]
  v_exp_f32 v155, v155
  v_mfma_f32_16x16x32_bf16 v[180:183], a[88:91], a[136:139], v[180:183]
  v_exp_f32 v156, v156
  v_cvt_pk_bf16_f32 v153, v154, v155
  v_mfma_f32_16x16x32_bf16 v[180:183], a[92:95], a[140:143], v[180:183]
  v_exp_f32 v157, v157
  v_mfma_f32_16x16x32_bf16 v[188:191], a[92:95], a[156:159], v[212:215]
  v_exp_f32 v158, v158
  v_cvt_pk_bf16_f32 v154, v156, v157
  v_mfma_f32_16x16x32_bf16 v[188:191], a[88:91], a[152:155], v[188:191]
  ds_read_b128 a[96:99], v247 offset:0
  v_exp_f32 v159, v159
  v_mfma_f32_16x16x32_bf16 v[188:191], a[84:87], a[148:151], v[188:191]
  v_exp_f32 v160, v160
  v_cvt_pk_bf16_f32 v155, v158, v159
  v_mfma_f32_16x16x32_bf16 v[188:191], a[80:83], a[144:147], v[188:191]
  v_exp_f32 v161, v161
  v_mfma_f32_16x16x32_bf16 v[196:199], a[80:83], a[160:163], v[216:219]
  v_exp_f32 v162, v162
  v_cvt_pk_bf16_f32 v160, v160, v161
  v_mfma_f32_16x16x32_bf16 v[196:199], a[84:87], a[164:167], v[196:199]
  ds_read_b128 a[100:103], v247 offset:1024
  v_exp_f32 v163, v163
  v_mfma_f32_16x16x32_bf16 v[196:199], a[88:91], a[168:171], v[196:199]
  v_exp_f32 v164, v164
  v_cvt_pk_bf16_f32 v161, v162, v163
  v_mfma_f32_16x16x32_bf16 v[196:199], a[92:95], a[172:175], v[196:199]
  v_exp_f32 v165, v165
  v_mfma_f32_16x16x32_bf16 v[204:207], a[92:95], a[188:191], v[220:223]
  v_exp_f32 v166, v166
  v_cvt_pk_bf16_f32 v162, v164, v165
  v_mfma_f32_16x16x32_bf16 v[204:207], a[88:91], a[184:187], v[204:207]
  ds_read_b128 a[104:107], v247 offset:2048
  v_exp_f32 v167, v167
  v_mfma_f32_16x16x32_bf16 v[204:207], a[84:87], a[180:183], v[204:207]
  v_exp_f32 v168, v168
  v_cvt_pk_bf16_f32 v163, v166, v167
  v_mfma_f32_16x16x32_bf16 v[204:207], a[80:83], a[176:179], v[204:207]
  s_waitcnt lgkmcnt(1)
  v_exp_f32 v169, v169
  v_mfma_f32_16x16x32_bf16 v[0:3], a[96:99], v[144:147], 0
  v_exp_f32 v170, v170
  v_cvt_pk_bf16_f32 v168, v168, v169
  v_mfma_f32_16x16x32_bf16 v[32:35], a[96:99], v[152:155], 0
  v_exp_f32 v171, v171
  v_exp_f32 v172, v172
  v_exp_f32 v173, v173
  v_exp_f32 v174, v174
  v_exp_f32 v175, v175
  v_cvt_pk_bf16_f32 v169, v170, v171
  v_cvt_pk_bf16_f32 v170, v172, v173
  v_cvt_pk_bf16_f32 v171, v174, v175
  v_mfma_f32_16x16x32_bf16 v[64:67], a[96:99], v[160:163], 0
  ds_read_b128 a[108:111], v247 offset:3072
  v_mfma_f32_16x16x32_bf16 v[96:99], a[96:99], v[168:171], 0
  ds_read_b128 a[112:115], v247 offset:4096
  v_mfma_f32_16x16x32_bf16 v[100:103], a[100:103], v[168:171], 0
  v_exp_f32 v176, v176
  v_mfma_f32_16x16x32_bf16 v[68:71], a[100:103], v[160:163], 0
  v_exp_f32 v177, v177
  v_mfma_f32_16x16x32_bf16 v[36:39], a[100:103], v[152:155], 0
  ds_read_b128 a[116:119], v247 offset:5120
  v_cvt_pk_bf16_f32 v176, v176, v177
  v_mfma_f32_16x16x32_bf16 v[4:7], a[100:103], v[144:147], 0
  s_waitcnt lgkmcnt(2)
  v_exp_f32 v178, v178
  v_mfma_f32_16x16x32_bf16 v[8:11], a[104:107], v[144:147], 0
  v_exp_f32 v179, v179
  v_mfma_f32_16x16x32_bf16 v[40:43], a[104:107], v[152:155], 0
  v_exp_f32 v180, v180
  v_mfma_f32_16x16x32_bf16 v[72:75], a[104:107], v[160:163], 0
  ds_read_b128 a[120:123], v247 offset:6144
  v_cvt_pk_bf16_f32 v177, v178, v179
  v_mfma_f32_16x16x32_bf16 v[104:107], a[104:107], v[168:171], 0
  v_exp_f32 v181, v181
  v_mfma_f32_16x16x32_bf16 v[108:111], a[108:111], v[168:171], 0
  v_exp_f32 v182, v182
  v_mfma_f32_16x16x32_bf16 v[76:79], a[108:111], v[160:163], 0
  ds_read_b128 a[124:127], v247 offset:7168
  v_cvt_pk_bf16_f32 v178, v180, v181
  v_mfma_f32_16x16x32_bf16 v[44:47], a[108:111], v[152:155], 0
  v_exp_f32 v183, v183
  v_mfma_f32_16x16x32_bf16 v[12:15], a[108:111], v[144:147], 0
  s_waitcnt lgkmcnt(2)
  v_exp_f32 v184, v184
  v_mfma_f32_16x16x32_bf16 v[16:19], a[112:115], v[144:147], 0
  v_cvt_pk_bf16_f32 v179, v182, v183
  v_mfma_f32_16x16x32_bf16 v[48:51], a[112:115], v[152:155], 0
  v_exp_f32 v185, v185
  v_mfma_f32_16x16x32_bf16 v[80:83], a[112:115], v[160:163], 0
  v_add_u32 v243, 16384, v243
  v_and_b32 v243, 0xffff, v243
  v_mfma_f32_16x16x32_bf16 v[112:115], a[112:115], v[168:171], 0
  v_exp_f32 v186, v186
  v_mfma_f32_16x16x32_bf16 v[116:119], a[116:119], v[168:171], 0
  v_cvt_pk_bf16_f32 v184, v184, v185
  v_mfma_f32_16x16x32_bf16 v[84:87], a[116:119], v[160:163], 0
  v_exp_f32 v187, v187
  v_mfma_f32_16x16x32_bf16 v[52:55], a[116:119], v[152:155], 0
  v_exp_f32 v188, v188
  v_mfma_f32_16x16x32_bf16 v[20:23], a[116:119], v[144:147], 0
  s_waitcnt vmcnt(12) lgkmcnt(0)
  s_barrier
  v_mfma_f32_16x16x32_bf16 v[24:27], a[120:123], v[144:147], 0
  s_and_b32 s48, s55, 0xffff
  ds_read_b128 a[64:67], v243 offset:0
  v_cvt_pk_bf16_f32 v185, v186, v187
  v_mfma_f32_16x16x32_bf16 v[56:59], a[120:123], v[152:155], 0
  s_add_u32 m0, s48, s60
  ds_read_b128 a[68:71], v243 offset:1024
  v_cmp_gt_i32 s[76:77], 0, v242
  v_mfma_f32_16x16x32_bf16 v[88:91], a[120:123], v[160:163], 0
  v_exp_f32 v189, v189
  v_mfma_f32_16x16x32_bf16 v[120:123], a[120:123], v[168:171], 0
  ds_read_b128 a[72:75], v243 offset:2048
  v_cmp_gt_i32 s[78:79], 1, v242
  v_mfma_f32_16x16x32_bf16 v[124:127], a[124:127], v[168:171], 0
  v_cmp_gt_i32 s[80:81], 2, v242
  v_cmp_gt_i32 s[82:83], 3, v242
  v_cndmask_b32 v224, v212, v240, s[76:77]
  v_mfma_f32_16x16x32_bf16 v[92:95], a[124:127], v[160:163], 0
  v_cndmask_b32 v225, v213, v240, s[78:79]
  v_cndmask_b32 v226, v214, v240, s[80:81]
  v_cndmask_b32 v227, v215, v240, s[82:83]
  v_mfma_f32_16x16x32_bf16 v[60:63], a[124:127], v[152:155], 0
  v_exp_f32 v190, v190
  v_cvt_pk_bf16_f32 v186, v188, v189
  v_mfma_f32_16x16x32_bf16 v[28:31], a[124:127], v[144:147], 0
  buffer_load_dwordx4 v244, s[12:15], s55 offen offset:0 sc1 lds
  v_mfma_f32_16x16x32_bf16 v[128:131], a[232:235], v[144:147], 0
  ds_read_b128 a[76:79], v243 offset:3072
  v_exp_f32 v191, v191
  v_mfma_f32_16x16x32_bf16 v[132:135], a[232:235], v[152:155], 0
  buffer_load_dwordx4 v244, s[12:15], s55 offen offset:1024 sc1 lds
  v_cvt_pk_bf16_f32 v187, v190, v191
  v_mfma_f32_16x16x32_bf16 v[136:139], a[232:235], v[160:163], 0
  v_exp_f32 v192, v192
  v_mfma_f32_16x16x32_bf16 v[140:143], a[232:235], v[168:171], 0
  s_waitcnt lgkmcnt(0)
  v_exp_f32 v193, v193
  v_mfma_f32_16x16x32_bf16 v[152:155], a[64:67], a[144:147], v[224:227]
  buffer_load_dwordx4 v244, s[12:15], s55 offen offset:2048 sc1 lds
  v_cvt_pk_bf16_f32 v192, v192, v193
  v_mfma_f32_16x16x32_bf16 v[152:155], a[68:71], a[148:151], v[152:155]
  ds_read_b128 a[80:83], v243 offset:4096
  v_exp_f32 v194, v194
  v_mfma_f32_16x16x32_bf16 v[152:155], a[72:75], a[152:155], v[152:155]
  buffer_load_dwordx4 v244, s[12:15], s55 offen offset:3072 sc1 lds
  v_mfma_f32_16x16x32_bf16 v[152:155], a[76:79], a[156:159], v[152:155]
  s_add_u32 s55, s55, 16384
  ds_read_b128 a[84:87], v243 offset:5120
  v_exp_f32 v195, v195
  v_mfma_f32_16x16x32_bf16 v[160:163], a[76:79], a[172:175], v[216:219]
  s_and_b32 s48, s54, 0xffff
  v_exp_f32 v196, v196
  v_cvt_pk_bf16_f32 v193, v194, v195
  v_mfma_f32_16x16x32_bf16 v[160:163], a[72:75], a[168:171], v[160:163]
  s_add_u32 m0, s48, s50
  ds_read_b128 a[88:91], v243 offset:6144
  v_cmp_gt_i32 s[76:77], 16, v242
  v_cmp_gt_i32 s[78:79], 17, v242
  v_mfma_f32_16x16x32_bf16 v[160:163], a[68:71], a[164:167], v[160:163]
  v_cmp_gt_i32 s[80:81], 18, v242
  v_cmp_gt_i32 s[82:83], 19, v242
  v_cndmask_b32 v228, v212, v240, s[76:77]
  v_mfma_f32_16x16x32_bf16 v[160:163], a[64:67], a[160:163], v[160:163]
  v_cndmask_b32 v229, v213, v240, s[78:79]
  v_cndmask_b32 v230, v214, v240, s[80:81]
  v_cndmask_b32 v231, v215, v240, s[82:83]
  v_mfma_f32_16x16x32_bf16 v[168:171], a[64:67], a[176:179], v[220:223]
  ds_read_b128 a[92:95], v243 offset:7168
  v_exp_f32 v197, v197
  v_mfma_f32_16x16x32_bf16 v[168:171], a[68:71], a[180:183], v[168:171]
  v_exp_f32 v198, v198
  v_cvt_pk_bf16_f32 v194, v196, v197
  v_mfma_f32_16x16x32_bf16 v[168:171], a[72:75], a[184:187], v[168:171]
  buffer_load_dwordx4 v244, s[8:11], s54 offen offset:0 sc1 lds
  v_mfma_f32_16x16x32_bf16 v[168:171], a[76:79], a[188:191], v[168:171]
  s_waitcnt lgkmcnt(0)
  v_exp_f32 v199, v199
  v_mfma_f32_16x16x32_bf16 v[156:159], a[80:83], a[144:147], v[228:231]
  buffer_load_dwordx4 v244, s[8:11], s54 offen offset:1024 sc1 lds
  v_cvt_pk_bf16_f32 v195, v198, v199
  v_mfma_f32_16x16x32_bf16 v[156:159], a[84:87], a[148:151], v[156:159]
  ds_read_b128 a[96:99], v247 offset:8192
  v_exp_f32 v200, v200
  v_mfma_f32_16x16x32_bf16 v[156:159], a[88:91], a[152:155], v[156:159]
  v_exp_f32 v201, v201
  v_mfma_f32_16x16x32_bf16 v[156:159], a[92:95], a[156:159], v[156:159]
  buffer_load_dwordx4 v244, s[8:11], s54 offen offset:2048 sc1 lds
  v_cvt_pk_bf16_f32 v200, v200, v201
  v_mfma_f32_16x16x32_bf16 v[164:167], a[92:95], a[172:175], v[216:219]
  ds_read_b128 a[100:103], v247 offset:9216
  v_exp_f32 v202, v202
  v_mfma_f32_16x16x32_bf16 v[164:167], a[88:91], a[168:171], v[164:167]
  buffer_load_dwordx4 v244, s[8:11], s54 offen offset:3072 sc1 lds
  s_add_u32 s54, s54, 16384
  v_mfma_f32_16x16x32_bf16 v[164:167], a[84:87], a[164:167], v[164:167]
  s_lshl_b32 s51, s47, 7
  v_exp_f32 v203, v203
  v_mfma_f32_16x16x32_bf16 v[164:167], a[80:83], a[160:163], v[164:167]
  s_add_u32 s51, s51, 0x1000
  v_exp_f32 v204, v204
  v_cvt_pk_bf16_f32 v201, v202, v203
  v_mfma_f32_16x16x32_bf16 v[172:175], a[80:83], a[176:179], v[220:223]
  v_and_b32 v252, 31, v249
  v_exp_f32 v205, v205
  v_mfma_f32_16x16x32_bf16 v[172:175], a[84:87], a[180:183], v[172:175]
  ds_read_b128 a[104:107], v247 offset:10240
  v_lshlrev_b32 v252, 2, v252
  v_cvt_pk_bf16_f32 v202, v204, v205
  v_mfma_f32_16x16x32_bf16 v[172:175], a[88:91], a[184:187], v[172:175]
  v_exp_f32 v206, v206
  v_mfma_f32_16x16x32_bf16 v[172:175], a[92:95], a[188:191], v[172:175]
  s_waitcnt lgkmcnt(1)
  buffer_load_dword v253, v252, s[68:71], s51 offen sc1
  v_mfma_f32_16x16x32_bf16 v[0:3], a[96:99], v[176:179], v[0:3]
  s_lshl_b32 s48, s45, 2
  ds_read_b128 a[108:111], v247 offset:11264
  v_exp_f32 v207, v207
  v_mfma_f32_16x16x32_bf16 v[32:35], a[96:99], v[184:187], v[32:35]
  s_add_u32 s48, s48, s46
  s_mul_i32 s48, s48, 20480
  v_cvt_pk_bf16_f32 v203, v206, v207
  v_mfma_f32_16x16x32_bf16 v[64:67], a[96:99], v[192:195], v[64:67]
  s_mul_i32 s52, s46, 320
  v_exp_f32 v152, v152
  v_mfma_f32_16x16x32_bf16 v[96:99], a[96:99], v[200:203], v[96:99]
  s_sub_u32 s48, s48, s52
  ds_read_b128 a[112:115], v247 offset:12288
  s_add_u32 s48, s48, s61
  v_mfma_f32_16x16x32_bf16 v[100:103], a[100:103], v[200:203], v[100:103]
  v_exp_f32 v153, v153
  v_mfma_f32_16x16x32_bf16 v[68:71], a[100:103], v[192:195], v[68:71]
  v_exp_f32 v154, v154
  v_mfma_f32_16x16x32_bf16 v[36:39], a[100:103], v[184:187], v[36:39]
  v_min_u32 v250, 39, v249
  v_cvt_pk_bf16_f32 v152, v152, v153
  v_mfma_f32_16x16x32_bf16 v[4:7], a[100:103], v[176:179], v[4:7]
  s_waitcnt lgkmcnt(1)
  ds_read_b128 a[116:119], v247 offset:13312
  v_lshlrev_b32 v250, 7, v250
  v_mfma_f32_16x16x32_bf16 v[8:11], a[104:107], v[176:179], v[8:11]
  v_exp_f32 v155, v155
  v_mfma_f32_16x16x32_bf16 v[40:43], a[104:107], v[184:187], v[40:43]
  buffer_load_dword v251, v250, s[24:27], s48 offen
  v_mfma_f32_16x16x32_bf16 v[72:75], a[104:107], v[192:195], v[72:75]
  v_exp_f32 v156, v156
  v_cvt_pk_bf16_f32 v153, v154, v155
  v_mfma_f32_16x16x32_bf16 v[104:107], a[104:107], v[200:203], v[104:107]
  s_getpc_b64 s[52:53]
recurrent_scan__compressed_kv_cla__dense_activation_silu__prompt_kernel_cp2:
  s_add_u32 s52, s52, recurrent_scan__compressed_kv_cla__dense_activation_silu__prompt_kernel_x-recurrent_scan__compressed_kv_cla__dense_activation_silu__prompt_kernel_cp2
  s_addc_u32 s53, s53, 0
  v_mfma_f32_16x16x32_bf16 v[108:111], a[108:111], v[200:203], v[108:111]
  s_lshr_b32 s48, s2, 3
  ds_read_b128 a[120:123], v247 offset:14336
  v_exp_f32 v157, v157
  v_mfma_f32_16x16x32_bf16 v[76:79], a[108:111], v[192:195], v[76:79]
  s_lshl_b32 s48, s48, 2
  ds_read_b128 a[124:127], v247 offset:15360
  v_cvt_pk_bf16_f32 v154, v156, v157
  v_mfma_f32_16x16x32_bf16 v[44:47], a[108:111], v[184:187], v[44:47]
  s_add_u32 s48, s48, s3
  v_exp_f32 v158, v158
  v_mfma_f32_16x16x32_bf16 v[12:15], a[108:111], v[176:179], v[12:15]
  s_waitcnt lgkmcnt(2)
  v_add_u32 v247, 16384, v247
  v_and_or_b32 v247, v247, s57, v245
  v_mfma_f32_16x16x32_bf16 v[16:19], a[112:115], v[176:179], v[16:19]
  s_mul_i32 s48, s48, 256
  v_exp_f32 v159, v159
  v_mfma_f32_16x16x32_bf16 v[48:51], a[112:115], v[184:187], v[48:51]
  v_exp_f32 v160, v160
  v_mfma_f32_16x16x32_bf16 v[80:83], a[112:115], v[192:195], v[80:83]
  v_and_b32 v250, 1, v249
  v_cvt_pk_bf16_f32 v155, v158, v159
  v_mfma_f32_16x16x32_bf16 v[112:115], a[112:115], v[200:203], v[112:115]
  v_exp_f32 v161, v161
  v_mfma_f32_16x16x32_bf16 v[116:119], a[116:119], v[200:203], v[116:119]
  v_lshlrev_b32 v250, 7, v250
  v_add_u32 v250, s48, v250
  v_mfma_f32_16x16x32_bf16 v[84:87], a[116:119], v[192:195], v[84:87]
  v_exp_f32 v162, v162
  v_mfma_f32_16x16x32_bf16 v[52:55], a[116:119], v[184:187], v[52:55]
  v_min_u32 v250, recurrent_scan__compressed_kv_cla__dense_activation_silu__prompt_kernel_last-recurrent_scan__compressed_kv_cla__dense_activation_silu__prompt_kernel_x, v250
  v_cvt_pk_bf16_f32 v160, v160, v161
  v_mfma_f32_16x16x32_bf16 v[20:23], a[116:119], v[176:179], v[20:23]
  s_waitcnt lgkmcnt(0)
  ds_read_b128 a[64:67], v243 offset:8192
  v_mfma_f32_16x16x32_bf16 v[24:27], a[120:123], v[176:179], v[24:27]
  global_load_dword v251, v250, s[52:53]
  v_mfma_f32_16x16x32_bf16 v[56:59], a[120:123], v[184:187], v[56:59]
  ds_read_b128 a[68:71], v243 offset:9216
  v_mfma_f32_16x16x32_bf16 v[88:91], a[120:123], v[192:195], v[88:91]
  v_exp_f32 v163, v163
  v_mfma_f32_16x16x32_bf16 v[120:123], a[120:123], v[200:203], v[120:123]
  ds_read_b128 a[72:75], v243 offset:10240
  v_cvt_pk_bf16_f32 v161, v162, v163
  v_mfma_f32_16x16x32_bf16 v[124:127], a[124:127], v[200:203], v[124:127]
  v_exp_f32 v164, v164
  v_mfma_f32_16x16x32_bf16 v[92:95], a[124:127], v[192:195], v[92:95]
  ds_read_b128 a[76:79], v243 offset:11264
  v_mfma_f32_16x16x32_bf16 v[60:63], a[124:127], v[184:187], v[60:63]
  v_exp_f32 v165, v165
  v_mfma_f32_16x16x32_bf16 v[28:31], a[124:127], v[176:179], v[28:31]
  v_exp_f32 v166, v166
  v_mfma_f32_16x16x32_bf16 v[128:131], a[232:235], v[176:179], v[128:131]
  v_cvt_pk_bf16_f32 v162, v164, v165
  v_mfma_f32_16x16x32_bf16 v[132:135], a[232:235], v[184:187], v[132:135]
  v_exp_f32 v167, v167
  v_mfma_f32_16x16x32_bf16 v[136:139], a[232:235], v[192:195], v[136:139]
  v_cvt_pk_bf16_f32 v163, v166, v167
  v_mfma_f32_16x16x32_bf16 v[140:143], a[232:235], v[200:203], v[140:143]
  s_waitcnt vmcnt(2)
  v_cmp_ne_u32 vcc, 1, v253
  s_cbranch_vccnz recurrent_scan__compressed_kv_cla__dense_activation_silu__prompt_kernel_spin3
recurrent_scan__compressed_kv_cla__dense_activation_silu__prompt_kernel_back3:
  v_cmp_gt_i32 s[76:77], 32, v242
  v_cmp_gt_i32 s[78:79], 33, v242
  v_cmp_gt_i32 s[80:81], 34, v242
  v_cmp_gt_i32 s[82:83], 35, v242
  v_cndmask_b32 v224, v212, v240, s[76:77]
  v_cndmask_b32 v225, v213, v240, s[78:79]
  v_cndmask_b32 v226, v214, v240, s[80:81]
  v_cndmask_b32 v227, v215, v240, s[82:83]
  s_waitcnt lgkmcnt(0)
  s_nop 0
  v_mfma_f32_16x16x32_bf16 v[184:187], a[64:67], a[144:147], v[224:227]
  ds_read_b128 a[80:83], v243 offset:12288
  v_cmp_gt_i32 s[76:77], 48, v242
  v_mfma_f32_16x16x32_bf16 v[184:187], a[68:71], a[148:151], v[184:187]
  ds_read_b128 a[84:87], v243 offset:13312
  v_cmp_gt_i32 s[78:79], 49, v242
  v_mfma_f32_16x16x32_bf16 v[184:187], a[72:75], a[152:155], v[184:187]
  ds_read_b128 a[88:91], v243 offset:14336
  v_cmp_gt_i32 s[80:81], 50, v242
  v_mfma_f32_16x16x32_bf16 v[184:187], a[76:79], a[156:159], v[184:187]
  v_exp_f32 v168, v168
  v_mfma_f32_16x16x32_bf16 v[192:195], a[76:79], a[172:175], v[216:219]
  v_cmp_gt_i32 s[82:83], 51, v242
  v_cndmask_b32 v228, v212, v240, s[76:77]
  v_cndmask_b32 v229, v213, v240, s[78:79]
  v_mfma_f32_16x16x32_bf16 v[192:195], a[72:75], a[168:171], v[192:195]
  v_cndmask_b32 v230, v214, v240, s[80:81]
  v_cndmask_b32 v231, v215, v240, s[82:83]
  v_mfma_f32_16x16x32_bf16 v[192:195], a[68:71], a[164:167], v[192:195]
  ds_read_b128 a[92:95], v243 offset:15360
  v_exp_f32 v169, v169
  v_mfma_f32_16x16x32_bf16 v[192:195], a[64:67], a[160:163], v[192:195]
  s_mov_b32 m0, s62
  ds_read_b128 a[96:99], v247 offset:0
  v_cvt_pk_bf16_f32 v168, v168, v169
  v_mfma_f32_16x16x32_bf16 v[200:203], a[64:67], a[176:179], v[220:223]
  v_exp_f32 v170, v170
  v_mfma_f32_16x16x32_bf16 v[200:203], a[68:71], a[180:183], v[200:203]
  buffer_load_dwordx4 v232, s[28:31], s58 offen offset:0 lds
  v_mfma_f32_16x16x32_bf16 v[200:203], a[72:75], a[184:187], v[200:203]
  v_exp_f32 v171, v171
  v_mfma_f32_16x16x32_bf16 v[200:203], a[76:79], a[188:191], v[200:203]
  s_waitcnt lgkmcnt(1)
  buffer_load_dwordx4 v233, s[28:31], s58 offen offset:1024 lds
  v_mfma_f32_16x16x32_bf16 v[188:191], a[80:83], a[144:147], v[228:231]
  ds_read_b128 a[100:103], v247 offset:1024
  v_cvt_pk_bf16_f32 v169, v170, v171
  v_mfma_f32_16x16x32_bf16 v[188:191], a[84:87], a[148:151], v[188:191]
  v_exp_f32 v172, v172
  v_mfma_f32_16x16x32_bf16 v[188:191], a[88:91], a[152:155], v[188:191]
  buffer_load_dwordx4 v234, s[28:31], s58 offen offset:2048 lds
  v_mfma_f32_16x16x32_bf16 v[188:191], a[92:95], a[156:159], v[188:191]
  s_add_u32 m0, s62, 3072
  v_exp_f32 v173, v173
  v_mfma_f32_16x16x32_bf16 v[196:199], a[92:95], a[172:175], v[216:219]
  s_add_u32 s58, s58, 20480
  ds_read_b128 a[104:107], v247 offset:2048
  v_cvt_pk_bf16_f32 v170, v172, v173
  v_mfma_f32_16x16x32_bf16 v[196:199], a[88:91], a[168:171], v[196:199]
  v_exp_f32 v174, v174
  v_mfma_f32_16x16x32_bf16 v[196:199], a[84:87], a[164:167], v[196:199]
  buffer_load_dwordx4 v232, s[28:31], s58 offen offset:0 lds
  v_mfma_f32_16x16x32_bf16 v[196:199], a[80:83], a[160:163], v[196:199]
  ds_read_b128 a[108:111], v247 offset:3072
  v_mfma_f32_16x16x32_bf16 v[204:207], a[80:83], a[176:179], v[220:223]
  buffer_load_dwordx4 v233, s[28:31], s58 offen offset:1024 lds
  v_mfma_f32_16x16x32_bf16 v[204:207], a[84:87], a[180:183], v[204:207]
  v_exp_f32 v175, v175
  v_mfma_f32_16x16x32_bf16 v[204:207], a[88:91], a[184:187], v[204:207]
  ds_read_b128 a[112:115], v247 offset:4096
  v_cvt_pk_bf16_f32 v171, v174, v175
  v_mfma_f32_16x16x32_bf16 v[204:207], a[92:95], a[188:191], v[204:207]
  s_waitcnt lgkmcnt(3)
  buffer_load_dwordx4 v234, s[28:31], s58 offen offset:2048 lds
  v_mfma_f32_16x16x32_bf16 v[32:35], a[96:99], v[152:155], v[32:35]
  s_add_u32 s58, s58, 20480
  ds_read_b128 a[116:119], v247 offset:5120
  v_mfma_f32_16x16x32_bf16 v[64:67], a[96:99], v[160:163], v[64:67]
  buffer_load_dwordx4 a[208:211], v248, s[4:7], s59 offen sc1
  v_mfma_f32_16x16x32_bf16 v[96:99], a[96:99], v[168:171], v[96:99]
  v_exp_f32 v184, v184
  v_mfma_f32_16x16x32_bf16 v[100:103], a[100:103], v[168:171], v[100:103]
  ds_read_b128 a[120:123], v247 offset:6144
  v_mfma_f32_16x16x32_bf16 v[68:71], a[100:103], v[160:163], v[68:71]
  v_exp_f32 v185, v185
  v_mfma_f32_16x16x32_bf16 v[36:39], a[100:103], v[152:155], v[36:39]
  s_waitcnt lgkmcnt(3)
  buffer_load_dwordx4 a[212:215], v248, s[20:23], s59 offen sc1
  v_mfma_f32_16x16x32_bf16 v[40:43], a[104:107], v[152:155], v[40:43]
  v_exp_f32 v186, v186
  v_mfma_f32_16x16x32_bf16 v[72:75], a[104:107], v[160:163], v[72:75]
  ds_read_b128 a[124:127], v247 offset:7168
  v_cvt_pk_bf16_f32 v184, v184, v185
  v_mfma_f32_16x16x32_bf16 v[104:107], a[104:107], v[168:171], v[104:107]
  buffer_load_dwordx4 a[216:219], v248, s[36:39], s59 offen sc1
  v_mfma_f32_16x16x32_bf16 v[108:111], a[108:111], v[168:171], v[108:111]
  v_exp_f32 v187, v187
  v_mfma_f32_16x16x32_bf16 v[76:79], a[108:111], v[160:163], v[76:79]
  buffer_load_dwordx4 a[220:223], v248, s[40:43], s59 offen sc1
  v_mfma_f32_16x16x32_bf16 v[44:47], a[108:111], v[152:155], v[44:47]
  s_waitcnt lgkmcnt(2)
  v_add_u32 v243, 16384, v243
  v_and_b32 v243, 0xffff, v243
  v_mfma_f32_16x16x32_bf16 v[48:51], a[112:115], v[152:155], v[48:51]
  s_add_u32 s59, s59, 1024
  v_cvt_pk_bf16_f32 v185, v186, v187
  v_mfma_f32_16x16x32_bf16 v[80:83], a[112:115], v[160:163], v[80:83]
  v_exp_f32 v188, v188
  v_mfma_f32_16x16x32_bf16 v[112:115], a[112:115], v[168:171], v[112:115]
  s_waitcnt vmcnt(20) lgkmcnt(0)
  s_barrier
  ds_read_b128 a[64:67], v243 offset:0
  v_mfma_f32_16x16x32_bf16 v[116:119], a[116:119], v[168:171], v[116:119]
  s_and_b32 s48, s55, 0xffff
  v_exp_f32 v189, v189
  v_mfma_f32_16x16x32_bf16 v[84:87], a[116:119], v[160:163], v[84:87]
  s_add_u32 m0, s48, s60
  v_exp_f32 v190, v190
  v_mfma_f32_16x16x32_bf16 v[52:55], a[116:119], v[152:155], v[52:55]
  ds_read_b128 a[68:71], v243 offset:1024
  v_cvt_pk_bf16_f32 v186, v188, v189
  v_mfma_f32_16x16x32_bf16 v[56:59], a[120:123], v[152:155], v[56:59]
  ds_read_b128 a[72:75], v243 offset:2048
  v_mfma_f32_16x16x32_bf16 v[88:91], a[120:123], v[160:163], v[88:91]
  v_exp_f32 v191, v191
  v_mfma_f32_16x16x32_bf16 v[120:123], a[120:123], v[168:171], v[120:123]
  ds_read_b128 a[76:79], v243 offset:3072
  v_cvt_pk_bf16_f32 v187, v190, v191
  v_mfma_f32_16x16x32_bf16 v[124:127], a[124:127], v[168:171], v[124:127]
  v_exp_f32 v192, v192
  v_mfma_f32_16x16x32_bf16 v[92:95], a[124:127], v[160:163], v[92:95]
  ds_read_b128 a[80:83], v243 offset:4096
  v_mfma_f32_16x16x32_bf16 v[60:63], a[124:127], v[152:155], v[60:63]
  buffer_load_dwordx4 v244, s[12:15], s55 offen offset:0 sc1 lds
  v_mfma_f32_16x16x32_bf16 v[132:135], a[232:235], v[152:155], v[132:135]
  v_exp_f32 v193, v193
  v_mfma_f32_16x16x32_bf16 v[136:139], a[232:235], v[160:163], v[136:139]
  ds_read_b128 a[84:87], v243 offset:5120
  v_cvt_pk_bf16_f32 v192, v192, v193
  v_mfma_f32_16x16x32_bf16 v[140:143], a[232:235], v[168:171], v[140:143]
  s_waitcnt lgkmcnt(2)
  v_exp_f32 v194, v194
  v_mfma_f32_16x16x32_bf16 v[144:147], a[64:67], a[160:163], v[216:219]
  ds_read_b128 a[88:91], v243 offset:6144
  v_mfma_f32_16x16x32_bf16 v[144:147], a[68:71], a[164:167], v[144:147]
  buffer_load_dwordx4 v244, s[12:15], s55 offen offset:1024 sc1 lds
  v_mfma_f32_16x16x32_bf16 v[144:147], a[72:75], a[168:171], v[144:147]
  ds_read_b128 a[92:95], v243 offset:7168
  v_exp_f32 v195, v195
  v_mfma_f32_16x16x32_bf16 v[144:147], a[76:79], a[172:175], v[144:147]
  ds_read_b128 a[96:99], v243 offset:8192
  v_cvt_pk_bf16_f32 v193, v194, v195
  v_mfma_f32_16x16x32_bf16 v[152:155], a[76:79], a[188:191], v[220:223]
  v_exp_f32 v196, v196
  v_mfma_f32_16x16x32_bf16 v[152:155], a[72:75], a[184:187], v[152:155]
  ds_read_b128 a[100:103], v243 offset:9216
  v_mfma_f32_16x16x32_bf16 v[152:155], a[68:71], a[180:183], v[152:155]
  v_exp_f32 v197, v197
  v_mfma_f32_16x16x32_bf16 v[152:155], a[64:67], a[176:179], v[152:155]
  s_waitcnt lgkmcnt(2)
  buffer_load_dwordx4 v244, s[12:15], s55 offen offset:2048 sc1 lds
  v_mfma_f32_16x16x32_bf16 v[148:151], a[80:83], a[160:163], v[216:219]
  ds_read_b128 a[104:107], v243 offset:10240
  v_cvt_pk_bf16_f32 v194, v196, v197
  v_mfma_f32_16x16x32_bf16 v[148:151], a[84:87], a[164:167], v[148:151]
  v_exp_f32 v198, v198
  v_mfma_f32_16x16x32_bf16 v[148:151], a[88:91], a[168:171], v[148:151]
  ds_read_b128 a[108:111], v243 offset:11264
  v_mfma_f32_16x16x32_bf16 v[148:151], a[92:95], a[172:175], v[148:151]
  v_exp_f32 v199, v199
  v_mfma_f32_16x16x32_bf16 v[156:159], a[92:95], a[188:191], v[220:223]
  ds_read_b128 a[112:115], v243 offset:12288
  v_cvt_pk_bf16_f32 v195, v198, v199
  v_mfma_f32_16x16x32_bf16 v[156:159], a[88:91], a[184:187], v[156:159]
  buffer_load_dwordx4 v244, s[12:15], s55 offen offset:3072 sc1 lds
  v_mfma_f32_16x16x32_bf16 v[156:159], a[84:87], a[180:183], v[156:159]
  s_add_u32 s55, s55, 16384
  ds_read_b128 a[116:119], v243 offset:13312
  v_exp_f32 v200, v200
  v_mfma_f32_16x16x32_bf16 v[156:159], a[80:83], a[176:179], v[156:159]
  s_waitcnt lgkmcnt(2)
  v_exp_f32 v201, v201
  v_mfma_f32_16x16x32_bf16 v[160:163], a[96:99], a[160:163], v[216:219]
  s_and_b32 s48, s54, 0xffff
  ds_read_b128 a[120:123], v243 offset:14336
  v_cvt_pk_bf16_f32 v200, v200, v201
  v_mfma_f32_16x16x32_bf16 v[160:163], a[100:103], a[164:167], v[160:163]
  s_add_u32 m0, s48, s50
  ds_read_b128 a[124:127], v243 offset:15360
  v_mfma_f32_16x16x32_bf16 v[160:163], a[104:107], a[168:171], v[160:163]
  v_exp_f32 v202, v202
  v_mfma_f32_16x16x32_bf16 v[160:163], a[108:111], a[172:175], v[160:163]
  ds_read_b128 a[64:67], v247 offset:8192
  v_mfma_f32_16x16x32_bf16 v[168:171], a[108:111], a[188:191], v[220:223]
  v_exp_f32 v203, v203
  v_mfma_f32_16x16x32_bf16 v[168:171], a[104:107], a[184:187], v[168:171]
  v_exp_f32 v204, v204
  v_mfma_f32_16x16x32_bf16 v[168:171], a[100:103], a[180:183], v[168:171]
  ds_read_b128 a[68:71], v247 offset:9216
  v_cvt_pk_bf16_f32 v201, v202, v203
  v_mfma_f32_16x16x32_bf16 v[168:171], a[96:99], a[176:179], v[168:171]
  s_waitcnt lgkmcnt(2)
  v_exp_f32 v205, v205
  v_mfma_f32_16x16x32_bf16 v[164:167], a[112:115], a[160:163], v[216:219]
  buffer_load_dwordx4 v244, s[8:11], s54 offen offset:0 sc1 lds
  v_mfma_f32_16x16x32_bf16 v[164:167], a[116:119], a[164:167], v[164:167]
  ds_read_b128 a[72:75], v247 offset:10240
  v_cvt_pk_bf16_f32 v202, v204, v205
  v_mfma_f32_16x16x32_bf16 v[164:167], a[120:123], a[168:171], v[164:167]
  v_exp_f32 v206, v206
  v_mfma_f32_16x16x32_bf16 v[164:167], a[124:127], a[172:175], v[164:167]
  ds_read_b128 a[76:79], v247 offset:11264
  v_mfma_f32_16x16x32_bf16 v[172:175], a[124:127], a[188:191], v[220:223]
  v_exp_f32 v207, v207
  v_mfma_f32_16x16x32_bf16 v[172:175], a[120:123], a[184:187], v[172:175]
  ds_read_b128 a[80:83], v247 offset:12288
  v_cvt_pk_bf16_f32 v203, v206, v207
  v_mfma_f32_16x16x32_bf16 v[172:175], a[116:119], a[180:183], v[172:175]
  buffer_load_dwordx4 v244, s[8:11], s54 offen offset:1024 sc1 lds
  v_mfma_f32_16x16x32_bf16 v[172:175], a[112:115], a[176:179], v[172:175]
  s_waitcnt lgkmcnt(3)
  v_exp_f32 v144, v144
  v_mfma_f32_16x16x32_bf16 v[32:35], a[64:67], v[184:187], v[32:35]
  ds_read_b128 a[84:87], v247 offset:13312
  v_mfma_f32_16x16x32_bf16 v[64:67], a[64:67], v[192:195], v[64:67]
  v_exp_f32 v145, v145
  v_mfma_f32_16x16x32_bf16 v[96:99], a[64:67], v[200:203], v[96:99]
  buffer_load_dwordx4 v244, s[8:11], s54 offen offset:2048 sc1 lds
  v_mfma_f32_16x16x32_bf16 v[100:103], a[68:71], v[200:203], v[100:103]
  ds_read_b128 a[88:91], v247 offset:14336
  v_cvt_pk_bf16_f32 v144, v144, v145
  v_mfma_f32_16x16x32_bf16 v[68:71], a[68:71], v[192:195], v[68:71]
  v_exp_f32 v146, v146
  v_mfma_f32_16x16x32_bf16 v[36:39], a[68:71], v[184:187], v[36:39]
  s_waitcnt lgkmcnt(3)
  v_exp_f32 v147, v147
  v_mfma_f32_16x16x32_bf16 v[40:43], a[72:75], v[184:187], v[40:43]
  ds_read_b128 a[92:95], v247 offset:15360
  v_add_u32 v247, 16384, v247
  v_mfma_f32_16x16x32_bf16 v[72:75], a[72:75], v[192:195], v[72:75]
  v_and_or_b32 v247, v247, s57, v245
  v_cvt_pk_bf16_f32 v145, v146, v147
  v_mfma_f32_16x16x32_bf16 v[104:107], a[72:75], v[200:203], v[104:107]
  buffer_load_dwordx4 v244, s[8:11], s54 offen offset:3072 sc1 lds
  v_mfma_f32_16x16x32_bf16 v[108:111], a[76:79], v[200:203], v[108:111]
  s_add_u32 s54, s54, 16384
  v_exp_f32 v148, v148
  v_mfma_f32_16x16x32_bf16 v[76:79], a[76:79], v[192:195], v[76:79]
  v_exp_f32 v149, v149
  v_mfma_f32_16x16x32_bf16 v[44:47], a[76:79], v[184:187], v[44:47]
  s_waitcnt lgkmcnt(2)
  ds_read_b128 a[96:99], v243 offset:16384
  v_cvt_pk_bf16_f32 v146, v148, v149
  v_mfma_f32_16x16x32_bf16 v[48:51], a[80:83], v[184:187], v[48:51]
  v_exp_f32 v150, v150
  v_mfma_f32_16x16x32_bf16 v[80:83], a[80:83], v[192:195], v[80:83]
  ds_read_b128 a[100:103], v243 offset:17408
  v_mfma_f32_16x16x32_bf16 v[112:115], a[80:83], v[200:203], v[112:115]
  v_exp_f32 v151, v151
  v_mfma_f32_16x16x32_bf16 v[116:119], a[84:87], v[200:203], v[116:119]
  ds_read_b128 a[104:107], v243 offset:18432
  v_cvt_pk_bf16_f32 v147, v150, v151
  v_mfma_f32_16x16x32_bf16 v[84:87], a[84:87], v[192:195], v[84:87]
  v_exp_f32 v152, v152
  v_mfma_f32_16x16x32_bf16 v[52:55], a[84:87], v[184:187], v[52:55]
  s_waitcnt lgkmcnt(3)
  ds_read_b128 a[108:111], v243 offset:19456
  v_mfma_f32_16x16x32_bf16 v[56:59], a[88:91], v[184:187], v[56:59]
  v_exp_f32 v153, v153
  v_mfma_f32_16x16x32_bf16 v[88:91], a[88:91], v[192:195], v[88:91]
  ds_read_b128 a[112:115], v243 offset:20480
  v_cvt_pk_bf16_f32 v152, v152, v153
  v_mfma_f32_16x16x32_bf16 v[120:123], a[88:91], v[200:203], v[120:123]
  v_exp_f32 v154, v154
  v_mfma_f32_16x16x32_bf16 v[124:127], a[92:95], v[200:203], v[124:127]
  ds_read_b128 a[116:119], v243 offset:21504
  v_mfma_f32_16x16x32_bf16 v[92:95], a[92:95], v[192:195], v[92:95]
  v_exp_f32 v155, v155
  v_mfma_f32_16x16x32_bf16 v[60:63], a[92:95], v[184:187], v[60:63]
  ds_read_b128 a[120:123], v243 offset:22528
  v_cvt_pk_bf16_f32 v153, v154, v155
  v_mfma_f32_16x16x32_bf16 v[132:135], a[232:235], v[184:187], v[132:135]
  ds_read_b128 a[124:127], v243 offset:23552
  v_mfma_f32_16x16x32_bf16 v[136:139], a[232:235], v[192:195], v[136:139]
  v_mfma_f32_16x16x32_bf16 v[140:143], a[232:235], v[200:203], v[140:143]
  s_branch recurrent_scan__compressed_kv_cla__dense_activation_silu__prompt_kernel_lo
recurrent_scan__compressed_kv_cla__dense_activation_silu__prompt_kernel_pd:
  ds_read_b128 a[96:99], v243 offset:0
  ds_read_b128 a[100:103], v243 offset:1024
  ds_read_b128 a[104:107], v243 offset:2048
  ds_read_b128 a[108:111], v243 offset:3072
  s_waitcnt lgkmcnt(0)
  v_mfma_f32_16x16x32_bf16 v[144:147], a[96:99], a[128:131], 0
  ds_read_b128 a[112:115], v243 offset:4096
  v_mfma_f32_16x16x32_bf16 v[144:147], a[100:103], a[132:135], v[144:147]
  ds_read_b128 a[116:119], v243 offset:5120
  v_mfma_f32_16x16x32_bf16 v[144:147], a[104:107], a[136:139], v[144:147]
  ds_read_b128 a[120:123], v243 offset:6144
  v_mfma_f32_16x16x32_bf16 v[144:147], a[108:111], a[140:143], v[144:147]
  ds_read_b128 a[124:127], v243 offset:7168
  v_mfma_f32_16x16x32_bf16 v[152:155], a[108:111], a[156:159], 0
  v_mfma_f32_16x16x32_bf16 v[152:155], a[104:107], a[152:155], v[152:155]
  v_mfma_f32_16x16x32_bf16 v[152:155], a[100:103], a[148:151], v[152:155]
  v_mfma_f32_16x16x32_bf16 v[152:155], a[96:99], a[144:147], v[152:155]
  v_mfma_f32_16x16x32_bf16 v[160:163], a[96:99], a[160:163], 0
  v_mfma_f32_16x16x32_bf16 v[160:163], a[100:103], a[164:167], v[160:163]
  v_mfma_f32_16x16x32_bf16 v[160:163], a[104:107], a[168:171], v[160:163]
  v_mfma_f32_16x16x32_bf16 v[160:163], a[108:111], a[172:175], v[160:163]
  v_mfma_f32_16x16x32_bf16 v[168:171], a[108:111], a[188:191], 0
  v_mfma_f32_16x16x32_bf16 v[168:171], a[104:107], a[184:187], v[168:171]
  ds_read_b128 a[64:67], v243 offset:8192
  v_mfma_f32_16x16x32_bf16 v[168:171], a[100:103], a[180:183], v[168:171]
  v_mfma_f32_16x16x32_bf16 v[168:171], a[96:99], a[176:179], v[168:171]
  s_waitcnt lgkmcnt(1)
  ds_read_b128 a[68:71], v243 offset:9216
  v_mfma_f32_16x16x32_bf16 v[148:151], a[112:115], a[128:131], 0
  v_mfma_f32_16x16x32_bf16 v[148:151], a[116:119], a[132:135], v[148:151]
  ds_read_b128 a[72:75], v243 offset:10240
  v_mfma_f32_16x16x32_bf16 v[148:151], a[120:123], a[136:139], v[148:151]
  v_mfma_f32_16x16x32_bf16 v[148:151], a[124:127], a[140:143], v[148:151]
  ds_read_b128 a[76:79], v243 offset:11264
  v_mfma_f32_16x16x32_bf16 v[156:159], a[124:127], a[156:159], 0
  v_mfma_f32_16x16x32_bf16 v[156:159], a[120:123], a[152:155], v[156:159]
  v_mfma_f32_16x16x32_bf16 v[156:159], a[116:119], a[148:151], v[156:159]
  v_mfma_f32_16x16x32_bf16 v[156:159], a[112:115], a[144:147], v[156:159]
  v_mfma_f32_16x16x32_bf16 v[164:167], a[112:115], a[160:163], 0
  v_mfma_f32_16x16x32_bf16 v[164:167], a[116:119], a[164:167], v[164:167]
  v_mfma_f32_16x16x32_bf16 v[164:167], a[120:123], a[168:171], v[164:167]
  v_mfma_f32_16x16x32_bf16 v[164:167], a[124:127], a[172:175], v[164:167]
  v_mfma_f32_16x16x32_bf16 v[172:175], a[124:127], a[188:191], 0
  v_mfma_f32_16x16x32_bf16 v[172:175], a[120:123], a[184:187], v[172:175]
  v_mfma_f32_16x16x32_bf16 v[172:175], a[116:119], a[180:183], v[172:175]
  v_mfma_f32_16x16x32_bf16 v[172:175], a[112:115], a[176:179], v[172:175]
  v_max3_f32 v250, v144, v145, v146
  v_max3_f32 v251, v152, v153, v154
  v_max3_f32 v252, v160, v161, v162
  v_max3_f32 v253, v168, v169, v170
  v_max3_f32 v250, v250, v147, v148
  v_max3_f32 v251, v251, v155, v156
  v_max3_f32 v252, v252, v163, v164
  s_nop 0
  v_max3_f32 v253, v253, v171, v172
  v_max3_f32 v250, v250, v149, v150
  v_max3_f32 v251, v251, v157, v158
  v_max3_f32 v252, v252, v165, v166
  v_max3_f32 v253, v253, v173, v174
  v_max_f32 v250, v250, v151
  v_max_f32 v251, v251, v159
  v_max_f32 v252, v252, v167
  v_max_f32 v253, v253, v175
  v_mov_b32 v224, v250
  v_mov_b32 v225, v251
  v_mov_b32 v226, v252
  v_mov_b32 v227, v253
  v_permlane16_swap_b32 v224, v250
  v_permlane16_swap_b32 v225, v251
  v_permlane16_swap_b32 v226, v252
  v_permlane16_swap_b32 v227, v253
  v_max_f32 v250, v250, v224
  v_max_f32 v251, v251, v225
  v_max_f32 v252, v252, v226
  v_max_f32 v253, v253, v227
  v_mov_b32 v224, v250
  v_mov_b32 v225, v251
  v_mov_b32 v226, v252
  v_mov_b32 v227, v253
  v_permlane32_swap_b32 v224, v250
  v_permlane32_swap_b32 v225, v251
  v_permlane32_swap_b32 v226, v252
  v_permlane32_swap_b32 v227, v253
  v_max_f32 v250, v250, v224
  v_max_f32 v251, v251, v225
  v_max_f32 v252, v252, v226
  v_max_f32 v253, v253, v227
  v_mul_f32 v208, -1.0, v250
  v_mul_f32 v209, -1.0, v250
  v_mul_f32 v212, -1.0, v251
  v_mul_f32 v213, -1.0, v251
  v_mul_f32 v216, -1.0, v252
  v_mul_f32 v217, -1.0, v252
  v_mul_f32 v220, -1.0, v253
  v_mul_f32 v221, -1.0, v253
  v_pk_mov_b32 v[210:211], v[208:209], v[208:209] op_sel:[0,1]
  v_pk_mov_b32 v[214:215], v[212:213], v[212:213] op_sel:[0,1]
  v_pk_mov_b32 v[218:219], v[216:217], v[216:217] op_sel:[0,1]
  v_pk_mov_b32 v[222:223], v[220:221], v[220:221] op_sel:[0,1]
  v_pk_add_f32 v[144:145], v[144:145], v[208:209]
  v_pk_add_f32 v[146:147], v[146:147], v[208:209]
  v_pk_add_f32 v[148:149], v[148:149], v[208:209]
  v_pk_add_f32 v[150:151], v[150:151], v[208:209]
  v_pk_add_f32 v[152:153], v[152:153], v[212:213]
  v_pk_add_f32 v[154:155], v[154:155], v[212:213]
  v_pk_add_f32 v[156:157], v[156:157], v[212:213]
  v_pk_add_f32 v[158:159], v[158:159], v[212:213]
  v_pk_add_f32 v[160:161], v[160:161], v[216:217]
  v_pk_add_f32 v[162:163], v[162:163], v[216:217]
  v_pk_add_f32 v[164:165], v[164:165], v[216:217]
  v_pk_add_f32 v[166:167], v[166:167], v[216:217]
  v_pk_add_f32 v[168:169], v[168:169], v[220:221]
  v_pk_add_f32 v[170:171], v[170:171], v[220:221]
  v_pk_add_f32 v[172:173], v[172:173], v[220:221]
  v_pk_add_f32 v[174:175], v[174:175], v[220:221]
  s_lshl_b32 s56, s45, 1
  s_sub_u32 s56, s56, 4
  s_waitcnt lgkmcnt(0)
  v_mfma_f32_16x16x32_bf16 v[176:179], a[64:67], a[128:131], v[208:211]
  ds_read_b128 a[80:83], v243 offset:12288
  v_mfma_f32_16x16x32_bf16 v[176:179], a[68:71], a[132:135], v[176:179]
  v_exp_f32 v144, v144
  v_mfma_f32_16x16x32_bf16 v[176:179], a[72:75], a[136:139], v[176:179]
  v_exp_f32 v145, v145
  v_mfma_f32_16x16x32_bf16 v[176:179], a[76:79], a[140:143], v[176:179]
  v_exp_f32 v146, v146
  v_mfma_f32_16x16x32_bf16 v[184:187], a[76:79], a[156:159], v[212:215]
  ds_read_b128 a[84:87], v243 offset:13312
  v_cvt_pk_bf16_f32 v144, v144, v145
  v_mfma_f32_16x16x32_bf16 v[184:187], a[72:75], a[152:155], v[184:187]
  v_exp_f32 v147, v147
  v_mfma_f32_16x16x32_bf16 v[184:187], a[68:71], a[148:151], v[184:187]
  v_exp_f32 v148, v148
  v_mfma_f32_16x16x32_bf16 v[184:187], a[64:67], a[144:147], v[184:187]
  ds_read_b128 a[88:91], v243 offset:14336
  v_cvt_pk_bf16_f32 v145, v146, v147
  v_mfma_f32_16x16x32_bf16 v[192:195], a[64:67], a[160:163], v[216:219]
  v_exp_f32 v149, v149
  v_mfma_f32_16x16x32_bf16 v[192:195], a[68:71], a[164:167], v[192:195]
  v_exp_f32 v150, v150
  v_mfma_f32_16x16x32_bf16 v[192:195], a[72:75], a[168:171], v[192:195]
  ds_read_b128 a[92:95], v243 offset:15360
  v_cvt_pk_bf16_f32 v146, v148, v149
  v_mfma_f32_16x16x32_bf16 v[192:195], a[76:79], a[172:175], v[192:195]
  v_exp_f32 v151, v151
  v_mfma_f32_16x16x32_bf16 v[200:203], a[76:79], a[188:191], v[220:223]
  v_exp_f32 v152, v152
  v_cvt_pk_bf16_f32 v147, v150, v151
  v_mfma_f32_16x16x32_bf16 v[200:203], a[72:75], a[184:187], v[200:203]
  v_exp_f32 v153, v153
  v_mfma_f32_16x16x32_bf16 v[200:203], a[68:71], a[180:183], v[200:203]
  v_exp_f32 v154, v154
  v_cvt_pk_bf16_f32 v152, v152, v153
  v_mfma_f32_16x16x32_bf16 v[200:203], a[64:67], a[176:179], v[200:203]
  s_waitcnt lgkmcnt(0)
  v_exp_f32 v155, v155
  v_mfma_f32_16x16x32_bf16 v[180:183], a[80:83], a[128:131], v[208:211]
  v_exp_f32 v156, v156
  v_cvt_pk_bf16_f32 v153, v154, v155
  v_mfma_f32_16x16x32_bf16 v[180:183], a[84:87], a[132:135], v[180:183]
  v_exp_f32 v157, v157
  v_mfma_f32_16x16x32_bf16 v[180:183], a[88:91], a[136:139], v[180:183]
  v_exp_f32 v158, v158
  v_cvt_pk_bf16_f32 v154, v156, v157
  v_mfma_f32_16x16x32_bf16 v[180:183], a[92:95], a[140:143], v[180:183]
  v_exp_f32 v159, v159
  v_mfma_f32_16x16x32_bf16 v[188:191], a[92:95], a[156:159], v[212:215]
  ds_read_b128 a[96:99], v247 offset:0
  v_exp_f32 v160, v160
  v_mfma_f32_16x16x32_bf16 v[188:191], a[88:91], a[152:155], v[188:191]
  v_exp_f32 v161, v161
  v_cvt_pk_bf16_f32 v155, v158, v159
  v_mfma_f32_16x16x32_bf16 v[188:191], a[84:87], a[148:151], v[188:191]
  v_exp_f32 v162, v162
  v_cvt_pk_bf16_f32 v160, v160, v161
  v_mfma_f32_16x16x32_bf16 v[188:191], a[80:83], a[144:147], v[188:191]
  v_exp_f32 v163, v163
  v_mfma_f32_16x16x32_bf16 v[196:199], a[80:83], a[160:163], v[216:219]
  ds_read_b128 a[100:103], v247 offset:1024
  v_exp_f32 v164, v164
  v_mfma_f32_16x16x32_bf16 v[196:199], a[84:87], a[164:167], v[196:199]
  v_exp_f32 v165, v165
  v_cvt_pk_bf16_f32 v161, v162, v163
  v_mfma_f32_16x16x32_bf16 v[196:199], a[88:91], a[168:171], v[196:199]
  v_exp_f32 v166, v166
  v_cvt_pk_bf16_f32 v162, v164, v165
  v_mfma_f32_16x16x32_bf16 v[196:199], a[92:95], a[172:175], v[196:199]
  v_exp_f32 v167, v167
  v_mfma_f32_16x16x32_bf16 v[204:207], a[92:95], a[188:191], v[220:223]
  ds_read_b128 a[104:107], v247 offset:2048
  v_exp_f32 v168, v168
  v_mfma_f32_16x16x32_bf16 v[204:207], a[88:91], a[184:187], v[204:207]
  v_exp_f32 v169, v169
  v_cvt_pk_bf16_f32 v163, v166, v167
  v_mfma_f32_16x16x32_bf16 v[204:207], a[84:87], a[180:183], v[204:207]
  v_exp_f32 v170, v170
  v_cvt_pk_bf16_f32 v168, v168, v169
  v_mfma_f32_16x16x32_bf16 v[204:207], a[80:83], a[176:179], v[204:207]
  s_waitcnt lgkmcnt(1)
  v_exp_f32 v171, v171
  v_mfma_f32_16x16x32_bf16 v[0:3], a[96:99], v[144:147], 0
  ds_read_b128 a[108:111], v247 offset:3072
  v_exp_f32 v172, v172
  v_mfma_f32_16x16x32_bf16 v[32:35], a[96:99], v[152:155], 0
  v_exp_f32 v173, v173
  v_exp_f32 v174, v174
  v_exp_f32 v175, v175
  v_cvt_pk_bf16_f32 v169, v170, v171
  v_cvt_pk_bf16_f32 v170, v172, v173
  v_cvt_pk_bf16_f32 v171, v174, v175
  v_mfma_f32_16x16x32_bf16 v[64:67], a[96:99], v[160:163], 0
  ds_read_b128 a[112:115], v247 offset:4096
  v_mfma_f32_16x16x32_bf16 v[96:99], a[96:99], v[168:171], 0
  v_exp_f32 v176, v176
  v_mfma_f32_16x16x32_bf16 v[100:103], a[100:103], v[168:171], 0
  v_exp_f32 v177, v177
  v_mfma_f32_16x16x32_bf16 v[68:71], a[100:103], v[160:163], 0
  ds_read_b128 a[116:119], v247 offset:5120
  v_cvt_pk_bf16_f32 v176, v176, v177
  v_mfma_f32_16x16x32_bf16 v[36:39], a[100:103], v[152:155], 0
  v_exp_f32 v178, v178
  v_mfma_f32_16x16x32_bf16 v[4:7], a[100:103], v[144:147], 0
  s_waitcnt lgkmcnt(2)
  v_exp_f32 v179, v179
  v_mfma_f32_16x16x32_bf16 v[8:11], a[104:107], v[144:147], 0
  ds_read_b128 a[120:123], v247 offset:6144
  v_cvt_pk_bf16_f32 v177, v178, v179
  v_mfma_f32_16x16x32_bf16 v[40:43], a[104:107], v[152:155], 0
  v_exp_f32 v180, v180
  v_mfma_f32_16x16x32_bf16 v[72:75], a[104:107], v[160:163], 0
  v_exp_f32 v181, v181
  v_mfma_f32_16x16x32_bf16 v[104:107], a[104:107], v[168:171], 0
  ds_read_b128 a[124:127], v247 offset:7168
  v_cvt_pk_bf16_f32 v178, v180, v181
  v_mfma_f32_16x16x32_bf16 v[108:111], a[108:111], v[168:171], 0
  v_exp_f32 v182, v182
  v_mfma_f32_16x16x32_bf16 v[76:79], a[108:111], v[160:163], 0
  v_exp_f32 v183, v183
  v_mfma_f32_16x16x32_bf16 v[44:47], a[108:111], v[152:155], 0
  v_exp_f32 v184, v184
  v_mfma_f32_16x16x32_bf16 v[12:15], a[108:111], v[144:147], 0
  s_waitcnt lgkmcnt(2)
  v_cvt_pk_bf16_f32 v179, v182, v183
  v_mfma_f32_16x16x32_bf16 v[16:19], a[112:115], v[144:147], 0
  v_exp_f32 v185, v185
  v_mfma_f32_16x16x32_bf16 v[48:51], a[112:115], v[152:155], 0
  v_add_u32 v243, 16384, v243
  v_and_b32 v243, 0xffff, v243
  v_mfma_f32_16x16x32_bf16 v[80:83], a[112:115], v[160:163], 0
  v_exp_f32 v186, v186
  v_mfma_f32_16x16x32_bf16 v[112:115], a[112:115], v[168:171], 0
  v_cvt_pk_bf16_f32 v184, v184, v185
  v_mfma_f32_16x16x32_bf16 v[116:119], a[116:119], v[168:171], 0
  v_exp_f32 v187, v187
  v_mfma_f32_16x16x32_bf16 v[84:87], a[116:119], v[160:163], 0
  v_exp_f32 v188, v188
  v_mfma_f32_16x16x32_bf16 v[52:55], a[116:119], v[152:155], 0
  v_cvt_pk_bf16_f32 v185, v186, v187
  v_mfma_f32_16x16x32_bf16 v[20:23], a[116:119], v[144:147], 0
  s_waitcnt vmcnt(12) lgkmcnt(0)
  s_barrier
  v_mfma_f32_16x16x32_bf16 v[24:27], a[120:123], v[144:147], 0
  s_and_b32 s48, s55, 0xffff
  ds_read_b128 a[64:67], v243 offset:0
  s_add_u32 m0, s48, s60
  v_mfma_f32_16x16x32_bf16 v[56:59], a[120:123], v[152:155], 0
  ds_read_b128 a[68:71], v243 offset:1024
  v_mfma_f32_16x16x32_bf16 v[88:91], a[120:123], v[160:163], 0
  ds_read_b128 a[72:75], v243 offset:2048
  v_mfma_f32_16x16x32_bf16 v[120:123], a[120:123], v[168:171], 0
  ds_read_b128 a[76:79], v243 offset:3072
  v_mfma_f32_16x16x32_bf16 v[124:127], a[124:127], v[168:171], 0
  v_exp_f32 v189, v189
  v_mfma_f32_16x16x32_bf16 v[92:95], a[124:127], v[160:163], 0
  buffer_load_dwordx4 v244, s[12:15], s55 offen offset:0 sc1 lds
  v_mfma_f32_16x16x32_bf16 v[60:63], a[124:127], v[152:155], 0
  v_exp_f32 v190, v190
  v_mfma_f32_16x16x32_bf16 v[28:31], a[124:127], v[144:147], 0
  v_cvt_pk_bf16_f32 v186, v188, v189
  v_mfma_f32_16x16x32_bf16 v[128:131], a[232:235], v[144:147], 0
  v_exp_f32 v191, v191
  v_mfma_f32_16x16x32_bf16 v[132:135], a[232:235], v[152:155], 0
  v_exp_f32 v192, v192
  v_mfma_f32_16x16x32_bf16 v[136:139], a[232:235], v[160:163], 0
  ds_read_b128 a[80:83], v243 offset:4096
  v_cvt_pk_bf16_f32 v187, v190, v191
  v_mfma_f32_16x16x32_bf16 v[140:143], a[232:235], v[168:171], 0
  s_waitcnt lgkmcnt(1)
  buffer_load_dwordx4 v244, s[12:15], s55 offen offset:1024 sc1 lds
  v_mfma_f32_16x16x32_bf16 v[144:147], a[64:67], a[128:131], v[208:211]
  v_exp_f32 v193, v193
  v_mfma_f32_16x16x32_bf16 v[144:147], a[68:71], a[132:135], v[144:147]
  v_exp_f32 v194, v194
  v_mfma_f32_16x16x32_bf16 v[144:147], a[72:75], a[136:139], v[144:147]
  ds_read_b128 a[84:87], v243 offset:5120
  v_cvt_pk_bf16_f32 v192, v192, v193
  v_mfma_f32_16x16x32_bf16 v[144:147], a[76:79], a[140:143], v[144:147]
  buffer_load_dwordx4 v244, s[12:15], s55 offen offset:2048 sc1 lds
  v_mfma_f32_16x16x32_bf16 v[152:155], a[76:79], a[156:159], v[212:215]
  v_exp_f32 v195, v195
  v_mfma_f32_16x16x32_bf16 v[152:155], a[72:75], a[152:155], v[152:155]
  ds_read_b128 a[88:91], v243 offset:6144
  v_cvt_pk_bf16_f32 v193, v194, v195
  v_mfma_f32_16x16x32_bf16 v[152:155], a[68:71], a[148:151], v[152:155]
  v_exp_f32 v196, v196
  v_mfma_f32_16x16x32_bf16 v[152:155], a[64:67], a[144:147], v[152:155]
  ds_read_b128 a[92:95], v243 offset:7168
  v_mfma_f32_16x16x32_bf16 v[160:163], a[64:67], a[160:163], v[216:219]
  v_exp_f32 v197, v197
  v_mfma_f32_16x16x32_bf16 v[160:163], a[68:71], a[164:167], v[160:163]
  buffer_load_dwordx4 v244, s[12:15], s55 offen offset:3072 sc1 lds
  v_mfma_f32_16x16x32_bf16 v[160:163], a[72:75], a[168:171], v[160:163]
  s_add_u32 s55, s55, 16384
  v_exp_f32 v198, v198
  v_mfma_f32_16x16x32_bf16 v[160:163], a[76:79], a[172:175], v[160:163]
  s_and_b32 s48, s54, 0xffff
  s_add_u32 m0, s48, s50
  v_cvt_pk_bf16_f32 v194, v196, v197
  v_mfma_f32_16x16x32_bf16 v[168:171], a[76:79], a[188:191], v[220:223]
  v_exp_f32 v199, v199
  v_mfma_f32_16x16x32_bf16 v[168:171], a[72:75], a[184:187], v[168:171]
  v_exp_f32 v200, v200
  v_mfma_f32_16x16x32_bf16 v[168:171], a[68:71], a[180:183], v[168:171]
  ds_read_b128 a[96:99], v247 offset:8192
  v_cvt_pk_bf16_f32 v195, v198, v199
  v_mfma_f32_16x16x32_bf16 v[168:171], a[64:67], a[176:179], v[168:171]
  s_waitcnt lgkmcnt(1)
  v_exp_f32 v201, v201
  v_mfma_f32_16x16x32_bf16 v[148:151], a[80:83], a[128:131], v[208:211]
  v_exp_f32 v202, v202
  v_mfma_f32_16x16x32_bf16 v[148:151], a[84:87], a[132:135], v[148:151]
  ds_read_b128 a[100:103], v247 offset:9216
  v_cvt_pk_bf16_f32 v200, v200, v201
  v_mfma_f32_16x16x32_bf16 v[148:151], a[88:91], a[136:139], v[148:151]
  v_exp_f32 v203, v203
  v_mfma_f32_16x16x32_bf16 v[148:151], a[92:95], a[140:143], v[148:151]
  buffer_load_dwordx4 v244, s[8:11], s54 offen offset:0 sc1 lds
  v_mfma_f32_16x16x32_bf16 v[156:159], a[92:95], a[156:159], v[212:215]
  v_exp_f32 v204, v204
  v_mfma_f32_16x16x32_bf16 v[156:159], a[88:91], a[152:155], v[156:159]
  ds_read_b128 a[104:107], v247 offset:10240
  v_cvt_pk_bf16_f32 v201, v202, v203
  v_mfma_f32_16x16x32_bf16 v[156:159], a[84:87], a[148:151], v[156:159]
  v_exp_f32 v205, v205
  v_mfma_f32_16x16x32_bf16 v[156:159], a[80:83], a[144:147], v[156:159]
  v_exp_f32 v206, v206
  v_mfma_f32_16x16x32_bf16 v[164:167], a[80:83], a[160:163], v[216:219]
  buffer_load_dwordx4 v244, s[8:11], s54 offen offset:1024 sc1 lds
  v_mfma_f32_16x16x32_bf16 v[164:167], a[84:87], a[164:167], v[164:167]
  ds_read_b128 a[108:111], v247 offset:11264
  v_cvt_pk_bf16_f32 v202, v204, v205
  v_mfma_f32_16x16x32_bf16 v[164:167], a[88:91], a[168:171], v[164:167]
  v_exp_f32 v207, v207
  v_mfma_f32_16x16x32_bf16 v[164:167], a[92:95], a[172:175], v[164:167]
  v_cvt_pk_bf16_f32 v203, v206, v207
  v_mfma_f32_16x16x32_bf16 v[172:175], a[92:95], a[188:191], v[220:223]
  v_exp_f32 v144, v144
  v_mfma_f32_16x16x32_bf16 v[172:175], a[88:91], a[184:187], v[172:175]
  buffer_load_dwordx4 v244, s[8:11], s54 offen offset:2048 sc1 lds
  v_mfma_f32_16x16x32_bf16 v[172:175], a[84:87], a[180:183], v[172:175]
  ds_read_b128 a[112:115], v247 offset:12288
  v_mfma_f32_16x16x32_bf16 v[172:175], a[80:83], a[176:179], v[172:175]
  s_waitcnt lgkmcnt(3)
  v_exp_f32 v145, v145
  v_mfma_f32_16x16x32_bf16 v[0:3], a[96:99], v[176:179], v[0:3]
  v_exp_f32 v146, v146
  v_mfma_f32_16x16x32_bf16 v[32:35], a[96:99], v[184:187], v[32:35]
  ds_read_b128 a[116:119], v247 offset:13312
  v_cvt_pk_bf16_f32 v144, v144, v145
  v_mfma_f32_16x16x32_bf16 v[64:67], a[96:99], v[192:195], v[64:67]
  buffer_load_dwordx4 v244, s[8:11], s54 offen offset:3072 sc1 lds
  v_mfma_f32_16x16x32_bf16 v[96:99], a[96:99], v[200:203], v[96:99]
  s_add_u32 s54, s54, 16384
  v_exp_f32 v147, v147
  v_mfma_f32_16x16x32_bf16 v[100:103], a[100:103], v[200:203], v[100:103]
  s_lshl_b32 s51, s47, 7
  v_exp_f32 v148, v148
  v_mfma_f32_16x16x32_bf16 v[68:71], a[100:103], v[192:195], v[68:71]
  s_add_u32 s51, s51, 0x1000
  ds_read_b128 a[120:123], v247 offset:14336
  v_cvt_pk_bf16_f32 v145, v146, v147
  v_mfma_f32_16x16x32_bf16 v[36:39], a[100:103], v[184:187], v[36:39]
  v_exp_f32 v149, v149
  v_mfma_f32_16x16x32_bf16 v[4:7], a[100:103], v[176:179], v[4:7]
  s_waitcnt lgkmcnt(3)
  v_cvt_pk_bf16_f32 v146, v148, v149
  v_mfma_f32_16x16x32_bf16 v[8:11], a[104:107], v[176:179], v[8:11]
  v_exp_f32 v150, v150
  v_mfma_f32_16x16x32_bf16 v[40:43], a[104:107], v[184:187], v[40:43]
  ds_read_b128 a[124:127], v247 offset:15360
  v_mfma_f32_16x16x32_bf16 v[72:75], a[104:107], v[192:195], v[72:75]
  v_exp_f32 v151, v151
  v_mfma_f32_16x16x32_bf16 v[104:107], a[104:107], v[200:203], v[104:107]
  v_exp_f32 v152, v152
  v_mfma_f32_16x16x32_bf16 v[108:111], a[108:111], v[200:203], v[108:111]
  v_add_u32 v247, 16384, v247
  v_and_or_b32 v247, v247, s57, v245
  v_mfma_f32_16x16x32_bf16 v[76:79], a[108:111], v[192:195], v[76:79]
  v_cvt_pk_bf16_f32 v147, v150, v151
  v_mfma_f32_16x16x32_bf16 v[44:47], a[108:111], v[184:187], v[44:47]
  v_and_b32 v252, 31, v249
  v_mfma_f32_16x16x32_bf16 v[12:15], a[108:111], v[176:179], v[12:15]
  s_waitcnt lgkmcnt(2)
  v_exp_f32 v153, v153
  v_mfma_f32_16x16x32_bf16 v[16:19], a[112:115], v[176:179], v[16:19]
  v_lshlrev_b32 v252, 2, v252
  v_cvt_pk_bf16_f32 v152, v152, v153
  v_mfma_f32_16x16x32_bf16 v[48:51], a[112:115], v[184:187], v[48:51]
  v_exp_f32 v154, v154
  v_mfma_f32_16x16x32_bf16 v[80:83], a[112:115], v[192:195], v[80:83]
  ds_read_b128 a[64:67], v243 offset:8192
  v_mfma_f32_16x16x32_bf16 v[112:115], a[112:115], v[200:203], v[112:115]
  buffer_load_dword v253, v252, s[68:71], s51 offen sc1
  v_mfma_f32_16x16x32_bf16 v[116:119], a[116:119], v[200:203], v[116:119]
  ds_read_b128 a[68:71], v243 offset:9216
  v_mfma_f32_16x16x32_bf16 v[84:87], a[116:119], v[192:195], v[84:87]
  v_exp_f32 v155, v155
  v_mfma_f32_16x16x32_bf16 v[52:55], a[116:119], v[184:187], v[52:55]
  ds_read_b128 a[72:75], v243 offset:10240
  v_cvt_pk_bf16_f32 v153, v154, v155
  v_mfma_f32_16x16x32_bf16 v[20:23], a[116:119], v[176:179], v[20:23]
  s_waitcnt lgkmcnt(3)
  v_exp_f32 v156, v156
  v_mfma_f32_16x16x32_bf16 v[24:27], a[120:123], v[176:179], v[24:27]
  ds_read_b128 a[76:79], v243 offset:11264
  v_mfma_f32_16x16x32_bf16 v[56:59], a[120:123], v[184:187], v[56:59]
  v_exp_f32 v157, v157
  v_mfma_f32_16x16x32_bf16 v[88:91], a[120:123], v[192:195], v[88:91]
  v_exp_f32 v158, v158
  v_mfma_f32_16x16x32_bf16 v[120:123], a[120:123], v[200:203], v[120:123]
  v_cvt_pk_bf16_f32 v154, v156, v157
  v_mfma_f32_16x16x32_bf16 v[124:127], a[124:127], v[200:203], v[124:127]
  v_exp_f32 v159, v159
  v_mfma_f32_16x16x32_bf16 v[92:95], a[124:127], v[192:195], v[92:95]
  v_cvt_pk_bf16_f32 v155, v158, v159
  v_mfma_f32_16x16x32_bf16 v[60:63], a[124:127], v[184:187], v[60:63]
  v_mfma_f32_16x16x32_bf16 v[28:31], a[124:127], v[176:179], v[28:31]
  v_mfma_f32_16x16x32_bf16 v[128:131], a[232:235], v[176:179], v[128:131]
  v_mfma_f32_16x16x32_bf16 v[132:135], a[232:235], v[184:187], v[132:135]
  v_mfma_f32_16x16x32_bf16 v[136:139], a[232:235], v[192:195], v[136:139]
  v_mfma_f32_16x16x32_bf16 v[140:143], a[232:235], v[200:203], v[140:143]
  s_waitcnt vmcnt(0)
  v_cmp_ne_u32 vcc, 1, v253
  s_cbranch_vccnz recurrent_scan__compressed_kv_cla__dense_activation_silu__prompt_kernel_spin4
recurrent_scan__compressed_kv_cla__dense_activation_silu__prompt_kernel_back4:
  s_cmp_eq_u32 s45, 1
  s_cbranch_scc0 recurrent_scan__compressed_kv_cla__dense_activation_silu__prompt_kernel_d2
  s_waitcnt lgkmcnt(0)
  v_mfma_f32_16x16x32_bf16 v[176:179], a[64:67], a[128:131], v[208:211]
  ds_read_b128 a[80:83], v243 offset:12288
  v_mfma_f32_16x16x32_bf16 v[176:179], a[68:71], a[132:135], v[176:179]
  v_exp_f32 v160, v160
  v_mfma_f32_16x16x32_bf16 v[176:179], a[72:75], a[136:139], v[176:179]
  v_exp_f32 v161, v161
  v_mfma_f32_16x16x32_bf16 v[176:179], a[76:79], a[140:143], v[176:179]
  ds_read_b128 a[84:87], v243 offset:13312
  v_cvt_pk_bf16_f32 v160, v160, v161
  v_mfma_f32_16x16x32_bf16 v[184:187], a[76:79], a[156:159], v[212:215]
  v_exp_f32 v162, v162
  v_mfma_f32_16x16x32_bf16 v[184:187], a[72:75], a[152:155], v[184:187]
  ds_read_b128 a[88:91], v243 offset:14336
  v_mfma_f32_16x16x32_bf16 v[184:187], a[68:71], a[148:151], v[184:187]
  s_mov_b32 m0, s62
  v_exp_f32 v163, v163
  v_mfma_f32_16x16x32_bf16 v[184:187], a[64:67], a[144:147], v[184:187]
  ds_read_b128 a[92:95], v243 offset:15360
  v_cvt_pk_bf16_f32 v161, v162, v163
  v_mfma_f32_16x16x32_bf16 v[192:195], a[64:67], a[160:163], v[216:219]
  v_exp_f32 v164, v164
  v_mfma_f32_16x16x32_bf16 v[192:195], a[68:71], a[164:167], v[192:195]
  buffer_load_dwordx4 v232, s[28:31], s58 offen offset:0 lds
  v_mfma_f32_16x16x32_bf16 v[192:195], a[72:75], a[168:171], v[192:195]
  v_exp_f32 v165, v165
  v_mfma_f32_16x16x32_bf16 v[192:195], a[76:79], a[172:175], v[192:195]
  v_exp_f32 v166, v166
  v_mfma_f32_16x16x32_bf16 v[200:203], a[76:79], a[188:191], v[220:223]
  v_cvt_pk_bf16_f32 v162, v164, v165
  v_mfma_f32_16x16x32_bf16 v[200:203], a[72:75], a[184:187], v[200:203]
  buffer_load_dwordx4 v233, s[28:31], s58 offen offset:1024 lds
  v_mfma_f32_16x16x32_bf16 v[200:203], a[68:71], a[180:183], v[200:203]
  v_exp_f32 v167, v167
  v_mfma_f32_16x16x32_bf16 v[200:203], a[64:67], a[176:179], v[200:203]
  s_waitcnt lgkmcnt(0)
  v_exp_f32 v168, v168
  v_mfma_f32_16x16x32_bf16 v[180:183], a[80:83], a[128:131], v[208:211]
  ds_read_b128 a[96:99], v247 offset:0
  v_cvt_pk_bf16_f32 v163, v166, v167
  v_mfma_f32_16x16x32_bf16 v[180:183], a[84:87], a[132:135], v[180:183]
  buffer_load_dwordx4 v234, s[28:31], s58 offen offset:2048 lds
  v_mfma_f32_16x16x32_bf16 v[180:183], a[88:91], a[136:139], v[180:183]
  s_add_u32 m0, s62, 3072
  v_exp_f32 v169, v169
  v_mfma_f32_16x16x32_bf16 v[180:183], a[92:95], a[140:143], v[180:183]
  s_add_u32 s58, s58, 20480
  v_exp_f32 v170, v170
  v_mfma_f32_16x16x32_bf16 v[188:191], a[92:95], a[156:159], v[212:215]
  ds_read_b128 a[100:103], v247 offset:1024
  v_cvt_pk_bf16_f32 v168, v168, v169
  v_mfma_f32_16x16x32_bf16 v[188:191], a[88:91], a[152:155], v[188:191]
  v_exp_f32 v171, v171
  v_mfma_f32_16x16x32_bf16 v[188:191], a[84:87], a[148:151], v[188:191]
  v_exp_f32 v172, v172
  v_mfma_f32_16x16x32_bf16 v[188:191], a[80:83], a[144:147], v[188:191]
  buffer_load_dwordx4 v232, s[28:31], s58 offen offset:0 lds
  v_mfma_f32_16x16x32_bf16 v[196:199], a[80:83], a[160:163], v[216:219]
  ds_read_b128 a[104:107], v247 offset:2048
  v_cvt_pk_bf16_f32 v169, v170, v171
  v_mfma_f32_16x16x32_bf16 v[196:199], a[84:87], a[164:167], v[196:199]
  v_exp_f32 v173, v173
  v_mfma_f32_16x16x32_bf16 v[196:199], a[88:91], a[168:171], v[196:199]
  buffer_load_dwordx4 v233, s[28:31], s58 offen offset:1024 lds
  v_mfma_f32_16x16x32_bf16 v[196:199], a[92:95], a[172:175], v[196:199]
  v_exp_f32 v174, v174
  v_mfma_f32_16x16x32_bf16 v[204:207], a[92:95], a[188:191], v[220:223]
  ds_read_b128 a[108:111], v247 offset:3072
  v_cvt_pk_bf16_f32 v170, v172, v173
  v_mfma_f32_16x16x32_bf16 v[204:207], a[88:91], a[184:187], v[204:207]
  v_exp_f32 v175, v175
  v_mfma_f32_16x16x32_bf16 v[204:207], a[84:87], a[180:183], v[204:207]
  buffer_load_dwordx4 v234, s[28:31], s58 offen offset:2048 lds
  v_mfma_f32_16x16x32_bf16 v[204:207], a[80:83], a[176:179], v[204:207]
  s_waitcnt lgkmcnt(2)
  ds_read_b128 a[112:115], v247 offset:4096
  v_cvt_pk_bf16_f32 v171, v174, v175
  v_mfma_f32_16x16x32_bf16 v[0:3], a[96:99], v[144:147], v[0:3]
  s_add_u32 s58, s58, 20480
  v_exp_f32 v176, v176
  v_mfma_f32_16x16x32_bf16 v[32:35], a[96:99], v[152:155], v[32:35]
  v_exp_f32 v177, v177
  v_mfma_f32_16x16x32_bf16 v[64:67], a[96:99], v[160:163], v[64:67]
  ds_read_b128 a[116:119], v247 offset:5120
  v_cvt_pk_bf16_f32 v176, v176, v177
  v_mfma_f32_16x16x32_bf16 v[96:99], a[96:99], v[168:171], v[96:99]
  buffer_load_dwordx4 a[208:211], v248, s[4:7], s59 offen sc1
  v_mfma_f32_16x16x32_bf16 v[100:103], a[100:103], v[168:171], v[100:103]
  v_exp_f32 v178, v178
  v_mfma_f32_16x16x32_bf16 v[68:71], a[100:103], v[160:163], v[68:71]
  v_exp_f32 v179, v179
  v_mfma_f32_16x16x32_bf16 v[36:39], a[100:103], v[152:155], v[36:39]
  ds_read_b128 a[120:123], v247 offset:6144
  v_cvt_pk_bf16_f32 v177, v178, v179
  v_mfma_f32_16x16x32_bf16 v[4:7], a[100:103], v[144:147], v[4:7]
  s_waitcnt lgkmcnt(3)
  buffer_load_dwordx4 a[212:215], v248, s[20:23], s59 offen sc1
  v_mfma_f32_16x16x32_bf16 v[8:11], a[104:107], v[144:147], v[8:11]
  v_exp_f32 v180, v180
  v_mfma_f32_16x16x32_bf16 v[40:43], a[104:107], v[152:155], v[40:43]
  v_exp_f32 v181, v181
  v_mfma_f32_16x16x32_bf16 v[72:75], a[104:107], v[160:163], v[72:75]
  ds_read_b128 a[124:127], v247 offset:7168
  v_cvt_pk_bf16_f32 v178, v180, v181
  v_mfma_f32_16x16x32_bf16 v[104:107], a[104:107], v[168:171], v[104:107]
  buffer_load_dwordx4 a[216:219], v248, s[36:39], s59 offen sc1
  v_mfma_f32_16x16x32_bf16 v[108:111], a[108:111], v[168:171], v[108:111]
  v_exp_f32 v182, v182
  v_mfma_f32_16x16x32_bf16 v[76:79], a[108:111], v[160:163], v[76:79]
  v_exp_f32 v183, v183
  v_mfma_f32_16x16x32_bf16 v[44:47], a[108:111], v[152:155], v[44:47]
  buffer_load_dwordx4 a[220:223], v248, s[40:43], s59 offen sc1
  v_mfma_f32_16x16x32_bf16 v[12:15], a[108:111], v[144:147], v[12:15]
  s_waitcnt lgkmcnt(2)
  v_exp_f32 v184, v184
  v_mfma_f32_16x16x32_bf16 v[16:19], a[112:115], v[144:147], v[16:19]
  s_add_u32 s59, s59, 1024
  v_cvt_pk_bf16_f32 v179, v182, v183
  v_mfma_f32_16x16x32_bf16 v[48:51], a[112:115], v[152:155], v[48:51]
  v_add_u32 v243, 16384, v243
  v_and_b32 v243, 0xffff, v243
  v_mfma_f32_16x16x32_bf16 v[80:83], a[112:115], v[160:163], v[80:83]
  v_exp_f32 v185, v185
  v_mfma_f32_16x16x32_bf16 v[112:115], a[112:115], v[168:171], v[112:115]
  v_exp_f32 v186, v186
  v_mfma_f32_16x16x32_bf16 v[116:119], a[116:119], v[168:171], v[116:119]
  v_cvt_pk_bf16_f32 v184, v184, v185
  v_mfma_f32_16x16x32_bf16 v[84:87], a[116:119], v[160:163], v[84:87]
  v_exp_f32 v187, v187
  v_mfma_f32_16x16x32_bf16 v[52:55], a[116:119], v[152:155], v[52:55]
  v_exp_f32 v188, v188
  v_mfma_f32_16x16x32_bf16 v[20:23], a[116:119], v[144:147], v[20:23]
  s_waitcnt vmcnt(22) lgkmcnt(0)
  s_barrier
  v_mfma_f32_16x16x32_bf16 v[24:27], a[120:123], v[144:147], v[24:27]
  s_and_b32 s48, s55, 0xffff
  ds_read_b128 a[64:67], v243 offset:0
  v_cvt_pk_bf16_f32 v185, v186, v187
  v_mfma_f32_16x16x32_bf16 v[56:59], a[120:123], v[152:155], v[56:59]
  s_add_u32 m0, s48, s60
  ds_read_b128 a[68:71], v243 offset:1024
  v_cmp_gt_i32 s[76:77], 0, v241
  v_mfma_f32_16x16x32_bf16 v[88:91], a[120:123], v[160:163], v[88:91]
  ds_read_b128 a[72:75], v243 offset:2048
  v_cmp_gt_i32 s[78:79], 1, v241
  v_mfma_f32_16x16x32_bf16 v[120:123], a[120:123], v[168:171], v[120:123]
  v_cmp_gt_i32 s[80:81], 2, v241
  v_cmp_gt_i32 s[82:83], 3, v241
  v_mfma_f32_16x16x32_bf16 v[124:127], a[124:127], v[168:171], v[124:127]
  v_cndmask_b32 v224, v208, v240, s[76:77]
  v_cndmask_b32 v225, v209, v240, s[78:79]
  v_cndmask_b32 v226, v210, v240, s[80:81]
  v_mfma_f32_16x16x32_bf16 v[92:95], a[124:127], v[160:163], v[92:95]
  ds_read_b128 a[76:79], v243 offset:3072
  v_cndmask_b32 v227, v211, v240, s[82:83]
  v_mfma_f32_16x16x32_bf16 v[60:63], a[124:127], v[152:155], v[60:63]
  v_exp_f32 v189, v189
  v_mfma_f32_16x16x32_bf16 v[28:31], a[124:127], v[144:147], v[28:31]
  v_exp_f32 v190, v190
  v_mfma_f32_16x16x32_bf16 v[128:131], a[232:235], v[144:147], v[128:131]
  v_cvt_pk_bf16_f32 v186, v188, v189
  v_mfma_f32_16x16x32_bf16 v[132:135], a[232:235], v[152:155], v[132:135]
  buffer_load_dwordx4 v244, s[12:15], s55 offen offset:0 sc1 lds
  v_mfma_f32_16x16x32_bf16 v[136:139], a[232:235], v[160:163], v[136:139]
  v_exp_f32 v191, v191
  v_mfma_f32_16x16x32_bf16 v[140:143], a[232:235], v[168:171], v[140:143]
  s_waitcnt lgkmcnt(0)
  v_exp_f32 v192, v192
  v_mfma_f32_16x16x32_bf16 v[144:147], a[64:67], a[128:131], v[224:227]
  ds_read_b128 a[80:83], v243 offset:4096
  v_cvt_pk_bf16_f32 v187, v190, v191
  v_mfma_f32_16x16x32_bf16 v[144:147], a[68:71], a[132:135], v[144:147]
  v_exp_f32 v193, v193
  v_mfma_f32_16x16x32_bf16 v[144:147], a[72:75], a[136:139], v[144:147]
  buffer_load_dwordx4 v244, s[12:15], s55 offen offset:1024 sc1 lds
  v_mfma_f32_16x16x32_bf16 v[144:147], a[76:79], a[140:143], v[144:147]
  v_exp_f32 v194, v194
  v_mfma_f32_16x16x32_bf16 v[152:155], a[76:79], a[156:159], v[212:215]
  ds_read_b128 a[84:87], v243 offset:5120
  v_cvt_pk_bf16_f32 v192, v192, v193
  v_mfma_f32_16x16x32_bf16 v[152:155], a[72:75], a[152:155], v[152:155]
  v_exp_f32 v195, v195
  v_mfma_f32_16x16x32_bf16 v[152:155], a[68:71], a[148:151], v[152:155]
  ds_read_b128 a[88:91], v243 offset:6144
  v_cvt_pk_bf16_f32 v193, v194, v195
  v_mfma_f32_16x16x32_bf16 v[152:155], a[64:67], a[144:147], v[152:155]
  v_exp_f32 v196, v196
  v_mfma_f32_16x16x32_bf16 v[160:163], a[64:67], a[160:163], v[216:219]
  v_cmp_gt_i32 s[76:77], 16, v241
  v_cmp_gt_i32 s[78:79], 17, v241
  v_cmp_gt_i32 s[80:81], 18, v241
  v_mfma_f32_16x16x32_bf16 v[160:163], a[68:71], a[164:167], v[160:163]
  v_cmp_gt_i32 s[82:83], 19, v241
  v_cndmask_b32 v228, v208, v240, s[76:77]
  v_cndmask_b32 v229, v209, v240, s[78:79]
  v_mfma_f32_16x16x32_bf16 v[160:163], a[72:75], a[168:171], v[160:163]
  ds_read_b128 a[92:95], v243 offset:7168
  v_cndmask_b32 v230, v210, v240, s[80:81]
  v_cndmask_b32 v231, v211, v240, s[82:83]
  v_mfma_f32_16x16x32_bf16 v[160:163], a[76:79], a[172:175], v[160:163]
  buffer_load_dwordx4 v244, s[12:15], s55 offen offset:2048 sc1 lds
  v_mfma_f32_16x16x32_bf16 v[168:171], a[76:79], a[188:191], v[220:223]
  v_exp_f32 v197, v197
  v_mfma_f32_16x16x32_bf16 v[168:171], a[72:75], a[184:187], v[168:171]
  v_exp_f32 v198, v198
  v_cvt_pk_bf16_f32 v194, v196, v197
  v_mfma_f32_16x16x32_bf16 v[168:171], a[68:71], a[180:183], v[168:171]
  v_exp_f32 v199, v199
  v_mfma_f32_16x16x32_bf16 v[168:171], a[64:67], a[176:179], v[168:171]
  s_waitcnt lgkmcnt(0)
  buffer_load_dwordx4 v244, s[12:15], s55 offen offset:3072 sc1 lds
  v_mfma_f32_16x16x32_bf16 v[148:151], a[80:83], a[128:131], v[228:231]
  v_exp_f32 v200, v200
  v_cvt_pk_bf16_f32 v195, v198, v199
  v_mfma_f32_16x16x32_bf16 v[148:151], a[84:87], a[132:135], v[148:151]
  s_add_u32 s55, s55, 16384
  v_exp_f32 v201, v201
  v_mfma_f32_16x16x32_bf16 v[148:151], a[88:91], a[136:139], v[148:151]
  s_and_b32 s48, s54, 0xffff
  ds_read_b128 a[96:99], v247 offset:8192
  v_cvt_pk_bf16_f32 v200, v200, v201
  v_mfma_f32_16x16x32_bf16 v[148:151], a[92:95], a[140:143], v[148:151]
  s_add_u32 m0, s48, s50
  v_exp_f32 v202, v202
  v_mfma_f32_16x16x32_bf16 v[156:159], a[92:95], a[156:159], v[212:215]
  v_exp_f32 v203, v203
  v_mfma_f32_16x16x32_bf16 v[156:159], a[88:91], a[152:155], v[156:159]
  ds_read_b128 a[100:103], v247 offset:9216
  v_cvt_pk_bf16_f32 v201, v202, v203
  v_mfma_f32_16x16x32_bf16 v[156:159], a[84:87], a[148:151], v[156:159]
  v_exp_f32 v204, v204
  v_mfma_f32_16x16x32_bf16 v[156:159], a[80:83], a[144:147], v[156:159]
  v_exp_f32 v205, v205
  v_mfma_f32_16x16x32_bf16 v[164:167], a[80:83], a[160:163], v[216:219]
  ds_read_b128 a[104:107], v247 offset:10240
  v_cvt_pk_bf16_f32 v202, v204, v205
  v_mfma_f32_16x16x32_bf16 v[164:167], a[84:87], a[164:167], v[164:167]
  v_exp_f32 v206, v206
  v_mfma_f32_16x16x32_bf16 v[164:167], a[88:91], a[168:171], v[164:167]
  v_exp_f32 v207, v207
  v_mfma_f32_16x16x32_bf16 v[164:167], a[92:95], a[172:175], v[164:167]
  ds_read_b128 a[108:111], v247 offset:11264
  v_cvt_pk_bf16_f32 v203, v206, v207
  v_mfma_f32_16x16x32_bf16 v[172:175], a[92:95], a[188:191], v[220:223]
  buffer_load_dwordx4 v244, s[8:11], s54 offen offset:0 sc1 lds
  v_mfma_f32_16x16x32_bf16 v[172:175], a[88:91], a[184:187], v[172:175]
  v_exp_f32 v144, v144
  v_mfma_f32_16x16x32_bf16 v[172:175], a[84:87], a[180:183], v[172:175]
  ds_read_b128 a[112:115], v247 offset:12288
  v_mfma_f32_16x16x32_bf16 v[172:175], a[80:83], a[176:179], v[172:175]
  s_waitcnt lgkmcnt(3)
  v_exp_f32 v145, v145
  v_mfma_f32_16x16x32_bf16 v[0:3], a[96:99], v[176:179], v[0:3]
  v_exp_f32 v146, v146
  v_mfma_f32_16x16x32_bf16 v[32:35], a[96:99], v[184:187], v[32:35]
  ds_read_b128 a[116:119], v247 offset:13312
  v_cvt_pk_bf16_f32 v144, v144, v145
  v_mfma_f32_16x16x32_bf16 v[64:67], a[96:99], v[192:195], v[64:67]
  buffer_load_dwordx4 v244, s[8:11], s54 offen offset:1024 sc1 lds
  v_mfma_f32_16x16x32_bf16 v[96:99], a[96:99], v[200:203], v[96:99]
  v_exp_f32 v147, v147
  v_mfma_f32_16x16x32_bf16 v[100:103], a[100:103], v[200:203], v[100:103]
  v_exp_f32 v148, v148
  v_mfma_f32_16x16x32_bf16 v[68:71], a[100:103], v[192:195], v[68:71]
  ds_read_b128 a[120:123], v247 offset:14336
  v_cvt_pk_bf16_f32 v145, v146, v147
  v_mfma_f32_16x16x32_bf16 v[36:39], a[100:103], v[184:187], v[36:39]
  v_exp_f32 v149, v149
  v_mfma_f32_16x16x32_bf16 v[4:7], a[100:103], v[176:179], v[4:7]
  s_waitcnt lgkmcnt(3)
  v_cvt_pk_bf16_f32 v146, v148, v149
  v_mfma_f32_16x16x32_bf16 v[8:11], a[104:107], v[176:179], v[8:11]
  buffer_load_dwordx4 v244, s[8:11], s54 offen offset:2048 sc1 lds
  v_mfma_f32_16x16x32_bf16 v[40:43], a[104:107], v[184:187], v[40:43]
  v_exp_f32 v150, v150
  v_mfma_f32_16x16x32_bf16 v[72:75], a[104:107], v[192:195], v[72:75]
  ds_read_b128 a[124:127], v247 offset:15360
  v_mfma_f32_16x16x32_bf16 v[104:107], a[104:107], v[200:203], v[104:107]
  v_exp_f32 v151, v151
  v_mfma_f32_16x16x32_bf16 v[108:111], a[108:111], v[200:203], v[108:111]
  v_add_u32 v247, 16384, v247
  v_and_or_b32 v247, v247, s57, v245
  v_mfma_f32_16x16x32_bf16 v[76:79], a[108:111], v[192:195], v[76:79]
  v_exp_f32 v152, v152
  v_mfma_f32_16x16x32_bf16 v[44:47], a[108:111], v[184:187], v[44:47]
  buffer_load_dwordx4 v244, s[8:11], s54 offen offset:3072 sc1 lds
  v_mfma_f32_16x16x32_bf16 v[12:15], a[108:111], v[176:179], v[12:15]
  s_waitcnt lgkmcnt(2)
  s_add_u32 s54, s54, 16384
  v_cvt_pk_bf16_f32 v147, v150, v151
  v_mfma_f32_16x16x32_bf16 v[16:19], a[112:115], v[176:179], v[16:19]
  v_exp_f32 v153, v153
  v_mfma_f32_16x16x32_bf16 v[48:51], a[112:115], v[184:187], v[48:51]
  v_exp_f32 v154, v154
  v_mfma_f32_16x16x32_bf16 v[80:83], a[112:115], v[192:195], v[80:83]
  ds_read_b128 a[64:67], v243 offset:8192
  v_cvt_pk_bf16_f32 v152, v152, v153
  v_mfma_f32_16x16x32_bf16 v[112:115], a[112:115], v[200:203], v[112:115]
  ds_read_b128 a[68:71], v243 offset:9216
  v_mfma_f32_16x16x32_bf16 v[116:119], a[116:119], v[200:203], v[116:119]
  v_exp_f32 v155, v155
  v_mfma_f32_16x16x32_bf16 v[84:87], a[116:119], v[192:195], v[84:87]
  ds_read_b128 a[72:75], v243 offset:10240
  v_cvt_pk_bf16_f32 v153, v154, v155
  v_mfma_f32_16x16x32_bf16 v[52:55], a[116:119], v[184:187], v[52:55]
  v_exp_f32 v156, v156
  v_mfma_f32_16x16x32_bf16 v[20:23], a[116:119], v[176:179], v[20:23]
  s_waitcnt lgkmcnt(3)
  ds_read_b128 a[76:79], v243 offset:11264
  v_mfma_f32_16x16x32_bf16 v[24:27], a[120:123], v[176:179], v[24:27]
  v_exp_f32 v157, v157
  v_mfma_f32_16x16x32_bf16 v[56:59], a[120:123], v[184:187], v[56:59]
  v_exp_f32 v158, v158
  v_mfma_f32_16x16x32_bf16 v[88:91], a[120:123], v[192:195], v[88:91]
  v_cvt_pk_bf16_f32 v154, v156, v157
  v_mfma_f32_16x16x32_bf16 v[120:123], a[120:123], v[200:203], v[120:123]
  v_exp_f32 v159, v159
  v_mfma_f32_16x16x32_bf16 v[124:127], a[124:127], v[200:203], v[124:127]
  v_cvt_pk_bf16_f32 v155, v158, v159
  v_mfma_f32_16x16x32_bf16 v[92:95], a[124:127], v[192:195], v[92:95]
  v_mfma_f32_16x16x32_bf16 v[60:63], a[124:127], v[184:187], v[60:63]
  v_mfma_f32_16x16x32_bf16 v[28:31], a[124:127], v[176:179], v[28:31]
  v_mfma_f32_16x16x32_bf16 v[128:131], a[232:235], v[176:179], v[128:131]
  v_mfma_f32_16x16x32_bf16 v[132:135], a[232:235], v[184:187], v[132:135]
  v_mfma_f32_16x16x32_bf16 v[136:139], a[232:235], v[192:195], v[136:139]
  v_mfma_f32_16x16x32_bf16 v[140:143], a[232:235], v[200:203], v[140:143]
  s_branch recurrent_scan__compressed_kv_cla__dense_activation_silu__prompt_kernel_m1
recurrent_scan__compressed_kv_cla__dense_activation_silu__prompt_kernel_d2:
  s_waitcnt lgkmcnt(0)
  v_mfma_f32_16x16x32_bf16 v[176:179], a[64:67], a[128:131], v[208:211]
  ds_read_b128 a[80:83], v243 offset:12288
  v_mfma_f32_16x16x32_bf16 v[176:179], a[68:71], a[132:135], v[176:179]
  v_exp_f32 v160, v160
  v_mfma_f32_16x16x32_bf16 v[176:179], a[72:75], a[136:139], v[176:179]
  v_exp_f32 v161, v161
  v_mfma_f32_16x16x32_bf16 v[176:179], a[76:79], a[140:143], v[176:179]
  ds_read_b128 a[84:87], v243 offset:13312
  v_cvt_pk_bf16_f32 v160, v160, v161
  v_mfma_f32_16x16x32_bf16 v[184:187], a[76:79], a[156:159], v[212:215]
  v_exp_f32 v162, v162
  v_mfma_f32_16x16x32_bf16 v[184:187], a[72:75], a[152:155], v[184:187]
  ds_read_b128 a[88:91], v243 offset:14336
  v_mfma_f32_16x16x32_bf16 v[184:187], a[68:71], a[148:151], v[184:187]
  s_mov_b32 m0, s62
  v_exp_f32 v163, v163
  v_mfma_f32_16x16x32_bf16 v[184:187], a[64:67], a[144:147], v[184:187]
  ds_read_b128 a[92:95], v243 offset:15360
  v_cvt_pk_bf16_f32 v161, v162, v163
  v_mfma_f32_16x16x32_bf16 v[192:195], a[64:67], a[160:163], v[216:219]
  v_exp_f32 v164, v164
  v_mfma_f32_16x16x32_bf16 v[192:195], a[68:71], a[164:167], v[192:195]
  buffer_load_dwordx4 v232, s[28:31], s58 offen offset:0 lds
  v_mfma_f32_16x16x32_bf16 v[192:195], a[72:75], a[168:171], v[192:195]
  v_exp_f32 v165, v165
  v_mfma_f32_16x16x32_bf16 v[192:195], a[76:79], a[172:175], v[192:195]
  v_exp_f32 v166, v166
  v_mfma_f32_16x16x32_bf16 v[200:203], a[76:79], a[188:191], v[220:223]
  v_cvt_pk_bf16_f32 v162, v164, v165
  v_mfma_f32_16x16x32_bf16 v[200:203], a[72:75], a[184:187], v[200:203]
  buffer_load_dwordx4 v233, s[28:31], s58 offen offset:1024 lds
  v_mfma_f32_16x16x32_bf16 v[200:203], a[68:71], a[180:183], v[200:203]
  v_exp_f32 v167, v167
  v_mfma_f32_16x16x32_bf16 v[200:203], a[64:67], a[176:179], v[200:203]
  s_waitcnt lgkmcnt(0)
  v_exp_f32 v168, v168
  v_mfma_f32_16x16x32_bf16 v[180:183], a[80:83], a[128:131], v[208:211]
  ds_read_b128 a[96:99], v247 offset:0
  v_cvt_pk_bf16_f32 v163, v166, v167
  v_mfma_f32_16x16x32_bf16 v[180:183], a[84:87], a[132:135], v[180:183]
  buffer_load_dwordx4 v234, s[28:31], s58 offen offset:2048 lds
  v_mfma_f32_16x16x32_bf16 v[180:183], a[88:91], a[136:139], v[180:183]
  s_add_u32 m0, s62, 3072
  v_exp_f32 v169, v169
  v_mfma_f32_16x16x32_bf16 v[180:183], a[92:95], a[140:143], v[180:183]
  s_add_u32 s58, s58, 20480
  v_exp_f32 v170, v170
  v_mfma_f32_16x16x32_bf16 v[188:191], a[92:95], a[156:159], v[212:215]
  ds_read_b128 a[100:103], v247 offset:1024
  v_cvt_pk_bf16_f32 v168, v168, v169
  v_mfma_f32_16x16x32_bf16 v[188:191], a[88:91], a[152:155], v[188:191]
  v_exp_f32 v171, v171
  v_mfma_f32_16x16x32_bf16 v[188:191], a[84:87], a[148:151], v[188:191]
  v_exp_f32 v172, v172
  v_mfma_f32_16x16x32_bf16 v[188:191], a[80:83], a[144:147], v[188:191]
  buffer_load_dwordx4 v232, s[28:31], s58 offen offset:0 lds
  v_mfma_f32_16x16x32_bf16 v[196:199], a[80:83], a[160:163], v[216:219]
  ds_read_b128 a[104:107], v247 offset:2048
  v_cvt_pk_bf16_f32 v169, v170, v171
  v_mfma_f32_16x16x32_bf16 v[196:199], a[84:87], a[164:167], v[196:199]
  v_exp_f32 v173, v173
  v_mfma_f32_16x16x32_bf16 v[196:199], a[88:91], a[168:171], v[196:199]
  buffer_load_dwordx4 v233, s[28:31], s58 offen offset:1024 lds
  v_mfma_f32_16x16x32_bf16 v[196:199], a[92:95], a[172:175], v[196:199]
  v_exp_f32 v174, v174
  v_mfma_f32_16x16x32_bf16 v[204:207], a[92:95], a[188:191], v[220:223]
  ds_read_b128 a[108:111], v247 offset:3072
  v_cvt_pk_bf16_f32 v170, v172, v173
  v_mfma_f32_16x16x32_bf16 v[204:207], a[88:91], a[184:187], v[204:207]
  v_exp_f32 v175, v175
  v_mfma_f32_16x16x32_bf16 v[204:207], a[84:87], a[180:183], v[204:207]
  buffer_load_dwordx4 v234, s[28:31], s58 offen offset:2048 lds
  v_mfma_f32_16x16x32_bf16 v[204:207], a[80:83], a[176:179], v[204:207]
  s_waitcnt lgkmcnt(2)
  ds_read_b128 a[112:115], v247 offset:4096
  v_cvt_pk_bf16_f32 v171, v174, v175
  v_mfma_f32_16x16x32_bf16 v[0:3], a[96:99], v[144:147], v[0:3]
  s_add_u32 s58, s58, 20480
  v_exp_f32 v176, v176
  v_mfma_f32_16x16x32_bf16 v[32:35], a[96:99], v[152:155], v[32:35]
  v_exp_f32 v177, v177
  v_mfma_f32_16x16x32_bf16 v[64:67], a[96:99], v[160:163], v[64:67]
  ds_read_b128 a[116:119], v247 offset:5120
  v_cvt_pk_bf16_f32 v176, v176, v177
  v_mfma_f32_16x16x32_bf16 v[96:99], a[96:99], v[168:171], v[96:99]
  buffer_load_dwordx4 a[208:211], v248, s[4:7], s59 offen sc1
  v_mfma_f32_16x16x32_bf16 v[100:103], a[100:103], v[168:171], v[100:103]
  v_exp_f32 v178, v178
  v_mfma_f32_16x16x32_bf16 v[68:71], a[100:103], v[160:163], v[68:71]
  v_exp_f32 v179, v179
  v_mfma_f32_16x16x32_bf16 v[36:39], a[100:103], v[152:155], v[36:39]
  ds_read_b128 a[120:123], v247 offset:6144
  v_cvt_pk_bf16_f32 v177, v178, v179
  v_mfma_f32_16x16x32_bf16 v[4:7], a[100:103], v[144:147], v[4:7]
  s_waitcnt lgkmcnt(3)
  buffer_load_dwordx4 a[212:215], v248, s[20:23], s59 offen sc1
  v_mfma_f32_16x16x32_bf16 v[8:11], a[104:107], v[144:147], v[8:11]
  v_exp_f32 v180, v180
  v_mfma_f32_16x16x32_bf16 v[40:43], a[104:107], v[152:155], v[40:43]
  v_exp_f32 v181, v181
  v_mfma_f32_16x16x32_bf16 v[72:75], a[104:107], v[160:163], v[72:75]
  ds_read_b128 a[124:127], v247 offset:7168
  v_cvt_pk_bf16_f32 v178, v180, v181
  v_mfma_f32_16x16x32_bf16 v[104:107], a[104:107], v[168:171], v[104:107]
  buffer_load_dwordx4 a[216:219], v248, s[36:39], s59 offen sc1
  v_mfma_f32_16x16x32_bf16 v[108:111], a[108:111], v[168:171], v[108:111]
  v_exp_f32 v182, v182
  v_mfma_f32_16x16x32_bf16 v[76:79], a[108:111], v[160:163], v[76:79]
  v_exp_f32 v183, v183
  v_mfma_f32_16x16x32_bf16 v[44:47], a[108:111], v[152:155], v[44:47]
  buffer_load_dwordx4 a[220:223], v248, s[40:43], s59 offen sc1
  v_mfma_f32_16x16x32_bf16 v[12:15], a[108:111], v[144:147], v[12:15]
  s_waitcnt lgkmcnt(2)
  v_exp_f32 v184, v184
  v_mfma_f32_16x16x32_bf16 v[16:19], a[112:115], v[144:147], v[16:19]
  s_add_u32 s59, s59, 1024
  v_cvt_pk_bf16_f32 v179, v182, v183
  v_mfma_f32_16x16x32_bf16 v[48:51], a[112:115], v[152:155], v[48:51]
  v_add_u32 v243, 16384, v243
  v_and_b32 v243, 0xffff, v243
  v_mfma_f32_16x16x32_bf16 v[80:83], a[112:115], v[160:163], v[80:83]
  v_exp_f32 v185, v185
  v_mfma_f32_16x16x32_bf16 v[112:115], a[112:115], v[168:171], v[112:115]
  v_exp_f32 v186, v186
  v_mfma_f32_16x16x32_bf16 v[116:119], a[116:119], v[168:171], v[116:119]
  v_cvt_pk_bf16_f32 v184, v184, v185
  v_mfma_f32_16x16x32_bf16 v[84:87], a[116:119], v[160:163], v[84:87]
  v_exp_f32 v187, v187
  v_mfma_f32_16x16x32_bf16 v[52:55], a[116:119], v[152:155], v[52:55]
  v_exp_f32 v188, v188
  v_mfma_f32_16x16x32_bf16 v[20:23], a[116:119], v[144:147], v[20:23]
  s_waitcnt vmcnt(22) lgkmcnt(0)
  s_barrier
  v_mfma_f32_16x16x32_bf16 v[24:27], a[120:123], v[144:147], v[24:27]
  s_and_b32 s48, s55, 0xffff
  ds_read_b128 a[64:67], v243 offset:0
  v_cvt_pk_bf16_f32 v185, v186, v187
  v_mfma_f32_16x16x32_bf16 v[56:59], a[120:123], v[152:155], v[56:59]
  s_add_u32 m0, s48, s60
  ds_read_b128 a[68:71], v243 offset:1024
  v_mfma_f32_16x16x32_bf16 v[88:91], a[120:123], v[160:163], v[88:91]
  ds_read_b128 a[72:75], v243 offset:2048
  v_mfma_f32_16x16x32_bf16 v[120:123], a[120:123], v[168:171], v[120:123]
  ds_read_b128 a[76:79], v243 offset:3072
  v_mfma_f32_16x16x32_bf16 v[124:127], a[124:127], v[168:171], v[124:127]
  v_exp_f32 v189, v189
  v_mfma_f32_16x16x32_bf16 v[92:95], a[124:127], v[160:163], v[92:95]
  v_exp_f32 v190, v190
  v_mfma_f32_16x16x32_bf16 v[60:63], a[124:127], v[152:155], v[60:63]
  v_cvt_pk_bf16_f32 v186, v188, v189
  v_mfma_f32_16x16x32_bf16 v[28:31], a[124:127], v[144:147], v[28:31]
  buffer_load_dwordx4 v244, s[12:15], s55 offen offset:0 sc1 lds
  v_mfma_f32_16x16x32_bf16 v[128:131], a[232:235], v[144:147], v[128:131]
  v_exp_f32 v191, v191
  v_mfma_f32_16x16x32_bf16 v[132:135], a[232:235], v[152:155], v[132:135]
  v_exp_f32 v192, v192
  v_mfma_f32_16x16x32_bf16 v[136:139], a[232:235], v[160:163], v[136:139]
  ds_read_b128 a[80:83], v243 offset:4096
  v_cvt_pk_bf16_f32 v187, v190, v191
  v_mfma_f32_16x16x32_bf16 v[140:143], a[232:235], v[168:171], v[140:143]
  s_waitcnt lgkmcnt(1)
  v_exp_f32 v193, v193
  v_mfma_f32_16x16x32_bf16 v[144:147], a[64:67], a[128:131], v[208:211]
  buffer_load_dwordx4 v244, s[12:15], s55 offen offset:1024 sc1 lds
  v_mfma_f32_16x16x32_bf16 v[144:147], a[68:71], a[132:135], v[144:147]
  v_exp_f32 v194, v194
  v_mfma_f32_16x16x32_bf16 v[144:147], a[72:75], a[136:139], v[144:147]
  ds_read_b128 a[84:87], v243 offset:5120
  v_cvt_pk_bf16_f32 v192, v192, v193
  v_mfma_f32_16x16x32_bf16 v[144:147], a[76:79], a[140:143], v[144:147]
  v_exp_f32 v195, v195
  v_mfma_f32_16x16x32_bf16 v[152:155], a[76:79], a[156:159], v[212:215]
  ds_read_b128 a[88:91], v243 offset:6144
  v_cvt_pk_bf16_f32 v193, v194, v195
  v_mfma_f32_16x16x32_bf16 v[152:155], a[72:75], a[152:155], v[152:155]
  v_exp_f32 v196, v196
  v_mfma_f32_16x16x32_bf16 v[152:155], a[68:71], a[148:151], v[152:155]
  buffer_load_dwordx4 v244, s[12:15], s55 offen offset:2048 sc1 lds
  v_mfma_f32_16x16x32_bf16 v[152:155], a[64:67], a[144:147], v[152:155]
  ds_read_b128 a[92:95], v243 offset:7168
  v_mfma_f32_16x16x32_bf16 v[160:163], a[64:67], a[160:163], v[216:219]
  v_exp_f32 v197, v197
  v_mfma_f32_16x16x32_bf16 v[160:163], a[68:71], a[164:167], v[160:163]
  v_exp_f32 v198, v198
  v_mfma_f32_16x16x32_bf16 v[160:163], a[72:75], a[168:171], v[160:163]
  v_cvt_pk_bf16_f32 v194, v196, v197
  v_mfma_f32_16x16x32_bf16 v[160:163], a[76:79], a[172:175], v[160:163]
  v_exp_f32 v199, v199
  v_mfma_f32_16x16x32_bf16 v[168:171], a[76:79], a[188:191], v[220:223]
  buffer_load_dwordx4 v244, s[12:15], s55 offen offset:3072 sc1 lds
  v_mfma_f32_16x16x32_bf16 v[168:171], a[72:75], a[184:187], v[168:171]
  s_add_u32 s55, s55, 16384
  v_exp_f32 v200, v200
  v_mfma_f32_16x16x32_bf16 v[168:171], a[68:71], a[180:183], v[168:171]
  s_and_b32 s48, s54, 0xffff
  ds_read_b128 a[96:99], v247 offset:8192
  v_cvt_pk_bf16_f32 v195, v198, v199
  v_mfma_f32_16x16x32_bf16 v[168:171], a[64:67], a[176:179], v[168:171]
  s_waitcnt lgkmcnt(1)
  v_exp_f32 v201, v201
  v_mfma_f32_16x16x32_bf16 v[148:151], a[80:83], a[128:131], v[208:211]
  v_exp_f32 v202, v202
  v_mfma_f32_16x16x32_bf16 v[148:151], a[84:87], a[132:135], v[148:151]
  s_add_u32 m0, s48, s50
  ds_read_b128 a[100:103], v247 offset:9216
  v_cvt_pk_bf16_f32 v200, v200, v201
  v_mfma_f32_16x16x32_bf16 v[148:151], a[88:91], a[136:139], v[148:151]
  v_exp_f32 v203, v203
  v_mfma_f32_16x16x32_bf16 v[148:151], a[92:95], a[140:143], v[148:151]
  v_exp_f32 v204, v204
  v_mfma_f32_16x16x32_bf16 v[156:159], a[92:95], a[156:159], v[212:215]
  v_cvt_pk_bf16_f32 v201, v202, v203
  v_mfma_f32_16x16x32_bf16 v[156:159], a[88:91], a[152:155], v[156:159]
  v_exp_f32 v205, v205
  v_mfma_f32_16x16x32_bf16 v[156:159], a[84:87], a[148:151], v[156:159]
  ds_read_b128 a[104:107], v247 offset:10240
  v_cvt_pk_bf16_f32 v202, v204, v205
  v_mfma_f32_16x16x32_bf16 v[156:159], a[80:83], a[144:147], v[156:159]
  v_exp_f32 v206, v206
  v_mfma_f32_16x16x32_bf16 v[164:167], a[80:83], a[160:163], v[216:219]
  v_exp_f32 v207, v207
  v_mfma_f32_16x16x32_bf16 v[164:167], a[84:87], a[164:167], v[164:167]
  ds_read_b128 a[108:111], v247 offset:11264
  v_cvt_pk_bf16_f32 v203, v206, v207
  v_mfma_f32_16x16x32_bf16 v[164:167], a[88:91], a[168:171], v[164:167]
  v_exp_f32 v144, v144
  v_mfma_f32_16x16x32_bf16 v[164:167], a[92:95], a[172:175], v[164:167]
  v_exp_f32 v145, v145
  v_mfma_f32_16x16x32_bf16 v[172:175], a[92:95], a[188:191], v[220:223]
  buffer_load_dwordx4 v244, s[8:11], s54 offen offset:0 sc1 lds
  v_mfma_f32_16x16x32_bf16 v[172:175], a[88:91], a[184:187], v[172:175]
  ds_read_b128 a[112:115], v247 offset:12288
  v_cvt_pk_bf16_f32 v144, v144, v145
  v_mfma_f32_16x16x32_bf16 v[172:175], a[84:87], a[180:183], v[172:175]
  v_exp_f32 v146, v146
  v_mfma_f32_16x16x32_bf16 v[172:175], a[80:83], a[176:179], v[172:175]
  s_waitcnt lgkmcnt(3)
  v_exp_f32 v147, v147
  v_mfma_f32_16x16x32_bf16 v[0:3], a[96:99], v[176:179], v[0:3]
  v_exp_f32 v148, v148
  v_mfma_f32_16x16x32_bf16 v[32:35], a[96:99], v[184:187], v[32:35]
  ds_read_b128 a[116:119], v247 offset:13312
  v_cvt_pk_bf16_f32 v145, v146, v147
  v_mfma_f32_16x16x32_bf16 v[64:67], a[96:99], v[192:195], v[64:67]
  buffer_load_dwordx4 v244, s[8:11], s54 offen offset:1024 sc1 lds
  v_mfma_f32_16x16x32_bf16 v[96:99], a[96:99], v[200:203], v[96:99]
  v_exp_f32 v149, v149
  v_mfma_f32_16x16x32_bf16 v[100:103], a[100:103], v[200:203], v[100:103]
  v_cvt_pk_bf16_f32 v146, v148, v149
  v_mfma_f32_16x16x32_bf16 v[68:71], a[100:103], v[192:195], v[68:71]
  ds_read_b128 a[120:123], v247 offset:14336
  v_mfma_f32_16x16x32_bf16 v[36:39], a[100:103], v[184:187], v[36:39]
  v_exp_f32 v150, v150
  v_mfma_f32_16x16x32_bf16 v[4:7], a[100:103], v[176:179], v[4:7]
  s_waitcnt lgkmcnt(3)
  v_exp_f32 v151, v151
  v_mfma_f32_16x16x32_bf16 v[8:11], a[104:107], v[176:179], v[8:11]
  buffer_load_dwordx4 v244, s[8:11], s54 offen offset:2048 sc1 lds
  v_mfma_f32_16x16x32_bf16 v[40:43], a[104:107], v[184:187], v[40:43]
  ds_read_b128 a[124:127], v247 offset:15360
  v_cvt_pk_bf16_f32 v147, v150, v151
  v_mfma_f32_16x16x32_bf16 v[72:75], a[104:107], v[192:195], v[72:75]
  v_exp_f32 v152, v152
  v_mfma_f32_16x16x32_bf16 v[104:107], a[104:107], v[200:203], v[104:107]
  v_exp_f32 v153, v153
  v_mfma_f32_16x16x32_bf16 v[108:111], a[108:111], v[200:203], v[108:111]
  v_add_u32 v247, 16384, v247
  v_and_or_b32 v247, v247, s57, v245
  v_mfma_f32_16x16x32_bf16 v[76:79], a[108:111], v[192:195], v[76:79]
  v_exp_f32 v154, v154
  v_mfma_f32_16x16x32_bf16 v[44:47], a[108:111], v[184:187], v[44:47]
  buffer_load_dwordx4 v244, s[8:11], s54 offen offset:3072 sc1 lds
  v_mfma_f32_16x16x32_bf16 v[12:15], a[108:111], v[176:179], v[12:15]
  s_waitcnt lgkmcnt(2)
  s_add_u32 s54, s54, 16384
  v_cvt_pk_bf16_f32 v152, v152, v153
  v_mfma_f32_16x16x32_bf16 v[16:19], a[112:115], v[176:179], v[16:19]
  v_exp_f32 v155, v155
  v_mfma_f32_16x16x32_bf16 v[48:51], a[112:115], v[184:187], v[48:51]
  ds_read_b128 a[64:67], v243 offset:8192
  v_cvt_pk_bf16_f32 v153, v154, v155
  v_mfma_f32_16x16x32_bf16 v[80:83], a[112:115], v[192:195], v[80:83]
  v_exp_f32 v156, v156
  v_mfma_f32_16x16x32_bf16 v[112:115], a[112:115], v[200:203], v[112:115]
  ds_read_b128 a[68:71], v243 offset:9216
  v_mfma_f32_16x16x32_bf16 v[116:119], a[116:119], v[200:203], v[116:119]
  v_exp_f32 v157, v157
  v_mfma_f32_16x16x32_bf16 v[84:87], a[116:119], v[192:195], v[84:87]
  ds_read_b128 a[72:75], v243 offset:10240
  v_cvt_pk_bf16_f32 v154, v156, v157
  v_mfma_f32_16x16x32_bf16 v[52:55], a[116:119], v[184:187], v[52:55]
  v_exp_f32 v158, v158
  v_mfma_f32_16x16x32_bf16 v[20:23], a[116:119], v[176:179], v[20:23]
  s_waitcnt lgkmcnt(3)
  ds_read_b128 a[76:79], v243 offset:11264
  v_mfma_f32_16x16x32_bf16 v[24:27], a[120:123], v[176:179], v[24:27]
  v_exp_f32 v159, v159
  v_mfma_f32_16x16x32_bf16 v[56:59], a[120:123], v[184:187], v[56:59]
  v_cvt_pk_bf16_f32 v155, v158, v159
  v_mfma_f32_16x16x32_bf16 v[88:91], a[120:123], v[192:195], v[88:91]
  v_mfma_f32_16x16x32_bf16 v[120:123], a[120:123], v[200:203], v[120:123]
  v_mfma_f32_16x16x32_bf16 v[124:127], a[124:127], v[200:203], v[124:127]
  v_mfma_f32_16x16x32_bf16 v[92:95], a[124:127], v[192:195], v[92:95]
  v_mfma_f32_16x16x32_bf16 v[60:63], a[124:127], v[184:187], v[60:63]
  v_mfma_f32_16x16x32_bf16 v[28:31], a[124:127], v[176:179], v[28:31]
  v_mfma_f32_16x16x32_bf16 v[128:131], a[232:235], v[176:179], v[128:131]
  v_mfma_f32_16x16x32_bf16 v[132:135], a[232:235], v[184:187], v[132:135]
  v_mfma_f32_16x16x32_bf16 v[136:139], a[232:235], v[192:195], v[136:139]
  v_mfma_f32_16x16x32_bf16 v[140:143], a[232:235], v[200:203], v[140:143]
recurrent_scan__compressed_kv_cla__dense_activation_silu__prompt_kernel_dd:
  s_waitcnt lgkmcnt(0)
  v_mfma_f32_16x16x32_bf16 v[176:179], a[64:67], a[128:131], v[208:211]
  s_waitcnt vmcnt(8)
  ds_read_b64_tr_b16 a[224:225], v235 offset:0
  v_mfma_f32_16x16x32_bf16 v[176:179], a[68:71], a[132:135], v[176:179]
  v_exp_f32 v160, v160
  v_mfma_f32_16x16x32_bf16 v[176:179], a[72:75], a[136:139], v[176:179]
  ds_read_b64_tr_b16 a[226:227], v235 offset:3072
  v_mfma_f32_16x16x32_bf16 v[176:179], a[76:79], a[140:143], v[176:179]
  ds_read_b64_tr_b16 a[228:229], v246 offset:32
  v_mfma_f32_16x16x32_bf16 v[184:187], a[76:79], a[156:159], v[212:215]
  ds_read_b64_tr_b16 a[230:231], v246 offset:3104
  v_mfma_f32_16x16x32_bf16 v[184:187], a[72:75], a[152:155], v[184:187]
  v_exp_f32 v161, v161
  v_mfma_f32_16x16x32_bf16 v[184:187], a[68:71], a[148:151], v[184:187]
  ds_read_b64_tr_b16 a[236:237], v235 offset:64
  v_cvt_pk_bf16_f32 v160, v160, v161
  v_mfma_f32_16x16x32_bf16 v[184:187], a[64:67], a[144:147], v[184:187]
  ds_read_b64_tr_b16 a[238:239], v235 offset:3136
  v_mfma_f32_16x16x32_bf16 v[192:195], a[64:67], a[160:163], v[216:219]
  ds_read_b64_tr_b16 a[240:241], v246 offset:96
  v_mfma_f32_16x16x32_bf16 v[192:195], a[68:71], a[164:167], v[192:195]
  v_exp_f32 v162, v162
  v_mfma_f32_16x16x32_bf16 v[192:195], a[72:75], a[168:171], v[192:195]
  ds_read_b64_tr_b16 a[242:243], v246 offset:3168
  v_mfma_f32_16x16x32_bf16 v[192:195], a[76:79], a[172:175], v[192:195]
  ds_read_b64_tr_b16 a[244:245], v235 offset:128
  v_mfma_f32_16x16x32_bf16 v[200:203], a[76:79], a[188:191], v[220:223]
  ds_read_b64_tr_b16 a[246:247], v235 offset:3200
  v_mfma_f32_16x16x32_bf16 v[200:203], a[72:75], a[184:187], v[200:203]
  v_exp_f32 v163, v163
  v_mfma_f32_16x16x32_bf16 v[200:203], a[68:71], a[180:183], v[200:203]
  v_cvt_pk_bf16_f32 v161, v162, v163
  v_mfma_f32_16x16x32_bf16 v[200:203], a[64:67], a[176:179], v[200:203]
  s_waitcnt lgkmcnt(6)
  v_exp_f32 v164, v164
  v_mfma_f32_16x16x32_bf16 a[0:3], a[224:227], a[208:211], a[0:3]
  v_exp_f32 v165, v165
  v_mfma_f32_16x16x32_bf16 a[20:23], a[224:227], a[212:215], a[20:23]
  ds_read_b128 a[80:83], v243 offset:12288
  v_cvt_pk_bf16_f32 v162, v164, v165
  v_mfma_f32_16x16x32_bf16 a[40:43], a[224:227], a[216:219], a[40:43]
  v_exp_f32 v166, v166
  v_mfma_f32_16x16x32_bf16 a[60:63], a[224:227], a[220:223], a[60:63]
  ds_read_b128 a[84:87], v243 offset:13312
  v_mfma_f32_16x16x32_bf16 a[192:195], a[228:231], a[220:223], a[192:195]
  v_exp_f32 v167, v167
  v_mfma_f32_16x16x32_bf16 a[44:47], a[228:231], a[216:219], a[44:47]
  ds_read_b128 a[88:91], v243 offset:14336
  v_cvt_pk_bf16_f32 v163, v166, v167
  v_mfma_f32_16x16x32_bf16 a[24:27], a[228:231], a[212:215], a[24:27]
  v_exp_f32 v168, v168
  v_mfma_f32_16x16x32_bf16 a[4:7], a[228:231], a[208:211], a[4:7]
  s_waitcnt lgkmcnt(5)
  ds_read_b128 a[92:95], v243 offset:15360
  v_mfma_f32_16x16x32_bf16 a[8:11], a[236:239], a[208:211], a[8:11]
  v_exp_f32 v169, v169
  v_mfma_f32_16x16x32_bf16 a[28:31], a[236:239], a[212:215], a[28:31]
  v_cvt_pk_bf16_f32 v168, v168, v169
  v_mfma_f32_16x16x32_bf16 a[48:51], a[236:239], a[216:219], a[48:51]
  v_exp_f32 v170, v170
  v_mfma_f32_16x16x32_bf16 a[196:199], a[236:239], a[220:223], a[196:199]
  v_exp_f32 v171, v171
  v_mfma_f32_16x16x32_bf16 a[200:203], a[240:243], a[220:223], a[200:203]
  v_mfma_f32_16x16x32_bf16 a[52:55], a[240:243], a[216:219], a[52:55]
  v_cvt_pk_bf16_f32 v169, v170, v171
  v_mfma_f32_16x16x32_bf16 a[32:35], a[240:243], a[212:215], a[32:35]
  v_exp_f32 v172, v172
  v_mfma_f32_16x16x32_bf16 a[12:15], a[240:243], a[208:211], a[12:15]
  s_waitcnt lgkmcnt(4)
  v_mfma_f32_16x16x32_bf16 a[16:19], a[244:247], a[208:211], a[16:19]
  s_mov_b32 m0, s62
  v_mfma_f32_16x16x32_bf16 a[36:39], a[244:247], a[212:215], a[36:39]
  ds_read_b128 a[96:99], v247 offset:0
  v_mfma_f32_16x16x32_bf16 a[56:59], a[244:247], a[216:219], a[56:59]
  buffer_load_dwordx4 v232, s[28:31], s58 offen offset:0 lds
  v_mfma_f32_16x16x32_bf16 a[204:207], a[244:247], a[220:223], a[204:207]
  s_waitcnt lgkmcnt(1)
  v_exp_f32 v173, v173
  v_mfma_f32_16x16x32_bf16 v[180:183], a[80:83], a[128:131], v[208:211]
  v_cvt_pk_bf16_f32 v170, v172, v173
  v_mfma_f32_16x16x32_bf16 v[180:183], a[84:87], a[132:135], v[180:183]
  buffer_load_dwordx4 v233, s[28:31], s58 offen offset:1024 lds
  v_mfma_f32_16x16x32_bf16 v[180:183], a[88:91], a[136:139], v[180:183]
  ds_read_b128 a[100:103], v247 offset:1024
  v_mfma_f32_16x16x32_bf16 v[180:183], a[92:95], a[140:143], v[180:183]
  v_exp_f32 v174, v174
  v_mfma_f32_16x16x32_bf16 v[188:191], a[92:95], a[156:159], v[212:215]
  buffer_load_dwordx4 v234, s[28:31], s58 offen offset:2048 lds
  v_mfma_f32_16x16x32_bf16 v[188:191], a[88:91], a[152:155], v[188:191]
  s_add_u32 m0, s62, 3072
  ds_read_b128 a[104:107], v247 offset:2048
  s_add_u32 s58, s58, 20480
  v_mfma_f32_16x16x32_bf16 v[188:191], a[84:87], a[148:151], v[188:191]
  v_exp_f32 v175, v175
  v_mfma_f32_16x16x32_bf16 v[188:191], a[80:83], a[144:147], v[188:191]
  v_cvt_pk_bf16_f32 v171, v174, v175
  v_mfma_f32_16x16x32_bf16 v[196:199], a[80:83], a[160:163], v[216:219]
  v_mfma_f32_16x16x32_bf16 v[196:199], a[84:87], a[164:167], v[196:199]
  ds_read_b128 a[108:111], v247 offset:3072
  v_mfma_f32_16x16x32_bf16 v[196:199], a[88:91], a[168:171], v[196:199]
  v_exp_f32 v176, v176
  v_mfma_f32_16x16x32_bf16 v[196:199], a[92:95], a[172:175], v[196:199]
  buffer_load_dwordx4 v232, s[28:31], s58 offen offset:0 lds
  v_mfma_f32_16x16x32_bf16 v[204:207], a[92:95], a[188:191], v[220:223]
  v_exp_f32 v177, v177
  v_mfma_f32_16x16x32_bf16 v[204:207], a[88:91], a[184:187], v[204:207]
  ds_read_b128 a[112:115], v247 offset:4096
  v_cvt_pk_bf16_f32 v176, v176, v177
  v_mfma_f32_16x16x32_bf16 v[204:207], a[84:87], a[180:183], v[204:207]
  buffer_load_dwordx4 v233, s[28:31], s58 offen offset:1024 lds
  v_mfma_f32_16x16x32_bf16 v[204:207], a[80:83], a[176:179], v[204:207]
  s_waitcnt lgkmcnt(3)
  v_exp_f32 v178, v178
  v_mfma_f32_16x16x32_bf16 v[0:3], a[96:99], v[144:147], v[0:3]
  v_exp_f32 v179, v179
  v_mfma_f32_16x16x32_bf16 v[32:35], a[96:99], v[152:155], v[32:35]
  buffer_load_dwordx4 v234, s[28:31], s58 offen offset:2048 lds
  v_mfma_f32_16x16x32_bf16 v[64:67], a[96:99], v[160:163], v[64:67]
  s_add_u32 s58, s58, 20480
  ds_read_b128 a[116:119], v247 offset:5120
  v_cvt_pk_bf16_f32 v177, v178, v179
  v_mfma_f32_16x16x32_bf16 v[96:99], a[96:99], v[168:171], v[96:99]
  v_exp_f32 v180, v180
  v_mfma_f32_16x16x32_bf16 v[100:103], a[100:103], v[168:171], v[100:103]
  v_exp_f32 v181, v181
  v_mfma_f32_16x16x32_bf16 v[68:71], a[100:103], v[160:163], v[68:71]
  buffer_load_dwordx4 a[208:211], v248, s[4:7], s59 offen sc1
  v_mfma_f32_16x16x32_bf16 v[36:39], a[100:103], v[152:155], v[36:39]
  ds_read_b128 a[120:123], v247 offset:6144
  v_cvt_pk_bf16_f32 v178, v180, v181
  v_mfma_f32_16x16x32_bf16 v[4:7], a[100:103], v[144:147], v[4:7]
  s_waitcnt lgkmcnt(3)
  v_exp_f32 v182, v182
  v_mfma_f32_16x16x32_bf16 v[8:11], a[104:107], v[144:147], v[8:11]
  v_exp_f32 v183, v183
  v_mfma_f32_16x16x32_bf16 v[40:43], a[104:107], v[152:155], v[40:43]
  buffer_load_dwordx4 a[212:215], v248, s[20:23], s59 offen sc1
  v_mfma_f32_16x16x32_bf16 v[72:75], a[104:107], v[160:163], v[72:75]
  ds_read_b128 a[124:127], v247 offset:7168
  v_cvt_pk_bf16_f32 v179, v182, v183
  v_mfma_f32_16x16x32_bf16 v[104:107], a[104:107], v[168:171], v[104:107]
  v_exp_f32 v184, v184
  v_mfma_f32_16x16x32_bf16 v[108:111], a[108:111], v[168:171], v[108:111]
  buffer_load_dwordx4 a[216:219], v248, s[36:39], s59 offen sc1
  v_mfma_f32_16x16x32_bf16 v[76:79], a[108:111], v[160:163], v[76:79]
  v_exp_f32 v185, v185
  v_mfma_f32_16x16x32_bf16 v[44:47], a[108:111], v[152:155], v[44:47]
  v_exp_f32 v186, v186
  v_mfma_f32_16x16x32_bf16 v[12:15], a[108:111], v[144:147], v[12:15]
  s_waitcnt lgkmcnt(2)
  buffer_load_dwordx4 a[220:223], v248, s[40:43], s59 offen sc1
  v_mfma_f32_16x16x32_bf16 v[16:19], a[112:115], v[144:147], v[16:19]
  s_add_u32 s59, s59, 1024
  v_cvt_pk_bf16_f32 v184, v184, v185
  v_mfma_f32_16x16x32_bf16 v[48:51], a[112:115], v[152:155], v[48:51]
  v_add_u32 v243, 16384, v243
  v_and_b32 v243, 0xffff, v243
  v_mfma_f32_16x16x32_bf16 v[80:83], a[112:115], v[160:163], v[80:83]
  v_exp_f32 v187, v187
  v_mfma_f32_16x16x32_bf16 v[112:115], a[112:115], v[168:171], v[112:115]
  v_exp_f32 v188, v188
  v_mfma_f32_16x16x32_bf16 v[116:119], a[116:119], v[168:171], v[116:119]
  v_cvt_pk_bf16_f32 v185, v186, v187
  v_mfma_f32_16x16x32_bf16 v[84:87], a[116:119], v[160:163], v[84:87]
  v_exp_f32 v189, v189
  v_mfma_f32_16x16x32_bf16 v[52:55], a[116:119], v[152:155], v[52:55]
  v_exp_f32 v190, v190
  v_mfma_f32_16x16x32_bf16 v[20:23], a[116:119], v[144:147], v[20:23]
  s_waitcnt vmcnt(22) lgkmcnt(0)
  s_barrier
  v_mfma_f32_16x16x32_bf16 v[24:27], a[120:123], v[144:147], v[24:27]
  s_and_b32 s48, s55, 0xffff
  ds_read_b128 a[64:67], v243 offset:0
  s_add_u32 m0, s48, s60
  v_mfma_f32_16x16x32_bf16 v[56:59], a[120:123], v[152:155], v[56:59]
  ds_read_b128 a[68:71], v243 offset:1024
  v_cvt_pk_bf16_f32 v186, v188, v189
  v_mfma_f32_16x16x32_bf16 v[88:91], a[120:123], v[160:163], v[88:91]
  ds_read_b128 a[72:75], v243 offset:2048
  v_mfma_f32_16x16x32_bf16 v[120:123], a[120:123], v[168:171], v[120:123]
  ds_read_b128 a[76:79], v243 offset:3072
  v_mfma_f32_16x16x32_bf16 v[124:127], a[124:127], v[168:171], v[124:127]
  v_exp_f32 v191, v191
  v_mfma_f32_16x16x32_bf16 v[92:95], a[124:127], v[160:163], v[92:95]
  v_exp_f32 v192, v192
  v_mfma_f32_16x16x32_bf16 v[60:63], a[124:127], v[152:155], v[60:63]
  buffer_load_dwordx4 v244, s[12:15], s55 offen offset:0 sc1 lds
  v_mfma_f32_16x16x32_bf16 v[28:31], a[124:127], v[144:147], v[28:31]
  v_cvt_pk_bf16_f32 v187, v190, v191
  v_mfma_f32_16x16x32_bf16 v[128:131], a[232:235], v[144:147], v[128:131]
  v_exp_f32 v193, v193
  v_mfma_f32_16x16x32_bf16 v[132:135], a[232:235], v[152:155], v[132:135]
  ds_read_b128 a[80:83], v243 offset:4096
  v_cvt_pk_bf16_f32 v192, v192, v193
  v_mfma_f32_16x16x32_bf16 v[136:139], a[232:235], v[160:163], v[136:139]
  v_exp_f32 v194, v194
  v_mfma_f32_16x16x32_bf16 v[140:143], a[232:235], v[168:171], v[140:143]
  s_waitcnt lgkmcnt(1)
  ds_read_b128 a[84:87], v243 offset:5120
  v_mfma_f32_16x16x32_bf16 v[144:147], a[64:67], a[128:131], v[208:211]
  buffer_load_dwordx4 v244, s[12:15], s55 offen offset:1024 sc1 lds
  v_mfma_f32_16x16x32_bf16 v[144:147], a[68:71], a[132:135], v[144:147]
  v_exp_f32 v195, v195
  v_mfma_f32_16x16x32_bf16 v[144:147], a[72:75], a[136:139], v[144:147]
  ds_read_b128 a[88:91], v243 offset:6144
  v_cvt_pk_bf16_f32 v193, v194, v195
  v_mfma_f32_16x16x32_bf16 v[144:147], a[76:79], a[140:143], v[144:147]
  v_exp_f32 v196, v196
  v_mfma_f32_16x16x32_bf16 v[152:155], a[76:79], a[156:159], v[212:215]
  ds_read_b128 a[92:95], v243 offset:7168
  v_mfma_f32_16x16x32_bf16 v[152:155], a[72:75], a[152:155], v[152:155]
  v_exp_f32 v197, v197
  v_mfma_f32_16x16x32_bf16 v[152:155], a[68:71], a[148:151], v[152:155]
  buffer_load_dwordx4 v244, s[12:15], s55 offen offset:2048 sc1 lds
  v_mfma_f32_16x16x32_bf16 v[152:155], a[64:67], a[144:147], v[152:155]
  v_exp_f32 v198, v198
  v_mfma_f32_16x16x32_bf16 v[160:163], a[64:67], a[160:163], v[216:219]
  v_cvt_pk_bf16_f32 v194, v196, v197
  v_mfma_f32_16x16x32_bf16 v[160:163], a[68:71], a[164:167], v[160:163]
  v_exp_f32 v199, v199
  v_mfma_f32_16x16x32_bf16 v[160:163], a[72:75], a[168:171], v[160:163]
  v_exp_f32 v200, v200
  v_mfma_f32_16x16x32_bf16 v[160:163], a[76:79], a[172:175], v[160:163]
  v_cvt_pk_bf16_f32 v195, v198, v199
  v_mfma_f32_16x16x32_bf16 v[168:171], a[76:79], a[188:191], v[220:223]
  buffer_load_dwordx4 v244, s[12:15], s55 offen offset:3072 sc1 lds
  v_mfma_f32_16x16x32_bf16 v[168:171], a[72:75], a[184:187], v[168:171]
  s_add_u32 s55, s55, 16384
  v_exp_f32 v201, v201
  v_mfma_f32_16x16x32_bf16 v[168:171], a[68:71], a[180:183], v[168:171]
  s_and_b32 s48, s54, 0xffff
  ds_read_b128 a[96:99], v247 offset:8192
  v_cvt_pk_bf16_f32 v200, v200, v201
  v_mfma_f32_16x16x32_bf16 v[168:171], a[64:67], a[176:179], v[168:171]
  s_waitcnt lgkmcnt(1)
  v_exp_f32 v202, v202
  v_mfma_f32_16x16x32_bf16 v[148:151], a[80:83], a[128:131], v[208:211]
  v_exp_f32 v203, v203
  v_mfma_f32_16x16x32_bf16 v[148:151], a[84:87], a[132:135], v[148:151]
  s_add_u32 m0, s48, s50
  ds_read_b128 a[100:103], v247 offset:9216
  v_cvt_pk_bf16_f32 v201, v202, v203
  v_mfma_f32_16x16x32_bf16 v[148:151], a[88:91], a[136:139], v[148:151]
  v_exp_f32 v204, v204
  v_mfma_f32_16x16x32_bf16 v[148:151], a[92:95], a[140:143], v[148:151]
  v_exp_f32 v205, v205
  v_mfma_f32_16x16x32_bf16 v[156:159], a[92:95], a[156:159], v[212:215]
  v_exp_f32 v206, v206
  v_mfma_f32_16x16x32_bf16 v[156:159], a[88:91], a[152:155], v[156:159]
  ds_read_b128 a[104:107], v247 offset:10240
  v_cvt_pk_bf16_f32 v202, v204, v205
  v_mfma_f32_16x16x32_bf16 v[156:159], a[84:87], a[148:151], v[156:159]
  v_exp_f32 v207, v207
  v_mfma_f32_16x16x32_bf16 v[156:159], a[80:83], a[144:147], v[156:159]
  v_cvt_pk_bf16_f32 v203, v206, v207
  v_mfma_f32_16x16x32_bf16 v[164:167], a[80:83], a[160:163], v[216:219]
  v_exp_f32 v144, v144
  v_mfma_f32_16x16x32_bf16 v[164:167], a[84:87], a[164:167], v[164:167]
  ds_read_b128 a[108:111], v247 offset:11264
  v_mfma_f32_16x16x32_bf16 v[164:167], a[88:91], a[168:171], v[164:167]
  v_exp_f32 v145, v145
  v_mfma_f32_16x16x32_bf16 v[164:167], a[92:95], a[172:175], v[164:167]
  v_exp_f32 v146, v146
  v_mfma_f32_16x16x32_bf16 v[172:175], a[92:95], a[188:191], v[220:223]
  buffer_load_dwordx4 v244, s[8:11], s54 offen offset:0 sc1 lds
  v_mfma_f32_16x16x32_bf16 v[172:175], a[88:91], a[184:187], v[172:175]
  ds_read_b128 a[112:115], v247 offset:12288
  v_cvt_pk_bf16_f32 v144, v144, v145
  v_mfma_f32_16x16x32_bf16 v[172:175], a[84:87], a[180:183], v[172:175]
  v_exp_f32 v147, v147
  v_mfma_f32_16x16x32_bf16 v[172:175], a[80:83], a[176:179], v[172:175]
  s_waitcnt lgkmcnt(3)
  v_exp_f32 v148, v148
  v_mfma_f32_16x16x32_bf16 v[0:3], a[96:99], v[176:179], v[0:3]
  v_cvt_pk_bf16_f32 v145, v146, v147
  v_mfma_f32_16x16x32_bf16 v[32:35], a[96:99], v[184:187], v[32:35]
  ds_read_b128 a[116:119], v247 offset:13312
  v_mfma_f32_16x16x32_bf16 v[64:67], a[96:99], v[192:195], v[64:67]
  buffer_load_dwordx4 v244, s[8:11], s54 offen offset:1024 sc1 lds
  v_mfma_f32_16x16x32_bf16 v[96:99], a[96:99], v[200:203], v[96:99]
  v_exp_f32 v149, v149
  v_mfma_f32_16x16x32_bf16 v[100:103], a[100:103], v[200:203], v[100:103]
  v_cvt_pk_bf16_f32 v146, v148, v149
  v_mfma_f32_16x16x32_bf16 v[68:71], a[100:103], v[192:195], v[68:71]
  ds_read_b128 a[120:123], v247 offset:14336
  v_mfma_f32_16x16x32_bf16 v[36:39], a[100:103], v[184:187], v[36:39]
  v_exp_f32 v150, v150
  v_mfma_f32_16x16x32_bf16 v[4:7], a[100:103], v[176:179], v[4:7]
  s_waitcnt lgkmcnt(3)
  v_exp_f32 v151, v151
  v_mfma_f32_16x16x32_bf16 v[8:11], a[104:107], v[176:179], v[8:11]
  buffer_load_dwordx4 v244, s[8:11], s54 offen offset:2048 sc1 lds
  v_mfma_f32_16x16x32_bf16 v[40:43], a[104:107], v[184:187], v[40:43]
  ds_read_b128 a[124:127], v247 offset:15360
  v_cvt_pk_bf16_f32 v147, v150, v151
  v_mfma_f32_16x16x32_bf16 v[72:75], a[104:107], v[192:195], v[72:75]
  v_exp_f32 v152, v152
  v_mfma_f32_16x16x32_bf16 v[104:107], a[104:107], v[200:203], v[104:107]
  v_exp_f32 v153, v153
  v_mfma_f32_16x16x32_bf16 v[108:111], a[108:111], v[200:203], v[108:111]
  v_add_u32 v247, 16384, v247
  v_and_or_b32 v247, v247, s57, v245
  v_mfma_f32_16x16x32_bf16 v[76:79], a[108:111], v[192:195], v[76:79]
  v_exp_f32 v154, v154
  v_mfma_f32_16x16x32_bf16 v[44:47], a[108:111], v[184:187], v[44:47]
  buffer_load_dwordx4 v244, s[8:11], s54 offen offset:3072 sc1 lds
  v_mfma_f32_16x16x32_bf16 v[12:15], a[108:111], v[176:179], v[12:15]
  s_waitcnt lgkmcnt(2)
  s_add_u32 s54, s54, 16384
  v_cvt_pk_bf16_f32 v152, v152, v153
  v_mfma_f32_16x16x32_bf16 v[16:19], a[112:115], v[176:179], v[16:19]
  v_exp_f32 v155, v155
  v_mfma_f32_16x16x32_bf16 v[48:51], a[112:115], v[184:187], v[48:51]
  ds_read_b128 a[64:67], v243 offset:8192
  v_cvt_pk_bf16_f32 v153, v154, v155
  v_mfma_f32_16x16x32_bf16 v[80:83], a[112:115], v[192:195], v[80:83]
  v_exp_f32 v156, v156
  v_mfma_f32_16x16x32_bf16 v[112:115], a[112:115], v[200:203], v[112:115]
  ds_read_b128 a[68:71], v243 offset:9216
  v_mfma_f32_16x16x32_bf16 v[116:119], a[116:119], v[200:203], v[116:119]
  v_exp_f32 v157, v157
  v_mfma_f32_16x16x32_bf16 v[84:87], a[116:119], v[192:195], v[84:87]
  ds_read_b128 a[72:75], v243 offset:10240
  v_cvt_pk_bf16_f32 v154, v156, v157
  v_mfma_f32_16x16x32_bf16 v[52:55], a[116:119], v[184:187], v[52:55]
  v_exp_f32 v158, v158
  v_mfma_f32_16x16x32_bf16 v[20:23], a[116:119], v[176:179], v[20:23]
  s_waitcnt lgkmcnt(3)
  ds_read_b128 a[76:79], v243 offset:11264
  v_mfma_f32_16x16x32_bf16 v[24:27], a[120:123], v[176:179], v[24:27]
  v_exp_f32 v159, v159
  v_mfma_f32_16x16x32_bf16 v[56:59], a[120:123], v[184:187], v[56:59]
  v_cvt_pk_bf16_f32 v155, v158, v159
  v_mfma_f32_16x16x32_bf16 v[88:91], a[120:123], v[192:195], v[88:91]
  v_mfma_f32_16x16x32_bf16 v[120:123], a[120:123], v[200:203], v[120:123]
  v_mfma_f32_16x16x32_bf16 v[124:127], a[124:127], v[200:203], v[124:127]
  v_mfma_f32_16x16x32_bf16 v[92:95], a[124:127], v[192:195], v[92:95]
  v_mfma_f32_16x16x32_bf16 v[60:63], a[124:127], v[184:187], v[60:63]
  v_mfma_f32_16x16x32_bf16 v[28:31], a[124:127], v[176:179], v[28:31]
  v_mfma_f32_16x16x32_bf16 v[128:131], a[232:235], v[176:179], v[128:131]
  s_sub_u32 s56, s56, 1
  v_mfma_f32_16x16x32_bf16 v[132:135], a[232:235], v[184:187], v[132:135]
  v_mfma_f32_16x16x32_bf16 v[136:139], a[232:235], v[192:195], v[136:139]
  v_mfma_f32_16x16x32_bf16 v[140:143], a[232:235], v[200:203], v[140:143]
  s_cbranch_scc0 recurrent_scan__compressed_kv_cla__dense_activation_silu__prompt_kernel_dd
recurrent_scan__compressed_kv_cla__dense_activation_silu__prompt_kernel_dm1:
  s_waitcnt lgkmcnt(0)
  v_mfma_f32_16x16x32_bf16 v[176:179], a[64:67], a[128:131], v[208:211]
  s_waitcnt vmcnt(8)
  ds_read_b64_tr_b16 a[224:225], v235 offset:0
  v_mfma_f32_16x16x32_bf16 v[176:179], a[68:71], a[132:135], v[176:179]
  v_exp_f32 v160, v160
  v_mfma_f32_16x16x32_bf16 v[176:179], a[72:75], a[136:139], v[176:179]
  ds_read_b64_tr_b16 a[226:227], v235 offset:3072
  v_mfma_f32_16x16x32_bf16 v[176:179], a[76:79], a[140:143], v[176:179]
  ds_read_b64_tr_b16 a[228:229], v246 offset:32
  v_mfma_f32_16x16x32_bf16 v[184:187], a[76:79], a[156:159], v[212:215]
  ds_read_b64_tr_b16 a[230:231], v246 offset:3104
  v_mfma_f32_16x16x32_bf16 v[184:187], a[72:75], a[152:155], v[184:187]
  v_exp_f32 v161, v161
  v_mfma_f32_16x16x32_bf16 v[184:187], a[68:71], a[148:151], v[184:187]
  ds_read_b64_tr_b16 a[236:237], v235 offset:64
  v_cvt_pk_bf16_f32 v160, v160, v161
  v_mfma_f32_16x16x32_bf16 v[184:187], a[64:67], a[144:147], v[184:187]
  ds_read_b64_tr_b16 a[238:239], v235 offset:3136
  v_mfma_f32_16x16x32_bf16 v[192:195], a[64:67], a[160:163], v[216:219]
  ds_read_b64_tr_b16 a[240:241], v246 offset:96
  v_mfma_f32_16x16x32_bf16 v[192:195], a[68:71], a[164:167], v[192:195]
  v_exp_f32 v162, v162
  v_mfma_f32_16x16x32_bf16 v[192:195], a[72:75], a[168:171], v[192:195]
  ds_read_b64_tr_b16 a[242:243], v246 offset:3168
  v_mfma_f32_16x16x32_bf16 v[192:195], a[76:79], a[172:175], v[192:195]
  ds_read_b64_tr_b16 a[244:245], v235 offset:128
  v_mfma_f32_16x16x32_bf16 v[200:203], a[76:79], a[188:191], v[220:223]
  ds_read_b64_tr_b16 a[246:247], v235 offset:3200
  v_mfma_f32_16x16x32_bf16 v[200:203], a[72:75], a[184:187], v[200:203]
  v_exp_f32 v163, v163
  v_mfma_f32_16x16x32_bf16 v[200:203], a[68:71], a[180:183], v[200:203]
  v_cvt_pk_bf16_f32 v161, v162, v163
  v_mfma_f32_16x16x32_bf16 v[200:203], a[64:67], a[176:179], v[200:203]
  s_waitcnt lgkmcnt(6)
  v_exp_f32 v164, v164
  v_mfma_f32_16x16x32_bf16 a[0:3], a[224:227], a[208:211], a[0:3]
  v_exp_f32 v165, v165
  v_mfma_f32_16x16x32_bf16 a[20:23], a[224:227], a[212:215], a[20:23]
  ds_read_b128 a[80:83], v243 offset:12288
  v_cvt_pk_bf16_f32 v162, v164, v165
  v_mfma_f32_16x16x32_bf16 a[40:43], a[224:227], a[216:219], a[40:43]
  v_exp_f32 v166, v166
  v_mfma_f32_16x16x32_bf16 a[60:63], a[224:227], a[220:223], a[60:63]
  ds_read_b128 a[84:87], v243 offset:13312
  v_mfma_f32_16x16x32_bf16 a[192:195], a[228:231], a[220:223], a[192:195]
  v_exp_f32 v167, v167
  v_mfma_f32_16x16x32_bf16 a[44:47], a[228:231], a[216:219], a[44:47]
  ds_read_b128 a[88:91], v243 offset:14336
  v_cvt_pk_bf16_f32 v163, v166, v167
  v_mfma_f32_16x16x32_bf16 a[24:27], a[228:231], a[212:215], a[24:27]
  v_exp_f32 v168, v168
  v_mfma_f32_16x16x32_bf16 a[4:7], a[228:231], a[208:211], a[4:7]
  s_waitcnt lgkmcnt(5)
  ds_read_b128 a[92:95], v243 offset:15360
  v_mfma_f32_16x16x32_bf16 a[8:11], a[236:239], a[208:211], a[8:11]
  v_exp_f32 v169, v169
  v_mfma_f32_16x16x32_bf16 a[28:31], a[236:239], a[212:215], a[28:31]
  v_cvt_pk_bf16_f32 v168, v168, v169
  v_mfma_f32_16x16x32_bf16 a[48:51], a[236:239], a[216:219], a[48:51]
  v_exp_f32 v170, v170
  v_mfma_f32_16x16x32_bf16 a[196:199], a[236:239], a[220:223], a[196:199]
  v_exp_f32 v171, v171
  v_mfma_f32_16x16x32_bf16 a[200:203], a[240:243], a[220:223], a[200:203]
  v_mfma_f32_16x16x32_bf16 a[52:55], a[240:243], a[216:219], a[52:55]
  v_cvt_pk_bf16_f32 v169, v170, v171
  v_mfma_f32_16x16x32_bf16 a[32:35], a[240:243], a[212:215], a[32:35]
  v_exp_f32 v172, v172
  v_mfma_f32_16x16x32_bf16 a[12:15], a[240:243], a[208:211], a[12:15]
  s_waitcnt lgkmcnt(4)
  v_mfma_f32_16x16x32_bf16 a[16:19], a[244:247], a[208:211], a[16:19]
  s_mov_b32 m0, s62
  v_mfma_f32_16x16x32_bf16 a[36:39], a[244:247], a[212:215], a[36:39]
  ds_read_b128 a[96:99], v247 offset:0
  v_mfma_f32_16x16x32_bf16 a[56:59], a[244:247], a[216:219], a[56:59]
  buffer_load_dwordx4 v232, s[28:31], s58 offen offset:0 lds
  v_mfma_f32_16x16x32_bf16 a[204:207], a[244:247], a[220:223], a[204:207]
  s_waitcnt lgkmcnt(1)
  v_exp_f32 v173, v173
  v_mfma_f32_16x16x32_bf16 v[180:183], a[80:83], a[128:131], v[208:211]
  v_cvt_pk_bf16_f32 v170, v172, v173
  v_mfma_f32_16x16x32_bf16 v[180:183], a[84:87], a[132:135], v[180:183]
  buffer_load_dwordx4 v233, s[28:31], s58 offen offset:1024 lds
  v_mfma_f32_16x16x32_bf16 v[180:183], a[88:91], a[136:139], v[180:183]
  ds_read_b128 a[100:103], v247 offset:1024
  v_mfma_f32_16x16x32_bf16 v[180:183], a[92:95], a[140:143], v[180:183]
  v_exp_f32 v174, v174
  v_mfma_f32_16x16x32_bf16 v[188:191], a[92:95], a[156:159], v[212:215]
  buffer_load_dwordx4 v234, s[28:31], s58 offen offset:2048 lds
  v_mfma_f32_16x16x32_bf16 v[188:191], a[88:91], a[152:155], v[188:191]
  s_add_u32 m0, s62, 3072
  ds_read_b128 a[104:107], v247 offset:2048
  s_add_u32 s58, s58, 20480
  v_mfma_f32_16x16x32_bf16 v[188:191], a[84:87], a[148:151], v[188:191]
  v_exp_f32 v175, v175
  v_mfma_f32_16x16x32_bf16 v[188:191], a[80:83], a[144:147], v[188:191]
  v_cvt_pk_bf16_f32 v171, v174, v175
  v_mfma_f32_16x16x32_bf16 v[196:199], a[80:83], a[160:163], v[216:219]
  v_mfma_f32_16x16x32_bf16 v[196:199], a[84:87], a[164:167], v[196:199]
  ds_read_b128 a[108:111], v247 offset:3072
  v_mfma_f32_16x16x32_bf16 v[196:199], a[88:91], a[168:171], v[196:199]
  v_exp_f32 v176, v176
  v_mfma_f32_16x16x32_bf16 v[196:199], a[92:95], a[172:175], v[196:199]
  buffer_load_dwordx4 v232, s[28:31], s58 offen offset:0 lds
  v_mfma_f32_16x16x32_bf16 v[204:207], a[92:95], a[188:191], v[220:223]
  v_exp_f32 v177, v177
  v_mfma_f32_16x16x32_bf16 v[204:207], a[88:91], a[184:187], v[204:207]
  ds_read_b128 a[112:115], v247 offset:4096
  v_cvt_pk_bf16_f32 v176, v176, v177
  v_mfma_f32_16x16x32_bf16 v[204:207], a[84:87], a[180:183], v[204:207]
  buffer_load_dwordx4 v233, s[28:31], s58 offen offset:1024 lds
  v_mfma_f32_16x16x32_bf16 v[204:207], a[80:83], a[176:179], v[204:207]
  s_waitcnt lgkmcnt(3)
  v_exp_f32 v178, v178
  v_mfma_f32_16x16x32_bf16 v[0:3], a[96:99], v[144:147], v[0:3]
  v_exp_f32 v179, v179
  v_mfma_f32_16x16x32_bf16 v[32:35], a[96:99], v[152:155], v[32:35]
  buffer_load_dwordx4 v234, s[28:31], s58 offen offset:2048 lds
  v_mfma_f32_16x16x32_bf16 v[64:67], a[96:99], v[160:163], v[64:67]
  s_add_u32 s58, s58, 20480
  ds_read_b128 a[116:119], v247 offset:5120
  v_cvt_pk_bf16_f32 v177, v178, v179
  v_mfma_f32_16x16x32_bf16 v[96:99], a[96:99], v[168:171], v[96:99]
  v_exp_f32 v180, v180
  v_mfma_f32_16x16x32_bf16 v[100:103], a[100:103], v[168:171], v[100:103]
  v_exp_f32 v181, v181
  v_mfma_f32_16x16x32_bf16 v[68:71], a[100:103], v[160:163], v[68:71]
  buffer_load_dwordx4 a[208:211], v248, s[4:7], s59 offen sc1
  v_mfma_f32_16x16x32_bf16 v[36:39], a[100:103], v[152:155], v[36:39]
  ds_read_b128 a[120:123], v247 offset:6144
  v_cvt_pk_bf16_f32 v178, v180, v181
  v_mfma_f32_16x16x32_bf16 v[4:7], a[100:103], v[144:147], v[4:7]
  s_waitcnt lgkmcnt(3)
  v_exp_f32 v182, v182
  v_mfma_f32_16x16x32_bf16 v[8:11], a[104:107], v[144:147], v[8:11]
  v_exp_f32 v183, v183
  v_mfma_f32_16x16x32_bf16 v[40:43], a[104:107], v[152:155], v[40:43]
  buffer_load_dwordx4 a[212:215], v248, s[20:23], s59 offen sc1
  v_mfma_f32_16x16x32_bf16 v[72:75], a[104:107], v[160:163], v[72:75]
  ds_read_b128 a[124:127], v247 offset:7168
  v_cvt_pk_bf16_f32 v179, v182, v183
  v_mfma_f32_16x16x32_bf16 v[104:107], a[104:107], v[168:171], v[104:107]
  v_exp_f32 v184, v184
  v_mfma_f32_16x16x32_bf16 v[108:111], a[108:111], v[168:171], v[108:111]
  buffer_load_dwordx4 a[216:219], v248, s[36:39], s59 offen sc1
  v_mfma_f32_16x16x32_bf16 v[76:79], a[108:111], v[160:163], v[76:79]
  v_exp_f32 v185, v185
  v_mfma_f32_16x16x32_bf16 v[44:47], a[108:111], v[152:155], v[44:47]
  v_exp_f32 v186, v186
  v_mfma_f32_16x16x32_bf16 v[12:15], a[108:111], v[144:147], v[12:15]
  s_waitcnt lgkmcnt(2)
  buffer_load_dwordx4 a[220:223], v248, s[40:43], s59 offen sc1
  v_mfma_f32_16x16x32_bf16 v[16:19], a[112:115], v[144:147], v[16:19]
  s_add_u32 s59, s59, 1024
  v_cvt_pk_bf16_f32 v184, v184, v185
  v_mfma_f32_16x16x32_bf16 v[48:51], a[112:115], v[152:155], v[48:51]
  v_add_u32 v243, 16384, v243
  v_and_b32 v243, 0xffff, v243
  v_mfma_f32_16x16x32_bf16 v[80:83], a[112:115], v[160:163], v[80:83]
  v_exp_f32 v187, v187
  v_mfma_f32_16x16x32_bf16 v[112:115], a[112:115], v[168:171], v[112:115]
  v_exp_f32 v188, v188
  v_mfma_f32_16x16x32_bf16 v[116:119], a[116:119], v[168:171], v[116:119]
  v_cvt_pk_bf16_f32 v185, v186, v187
  v_mfma_f32_16x16x32_bf16 v[84:87], a[116:119], v[160:163], v[84:87]
  v_exp_f32 v189, v189
  v_mfma_f32_16x16x32_bf16 v[52:55], a[116:119], v[152:155], v[52:55]
  v_exp_f32 v190, v190
  v_mfma_f32_16x16x32_bf16 v[20:23], a[116:119], v[144:147], v[20:23]
  s_waitcnt vmcnt(22) lgkmcnt(0)
  s_barrier
  v_mfma_f32_16x16x32_bf16 v[24:27], a[120:123], v[144:147], v[24:27]
  s_and_b32 s48, s55, 0xffff
  ds_read_b128 a[64:67], v243 offset:0
  v_cmp_gt_i32 s[76:77], 0, v241
  v_mfma_f32_16x16x32_bf16 v[56:59], a[120:123], v[152:155], v[56:59]
  s_add_u32 m0, s48, s60
  ds_read_b128 a[68:71], v243 offset:1024
  v_cmp_gt_i32 s[78:79], 1, v241
  v_mfma_f32_16x16x32_bf16 v[88:91], a[120:123], v[160:163], v[88:91]
  ds_read_b128 a[72:75], v243 offset:2048
  v_cmp_gt_i32 s[80:81], 2, v241
  v_mfma_f32_16x16x32_bf16 v[120:123], a[120:123], v[168:171], v[120:123]
  v_cmp_gt_i32 s[82:83], 3, v241
  v_cndmask_b32 v224, v208, v240, s[76:77]
  v_mfma_f32_16x16x32_bf16 v[124:127], a[124:127], v[168:171], v[124:127]
  v_cndmask_b32 v225, v209, v240, s[78:79]
  v_cndmask_b32 v226, v210, v240, s[80:81]
  v_cndmask_b32 v227, v211, v240, s[82:83]
  v_mfma_f32_16x16x32_bf16 v[92:95], a[124:127], v[160:163], v[92:95]
  ds_read_b128 a[76:79], v243 offset:3072
  v_cvt_pk_bf16_f32 v186, v188, v189
  v_mfma_f32_16x16x32_bf16 v[60:63], a[124:127], v[152:155], v[60:63]
  buffer_load_dwordx4 v244, s[12:15], s55 offen offset:0 sc1 lds
  v_mfma_f32_16x16x32_bf16 v[28:31], a[124:127], v[144:147], v[28:31]
  v_exp_f32 v191, v191
  v_mfma_f32_16x16x32_bf16 v[128:131], a[232:235], v[144:147], v[128:131]
  v_exp_f32 v192, v192
  v_mfma_f32_16x16x32_bf16 v[132:135], a[232:235], v[152:155], v[132:135]
  ds_read_b128 a[80:83], v243 offset:4096
  v_cvt_pk_bf16_f32 v187, v190, v191
  v_mfma_f32_16x16x32_bf16 v[136:139], a[232:235], v[160:163], v[136:139]
  v_exp_f32 v193, v193
  v_mfma_f32_16x16x32_bf16 v[140:143], a[232:235], v[168:171], v[140:143]
  s_waitcnt lgkmcnt(1)
  v_exp_f32 v194, v194
  v_mfma_f32_16x16x32_bf16 v[144:147], a[64:67], a[128:131], v[224:227]
  buffer_load_dwordx4 v244, s[12:15], s55 offen offset:1024 sc1 lds
  v_mfma_f32_16x16x32_bf16 v[144:147], a[68:71], a[132:135], v[144:147]
  ds_read_b128 a[84:87], v243 offset:5120
  v_cvt_pk_bf16_f32 v192, v192, v193
  v_mfma_f32_16x16x32_bf16 v[144:147], a[72:75], a[136:139], v[144:147]
  v_exp_f32 v195, v195
  v_mfma_f32_16x16x32_bf16 v[144:147], a[76:79], a[140:143], v[144:147]
  ds_read_b128 a[88:91], v243 offset:6144
  v_cvt_pk_bf16_f32 v193, v194, v195
  v_mfma_f32_16x16x32_bf16 v[152:155], a[76:79], a[156:159], v[212:215]
  v_exp_f32 v196, v196
  v_mfma_f32_16x16x32_bf16 v[152:155], a[72:75], a[152:155], v[152:155]
  v_cmp_gt_i32 s[76:77], 16, v241
  v_cmp_gt_i32 s[78:79], 17, v241
  v_mfma_f32_16x16x32_bf16 v[152:155], a[68:71], a[148:151], v[152:155]
  v_cmp_gt_i32 s[80:81], 18, v241
  v_cmp_gt_i32 s[82:83], 19, v241
  v_mfma_f32_16x16x32_bf16 v[152:155], a[64:67], a[144:147], v[152:155]
  v_cndmask_b32 v228, v208, v240, s[76:77]
  v_cndmask_b32 v229, v209, v240, s[78:79]
  v_mfma_f32_16x16x32_bf16 v[160:163], a[64:67], a[160:163], v[216:219]
  v_cndmask_b32 v230, v210, v240, s[80:81]
  v_cndmask_b32 v231, v211, v240, s[82:83]
  v_mfma_f32_16x16x32_bf16 v[160:163], a[68:71], a[164:167], v[160:163]
  buffer_load_dwordx4 v244, s[12:15], s55 offen offset:2048 sc1 lds
  v_mfma_f32_16x16x32_bf16 v[160:163], a[72:75], a[168:171], v[160:163]
  ds_read_b128 a[92:95], v243 offset:7168
  v_exp_f32 v197, v197
  v_mfma_f32_16x16x32_bf16 v[160:163], a[76:79], a[172:175], v[160:163]
  v_exp_f32 v198, v198
  v_mfma_f32_16x16x32_bf16 v[168:171], a[76:79], a[188:191], v[220:223]
  v_cvt_pk_bf16_f32 v194, v196, v197
  v_mfma_f32_16x16x32_bf16 v[168:171], a[72:75], a[184:187], v[168:171]
  v_exp_f32 v199, v199
  v_mfma_f32_16x16x32_bf16 v[168:171], a[68:71], a[180:183], v[168:171]
  buffer_load_dwordx4 v244, s[12:15], s55 offen offset:3072 sc1 lds
  v_mfma_f32_16x16x32_bf16 v[168:171], a[64:67], a[176:179], v[168:171]
  s_waitcnt lgkmcnt(0)
  v_exp_f32 v200, v200
  v_mfma_f32_16x16x32_bf16 v[148:151], a[80:83], a[128:131], v[228:231]
  s_add_u32 s55, s55, 16384
  ds_read_b128 a[96:99], v247 offset:8192
  v_cvt_pk_bf16_f32 v195, v198, v199
  v_mfma_f32_16x16x32_bf16 v[148:151], a[84:87], a[132:135], v[148:151]
  s_and_b32 s48, s54, 0xffff
  v_exp_f32 v201, v201
  v_mfma_f32_16x16x32_bf16 v[148:151], a[88:91], a[136:139], v[148:151]
  s_add_u32 m0, s48, s50
  v_exp_f32 v202, v202
  v_mfma_f32_16x16x32_bf16 v[148:151], a[92:95], a[140:143], v[148:151]
  ds_read_b128 a[100:103], v247 offset:9216
  v_cvt_pk_bf16_f32 v200, v200, v201
  v_mfma_f32_16x16x32_bf16 v[156:159], a[92:95], a[156:159], v[212:215]
  v_exp_f32 v203, v203
  v_mfma_f32_16x16x32_bf16 v[156:159], a[88:91], a[152:155], v[156:159]
  v_exp_f32 v204, v204
  v_mfma_f32_16x16x32_bf16 v[156:159], a[84:87], a[148:151], v[156:159]
  ds_read_b128 a[104:107], v247 offset:10240
  v_cvt_pk_bf16_f32 v201, v202, v203
  v_mfma_f32_16x16x32_bf16 v[156:159], a[80:83], a[144:147], v[156:159]
  v_exp_f32 v205, v205
  v_mfma_f32_16x16x32_bf16 v[164:167], a[80:83], a[160:163], v[216:219]
  v_exp_f32 v206, v206
  v_mfma_f32_16x16x32_bf16 v[164:167], a[84:87], a[164:167], v[164:167]
  ds_read_b128 a[108:111], v247 offset:11264
  v_cvt_pk_bf16_f32 v202, v204, v205
  v_mfma_f32_16x16x32_bf16 v[164:167], a[88:91], a[168:171], v[164:167]
  v_exp_f32 v207, v207
  v_mfma_f32_16x16x32_bf16 v[164:167], a[92:95], a[172:175], v[164:167]
  v_cvt_pk_bf16_f32 v203, v206, v207
  v_mfma_f32_16x16x32_bf16 v[172:175], a[92:95], a[188:191], v[220:223]
  buffer_load_dwordx4 v244, s[8:11], s54 offen offset:0 sc1 lds
  v_mfma_f32_16x16x32_bf16 v[172:175], a[88:91], a[184:187], v[172:175]
  v_exp_f32 v144, v144
  v_mfma_f32_16x16x32_bf16 v[172:175], a[84:87], a[180:183], v[172:175]
  ds_read_b128 a[112:115], v247 offset:12288
  v_mfma_f32_16x16x32_bf16 v[172:175], a[80:83], a[176:179], v[172:175]
  s_waitcnt lgkmcnt(3)
  v_exp_f32 v145, v145
  v_mfma_f32_16x16x32_bf16 v[0:3], a[96:99], v[176:179], v[0:3]
  v_exp_f32 v146, v146
  v_mfma_f32_16x16x32_bf16 v[32:35], a[96:99], v[184:187], v[32:35]
  ds_read_b128 a[116:119], v247 offset:13312
  v_cvt_pk_bf16_f32 v144, v144, v145
  v_mfma_f32_16x16x32_bf16 v[64:67], a[96:99], v[192:195], v[64:67]
  buffer_load_dwordx4 v244, s[8:11], s54 offen offset:1024 sc1 lds
  v_mfma_f32_16x16x32_bf16 v[96:99], a[96:99], v[200:203], v[96:99]
  v_exp_f32 v147, v147
  v_mfma_f32_16x16x32_bf16 v[100:103], a[100:103], v[200:203], v[100:103]
  v_exp_f32 v148, v148
  v_mfma_f32_16x16x32_bf16 v[68:71], a[100:103], v[192:195], v[68:71]
  ds_read_b128 a[120:123], v247 offset:14336
  v_cvt_pk_bf16_f32 v145, v146, v147
  v_mfma_f32_16x16x32_bf16 v[36:39], a[100:103], v[184:187], v[36:39]
  v_exp_f32 v149, v149
  v_mfma_f32_16x16x32_bf16 v[4:7], a[100:103], v[176:179], v[4:7]
  s_waitcnt lgkmcnt(3)
  v_cvt_pk_bf16_f32 v146, v148, v149
  v_mfma_f32_16x16x32_bf16 v[8:11], a[104:107], v[176:179], v[8:11]
  buffer_load_dwordx4 v244, s[8:11], s54 offen offset:2048 sc1 lds
  v_mfma_f32_16x16x32_bf16 v[40:43], a[104:107], v[184:187], v[40:43]
  v_exp_f32 v150, v150
  v_mfma_f32_16x16x32_bf16 v[72:75], a[104:107], v[192:195], v[72:75]
  ds_read_b128 a[124:127], v247 offset:15360
  v_mfma_f32_16x16x32_bf16 v[104:107], a[104:107], v[200:203], v[104:107]
  v_exp_f32 v151, v151
  v_mfma_f32_16x16x32_bf16 v[108:111], a[108:111], v[200:203], v[108:111]
  v_add_u32 v247, 16384, v247
  v_and_or_b32 v247, v247, s57, v245
  v_mfma_f32_16x16x32_bf16 v[76:79], a[108:111], v[192:195], v[76:79]
  v_exp_f32 v152, v152
  v_mfma_f32_16x16x32_bf16 v[44:47], a[108:111], v[184:187], v[44:47]
  buffer_load_dwordx4 v244, s[8:11], s54 offen offset:3072 sc1 lds
  v_mfma_f32_16x16x32_bf16 v[12:15], a[108:111], v[176:179], v[12:15]
  s_waitcnt lgkmcnt(2)
  s_add_u32 s54, s54, 16384
  v_cvt_pk_bf16_f32 v147, v150, v151
  v_mfma_f32_16x16x32_bf16 v[16:19], a[112:115], v[176:179], v[16:19]
  v_exp_f32 v153, v153
  v_mfma_f32_16x16x32_bf16 v[48:51], a[112:115], v[184:187], v[48:51]
  v_exp_f32 v154, v154
  v_mfma_f32_16x16x32_bf16 v[80:83], a[112:115], v[192:195], v[80:83]
  ds_read_b128 a[64:67], v243 offset:8192
  v_cvt_pk_bf16_f32 v152, v152, v153
  v_mfma_f32_16x16x32_bf16 v[112:115], a[112:115], v[200:203], v[112:115]
  ds_read_b128 a[68:71], v243 offset:9216
  v_mfma_f32_16x16x32_bf16 v[116:119], a[116:119], v[200:203], v[116:119]
  v_exp_f32 v155, v155
  v_mfma_f32_16x16x32_bf16 v[84:87], a[116:119], v[192:195], v[84:87]
  ds_read_b128 a[72:75], v243 offset:10240
  v_cvt_pk_bf16_f32 v153, v154, v155
  v_mfma_f32_16x16x32_bf16 v[52:55], a[116:119], v[184:187], v[52:55]
  v_exp_f32 v156, v156
  v_mfma_f32_16x16x32_bf16 v[20:23], a[116:119], v[176:179], v[20:23]
  s_waitcnt lgkmcnt(3)
  ds_read_b128 a[76:79], v243 offset:11264
  v_mfma_f32_16x16x32_bf16 v[24:27], a[120:123], v[176:179], v[24:27]
  v_exp_f32 v157, v157
  v_mfma_f32_16x16x32_bf16 v[56:59], a[120:123], v[184:187], v[56:59]
  v_exp_f32 v158, v158
  v_mfma_f32_16x16x32_bf16 v[88:91], a[120:123], v[192:195], v[88:91]
  v_cvt_pk_bf16_f32 v154, v156, v157
  v_mfma_f32_16x16x32_bf16 v[120:123], a[120:123], v[200:203], v[120:123]
  v_exp_f32 v159, v159
  v_mfma_f32_16x16x32_bf16 v[124:127], a[124:127], v[200:203], v[124:127]
  v_cvt_pk_bf16_f32 v155, v158, v159
  v_mfma_f32_16x16x32_bf16 v[92:95], a[124:127], v[192:195], v[92:95]
  v_mfma_f32_16x16x32_bf16 v[60:63], a[124:127], v[184:187], v[60:63]
  v_mfma_f32_16x16x32_bf16 v[28:31], a[124:127], v[176:179], v[28:31]
  v_mfma_f32_16x16x32_bf16 v[128:131], a[232:235], v[176:179], v[128:131]
  v_mfma_f32_16x16x32_bf16 v[132:135], a[232:235], v[184:187], v[132:135]
  v_mfma_f32_16x16x32_bf16 v[136:139], a[232:235], v[192:195], v[136:139]
  v_mfma_f32_16x16x32_bf16 v[140:143], a[232:235], v[200:203], v[140:143]
recurrent_scan__compressed_kv_cla__dense_activation_silu__prompt_kernel_m1:
  v_cmp_gt_i32 s[76:77], 32, v241
  v_cmp_gt_i32 s[78:79], 33, v241
  v_cmp_gt_i32 s[80:81], 34, v241
  v_cmp_gt_i32 s[82:83], 35, v241
  v_cndmask_b32 v224, v208, v240, s[76:77]
  v_cndmask_b32 v225, v209, v240, s[78:79]
  v_cndmask_b32 v226, v210, v240, s[80:81]
  v_cndmask_b32 v227, v211, v240, s[82:83]
  s_waitcnt lgkmcnt(0)
  s_nop 0
  v_mfma_f32_16x16x32_bf16 v[176:179], a[64:67], a[128:131], v[224:227]
  s_waitcnt vmcnt(8)
  ds_read_b64_tr_b16 a[224:225], v235 offset:0
  v_mfma_f32_16x16x32_bf16 v[176:179], a[68:71], a[132:135], v[176:179]
  v_exp_f32 v160, v160
  v_mfma_f32_16x16x32_bf16 v[176:179], a[72:75], a[136:139], v[176:179]
  ds_read_b64_tr_b16 a[226:227], v235 offset:3072
  v_mfma_f32_16x16x32_bf16 v[176:179], a[76:79], a[140:143], v[176:179]
  ds_read_b64_tr_b16 a[228:229], v246 offset:32
  v_mfma_f32_16x16x32_bf16 v[184:187], a[76:79], a[156:159], v[212:215]
  ds_read_b64_tr_b16 a[230:231], v246 offset:3104
  v_mfma_f32_16x16x32_bf16 v[184:187], a[72:75], a[152:155], v[184:187]
  v_exp_f32 v161, v161
  v_mfma_f32_16x16x32_bf16 v[184:187], a[68:71], a[148:151], v[184:187]
  ds_read_b64_tr_b16 a[236:237], v235 offset:64
  v_cvt_pk_bf16_f32 v160, v160, v161
  v_mfma_f32_16x16x32_bf16 v[184:187], a[64:67], a[144:147], v[184:187]
  ds_read_b64_tr_b16 a[238:239], v235 offset:3136
  v_mfma_f32_16x16x32_bf16 v[192:195], a[64:67], a[160:163], v[216:219]
  ds_read_b64_tr_b16 a[240:241], v246 offset:96
  v_mfma_f32_16x16x32_bf16 v[192:195], a[68:71], a[164:167], v[192:195]
  v_exp_f32 v162, v162
  v_mfma_f32_16x16x32_bf16 v[192:195], a[72:75], a[168:171], v[192:195]
  ds_read_b64_tr_b16 a[242:243], v246 offset:3168
  v_mfma_f32_16x16x32_bf16 v[192:195], a[76:79], a[172:175], v[192:195]
  ds_read_b64_tr_b16 a[244:245], v235 offset:128
  v_mfma_f32_16x16x32_bf16 v[200:203], a[76:79], a[188:191], v[220:223]
  ds_read_b64_tr_b16 a[246:247], v235 offset:3200
  v_mfma_f32_16x16x32_bf16 v[200:203], a[72:75], a[184:187], v[200:203]
  v_exp_f32 v163, v163
  v_mfma_f32_16x16x32_bf16 v[200:203], a[68:71], a[180:183], v[200:203]
  v_cvt_pk_bf16_f32 v161, v162, v163
  v_mfma_f32_16x16x32_bf16 v[200:203], a[64:67], a[176:179], v[200:203]
  s_waitcnt lgkmcnt(6)
  v_exp_f32 v164, v164
  v_mfma_f32_16x16x32_bf16 a[0:3], a[224:227], a[208:211], a[0:3]
  v_exp_f32 v165, v165
  v_mfma_f32_16x16x32_bf16 a[20:23], a[224:227], a[212:215], a[20:23]
  ds_read_b128 a[80:83], v243 offset:12288
  v_cvt_pk_bf16_f32 v162, v164, v165
  v_mfma_f32_16x16x32_bf16 a[40:43], a[224:227], a[216:219], a[40:43]
  v_exp_f32 v166, v166
  v_mfma_f32_16x16x32_bf16 a[60:63], a[224:227], a[220:223], a[60:63]
  ds_read_b128 a[84:87], v243 offset:13312
  v_mfma_f32_16x16x32_bf16 a[192:195], a[228:231], a[220:223], a[192:195]
  v_exp_f32 v167, v167
  v_mfma_f32_16x16x32_bf16 a[44:47], a[228:231], a[216:219], a[44:47]
  ds_read_b128 a[88:91], v243 offset:14336
  v_cvt_pk_bf16_f32 v163, v166, v167
  v_mfma_f32_16x16x32_bf16 a[24:27], a[228:231], a[212:215], a[24:27]
  v_exp_f32 v168, v168
  v_mfma_f32_16x16x32_bf16 a[4:7], a[228:231], a[208:211], a[4:7]
  s_waitcnt lgkmcnt(5)
  ds_read_b128 a[92:95], v243 offset:15360
  v_mfma_f32_16x16x32_bf16 a[8:11], a[236:239], a[208:211], a[8:11]
  v_cmp_gt_i32 s[76:77], 48, v241
  v_cmp_gt_i32 s[78:79], 49, v241
  v_mfma_f32_16x16x32_bf16 a[28:31], a[236:239], a[212:215], a[28:31]
  v_cmp_gt_i32 s[80:81], 50, v241
  v_cmp_gt_i32 s[82:83], 51, v241
  v_mfma_f32_16x16x32_bf16 a[48:51], a[236:239], a[216:219], a[48:51]
  v_cndmask_b32 v228, v208, v240, s[76:77]
  v_cndmask_b32 v229, v209, v240, s[78:79]
  v_mfma_f32_16x16x32_bf16 a[196:199], a[236:239], a[220:223], a[196:199]
  v_cndmask_b32 v230, v210, v240, s[80:81]
  v_cndmask_b32 v231, v211, v240, s[82:83]
  v_mfma_f32_16x16x32_bf16 a[200:203], a[240:243], a[220:223], a[200:203]
  v_exp_f32 v169, v169
  v_mfma_f32_16x16x32_bf16 a[52:55], a[240:243], a[216:219], a[52:55]
  v_cvt_pk_bf16_f32 v168, v168, v169
  v_mfma_f32_16x16x32_bf16 a[32:35], a[240:243], a[212:215], a[32:35]
  v_exp_f32 v170, v170
  v_mfma_f32_16x16x32_bf16 a[12:15], a[240:243], a[208:211], a[12:15]
  s_waitcnt lgkmcnt(4)
  v_exp_f32 v171, v171
  v_mfma_f32_16x16x32_bf16 a[16:19], a[244:247], a[208:211], a[16:19]
  s_mov_b32 m0, s62
  v_cvt_pk_bf16_f32 v169, v170, v171
  v_mfma_f32_16x16x32_bf16 a[36:39], a[244:247], a[212:215], a[36:39]
  ds_read_b128 a[96:99], v247 offset:0
  v_mfma_f32_16x16x32_bf16 a[56:59], a[244:247], a[216:219], a[56:59]
  buffer_load_dwordx4 v232, s[28:31], s58 offen offset:0 lds
  v_mfma_f32_16x16x32_bf16 a[204:207], a[244:247], a[220:223], a[204:207]
  s_waitcnt lgkmcnt(1)
  v_exp_f32 v172, v172
  v_mfma_f32_16x16x32_bf16 v[180:183], a[80:83], a[128:131], v[228:231]
  v_exp_f32 v173, v173
  v_mfma_f32_16x16x32_bf16 v[180:183], a[84:87], a[132:135], v[180:183]
  buffer_load_dwordx4 v233, s[28:31], s58 offen offset:1024 lds
  v_mfma_f32_16x16x32_bf16 v[180:183], a[88:91], a[136:139], v[180:183]
  ds_read_b128 a[100:103], v247 offset:1024
  v_cvt_pk_bf16_f32 v170, v172, v173
  v_mfma_f32_16x16x32_bf16 v[180:183], a[92:95], a[140:143], v[180:183]
  v_exp_f32 v174, v174
  v_mfma_f32_16x16x32_bf16 v[188:191], a[92:95], a[156:159], v[212:215]
  buffer_load_dwordx4 v234, s[28:31], s58 offen offset:2048 lds
  v_mfma_f32_16x16x32_bf16 v[188:191], a[88:91], a[152:155], v[188:191]
  s_add_u32 m0, s62, 3072
  ds_read_b128 a[104:107], v247 offset:2048
  s_add_u32 s58, s58, 20480
  v_mfma_f32_16x16x32_bf16 v[188:191], a[84:87], a[148:151], v[188:191]
  v_exp_f32 v175, v175
  v_mfma_f32_16x16x32_bf16 v[188:191], a[80:83], a[144:147], v[188:191]
  v_cvt_pk_bf16_f32 v171, v174, v175
  v_mfma_f32_16x16x32_bf16 v[196:199], a[80:83], a[160:163], v[216:219]
  v_mfma_f32_16x16x32_bf16 v[196:199], a[84:87], a[164:167], v[196:199]
  ds_read_b128 a[108:111], v247 offset:3072
  v_mfma_f32_16x16x32_bf16 v[196:199], a[88:91], a[168:171], v[196:199]
  v_exp_f32 v176, v176
  v_mfma_f32_16x16x32_bf16 v[196:199], a[92:95], a[172:175], v[196:199]
  buffer_load_dwordx4 v232, s[28:31], s58 offen offset:0 lds
  v_mfma_f32_16x16x32_bf16 v[204:207], a[92:95], a[188:191], v[220:223]
  v_exp_f32 v177, v177
  v_mfma_f32_16x16x32_bf16 v[204:207], a[88:91], a[184:187], v[204:207]
  ds_read_b128 a[112:115], v247 offset:4096
  v_cvt_pk_bf16_f32 v176, v176, v177
  v_mfma_f32_16x16x32_bf16 v[204:207], a[84:87], a[180:183], v[204:207]
  buffer_load_dwordx4 v233, s[28:31], s58 offen offset:1024 lds
  v_mfma_f32_16x16x32_bf16 v[204:207], a[80:83], a[176:179], v[204:207]
  s_waitcnt lgkmcnt(3)
  v_exp_f32 v178, v178
  v_mfma_f32_16x16x32_bf16 v[0:3], a[96:99], v[144:147], v[0:3]
  v_exp_f32 v179, v179
  v_mfma_f32_16x16x32_bf16 v[32:35], a[96:99], v[152:155], v[32:35]
  buffer_load_dwordx4 v234, s[28:31], s58 offen offset:2048 lds
  v_mfma_f32_16x16x32_bf16 v[64:67], a[96:99], v[160:163], v[64:67]
  s_add_u32 s58, s58, 20480
  ds_read_b128 a[116:119], v247 offset:5120
  v_cvt_pk_bf16_f32 v177, v178, v179
  v_mfma_f32_16x16x32_bf16 v[96:99], a[96:99], v[168:171], v[96:99]
  v_exp_f32 v180, v180
  v_mfma_f32_16x16x32_bf16 v[100:103], a[100:103], v[168:171], v[100:103]
  v_exp_f32 v181, v181
  v_mfma_f32_16x16x32_bf16 v[68:71], a[100:103], v[160:163], v[68:71]
  buffer_load_dwordx4 a[208:211], v248, s[4:7], s59 offen sc1
  v_mfma_f32_16x16x32_bf16 v[36:39], a[100:103], v[152:155], v[36:39]
  ds_read_b128 a[120:123], v247 offset:6144
  v_cvt_pk_bf16_f32 v178, v180, v181
  v_mfma_f32_16x16x32_bf16 v[4:7], a[100:103], v[144:147], v[4:7]
  s_waitcnt lgkmcnt(3)
  v_exp_f32 v182, v182
  v_mfma_f32_16x16x32_bf16 v[8:11], a[104:107], v[144:147], v[8:11]
  v_exp_f32 v183, v183
  v_mfma_f32_16x16x32_bf16 v[40:43], a[104:107], v[152:155], v[40:43]
  buffer_load_dwordx4 a[212:215], v248, s[20:23], s59 offen sc1
  v_mfma_f32_16x16x32_bf16 v[72:75], a[104:107], v[160:163], v[72:75]
  ds_read_b128 a[124:127], v247 offset:7168
  v_cvt_pk_bf16_f32 v179, v182, v183
  v_mfma_f32_16x16x32_bf16 v[104:107], a[104:107], v[168:171], v[104:107]
  v_exp_f32 v184, v184
  v_mfma_f32_16x16x32_bf16 v[108:111], a[108:111], v[168:171], v[108:111]
  buffer_load_dwordx4 a[216:219], v248, s[36:39], s59 offen sc1
  v_mfma_f32_16x16x32_bf16 v[76:79], a[108:111], v[160:163], v[76:79]
  v_exp_f32 v185, v185
  v_mfma_f32_16x16x32_bf16 v[44:47], a[108:111], v[152:155], v[44:47]
  v_exp_f32 v186, v186
  v_mfma_f32_16x16x32_bf16 v[12:15], a[108:111], v[144:147], v[12:15]
  s_waitcnt lgkmcnt(2)
  buffer_load_dwordx4 a[220:223], v248, s[40:43], s59 offen sc1
  v_mfma_f32_16x16x32_bf16 v[16:19], a[112:115], v[144:147], v[16:19]
  s_add_u32 s59, s59, 1024
  v_cvt_pk_bf16_f32 v184, v184, v185
  v_mfma_f32_16x16x32_bf16 v[48:51], a[112:115], v[152:155], v[48:51]
  v_add_u32 v243, 16384, v243
  v_and_b32 v243, 0xffff, v243
  v_mfma_f32_16x16x32_bf16 v[80:83], a[112:115], v[160:163], v[80:83]
  v_exp_f32 v187, v187
  v_mfma_f32_16x16x32_bf16 v[112:115], a[112:115], v[168:171], v[112:115]
  v_exp_f32 v188, v188
  v_mfma_f32_16x16x32_bf16 v[116:119], a[116:119], v[168:171], v[116:119]
  v_cvt_pk_bf16_f32 v185, v186, v187
  v_mfma_f32_16x16x32_bf16 v[84:87], a[116:119], v[160:163], v[84:87]
  v_exp_f32 v189, v189
  v_mfma_f32_16x16x32_bf16 v[52:55], a[116:119], v[152:155], v[52:55]
  v_exp_f32 v190, v190
  v_mfma_f32_16x16x32_bf16 v[20:23], a[116:119], v[144:147], v[20:23]
  s_waitcnt vmcnt(22) lgkmcnt(0)
  s_barrier
  v_mfma_f32_16x16x32_bf16 v[24:27], a[120:123], v[144:147], v[24:27]
  s_and_b32 s48, s55, 0xffff
  ds_read_b128 a[64:67], v243 offset:0
  v_cmp_gt_i32 s[76:77], 0, v242
  v_mfma_f32_16x16x32_bf16 v[56:59], a[120:123], v[152:155], v[56:59]
  s_add_u32 m0, s48, s60
  ds_read_b128 a[68:71], v243 offset:1024
  v_cmp_gt_i32 s[78:79], 1, v242
  v_mfma_f32_16x16x32_bf16 v[88:91], a[120:123], v[160:163], v[88:91]
  ds_read_b128 a[72:75], v243 offset:2048
  v_cmp_gt_i32 s[80:81], 2, v242
  v_mfma_f32_16x16x32_bf16 v[120:123], a[120:123], v[168:171], v[120:123]
  v_cmp_gt_i32 s[82:83], 3, v242
  v_cndmask_b32 v224, v212, v240, s[76:77]
  v_mfma_f32_16x16x32_bf16 v[124:127], a[124:127], v[168:171], v[124:127]
  v_cndmask_b32 v225, v213, v240, s[78:79]
  v_cndmask_b32 v226, v214, v240, s[80:81]
  v_cndmask_b32 v227, v215, v240, s[82:83]
  v_mfma_f32_16x16x32_bf16 v[92:95], a[124:127], v[160:163], v[92:95]
  ds_read_b128 a[76:79], v243 offset:3072
  v_cvt_pk_bf16_f32 v186, v188, v189
  v_mfma_f32_16x16x32_bf16 v[60:63], a[124:127], v[152:155], v[60:63]
  buffer_load_dwordx4 v244, s[12:15], s55 offen offset:0 sc1 lds
  v_mfma_f32_16x16x32_bf16 v[28:31], a[124:127], v[144:147], v[28:31]
  v_exp_f32 v191, v191
  v_mfma_f32_16x16x32_bf16 v[128:131], a[232:235], v[144:147], v[128:131]
  v_exp_f32 v192, v192
  v_cvt_pk_bf16_f32 v187, v190, v191
  v_mfma_f32_16x16x32_bf16 v[132:135], a[232:235], v[152:155], v[132:135]
  buffer_load_dwordx4 v244, s[12:15], s55 offen offset:1024 sc1 lds
  v_mfma_f32_16x16x32_bf16 v[136:139], a[232:235], v[160:163], v[136:139]
  v_exp_f32 v193, v193
  v_mfma_f32_16x16x32_bf16 v[140:143], a[232:235], v[168:171], v[140:143]
  s_waitcnt lgkmcnt(0)
  v_exp_f32 v194, v194
  v_mfma_f32_16x16x32_bf16 v[152:155], a[64:67], a[144:147], v[224:227]
  buffer_load_dwordx4 v244, s[12:15], s55 offen offset:2048 sc1 lds
  v_cvt_pk_bf16_f32 v192, v192, v193
  v_mfma_f32_16x16x32_bf16 v[152:155], a[68:71], a[148:151], v[152:155]
  ds_read_b128 a[80:83], v243 offset:4096
  v_cmp_gt_i32 s[76:77], 16, v242
  v_mfma_f32_16x16x32_bf16 v[152:155], a[72:75], a[152:155], v[152:155]
  ds_read_b128 a[84:87], v243 offset:5120
  v_exp_f32 v195, v195
  v_mfma_f32_16x16x32_bf16 v[152:155], a[76:79], a[156:159], v[152:155]
  buffer_load_dwordx4 v244, s[12:15], s55 offen offset:3072 sc1 lds
  v_cvt_pk_bf16_f32 v193, v194, v195
  v_mfma_f32_16x16x32_bf16 v[160:163], a[76:79], a[172:175], v[216:219]
  s_add_u32 s55, s55, 16384
  ds_read_b128 a[88:91], v243 offset:6144
  v_exp_f32 v196, v196
  v_mfma_f32_16x16x32_bf16 v[160:163], a[72:75], a[168:171], v[160:163]
  s_and_b32 s48, s54, 0xffff
  v_cmp_gt_i32 s[78:79], 17, v242
  v_cmp_gt_i32 s[80:81], 18, v242
  v_cmp_gt_i32 s[82:83], 19, v242
  v_mfma_f32_16x16x32_bf16 v[160:163], a[68:71], a[164:167], v[160:163]
  s_add_u32 m0, s48, s50
  v_cndmask_b32 v228, v212, v240, s[76:77]
  v_cndmask_b32 v229, v213, v240, s[78:79]
  v_cndmask_b32 v230, v214, v240, s[80:81]
  v_mfma_f32_16x16x32_bf16 v[160:163], a[64:67], a[160:163], v[160:163]
  ds_read_b128 a[92:95], v243 offset:7168
  v_cndmask_b32 v231, v215, v240, s[82:83]
  v_mfma_f32_16x16x32_bf16 v[168:171], a[64:67], a[176:179], v[220:223]
  v_exp_f32 v197, v197
  v_mfma_f32_16x16x32_bf16 v[168:171], a[68:71], a[180:183], v[168:171]
  v_exp_f32 v198, v198
  v_cvt_pk_bf16_f32 v194, v196, v197
  v_mfma_f32_16x16x32_bf16 v[168:171], a[72:75], a[184:187], v[168:171]
  v_exp_f32 v199, v199
  v_mfma_f32_16x16x32_bf16 v[168:171], a[76:79], a[188:191], v[168:171]
  s_waitcnt lgkmcnt(0)
  buffer_load_dwordx4 v244, s[8:11], s54 offen offset:0 sc1 lds
  v_cvt_pk_bf16_f32 v195, v198, v199
  v_mfma_f32_16x16x32_bf16 v[156:159], a[80:83], a[144:147], v[228:231]
  ds_read_b128 a[96:99], v247 offset:8192
  v_exp_f32 v200, v200
  v_mfma_f32_16x16x32_bf16 v[156:159], a[84:87], a[148:151], v[156:159]
  v_exp_f32 v201, v201
  v_mfma_f32_16x16x32_bf16 v[156:159], a[88:91], a[152:155], v[156:159]
  buffer_load_dwordx4 v244, s[8:11], s54 offen offset:1024 sc1 lds
  v_cvt_pk_bf16_f32 v200, v200, v201
  v_mfma_f32_16x16x32_bf16 v[156:159], a[92:95], a[156:159], v[156:159]
  v_exp_f32 v202, v202
  v_mfma_f32_16x16x32_bf16 v[164:167], a[92:95], a[172:175], v[216:219]
  buffer_load_dwordx4 v244, s[8:11], s54 offen offset:2048 sc1 lds
  v_mfma_f32_16x16x32_bf16 v[164:167], a[88:91], a[168:171], v[164:167]
  ds_read_b128 a[100:103], v247 offset:9216
  v_exp_f32 v203, v203
  v_mfma_f32_16x16x32_bf16 v[164:167], a[84:87], a[164:167], v[164:167]
  buffer_load_dwordx4 v244, s[8:11], s54 offen offset:3072 sc1 lds
  v_cvt_pk_bf16_f32 v201, v202, v203
  v_mfma_f32_16x16x32_bf16 v[164:167], a[80:83], a[160:163], v[164:167]
  s_add_u32 s54, s54, 16384
  v_exp_f32 v204, v204
  v_mfma_f32_16x16x32_bf16 v[172:175], a[80:83], a[176:179], v[220:223]
  s_lshl_b32 s48, s45, 2
  ds_read_b128 a[104:107], v247 offset:10240
  v_exp_f32 v205, v205
  v_mfma_f32_16x16x32_bf16 v[172:175], a[84:87], a[180:183], v[172:175]
  s_add_u32 s48, s48, s46
  v_exp_f32 v206, v206
  v_cvt_pk_bf16_f32 v202, v204, v205
  v_mfma_f32_16x16x32_bf16 v[172:175], a[88:91], a[184:187], v[172:175]
  s_mul_i32 s48, s48, 20480
  v_exp_f32 v207, v207
  v_mfma_f32_16x16x32_bf16 v[172:175], a[92:95], a[188:191], v[172:175]
  s_waitcnt lgkmcnt(1)
  ds_read_b128 a[108:111], v247 offset:11264
  v_cvt_pk_bf16_f32 v203, v206, v207
  v_mfma_f32_16x16x32_bf16 v[0:3], a[96:99], v[176:179], v[0:3]
  s_mul_i32 s52, s46, 320
  s_sub_u32 s48, s48, s52
  s_add_u32 s48, s48, s61
  v_mfma_f32_16x16x32_bf16 v[32:35], a[96:99], v[184:187], v[32:35]
  v_exp_f32 v152, v152
  v_mfma_f32_16x16x32_bf16 v[64:67], a[96:99], v[192:195], v[64:67]
  ds_read_b128 a[112:115], v247 offset:12288
  v_min_u32 v250, 39, v249
  v_mfma_f32_16x16x32_bf16 v[96:99], a[96:99], v[200:203], v[96:99]
  v_exp_f32 v153, v153
  v_mfma_f32_16x16x32_bf16 v[100:103], a[100:103], v[200:203], v[100:103]
  v_lshlrev_b32 v250, 7, v250
  v_cvt_pk_bf16_f32 v152, v152, v153
  v_mfma_f32_16x16x32_bf16 v[68:71], a[100:103], v[192:195], v[68:71]
  v_exp_f32 v154, v154
  v_mfma_f32_16x16x32_bf16 v[36:39], a[100:103], v[184:187], v[36:39]
  buffer_load_dword v251, v250, s[24:27], s48 offen
  v_mfma_f32_16x16x32_bf16 v[4:7], a[100:103], v[176:179], v[4:7]
  s_waitcnt lgkmcnt(1)
  ds_read_b128 a[116:119], v247 offset:13312
  v_mfma_f32_16x16x32_bf16 v[8:11], a[104:107], v[176:179], v[8:11]
  v_exp_f32 v155, v155
  v_mfma_f32_16x16x32_bf16 v[40:43], a[104:107], v[184:187], v[40:43]
  s_getpc_b64 s[52:53]
recurrent_scan__compressed_kv_cla__dense_activation_silu__prompt_kernel_cp3:
  s_add_u32 s52, s52, recurrent_scan__compressed_kv_cla__dense_activation_silu__prompt_kernel_x-recurrent_scan__compressed_kv_cla__dense_activation_silu__prompt_kernel_cp3
  s_addc_u32 s53, s53, 0
  v_mfma_f32_16x16x32_bf16 v[72:75], a[104:107], v[192:195], v[72:75]
  s_lshr_b32 s48, s2, 3
  v_exp_f32 v156, v156
  v_cvt_pk_bf16_f32 v153, v154, v155
  v_mfma_f32_16x16x32_bf16 v[104:107], a[104:107], v[200:203], v[104:107]
  s_lshl_b32 s48, s48, 2
  ds_read_b128 a[120:123], v247 offset:14336
  s_add_u32 s48, s48, s3
  v_mfma_f32_16x16x32_bf16 v[108:111], a[108:111], v[200:203], v[108:111]
  s_mul_i32 s48, s48, 256
  v_exp_f32 v157, v157
  v_mfma_f32_16x16x32_bf16 v[76:79], a[108:111], v[192:195], v[76:79]
  ds_read_b128 a[124:127], v247 offset:15360
  v_cvt_pk_bf16_f32 v154, v156, v157
  v_mfma_f32_16x16x32_bf16 v[44:47], a[108:111], v[184:187], v[44:47]
  v_exp_f32 v158, v158
  v_mfma_f32_16x16x32_bf16 v[12:15], a[108:111], v[176:179], v[12:15]
  s_waitcnt lgkmcnt(2)
  v_add_u32 v247, 16384, v247
  v_and_or_b32 v247, v247, s57, v245
  v_mfma_f32_16x16x32_bf16 v[16:19], a[112:115], v[176:179], v[16:19]
  v_exp_f32 v159, v159
  v_mfma_f32_16x16x32_bf16 v[48:51], a[112:115], v[184:187], v[48:51]
  v_exp_f32 v160, v160
  v_mfma_f32_16x16x32_bf16 v[80:83], a[112:115], v[192:195], v[80:83]
  v_and_b32 v250, 1, v249
  v_cvt_pk_bf16_f32 v155, v158, v159
  v_mfma_f32_16x16x32_bf16 v[112:115], a[112:115], v[200:203], v[112:115]
  v_lshlrev_b32 v250, 7, v250
  v_add_u32 v250, s48, v250
  v_mfma_f32_16x16x32_bf16 v[116:119], a[116:119], v[200:203], v[116:119]
  v_exp_f32 v161, v161
  v_mfma_f32_16x16x32_bf16 v[84:87], a[116:119], v[192:195], v[84:87]
  v_exp_f32 v162, v162
  v_mfma_f32_16x16x32_bf16 v[52:55], a[116:119], v[184:187], v[52:55]
  v_min_u32 v250, recurrent_scan__compressed_kv_cla__dense_activation_silu__prompt_kernel_last-recurrent_scan__compressed_kv_cla__dense_activation_silu__prompt_kernel_x, v250
  v_cvt_pk_bf16_f32 v160, v160, v161
  v_mfma_f32_16x16x32_bf16 v[20:23], a[116:119], v[176:179], v[20:23]
  s_waitcnt lgkmcnt(0)
  ds_read_b128 a[64:67], v243 offset:8192
  v_mfma_f32_16x16x32_bf16 v[24:27], a[120:123], v[176:179], v[24:27]
  global_load_dword v251, v250, s[52:53]
  v_mfma_f32_16x16x32_bf16 v[56:59], a[120:123], v[184:187], v[56:59]
  ds_read_b128 a[68:71], v243 offset:9216
  v_mfma_f32_16x16x32_bf16 v[88:91], a[120:123], v[192:195], v[88:91]
  v_exp_f32 v163, v163
  v_mfma_f32_16x16x32_bf16 v[120:123], a[120:123], v[200:203], v[120:123]
  ds_read_b128 a[72:75], v243 offset:10240
  v_cvt_pk_bf16_f32 v161, v162, v163
  v_mfma_f32_16x16x32_bf16 v[124:127], a[124:127], v[200:203], v[124:127]
  v_exp_f32 v164, v164
  v_mfma_f32_16x16x32_bf16 v[92:95], a[124:127], v[192:195], v[92:95]
  ds_read_b128 a[76:79], v243 offset:11264
  v_mfma_f32_16x16x32_bf16 v[60:63], a[124:127], v[184:187], v[60:63]
  v_exp_f32 v165, v165
  v_mfma_f32_16x16x32_bf16 v[28:31], a[124:127], v[176:179], v[28:31]
  v_exp_f32 v166, v166
  v_mfma_f32_16x16x32_bf16 v[128:131], a[232:235], v[176:179], v[128:131]
  v_cvt_pk_bf16_f32 v162, v164, v165
  v_mfma_f32_16x16x32_bf16 v[132:135], a[232:235], v[184:187], v[132:135]
  v_exp_f32 v167, v167
  v_mfma_f32_16x16x32_bf16 v[136:139], a[232:235], v[192:195], v[136:139]
  v_cvt_pk_bf16_f32 v163, v166, v167
  v_mfma_f32_16x16x32_bf16 v[140:143], a[232:235], v[200:203], v[140:143]
recurrent_scan__compressed_kv_cla__dense_activation_silu__prompt_kernel_m2:
  s_cmp_eq_u32 s45, 7
  s_cbranch_scc0 recurrent_scan__compressed_kv_cla__dense_activation_silu__prompt_kernel_m2s
  v_cmp_gt_i32 s[76:77], 32, v242
  v_cmp_gt_i32 s[78:79], 33, v242
  v_cmp_gt_i32 s[80:81], 34, v242
  v_cmp_gt_i32 s[82:83], 35, v242
  v_cndmask_b32 v224, v212, v240, s[76:77]
  v_cndmask_b32 v225, v213, v240, s[78:79]
  v_cndmask_b32 v226, v214, v240, s[80:81]
  v_cndmask_b32 v227, v215, v240, s[82:83]
  s_waitcnt lgkmcnt(0)
  s_nop 0
  v_mfma_f32_16x16x32_bf16 v[184:187], a[64:67], a[144:147], v[224:227]
  s_waitcnt vmcnt(10)
  ds_read_b64_tr_b16 a[224:225], v235 offset:0
  v_mfma_f32_16x16x32_bf16 v[184:187], a[68:71], a[148:151], v[184:187]
  v_exp_f32 v168, v168
  v_mfma_f32_16x16x32_bf16 v[184:187], a[72:75], a[152:155], v[184:187]
  ds_read_b64_tr_b16 a[226:227], v235 offset:3072
  v_mfma_f32_16x16x32_bf16 v[184:187], a[76:79], a[156:159], v[184:187]
  ds_read_b64_tr_b16 a[228:229], v246 offset:32
  v_mfma_f32_16x16x32_bf16 v[192:195], a[76:79], a[172:175], v[216:219]
  ds_read_b64_tr_b16 a[230:231], v246 offset:3104
  v_mfma_f32_16x16x32_bf16 v[192:195], a[72:75], a[168:171], v[192:195]
  ds_read_b64_tr_b16 a[236:237], v235 offset:64
  v_mfma_f32_16x16x32_bf16 v[192:195], a[68:71], a[164:167], v[192:195]
  ds_read_b64_tr_b16 a[238:239], v235 offset:3136
  v_mfma_f32_16x16x32_bf16 v[192:195], a[64:67], a[160:163], v[192:195]
  v_exp_f32 v169, v169
  v_mfma_f32_16x16x32_bf16 v[200:203], a[64:67], a[176:179], v[220:223]
  ds_read_b64_tr_b16 a[240:241], v246 offset:96
  v_cvt_pk_bf16_f32 v168, v168, v169
  v_mfma_f32_16x16x32_bf16 v[200:203], a[68:71], a[180:183], v[200:203]
  ds_read_b64_tr_b16 a[242:243], v246 offset:3168
  v_mfma_f32_16x16x32_bf16 v[200:203], a[72:75], a[184:187], v[200:203]
  ds_read_b64_tr_b16 a[244:245], v235 offset:128
  v_mfma_f32_16x16x32_bf16 v[200:203], a[76:79], a[188:191], v[200:203]
  s_waitcnt lgkmcnt(5)
  ds_read_b64_tr_b16 a[246:247], v235 offset:3200
  v_mfma_f32_16x16x32_bf16 a[0:3], a[224:227], a[208:211], a[0:3]
  v_exp_f32 v170, v170
  v_mfma_f32_16x16x32_bf16 a[20:23], a[224:227], a[212:215], a[20:23]
  v_exp_f32 v171, v171
  v_mfma_f32_16x16x32_bf16 a[40:43], a[224:227], a[216:219], a[40:43]
  ds_read_b128 a[80:83], v243 offset:12288
  v_cvt_pk_bf16_f32 v169, v170, v171
  v_mfma_f32_16x16x32_bf16 a[60:63], a[224:227], a[220:223], a[60:63]
  ds_read_b128 a[84:87], v243 offset:13312
  v_mfma_f32_16x16x32_bf16 a[192:195], a[228:231], a[220:223], a[192:195]
  v_exp_f32 v172, v172
  v_mfma_f32_16x16x32_bf16 a[44:47], a[228:231], a[216:219], a[44:47]
  ds_read_b128 a[88:91], v243 offset:14336
  v_mfma_f32_16x16x32_bf16 a[24:27], a[228:231], a[212:215], a[24:27]
  v_exp_f32 v173, v173
  v_mfma_f32_16x16x32_bf16 a[4:7], a[228:231], a[208:211], a[4:7]
  s_waitcnt lgkmcnt(5)
  ds_read_b128 a[92:95], v243 offset:15360
  v_mfma_f32_16x16x32_bf16 a[8:11], a[236:239], a[208:211], a[8:11]
  v_cmp_gt_i32 s[76:77], 48, v242
  v_cmp_gt_i32 s[78:79], 49, v242
  v_mfma_f32_16x16x32_bf16 a[28:31], a[236:239], a[212:215], a[28:31]
  v_cmp_gt_i32 s[80:81], 50, v242
  v_cmp_gt_i32 s[82:83], 51, v242
  v_mfma_f32_16x16x32_bf16 a[48:51], a[236:239], a[216:219], a[48:51]
  v_cndmask_b32 v228, v212, v240, s[76:77]
  v_cndmask_b32 v229, v213, v240, s[78:79]
  v_mfma_f32_16x16x32_bf16 a[196:199], a[236:239], a[220:223], a[196:199]
  v_cndmask_b32 v230, v214, v240, s[80:81]
  v_cndmask_b32 v231, v215, v240, s[82:83]
  v_mfma_f32_16x16x32_bf16 a[200:203], a[240:243], a[220:223], a[200:203]
  v_cvt_pk_bf16_f32 v170, v172, v173
  v_mfma_f32_16x16x32_bf16 a[52:55], a[240:243], a[216:219], a[52:55]
  ds_read_b128 a[96:99], v247 offset:0
  v_mfma_f32_16x16x32_bf16 a[32:35], a[240:243], a[212:215], a[32:35]
  v_exp_f32 v174, v174
  v_mfma_f32_16x16x32_bf16 a[12:15], a[240:243], a[208:211], a[12:15]
  s_waitcnt lgkmcnt(5)
  v_mfma_f32_16x16x32_bf16 a[16:19], a[244:247], a[208:211], a[16:19]
  ds_read_b128 a[100:103], v247 offset:1024
  v_mfma_f32_16x16x32_bf16 a[36:39], a[244:247], a[212:215], a[36:39]
  v_exp_f32 v175, v175
  v_mfma_f32_16x16x32_bf16 a[56:59], a[244:247], a[216:219], a[56:59]
  v_cvt_pk_bf16_f32 v171, v174, v175
  v_mfma_f32_16x16x32_bf16 a[204:207], a[244:247], a[220:223], a[204:207]
  s_waitcnt lgkmcnt(2)
  ds_read_b128 a[104:107], v247 offset:2048
  v_mfma_f32_16x16x32_bf16 v[188:191], a[80:83], a[144:147], v[228:231]
  v_mfma_f32_16x16x32_bf16 v[188:191], a[84:87], a[148:151], v[188:191]
  v_mfma_f32_16x16x32_bf16 v[188:191], a[88:91], a[152:155], v[188:191]
  ds_read_b128 a[108:111], v247 offset:3072
  v_mfma_f32_16x16x32_bf16 v[188:191], a[92:95], a[156:159], v[188:191]
  v_mfma_f32_16x16x32_bf16 v[196:199], a[92:95], a[172:175], v[216:219]
  v_exp_f32 v184, v184
  v_mfma_f32_16x16x32_bf16 v[196:199], a[88:91], a[168:171], v[196:199]
  ds_read_b128 a[112:115], v247 offset:4096
  v_mfma_f32_16x16x32_bf16 v[196:199], a[84:87], a[164:167], v[196:199]
  v_exp_f32 v185, v185
  v_mfma_f32_16x16x32_bf16 v[196:199], a[80:83], a[160:163], v[196:199]
  v_mfma_f32_16x16x32_bf16 v[204:207], a[80:83], a[176:179], v[220:223]
  ds_read_b128 a[116:119], v247 offset:5120
  v_cvt_pk_bf16_f32 v184, v184, v185
  v_mfma_f32_16x16x32_bf16 v[204:207], a[84:87], a[180:183], v[204:207]
  v_exp_f32 v186, v186
  v_mfma_f32_16x16x32_bf16 v[204:207], a[88:91], a[184:187], v[204:207]
  v_exp_f32 v187, v187
  v_mfma_f32_16x16x32_bf16 v[204:207], a[92:95], a[188:191], v[204:207]
  s_waitcnt lgkmcnt(4)
  ds_read_b128 a[120:123], v247 offset:6144
  v_mfma_f32_16x16x32_bf16 v[32:35], a[96:99], v[152:155], v[32:35]
  v_cvt_pk_bf16_f32 v185, v186, v187
  v_mfma_f32_16x16x32_bf16 v[64:67], a[96:99], v[160:163], v[64:67]
  v_exp_f32 v188, v188
  v_mfma_f32_16x16x32_bf16 v[96:99], a[96:99], v[168:171], v[96:99]
  ds_read_b128 a[124:127], v247 offset:7168
  v_mfma_f32_16x16x32_bf16 v[100:103], a[100:103], v[168:171], v[100:103]
  v_exp_f32 v189, v189
  v_mfma_f32_16x16x32_bf16 v[68:71], a[100:103], v[160:163], v[68:71]
  v_mfma_f32_16x16x32_bf16 v[36:39], a[100:103], v[152:155], v[36:39]
  s_waitcnt lgkmcnt(4)
  v_exp_f32 v190, v190
  v_mfma_f32_16x16x32_bf16 v[40:43], a[104:107], v[152:155], v[40:43]
  v_cvt_pk_bf16_f32 v186, v188, v189
  v_mfma_f32_16x16x32_bf16 v[72:75], a[104:107], v[160:163], v[72:75]
  v_mfma_f32_16x16x32_bf16 v[104:107], a[104:107], v[168:171], v[104:107]
  v_add_u32 v243, 16384, v243
  v_and_b32 v243, 0xffff, v243
  v_mfma_f32_16x16x32_bf16 v[108:111], a[108:111], v[168:171], v[108:111]
  v_exp_f32 v191, v191
  v_mfma_f32_16x16x32_bf16 v[76:79], a[108:111], v[160:163], v[76:79]
  v_exp_f32 v192, v192
  v_mfma_f32_16x16x32_bf16 v[44:47], a[108:111], v[152:155], v[44:47]
  s_waitcnt lgkmcnt(2)
  v_cvt_pk_bf16_f32 v187, v190, v191
  v_mfma_f32_16x16x32_bf16 v[48:51], a[112:115], v[152:155], v[48:51]
  v_exp_f32 v193, v193
  v_mfma_f32_16x16x32_bf16 v[80:83], a[112:115], v[160:163], v[80:83]
  v_mfma_f32_16x16x32_bf16 v[112:115], a[112:115], v[168:171], v[112:115]
  s_waitcnt vmcnt(10) lgkmcnt(0)
  s_barrier
  ds_read_b128 a[64:67], v243 offset:0
  v_mfma_f32_16x16x32_bf16 v[116:119], a[116:119], v[168:171], v[116:119]
  s_and_b32 s48, s55, 0xffff
  ds_read_b128 a[68:71], v243 offset:1024
  v_cmp_gt_i32 s[76:77], 0, v241
  v_mfma_f32_16x16x32_bf16 v[84:87], a[116:119], v[160:163], v[84:87]
  s_add_u32 m0, s48, s60
  ds_read_b128 a[72:75], v243 offset:2048
  v_cmp_gt_i32 s[78:79], 1, v241
  v_mfma_f32_16x16x32_bf16 v[52:55], a[116:119], v[152:155], v[52:55]
  v_cmp_gt_i32 s[80:81], 2, v241
  v_cmp_gt_i32 s[82:83], 3, v241
  v_mfma_f32_16x16x32_bf16 v[56:59], a[120:123], v[152:155], v[56:59]
  v_cndmask_b32 v224, v216, v240, s[76:77]
  v_cndmask_b32 v225, v217, v240, s[78:79]
  v_mfma_f32_16x16x32_bf16 v[88:91], a[120:123], v[160:163], v[88:91]
  v_cndmask_b32 v226, v218, v240, s[80:81]
  v_cndmask_b32 v227, v219, v240, s[82:83]
  v_mfma_f32_16x16x32_bf16 v[120:123], a[120:123], v[168:171], v[120:123]
  ds_read_b128 a[76:79], v243 offset:3072
  v_cvt_pk_bf16_f32 v192, v192, v193
  v_mfma_f32_16x16x32_bf16 v[124:127], a[124:127], v[168:171], v[124:127]
  ds_read_b128 a[80:83], v243 offset:4096
  v_mfma_f32_16x16x32_bf16 v[92:95], a[124:127], v[160:163], v[92:95]
  buffer_load_dwordx4 v244, s[12:15], s55 offen offset:0 sc1 lds
  v_mfma_f32_16x16x32_bf16 v[60:63], a[124:127], v[152:155], v[60:63]
  ds_read_b128 a[84:87], v243 offset:5120
  v_cmp_gt_i32 s[76:77], 16, v241
  v_mfma_f32_16x16x32_bf16 v[132:135], a[232:235], v[152:155], v[132:135]
  v_exp_f32 v194, v194
  v_mfma_f32_16x16x32_bf16 v[136:139], a[232:235], v[160:163], v[136:139]
  ds_read_b128 a[88:91], v243 offset:6144
  v_cmp_gt_i32 s[78:79], 17, v241
  v_mfma_f32_16x16x32_bf16 v[140:143], a[232:235], v[168:171], v[140:143]
  s_waitcnt lgkmcnt(3)
  v_cmp_gt_i32 s[80:81], 18, v241
  v_cmp_gt_i32 s[82:83], 19, v241
  v_mfma_f32_16x16x32_bf16 v[144:147], a[64:67], a[160:163], v[224:227]
  v_cndmask_b32 v228, v216, v240, s[76:77]
  v_cndmask_b32 v229, v217, v240, s[78:79]
  v_cndmask_b32 v230, v218, v240, s[80:81]
  v_mfma_f32_16x16x32_bf16 v[144:147], a[68:71], a[164:167], v[144:147]
  ds_read_b128 a[92:95], v243 offset:7168
  v_cndmask_b32 v231, v219, v240, s[82:83]
  v_mfma_f32_16x16x32_bf16 v[144:147], a[72:75], a[168:171], v[144:147]
  buffer_load_dwordx4 v244, s[12:15], s55 offen offset:1024 sc1 lds
  v_mfma_f32_16x16x32_bf16 v[144:147], a[76:79], a[172:175], v[144:147]
  v_exp_f32 v195, v195
  v_mfma_f32_16x16x32_bf16 v[152:155], a[76:79], a[188:191], v[220:223]
  ds_read_b128 a[96:99], v243 offset:8192
  v_cvt_pk_bf16_f32 v193, v194, v195
  v_mfma_f32_16x16x32_bf16 v[152:155], a[72:75], a[184:187], v[152:155]
  v_exp_f32 v196, v196
  v_mfma_f32_16x16x32_bf16 v[152:155], a[68:71], a[180:183], v[152:155]
  ds_read_b128 a[100:103], v243 offset:9216
  v_cmp_gt_i32 s[76:77], 32, v241
  v_mfma_f32_16x16x32_bf16 v[152:155], a[64:67], a[176:179], v[152:155]
  s_waitcnt lgkmcnt(2)
  v_exp_f32 v197, v197
  v_mfma_f32_16x16x32_bf16 v[148:151], a[80:83], a[160:163], v[228:231]
  buffer_load_dwordx4 v244, s[12:15], s55 offen offset:2048 sc1 lds
  v_cvt_pk_bf16_f32 v194, v196, v197
  v_mfma_f32_16x16x32_bf16 v[148:151], a[84:87], a[164:167], v[148:151]
  ds_read_b128 a[104:107], v243 offset:10240
  v_cmp_gt_i32 s[78:79], 33, v241
  v_cmp_gt_i32 s[80:81], 34, v241
  v_mfma_f32_16x16x32_bf16 v[148:151], a[88:91], a[168:171], v[148:151]
  v_cmp_gt_i32 s[82:83], 35, v241
  v_cndmask_b32 v224, v216, v240, s[76:77]
  v_cndmask_b32 v225, v217, v240, s[78:79]
  v_mfma_f32_16x16x32_bf16 v[148:151], a[92:95], a[172:175], v[148:151]
  ds_read_b128 a[108:111], v243 offset:11264
  v_cndmask_b32 v226, v218, v240, s[80:81]
  v_cndmask_b32 v227, v219, v240, s[82:83]
  v_mfma_f32_16x16x32_bf16 v[156:159], a[92:95], a[188:191], v[220:223]
  ds_read_b128 a[112:115], v243 offset:12288
  v_exp_f32 v198, v198
  v_mfma_f32_16x16x32_bf16 v[156:159], a[88:91], a[184:187], v[156:159]
  v_exp_f32 v199, v199
  v_mfma_f32_16x16x32_bf16 v[156:159], a[84:87], a[180:183], v[156:159]
  buffer_load_dwordx4 v244, s[12:15], s55 offen offset:3072 sc1 lds
  v_cvt_pk_bf16_f32 v195, v198, v199
  v_mfma_f32_16x16x32_bf16 v[156:159], a[80:83], a[176:179], v[156:159]
  s_waitcnt lgkmcnt(1)
  ds_read_b128 a[116:119], v243 offset:13312
  v_exp_f32 v200, v200
  v_mfma_f32_16x16x32_bf16 v[160:163], a[96:99], a[160:163], v[224:227]
  s_add_u32 s55, s55, 16384
  ds_read_b128 a[120:123], v243 offset:14336
  v_exp_f32 v201, v201
  v_mfma_f32_16x16x32_bf16 v[160:163], a[100:103], a[164:167], v[160:163]
  s_and_b32 s48, s54, 0xffff
  v_cmp_gt_i32 s[76:77], 48, v241
  v_cmp_gt_i32 s[78:79], 49, v241
  v_cmp_gt_i32 s[80:81], 50, v241
  v_mfma_f32_16x16x32_bf16 v[160:163], a[104:107], a[168:171], v[160:163]
  v_cmp_gt_i32 s[82:83], 51, v241
  v_cndmask_b32 v228, v216, v240, s[76:77]
  v_cndmask_b32 v229, v217, v240, s[78:79]
  v_mfma_f32_16x16x32_bf16 v[160:163], a[108:111], a[172:175], v[160:163]
  v_cvt_pk_bf16_f32 v200, v200, v201
  v_cndmask_b32 v230, v218, v240, s[80:81]
  v_cndmask_b32 v231, v219, v240, s[82:83]
  v_mfma_f32_16x16x32_bf16 v[168:171], a[108:111], a[188:191], v[220:223]
  s_add_u32 m0, s48, s50
  ds_read_b128 a[124:127], v243 offset:15360
  v_exp_f32 v202, v202
  v_mfma_f32_16x16x32_bf16 v[168:171], a[104:107], a[184:187], v[168:171]
  ds_read_b128 a[64:67], v247 offset:8192
  v_exp_f32 v203, v203
  v_mfma_f32_16x16x32_bf16 v[168:171], a[100:103], a[180:183], v[168:171]
  v_exp_f32 v204, v204
  v_cvt_pk_bf16_f32 v201, v202, v203
  v_mfma_f32_16x16x32_bf16 v[168:171], a[96:99], a[176:179], v[168:171]
  s_waitcnt lgkmcnt(1)
  ds_read_b128 a[68:71], v247 offset:9216
  v_mfma_f32_16x16x32_bf16 v[164:167], a[112:115], a[160:163], v[228:231]
  v_exp_f32 v205, v205
  v_mfma_f32_16x16x32_bf16 v[164:167], a[116:119], a[164:167], v[164:167]
  buffer_load_dwordx4 v244, s[8:11], s54 offen offset:0 sc1 lds
  v_mfma_f32_16x16x32_bf16 v[164:167], a[120:123], a[168:171], v[164:167]
  ds_read_b128 a[72:75], v247 offset:10240
  v_cvt_pk_bf16_f32 v202, v204, v205
  v_mfma_f32_16x16x32_bf16 v[164:167], a[124:127], a[172:175], v[164:167]
  v_exp_f32 v206, v206
  v_mfma_f32_16x16x32_bf16 v[172:175], a[124:127], a[188:191], v[220:223]
  ds_read_b128 a[76:79], v247 offset:11264
  v_mfma_f32_16x16x32_bf16 v[172:175], a[120:123], a[184:187], v[172:175]
  v_exp_f32 v207, v207
  v_mfma_f32_16x16x32_bf16 v[172:175], a[116:119], a[180:183], v[172:175]
  ds_read_b128 a[80:83], v247 offset:12288
  v_cvt_pk_bf16_f32 v203, v206, v207
  v_mfma_f32_16x16x32_bf16 v[172:175], a[112:115], a[176:179], v[172:175]
  s_waitcnt lgkmcnt(3)
  buffer_load_dwordx4 v244, s[8:11], s54 offen offset:1024 sc1 lds
  v_mfma_f32_16x16x32_bf16 v[32:35], a[64:67], v[184:187], v[32:35]
  v_exp_f32 v144, v144
  v_mfma_f32_16x16x32_bf16 v[64:67], a[64:67], v[192:195], v[64:67]
  ds_read_b128 a[84:87], v247 offset:13312
  v_mfma_f32_16x16x32_bf16 v[96:99], a[64:67], v[200:203], v[96:99]
  v_exp_f32 v145, v145
  v_mfma_f32_16x16x32_bf16 v[100:103], a[68:71], v[200:203], v[100:103]
  v_exp_f32 v146, v146
  v_mfma_f32_16x16x32_bf16 v[68:71], a[68:71], v[192:195], v[68:71]
  buffer_load_dwordx4 v244, s[8:11], s54 offen offset:2048 sc1 lds
  v_mfma_f32_16x16x32_bf16 v[36:39], a[68:71], v[184:187], v[36:39]
  s_waitcnt lgkmcnt(2)
  v_exp_f32 v147, v147
  v_cvt_pk_bf16_f32 v144, v144, v145
  v_mfma_f32_16x16x32_bf16 v[40:43], a[72:75], v[184:187], v[40:43]
  ds_read_b128 a[88:91], v247 offset:14336
  v_cvt_pk_bf16_f32 v145, v146, v147
  v_mfma_f32_16x16x32_bf16 v[72:75], a[72:75], v[192:195], v[72:75]
  v_exp_f32 v148, v148
  v_mfma_f32_16x16x32_bf16 v[104:107], a[72:75], v[200:203], v[104:107]
  v_exp_f32 v149, v149
  v_mfma_f32_16x16x32_bf16 v[108:111], a[76:79], v[200:203], v[108:111]
  ds_read_b128 a[92:95], v247 offset:15360
  v_exp_f32 v150, v150
  v_mfma_f32_16x16x32_bf16 v[76:79], a[76:79], v[192:195], v[76:79]
  v_add_u32 v247, 16384, v247
  v_and_or_b32 v247, v247, s57, v245
  v_cvt_pk_bf16_f32 v146, v148, v149
  v_mfma_f32_16x16x32_bf16 v[44:47], a[76:79], v[184:187], v[44:47]
  s_waitcnt lgkmcnt(2)
  v_exp_f32 v151, v151
  v_mfma_f32_16x16x32_bf16 v[48:51], a[80:83], v[184:187], v[48:51]
  buffer_load_dwordx4 v244, s[8:11], s54 offen offset:3072 sc1 lds
  v_cvt_pk_bf16_f32 v147, v150, v151
  v_mfma_f32_16x16x32_bf16 v[80:83], a[80:83], v[192:195], v[80:83]
  s_add_u32 s54, s54, 16384
  v_exp_f32 v152, v152
  v_mfma_f32_16x16x32_bf16 v[112:115], a[80:83], v[200:203], v[112:115]
  v_exp_f32 v153, v153
  v_mfma_f32_16x16x32_bf16 v[116:119], a[84:87], v[200:203], v[116:119]
  v_exp_f32 v154, v154
  v_cvt_pk_bf16_f32 v152, v152, v153
  v_mfma_f32_16x16x32_bf16 v[84:87], a[84:87], v[192:195], v[84:87]
  ds_read_b128 a[96:99], v243 offset:16384
  v_exp_f32 v155, v155
  v_mfma_f32_16x16x32_bf16 v[52:55], a[84:87], v[184:187], v[52:55]
  s_waitcnt lgkmcnt(1)
  v_exp_f32 v156, v156
  v_cvt_pk_bf16_f32 v153, v154, v155
  v_mfma_f32_16x16x32_bf16 v[56:59], a[88:91], v[184:187], v[56:59]
  ds_read_b128 a[100:103], v243 offset:17408
  v_exp_f32 v157, v157
  v_mfma_f32_16x16x32_bf16 v[88:91], a[88:91], v[192:195], v[88:91]
  v_exp_f32 v158, v158
  v_cvt_pk_bf16_f32 v154, v156, v157
  v_mfma_f32_16x16x32_bf16 v[120:123], a[88:91], v[200:203], v[120:123]
  ds_read_b128 a[104:107], v243 offset:18432
  v_exp_f32 v159, v159
  v_mfma_f32_16x16x32_bf16 v[124:127], a[92:95], v[200:203], v[124:127]
  v_exp_f32 v160, v160
  v_cvt_pk_bf16_f32 v155, v158, v159
  v_mfma_f32_16x16x32_bf16 v[92:95], a[92:95], v[192:195], v[92:95]
  ds_read_b128 a[108:111], v243 offset:19456
  v_exp_f32 v161, v161
  v_mfma_f32_16x16x32_bf16 v[60:63], a[92:95], v[184:187], v[60:63]
  ds_read_b128 a[112:115], v243 offset:20480
  v_cvt_pk_bf16_f32 v160, v160, v161
  v_mfma_f32_16x16x32_bf16 v[132:135], a[232:235], v[184:187], v[132:135]
  ds_read_b128 a[116:119], v243 offset:21504
  v_exp_f32 v162, v162
  v_mfma_f32_16x16x32_bf16 v[136:139], a[232:235], v[192:195], v[136:139]
  ds_read_b128 a[120:123], v243 offset:22528
  v_exp_f32 v163, v163
  v_mfma_f32_16x16x32_bf16 v[140:143], a[232:235], v[200:203], v[140:143]
  ds_read_b128 a[124:127], v243 offset:23552
  v_exp_f32 v164, v164
  v_exp_f32 v165, v165
  v_exp_f32 v166, v166
  v_exp_f32 v167, v167
  v_cvt_pk_bf16_f32 v161, v162, v163
  v_cvt_pk_bf16_f32 v162, v164, v165
  v_cvt_pk_bf16_f32 v163, v166, v167
  s_mov_b32 s51, 0x21800000
  s_mov_b32 s52, 0x5f800000
  v_cmp_gt_f32 s[76:77], v128, s51
  v_cmp_lt_f32 s[78:79], v128, s52
  v_rcp_f32 v250, v128
  s_and_b64 s[86:87], s[86:87], s[76:77]
  s_and_b64 s[86:87], s[86:87], s[78:79]
  v_cmp_gt_f32 s[76:77], v132, s51
  v_cmp_lt_f32 s[78:79], v132, s52
  s_waitcnt vmcnt(8)
  v_rcp_f32 v251, v132
  s_and_b64 s[86:87], s[86:87], s[76:77]
  s_and_b64 s[86:87], s[86:87], s[78:79]
  s_cmp_eq_u64 s[86:87], -1
  s_cselect_b32 s63, 0, 0x10000000
  v_pk_mul_f32 v[0:1], v[0:1], v[250:251] op_sel_hi:[1,0]
  v_pk_mul_f32 v[2:3], v[2:3], v[250:251] op_sel_hi:[1,0]
  v_pk_mul_f32 v[4:5], v[4:5], v[250:251] op_sel_hi:[1,0]
  v_pk_mul_f32 v[6:7], v[6:7], v[250:251] op_sel_hi:[1,0]
  v_cvt_pk_bf16_f32 v0, v0, v1
  v_cvt_pk_bf16_f32 v1, v2, v3
  v_cvt_pk_bf16_f32 v2, v4, v5
  v_cvt_pk_bf16_f32 v3, v6, v7
  buffer_store_dwordx4 v[0:3], v236, s[16:19], 0 offen offset:0 sc1
  v_pk_mul_f32 v[8:9], v[8:9], v[250:251] op_sel_hi:[1,0]
  v_pk_mul_f32 v[10:11], v[10:11], v[250:251] op_sel_hi:[1,0]
  v_pk_mul_f32 v[12:13], v[12:13], v[250:251] op_sel_hi:[1,0]
  v_pk_mul_f32 v[14:15], v[14:15], v[250:251] op_sel_hi:[1,0]
  v_cvt_pk_bf16_f32 v8, v8, v9
  v_cvt_pk_bf16_f32 v9, v10, v11
  v_cvt_pk_bf16_f32 v10, v12, v13
  v_cvt_pk_bf16_f32 v11, v14, v15
  buffer_store_dwordx4 v[8:11], v236, s[16:19], 0 offen offset:1024 sc1
  v_pk_mul_f32 v[16:17], v[16:17], v[250:251] op_sel_hi:[1,0]
  v_pk_mul_f32 v[18:19], v[18:19], v[250:251] op_sel_hi:[1,0]
  v_pk_mul_f32 v[20:21], v[20:21], v[250:251] op_sel_hi:[1,0]
  v_pk_mul_f32 v[22:23], v[22:23], v[250:251] op_sel_hi:[1,0]
  v_cvt_pk_bf16_f32 v16, v16, v17
  v_cvt_pk_bf16_f32 v17, v18, v19
  v_cvt_pk_bf16_f32 v18, v20, v21
  v_cvt_pk_bf16_f32 v19, v22, v23
  buffer_store_dwordx4 v[16:19], v236, s[16:19], 0 offen offset:2048 sc1
  v_pk_mul_f32 v[24:25], v[24:25], v[250:251] op_sel_hi:[1,0]
  v_pk_mul_f32 v[26:27], v[26:27], v[250:251] op_sel_hi:[1,0]
  v_pk_mul_f32 v[28:29], v[28:29], v[250:251] op_sel_hi:[1,0]
  v_pk_mul_f32 v[30:31], v[30:31], v[250:251] op_sel_hi:[1,0]
  v_cvt_pk_bf16_f32 v24, v24, v25
  v_cvt_pk_bf16_f32 v25, v26, v27
  v_cvt_pk_bf16_f32 v26, v28, v29
  v_cvt_pk_bf16_f32 v27, v30, v31
  buffer_store_dwordx4 v[24:27], v236, s[16:19], 0 offen offset:3072 sc1
  v_pk_mul_f32 v[32:33], v[32:33], v[250:251] op_sel:[0,1] op_sel_hi:[1,1]
  v_pk_mul_f32 v[34:35], v[34:35], v[250:251] op_sel:[0,1] op_sel_hi:[1,1]
  v_pk_mul_f32 v[36:37], v[36:37], v[250:251] op_sel:[0,1] op_sel_hi:[1,1]
  v_pk_mul_f32 v[38:39], v[38:39], v[250:251] op_sel:[0,1] op_sel_hi:[1,1]
  v_cvt_pk_bf16_f32 v32, v32, v33
  v_cvt_pk_bf16_f32 v33, v34, v35
  v_cvt_pk_bf16_f32 v34, v36, v37
  v_cvt_pk_bf16_f32 v35, v38, v39
  buffer_store_dwordx4 v[32:35], v237, s[16:19], 0 offen offset:0 sc1
  v_pk_mul_f32 v[40:41], v[40:41], v[250:251] op_sel:[0,1] op_sel_hi:[1,1]
  v_pk_mul_f32 v[42:43], v[42:43], v[250:251] op_sel:[0,1] op_sel_hi:[1,1]
  v_pk_mul_f32 v[44:45], v[44:45], v[250:251] op_sel:[0,1] op_sel_hi:[1,1]
  v_pk_mul_f32 v[46:47], v[46:47], v[250:251] op_sel:[0,1] op_sel_hi:[1,1]
  v_cvt_pk_bf16_f32 v40, v40, v41
  v_cvt_pk_bf16_f32 v41, v42, v43
  v_cvt_pk_bf16_f32 v42, v44, v45
  v_cvt_pk_bf16_f32 v43, v46, v47
  buffer_store_dwordx4 v[40:43], v237, s[16:19], 0 offen offset:1024 sc1
  v_pk_mul_f32 v[48:49], v[48:49], v[250:251] op_sel:[0,1] op_sel_hi:[1,1]
  v_pk_mul_f32 v[50:51], v[50:51], v[250:251] op_sel:[0,1] op_sel_hi:[1,1]
  v_pk_mul_f32 v[52:53], v[52:53], v[250:251] op_sel:[0,1] op_sel_hi:[1,1]
  v_pk_mul_f32 v[54:55], v[54:55], v[250:251] op_sel:[0,1] op_sel_hi:[1,1]
  v_cvt_pk_bf16_f32 v48, v48, v49
  v_cvt_pk_bf16_f32 v49, v50, v51
  v_cvt_pk_bf16_f32 v50, v52, v53
  v_cvt_pk_bf16_f32 v51, v54, v55
  buffer_store_dwordx4 v[48:51], v237, s[16:19], 0 offen offset:2048 sc1
  v_pk_mul_f32 v[56:57], v[56:57], v[250:251] op_sel:[0,1] op_sel_hi:[1,1]
  v_pk_mul_f32 v[58:59], v[58:59], v[250:251] op_sel:[0,1] op_sel_hi:[1,1]
  v_pk_mul_f32 v[60:61], v[60:61], v[250:251] op_sel:[0,1] op_sel_hi:[1,1]
  v_pk_mul_f32 v[62:63], v[62:63], v[250:251] op_sel:[0,1] op_sel_hi:[1,1]
  v_cvt_pk_bf16_f32 v56, v56, v57
  v_cvt_pk_bf16_f32 v57, v58, v59
  v_cvt_pk_bf16_f32 v58, v60, v61
  v_cvt_pk_bf16_f32 v59, v62, v63
  buffer_store_dwordx4 v[56:59], v237, s[16:19], 0 offen offset:3072 sc1
  s_branch recurrent_scan__compressed_kv_cla__dense_activation_silu__prompt_kernel_x
recurrent_scan__compressed_kv_cla__dense_activation_silu__prompt_kernel_m2s:
  v_cmp_gt_i32 s[76:77], 32, v242
  v_cmp_gt_i32 s[78:79], 33, v242
  v_cmp_gt_i32 s[80:81], 34, v242
  v_cmp_gt_i32 s[82:83], 35, v242
  v_cndmask_b32 v224, v212, v240, s[76:77]
  v_cndmask_b32 v225, v213, v240, s[78:79]
  v_cndmask_b32 v226, v214, v240, s[80:81]
  v_cndmask_b32 v227, v215, v240, s[82:83]
  s_waitcnt lgkmcnt(0)
  s_nop 0
  v_mfma_f32_16x16x32_bf16 v[184:187], a[64:67], a[144:147], v[224:227]
  s_waitcnt vmcnt(10)
  ds_read_b64_tr_b16 a[224:225], v235 offset:0
  v_mfma_f32_16x16x32_bf16 v[184:187], a[68:71], a[148:151], v[184:187]
  v_exp_f32 v168, v168
  v_mfma_f32_16x16x32_bf16 v[184:187], a[72:75], a[152:155], v[184:187]
  ds_read_b64_tr_b16 a[226:227], v235 offset:3072
  v_mfma_f32_16x16x32_bf16 v[184:187], a[76:79], a[156:159], v[184:187]
  ds_read_b64_tr_b16 a[228:229], v246 offset:32
  v_mfma_f32_16x16x32_bf16 v[192:195], a[76:79], a[172:175], v[216:219]
  ds_read_b64_tr_b16 a[230:231], v246 offset:3104
  v_mfma_f32_16x16x32_bf16 v[192:195], a[72:75], a[168:171], v[192:195]
  ds_read_b64_tr_b16 a[236:237], v235 offset:64
  v_mfma_f32_16x16x32_bf16 v[192:195], a[68:71], a[164:167], v[192:195]
  ds_read_b64_tr_b16 a[238:239], v235 offset:3136
  v_mfma_f32_16x16x32_bf16 v[192:195], a[64:67], a[160:163], v[192:195]
  v_exp_f32 v169, v169
  v_mfma_f32_16x16x32_bf16 v[200:203], a[64:67], a[176:179], v[220:223]
  ds_read_b64_tr_b16 a[240:241], v246 offset:96
  v_cvt_pk_bf16_f32 v168, v168, v169
  v_mfma_f32_16x16x32_bf16 v[200:203], a[68:71], a[180:183], v[200:203]
  ds_read_b64_tr_b16 a[242:243], v246 offset:3168
  v_mfma_f32_16x16x32_bf16 v[200:203], a[72:75], a[184:187], v[200:203]
  ds_read_b64_tr_b16 a[244:245], v235 offset:128
  v_mfma_f32_16x16x32_bf16 v[200:203], a[76:79], a[188:191], v[200:203]
  s_waitcnt lgkmcnt(5)
  ds_read_b64_tr_b16 a[246:247], v235 offset:3200
  v_mfma_f32_16x16x32_bf16 a[0:3], a[224:227], a[208:211], a[0:3]
  v_exp_f32 v170, v170
  v_mfma_f32_16x16x32_bf16 a[20:23], a[224:227], a[212:215], a[20:23]
  v_exp_f32 v171, v171
  v_mfma_f32_16x16x32_bf16 a[40:43], a[224:227], a[216:219], a[40:43]
  ds_read_b128 a[80:83], v243 offset:12288
  v_cvt_pk_bf16_f32 v169, v170, v171
  v_mfma_f32_16x16x32_bf16 a[60:63], a[224:227], a[220:223], a[60:63]
  ds_read_b128 a[84:87], v243 offset:13312
  v_mfma_f32_16x16x32_bf16 a[192:195], a[228:231], a[220:223], a[192:195]
  v_exp_f32 v172, v172
  v_mfma_f32_16x16x32_bf16 a[44:47], a[228:231], a[216:219], a[44:47]
  ds_read_b128 a[88:91], v243 offset:14336
  v_mfma_f32_16x16x32_bf16 a[24:27], a[228:231], a[212:215], a[24:27]
  v_exp_f32 v173, v173
  v_mfma_f32_16x16x32_bf16 a[4:7], a[228:231], a[208:211], a[4:7]
  s_waitcnt lgkmcnt(5)
  ds_read_b128 a[92:95], v243 offset:15360
  v_mfma_f32_16x16x32_bf16 a[8:11], a[236:239], a[208:211], a[8:11]
  v_cmp_gt_i32 s[76:77], 48, v242
  v_cmp_gt_i32 s[78:79], 49, v242
  v_mfma_f32_16x16x32_bf16 a[28:31], a[236:239], a[212:215], a[28:31]
  v_cmp_gt_i32 s[80:81], 50, v242
  v_cmp_gt_i32 s[82:83], 51, v242
  v_mfma_f32_16x16x32_bf16 a[48:51], a[236:239], a[216:219], a[48:51]
  v_cndmask_b32 v228, v212, v240, s[76:77]
  v_cndmask_b32 v229, v213, v240, s[78:79]
  v_mfma_f32_16x16x32_bf16 a[196:199], a[236:239], a[220:223], a[196:199]
  v_cndmask_b32 v230, v214, v240, s[80:81]
  v_cndmask_b32 v231, v215, v240, s[82:83]
  v_mfma_f32_16x16x32_bf16 a[200:203], a[240:243], a[220:223], a[200:203]
  v_cvt_pk_bf16_f32 v170, v172, v173
  v_mfma_f32_16x16x32_bf16 a[52:55], a[240:243], a[216:219], a[52:55]
  ds_read_b128 a[96:99], v247 offset:0
  v_mfma_f32_16x16x32_bf16 a[32:35], a[240:243], a[212:215], a[32:35]
  v_exp_f32 v174, v174
  v_mfma_f32_16x16x32_bf16 a[12:15], a[240:243], a[208:211], a[12:15]
  s_waitcnt lgkmcnt(5)
  v_mfma_f32_16x16x32_bf16 a[16:19], a[244:247], a[208:211], a[16:19]
  s_mov_b32 m0, s62
  ds_read_b128 a[100:103], v247 offset:1024
  v_mfma_f32_16x16x32_bf16 a[36:39], a[244:247], a[212:215], a[36:39]
  v_exp_f32 v175, v175
  v_mfma_f32_16x16x32_bf16 a[56:59], a[244:247], a[216:219], a[56:59]
  buffer_load_dwordx4 v232, s[28:31], s58 offen offset:0 lds
  v_mfma_f32_16x16x32_bf16 a[204:207], a[244:247], a[220:223], a[204:207]
  s_waitcnt lgkmcnt(2)
  ds_read_b128 a[104:107], v247 offset:2048
  v_cvt_pk_bf16_f32 v171, v174, v175
  v_mfma_f32_16x16x32_bf16 v[188:191], a[80:83], a[144:147], v[228:231]
  buffer_load_dwordx4 v233, s[28:31], s58 offen offset:1024 lds
  v_mfma_f32_16x16x32_bf16 v[188:191], a[84:87], a[148:151], v[188:191]
  v_mfma_f32_16x16x32_bf16 v[188:191], a[88:91], a[152:155], v[188:191]
  buffer_load_dwordx4 v234, s[28:31], s58 offen offset:2048 lds
  v_mfma_f32_16x16x32_bf16 v[188:191], a[92:95], a[156:159], v[188:191]
  s_add_u32 m0, s62, 3072
  ds_read_b128 a[108:111], v247 offset:3072
  s_add_u32 s58, s58, 20480
  v_mfma_f32_16x16x32_bf16 v[196:199], a[92:95], a[172:175], v[216:219]
  v_exp_f32 v184, v184
  v_mfma_f32_16x16x32_bf16 v[196:199], a[88:91], a[168:171], v[196:199]
  ds_read_b128 a[112:115], v247 offset:4096
  v_mfma_f32_16x16x32_bf16 v[196:199], a[84:87], a[164:167], v[196:199]
  buffer_load_dwordx4 v232, s[28:31], s58 offen offset:0 lds
  v_mfma_f32_16x16x32_bf16 v[196:199], a[80:83], a[160:163], v[196:199]
  v_exp_f32 v185, v185
  v_mfma_f32_16x16x32_bf16 v[204:207], a[80:83], a[176:179], v[220:223]
  buffer_load_dwordx4 v233, s[28:31], s58 offen offset:1024 lds
  v_mfma_f32_16x16x32_bf16 v[204:207], a[84:87], a[180:183], v[204:207]
  ds_read_b128 a[116:119], v247 offset:5120
  v_cvt_pk_bf16_f32 v184, v184, v185
  v_mfma_f32_16x16x32_bf16 v[204:207], a[88:91], a[184:187], v[204:207]
  buffer_load_dwordx4 v234, s[28:31], s58 offen offset:2048 lds
  v_mfma_f32_16x16x32_bf16 v[204:207], a[92:95], a[188:191], v[204:207]
  s_waitcnt lgkmcnt(4)
  ds_read_b128 a[120:123], v247 offset:6144
  s_add_u32 s58, s58, 20480
  v_mfma_f32_16x16x32_bf16 v[32:35], a[96:99], v[152:155], v[32:35]
  v_exp_f32 v186, v186
  v_mfma_f32_16x16x32_bf16 v[64:67], a[96:99], v[160:163], v[64:67]
  buffer_load_dwordx4 a[208:211], v248, s[4:7], s59 offen sc1
  v_mfma_f32_16x16x32_bf16 v[96:99], a[96:99], v[168:171], v[96:99]
  ds_read_b128 a[124:127], v247 offset:7168
  v_mfma_f32_16x16x32_bf16 v[100:103], a[100:103], v[168:171], v[100:103]
  buffer_load_dwordx4 a[212:215], v248, s[20:23], s59 offen sc1
  v_mfma_f32_16x16x32_bf16 v[68:71], a[100:103], v[160:163], v[68:71]
  v_exp_f32 v187, v187
  v_mfma_f32_16x16x32_bf16 v[36:39], a[100:103], v[152:155], v[36:39]
  s_waitcnt lgkmcnt(4)
  buffer_load_dwordx4 a[216:219], v248, s[36:39], s59 offen sc1
  v_mfma_f32_16x16x32_bf16 v[40:43], a[104:107], v[152:155], v[40:43]
  v_cvt_pk_bf16_f32 v185, v186, v187
  v_mfma_f32_16x16x32_bf16 v[72:75], a[104:107], v[160:163], v[72:75]
  buffer_load_dwordx4 a[220:223], v248, s[40:43], s59 offen sc1
  v_mfma_f32_16x16x32_bf16 v[104:107], a[104:107], v[168:171], v[104:107]
  s_add_u32 s59, s59, 1024
  v_add_u32 v243, 16384, v243
  v_and_b32 v243, 0xffff, v243
  v_mfma_f32_16x16x32_bf16 v[108:111], a[108:111], v[168:171], v[108:111]
  v_exp_f32 v188, v188
  v_mfma_f32_16x16x32_bf16 v[76:79], a[108:111], v[160:163], v[76:79]
  v_exp_f32 v189, v189
  v_mfma_f32_16x16x32_bf16 v[44:47], a[108:111], v[152:155], v[44:47]
  s_waitcnt lgkmcnt(2)
  v_exp_f32 v190, v190
  v_mfma_f32_16x16x32_bf16 v[48:51], a[112:115], v[152:155], v[48:51]
  v_cvt_pk_bf16_f32 v186, v188, v189
  v_mfma_f32_16x16x32_bf16 v[80:83], a[112:115], v[160:163], v[80:83]
  v_exp_f32 v191, v191
  v_mfma_f32_16x16x32_bf16 v[112:115], a[112:115], v[168:171], v[112:115]
  s_waitcnt vmcnt(20) lgkmcnt(0)
  s_barrier
  ds_read_b128 a[64:67], v243 offset:0
  v_mfma_f32_16x16x32_bf16 v[116:119], a[116:119], v[168:171], v[116:119]
  s_and_b32 s48, s55, 0xffff
  ds_read_b128 a[68:71], v243 offset:1024
  s_add_u32 m0, s48, s60
  v_mfma_f32_16x16x32_bf16 v[84:87], a[116:119], v[160:163], v[84:87]
  ds_read_b128 a[72:75], v243 offset:2048
  v_cvt_pk_bf16_f32 v187, v190, v191
  v_mfma_f32_16x16x32_bf16 v[52:55], a[116:119], v[152:155], v[52:55]
  ds_read_b128 a[76:79], v243 offset:3072
  v_mfma_f32_16x16x32_bf16 v[56:59], a[120:123], v[152:155], v[56:59]
  v_exp_f32 v192, v192
  v_mfma_f32_16x16x32_bf16 v[88:91], a[120:123], v[160:163], v[88:91]
  ds_read_b128 a[80:83], v243 offset:4096
  v_mfma_f32_16x16x32_bf16 v[120:123], a[120:123], v[168:171], v[120:123]
  buffer_load_dwordx4 v244, s[12:15], s55 offen offset:0 sc1 lds
  v_mfma_f32_16x16x32_bf16 v[124:127], a[124:127], v[168:171], v[124:127]
  v_exp_f32 v193, v193
  v_mfma_f32_16x16x32_bf16 v[92:95], a[124:127], v[160:163], v[92:95]
  ds_read_b128 a[84:87], v243 offset:5120
  v_cvt_pk_bf16_f32 v192, v192, v193
  v_mfma_f32_16x16x32_bf16 v[60:63], a[124:127], v[152:155], v[60:63]
  v_exp_f32 v194, v194
  v_mfma_f32_16x16x32_bf16 v[132:135], a[232:235], v[152:155], v[132:135]
  ds_read_b128 a[88:91], v243 offset:6144
  v_mfma_f32_16x16x32_bf16 v[136:139], a[232:235], v[160:163], v[136:139]
  buffer_load_dwordx4 v244, s[12:15], s55 offen offset:1024 sc1 lds
  v_mfma_f32_16x16x32_bf16 v[140:143], a[232:235], v[168:171], v[140:143]
  s_waitcnt lgkmcnt(3)
  ds_read_b128 a[92:95], v243 offset:7168
  v_mfma_f32_16x16x32_bf16 v[144:147], a[64:67], a[160:163], v[216:219]
  v_exp_f32 v195, v195
  v_mfma_f32_16x16x32_bf16 v[144:147], a[68:71], a[164:167], v[144:147]
  ds_read_b128 a[96:99], v243 offset:8192
  v_cvt_pk_bf16_f32 v193, v194, v195
  v_mfma_f32_16x16x32_bf16 v[144:147], a[72:75], a[168:171], v[144:147]
  v_exp_f32 v196, v196
  v_mfma_f32_16x16x32_bf16 v[144:147], a[76:79], a[172:175], v[144:147]
  ds_read_b128 a[100:103], v243 offset:9216
  v_mfma_f32_16x16x32_bf16 v[152:155], a[76:79], a[188:191], v[220:223]
  v_exp_f32 v197, v197
  v_mfma_f32_16x16x32_bf16 v[152:155], a[72:75], a[184:187], v[152:155]
  buffer_load_dwordx4 v244, s[12:15], s55 offen offset:2048 sc1 lds
  v_mfma_f32_16x16x32_bf16 v[152:155], a[68:71], a[180:183], v[152:155]
  ds_read_b128 a[104:107], v243 offset:10240
  v_cvt_pk_bf16_f32 v194, v196, v197
  v_mfma_f32_16x16x32_bf16 v[152:155], a[64:67], a[176:179], v[152:155]
  s_waitcnt lgkmcnt(3)
  v_exp_f32 v198, v198
  v_mfma_f32_16x16x32_bf16 v[148:151], a[80:83], a[160:163], v[216:219]
  ds_read_b128 a[108:111], v243 offset:11264
  v_mfma_f32_16x16x32_bf16 v[148:151], a[84:87], a[164:167], v[148:151]
  v_exp_f32 v199, v199
  v_mfma_f32_16x16x32_bf16 v[148:151], a[88:91], a[168:171], v[148:151]
  ds_read_b128 a[112:115], v243 offset:12288
  v_cvt_pk_bf16_f32 v195, v198, v199
  v_mfma_f32_16x16x32_bf16 v[148:151], a[92:95], a[172:175], v[148:151]
  buffer_load_dwordx4 v244, s[12:15], s55 offen offset:3072 sc1 lds
  v_mfma_f32_16x16x32_bf16 v[156:159], a[92:95], a[188:191], v[220:223]
  s_add_u32 s55, s55, 16384
  v_exp_f32 v200, v200
  v_mfma_f32_16x16x32_bf16 v[156:159], a[88:91], a[184:187], v[156:159]
  s_and_b32 s48, s54, 0xffff
  ds_read_b128 a[116:119], v243 offset:13312
  s_add_u32 m0, s48, s50
  v_mfma_f32_16x16x32_bf16 v[156:159], a[84:87], a[180:183], v[156:159]
  v_exp_f32 v201, v201
  v_mfma_f32_16x16x32_bf16 v[156:159], a[80:83], a[176:179], v[156:159]
  s_waitcnt lgkmcnt(2)
  ds_read_b128 a[120:123], v243 offset:14336
  v_cvt_pk_bf16_f32 v200, v200, v201
  v_mfma_f32_16x16x32_bf16 v[160:163], a[96:99], a[160:163], v[216:219]
  ds_read_b128 a[124:127], v243 offset:15360
  v_mfma_f32_16x16x32_bf16 v[160:163], a[100:103], a[164:167], v[160:163]
  v_exp_f32 v202, v202
  v_mfma_f32_16x16x32_bf16 v[160:163], a[104:107], a[168:171], v[160:163]
  ds_read_b128 a[64:67], v247 offset:8192
  v_mfma_f32_16x16x32_bf16 v[160:163], a[108:111], a[172:175], v[160:163]
  v_exp_f32 v203, v203
  v_mfma_f32_16x16x32_bf16 v[168:171], a[108:111], a[188:191], v[220:223]
  v_exp_f32 v204, v204
  v_mfma_f32_16x16x32_bf16 v[168:171], a[104:107], a[184:187], v[168:171]
  ds_read_b128 a[68:71], v247 offset:9216
  v_cvt_pk_bf16_f32 v201, v202, v203
  v_mfma_f32_16x16x32_bf16 v[168:171], a[100:103], a[180:183], v[168:171]
  v_exp_f32 v205, v205
  v_mfma_f32_16x16x32_bf16 v[168:171], a[96:99], a[176:179], v[168:171]
  s_waitcnt lgkmcnt(2)
  buffer_load_dwordx4 v244, s[8:11], s54 offen offset:0 sc1 lds
  v_mfma_f32_16x16x32_bf16 v[164:167], a[112:115], a[160:163], v[216:219]
  ds_read_b128 a[72:75], v247 offset:10240
  v_cvt_pk_bf16_f32 v202, v204, v205
  v_mfma_f32_16x16x32_bf16 v[164:167], a[116:119], a[164:167], v[164:167]
  v_exp_f32 v206, v206
  v_mfma_f32_16x16x32_bf16 v[164:167], a[120:123], a[168:171], v[164:167]
  ds_read_b128 a[76:79], v247 offset:11264
  v_mfma_f32_16x16x32_bf16 v[164:167], a[124:127], a[172:175], v[164:167]
  v_exp_f32 v207, v207
  v_mfma_f32_16x16x32_bf16 v[172:175], a[124:127], a[188:191], v[220:223]
  ds_read_b128 a[80:83], v247 offset:12288
  v_cvt_pk_bf16_f32 v203, v206, v207
  v_mfma_f32_16x16x32_bf16 v[172:175], a[120:123], a[184:187], v[172:175]
  buffer_load_dwordx4 v244, s[8:11], s54 offen offset:1024 sc1 lds
  v_mfma_f32_16x16x32_bf16 v[172:175], a[116:119], a[180:183], v[172:175]
  v_exp_f32 v144, v144
  v_mfma_f32_16x16x32_bf16 v[172:175], a[112:115], a[176:179], v[172:175]
  s_waitcnt lgkmcnt(3)
  ds_read_b128 a[84:87], v247 offset:13312
  v_mfma_f32_16x16x32_bf16 v[32:35], a[64:67], v[184:187], v[32:35]
  v_exp_f32 v145, v145
  v_mfma_f32_16x16x32_bf16 v[64:67], a[64:67], v[192:195], v[64:67]
  buffer_load_dwordx4 v244, s[8:11], s54 offen offset:2048 sc1 lds
  v_mfma_f32_16x16x32_bf16 v[96:99], a[64:67], v[200:203], v[96:99]
  ds_read_b128 a[88:91], v247 offset:14336
  v_cvt_pk_bf16_f32 v144, v144, v145
  v_mfma_f32_16x16x32_bf16 v[100:103], a[68:71], v[200:203], v[100:103]
  v_exp_f32 v146, v146
  v_mfma_f32_16x16x32_bf16 v[68:71], a[68:71], v[192:195], v[68:71]
  v_exp_f32 v147, v147
  v_mfma_f32_16x16x32_bf16 v[36:39], a[68:71], v[184:187], v[36:39]
  s_waitcnt lgkmcnt(3)
  ds_read_b128 a[92:95], v247 offset:15360
  v_add_u32 v247, 16384, v247
  v_mfma_f32_16x16x32_bf16 v[40:43], a[72:75], v[184:187], v[40:43]
  v_and_or_b32 v247, v247, s57, v245
  v_cvt_pk_bf16_f32 v145, v146, v147
  v_mfma_f32_16x16x32_bf16 v[72:75], a[72:75], v[192:195], v[72:75]
  buffer_load_dwordx4 v244, s[8:11], s54 offen offset:3072 sc1 lds
  v_mfma_f32_16x16x32_bf16 v[104:107], a[72:75], v[200:203], v[104:107]
  s_add_u32 s54, s54, 16384
  v_exp_f32 v148, v148
  v_mfma_f32_16x16x32_bf16 v[108:111], a[76:79], v[200:203], v[108:111]
  v_exp_f32 v149, v149
  v_mfma_f32_16x16x32_bf16 v[76:79], a[76:79], v[192:195], v[76:79]
  ds_read_b128 a[96:99], v243 offset:16384
  v_cvt_pk_bf16_f32 v146, v148, v149
  v_mfma_f32_16x16x32_bf16 v[44:47], a[76:79], v[184:187], v[44:47]
  s_waitcnt lgkmcnt(3)
  v_exp_f32 v150, v150
  v_mfma_f32_16x16x32_bf16 v[48:51], a[80:83], v[184:187], v[48:51]
  ds_read_b128 a[100:103], v243 offset:17408
  v_mfma_f32_16x16x32_bf16 v[80:83], a[80:83], v[192:195], v[80:83]
  v_exp_f32 v151, v151
  v_mfma_f32_16x16x32_bf16 v[112:115], a[80:83], v[200:203], v[112:115]
  ds_read_b128 a[104:107], v243 offset:18432
  v_cvt_pk_bf16_f32 v147, v150, v151
  v_mfma_f32_16x16x32_bf16 v[116:119], a[84:87], v[200:203], v[116:119]
  v_exp_f32 v152, v152
  v_mfma_f32_16x16x32_bf16 v[84:87], a[84:87], v[192:195], v[84:87]
  ds_read_b128 a[108:111], v243 offset:19456
  v_mfma_f32_16x16x32_bf16 v[52:55], a[84:87], v[184:187], v[52:55]
  s_waitcnt lgkmcnt(4)
  v_exp_f32 v153, v153
  v_mfma_f32_16x16x32_bf16 v[56:59], a[88:91], v[184:187], v[56:59]
  ds_read_b128 a[112:115], v243 offset:20480
  v_cvt_pk_bf16_f32 v152, v152, v153
  v_mfma_f32_16x16x32_bf16 v[88:91], a[88:91], v[192:195], v[88:91]
  v_exp_f32 v154, v154
  v_mfma_f32_16x16x32_bf16 v[120:123], a[88:91], v[200:203], v[120:123]
  ds_read_b128 a[116:119], v243 offset:21504
  v_mfma_f32_16x16x32_bf16 v[124:127], a[92:95], v[200:203], v[124:127]
  v_exp_f32 v155, v155
  v_mfma_f32_16x16x32_bf16 v[92:95], a[92:95], v[192:195], v[92:95]
  ds_read_b128 a[120:123], v243 offset:22528
  v_cvt_pk_bf16_f32 v153, v154, v155
  v_mfma_f32_16x16x32_bf16 v[60:63], a[92:95], v[184:187], v[60:63]
  ds_read_b128 a[124:127], v243 offset:23552
  v_mfma_f32_16x16x32_bf16 v[132:135], a[232:235], v[184:187], v[132:135]
  v_mfma_f32_16x16x32_bf16 v[136:139], a[232:235], v[192:195], v[136:139]
  v_mfma_f32_16x16x32_bf16 v[140:143], a[232:235], v[200:203], v[140:143]
recurrent_scan__compressed_kv_cla__dense_activation_silu__prompt_kernel_lo:
  s_mov_b32 s51, 0x21800000
  s_mov_b32 s52, 0x5f800000
  v_cmp_gt_f32 s[76:77], v128, s51
  v_cmp_lt_f32 s[78:79], v128, s52
  v_rcp_f32 v250, v128
  s_and_b64 s[86:87], s[86:87], s[76:77]
  s_and_b64 s[86:87], s[86:87], s[78:79]
  v_cmp_gt_f32 s[76:77], v132, s51
  v_cmp_lt_f32 s[78:79], v132, s52
  s_waitcnt vmcnt(18)
  v_rcp_f32 v251, v132
  s_and_b64 s[86:87], s[86:87], s[76:77]
  s_and_b64 s[86:87], s[86:87], s[78:79]
  s_cmp_eq_u64 s[86:87], -1
  s_cselect_b32 s63, 0, 0x10000000
  v_pk_mul_f32 v[0:1], v[0:1], v[250:251] op_sel_hi:[1,0]
  v_pk_mul_f32 v[2:3], v[2:3], v[250:251] op_sel_hi:[1,0]
  v_pk_mul_f32 v[4:5], v[4:5], v[250:251] op_sel_hi:[1,0]
  v_pk_mul_f32 v[6:7], v[6:7], v[250:251] op_sel_hi:[1,0]
  v_cvt_pk_bf16_f32 v0, v0, v1
  v_cvt_pk_bf16_f32 v1, v2, v3
  v_cvt_pk_bf16_f32 v2, v4, v5
  v_cvt_pk_bf16_f32 v3, v6, v7
  v_pk_mul_f32 v[8:9], v[8:9], v[250:251] op_sel_hi:[1,0]
  v_pk_mul_f32 v[10:11], v[10:11], v[250:251] op_sel_hi:[1,0]
  v_pk_mul_f32 v[12:13], v[12:13], v[250:251] op_sel_hi:[1,0]
  v_pk_mul_f32 v[14:15], v[14:15], v[250:251] op_sel_hi:[1,0]
  v_cvt_pk_bf16_f32 v8, v8, v9
  v_cvt_pk_bf16_f32 v9, v10, v11
  v_cvt_pk_bf16_f32 v10, v12, v13
  v_cvt_pk_bf16_f32 v11, v14, v15
  v_pk_mul_f32 v[16:17], v[16:17], v[250:251] op_sel_hi:[1,0]
  v_pk_mul_f32 v[18:19], v[18:19], v[250:251] op_sel_hi:[1,0]
  v_pk_mul_f32 v[20:21], v[20:21], v[250:251] op_sel_hi:[1,0]
  v_pk_mul_f32 v[22:23], v[22:23], v[250:251] op_sel_hi:[1,0]
  v_cvt_pk_bf16_f32 v16, v16, v17
  v_cvt_pk_bf16_f32 v17, v18, v19
  v_cvt_pk_bf16_f32 v18, v20, v21
  v_cvt_pk_bf16_f32 v19, v22, v23
  v_pk_mul_f32 v[24:25], v[24:25], v[250:251] op_sel_hi:[1,0]
  v_pk_mul_f32 v[26:27], v[26:27], v[250:251] op_sel_hi:[1,0]
  v_pk_mul_f32 v[28:29], v[28:29], v[250:251] op_sel_hi:[1,0]
  v_pk_mul_f32 v[30:31], v[30:31], v[250:251] op_sel_hi:[1,0]
  v_cvt_pk_bf16_f32 v24, v24, v25
  v_cvt_pk_bf16_f32 v25, v26, v27
  v_cvt_pk_bf16_f32 v26, v28, v29
  v_cvt_pk_bf16_f32 v27, v30, v31
  v_pk_mul_f32 v[32:33], v[32:33], v[250:251] op_sel:[0,1] op_sel_hi:[1,1]
  v_pk_mul_f32 v[34:35], v[34:35], v[250:251] op_sel:[0,1] op_sel_hi:[1,1]
  v_pk_mul_f32 v[36:37], v[36:37], v[250:251] op_sel:[0,1] op_sel_hi:[1,1]
  v_pk_mul_f32 v[38:39], v[38:39], v[250:251] op_sel:[0,1] op_sel_hi:[1,1]
  v_cvt_pk_bf16_f32 v32, v32, v33
  v_cvt_pk_bf16_f32 v33, v34, v35
  v_cvt_pk_bf16_f32 v34, v36, v37
  v_cvt_pk_bf16_f32 v35, v38, v39
  v_pk_mul_f32 v[40:41], v[40:41], v[250:251] op_sel:[0,1] op_sel_hi:[1,1]
  v_pk_mul_f32 v[42:43], v[42:43], v[250:251] op_sel:[0,1] op_sel_hi:[1,1]
  v_pk_mul_f32 v[44:45], v[44:45], v[250:251] op_sel:[0,1] op_sel_hi:[1,1]
  v_pk_mul_f32 v[46:47], v[46:47], v[250:251] op_sel:[0,1] op_sel_hi:[1,1]
  v_cvt_pk_bf16_f32 v40, v40, v41
  v_cvt_pk_bf16_f32 v41, v42, v43
  v_cvt_pk_bf16_f32 v42, v44, v45
  v_cvt_pk_bf16_f32 v43, v46, v47
  v_pk_mul_f32 v[48:49], v[48:49], v[250:251] op_sel:[0,1] op_sel_hi:[1,1]
  v_pk_mul_f32 v[50:51], v[50:51], v[250:251] op_sel:[0,1] op_sel_hi:[1,1]
  v_pk_mul_f32 v[52:53], v[52:53], v[250:251] op_sel:[0,1] op_sel_hi:[1,1]
  v_pk_mul_f32 v[54:55], v[54:55], v[250:251] op_sel:[0,1] op_sel_hi:[1,1]
  v_cvt_pk_bf16_f32 v48, v48, v49
  v_cvt_pk_bf16_f32 v49, v50, v51
  v_cvt_pk_bf16_f32 v50, v52, v53
  v_cvt_pk_bf16_f32 v51, v54, v55
  v_pk_mul_f32 v[56:57], v[56:57], v[250:251] op_sel:[0,1] op_sel_hi:[1,1]
  v_pk_mul_f32 v[58:59], v[58:59], v[250:251] op_sel:[0,1] op_sel_hi:[1,1]
  v_pk_mul_f32 v[60:61], v[60:61], v[250:251] op_sel:[0,1] op_sel_hi:[1,1]
  v_pk_mul_f32 v[62:63], v[62:63], v[250:251] op_sel:[0,1] op_sel_hi:[1,1]
  v_cvt_pk_bf16_f32 v56, v56, v57
  v_cvt_pk_bf16_f32 v57, v58, v59
  v_cvt_pk_bf16_f32 v58, v60, v61
  v_cvt_pk_bf16_f32 v59, v62, v63
  s_lshl_b32 s56, s45, 1
  s_sub_u32 s56, 11, s56
  s_and_b32 s52, s54, 0xffff
  s_add_u32 s52, s52, s50
  s_and_b32 s53, s55, 0xffff
  s_add_u32 s53, s53, s60
  s_mov_b32 s76, 0x8000
  s_mov_b32 s77, 0x8000
  v_add_u32 v250, 0x4000, v244
  v_add_u32 v251, 0x8000, v244
  s_waitcnt lgkmcnt(4)
  v_mfma_f32_16x16x32_bf16 v[176:179], a[96:99], a[160:163], v[216:219]
  buffer_store_dwordx4 v[0:3], v236, s[16:19], 0 offen offset:0 sc1
  v_mfma_f32_16x16x32_bf16 v[176:179], a[100:103], a[164:167], v[176:179]
  s_waitcnt vmcnt(9)
  ds_read_b64_tr_b16 a[224:225], v235 offset:0
  v_mfma_f32_16x16x32_bf16 v[176:179], a[104:107], a[168:171], v[176:179]
  v_exp_f32 v156, v156
  v_mfma_f32_16x16x32_bf16 v[176:179], a[108:111], a[172:175], v[176:179]
  ds_read_b64_tr_b16 a[226:227], v235 offset:3072
  v_mfma_f32_16x16x32_bf16 v[184:187], a[108:111], a[188:191], v[220:223]
  ds_read_b64_tr_b16 a[228:229], v246 offset:32
  ds_read_b64_tr_b16 a[230:231], v246 offset:3104
  v_mfma_f32_16x16x32_bf16 v[184:187], a[104:107], a[184:187], v[184:187]
  v_exp_f32 v157, v157
  v_mfma_f32_16x16x32_bf16 v[184:187], a[100:103], a[180:183], v[184:187]
  ds_read_b64_tr_b16 a[236:237], v235 offset:64
  v_cvt_pk_bf16_f32 v154, v156, v157
  v_mfma_f32_16x16x32_bf16 v[184:187], a[96:99], a[176:179], v[184:187]
  s_waitcnt lgkmcnt(1)
  buffer_store_dwordx4 v[8:11], v236, s[16:19], 0 offen offset:1024 sc1
  v_mfma_f32_16x16x32_bf16 a[0:3], a[224:227], a[208:211], a[0:3]
  ds_read_b64_tr_b16 a[238:239], v235 offset:3136
  v_mfma_f32_16x16x32_bf16 a[20:23], a[224:227], a[212:215], a[20:23]
  v_exp_f32 v158, v158
  v_mfma_f32_16x16x32_bf16 a[40:43], a[224:227], a[216:219], a[40:43]
  ds_read_b64_tr_b16 a[240:241], v246 offset:96
  v_mfma_f32_16x16x32_bf16 a[60:63], a[224:227], a[220:223], a[60:63]
  ds_read_b64_tr_b16 a[242:243], v246 offset:3168
  v_exp_f32 v159, v159
  v_mfma_f32_16x16x32_bf16 a[192:195], a[228:231], a[220:223], a[192:195]
  ds_read_b64_tr_b16 a[244:245], v235 offset:128
  v_cvt_pk_bf16_f32 v155, v158, v159
  v_mfma_f32_16x16x32_bf16 a[44:47], a[228:231], a[216:219], a[44:47]
  ds_read_b64_tr_b16 a[246:247], v235 offset:3200
  v_mfma_f32_16x16x32_bf16 a[24:27], a[228:231], a[212:215], a[24:27]
  v_exp_f32 v160, v160
  v_mfma_f32_16x16x32_bf16 a[4:7], a[228:231], a[208:211], a[4:7]
  s_waitcnt lgkmcnt(2)
  buffer_store_dwordx4 v[16:19], v236, s[16:19], 0 offen offset:2048 sc1
  v_mfma_f32_16x16x32_bf16 a[8:11], a[236:239], a[208:211], a[8:11]
  v_exp_f32 v161, v161
  v_mfma_f32_16x16x32_bf16 a[28:31], a[236:239], a[212:215], a[28:31]
  ds_read_b128 a[64:67], v243 offset:24576
  v_cvt_pk_bf16_f32 v160, v160, v161
  v_mfma_f32_16x16x32_bf16 a[48:51], a[236:239], a[216:219], a[48:51]
  v_exp_f32 v162, v162
  v_mfma_f32_16x16x32_bf16 a[196:199], a[236:239], a[220:223], a[196:199]
  buffer_store_dwordx4 v[24:27], v236, s[16:19], 0 offen offset:3072 sc1
  v_mfma_f32_16x16x32_bf16 a[200:203], a[240:243], a[220:223], a[200:203]
  v_exp_f32 v163, v163
  v_mfma_f32_16x16x32_bf16 a[52:55], a[240:243], a[216:219], a[52:55]
  ds_read_b128 a[68:71], v243 offset:25600
  v_cvt_pk_bf16_f32 v161, v162, v163
  v_mfma_f32_16x16x32_bf16 a[32:35], a[240:243], a[212:215], a[32:35]
  v_exp_f32 v164, v164
  v_mfma_f32_16x16x32_bf16 a[12:15], a[240:243], a[208:211], a[12:15]
  s_waitcnt lgkmcnt(2)
  v_exp_f32 v165, v165
  v_mfma_f32_16x16x32_bf16 a[16:19], a[244:247], a[208:211], a[16:19]
  s_mov_b32 m0, s62
  ds_read_b128 a[72:75], v243 offset:26624
  v_cvt_pk_bf16_f32 v162, v164, v165
  v_mfma_f32_16x16x32_bf16 a[36:39], a[244:247], a[212:215], a[36:39]
  v_exp_f32 v166, v166
  v_mfma_f32_16x16x32_bf16 a[56:59], a[244:247], a[216:219], a[56:59]
  buffer_load_dwordx4 v232, s[28:31], s58 offen offset:0 lds
  v_mfma_f32_16x16x32_bf16 a[204:207], a[244:247], a[220:223], a[204:207]
  ds_read_b128 a[76:79], v243 offset:27648
  v_mfma_f32_16x16x32_bf16 v[180:183], a[112:115], a[160:163], v[216:219]
  ds_read_b128 a[80:83], v243 offset:28672
  v_mfma_f32_16x16x32_bf16 v[180:183], a[116:119], a[164:167], v[180:183]
  v_exp_f32 v167, v167
  v_mfma_f32_16x16x32_bf16 v[180:183], a[120:123], a[168:171], v[180:183]
  buffer_load_dwordx4 v233, s[28:31], s58 offen offset:1024 lds
  v_mfma_f32_16x16x32_bf16 v[180:183], a[124:127], a[172:175], v[180:183]
  ds_read_b128 a[84:87], v243 offset:29696
  v_cvt_pk_bf16_f32 v163, v166, v167
  v_mfma_f32_16x16x32_bf16 v[188:191], a[124:127], a[188:191], v[220:223]
  v_exp_f32 v168, v168
  v_mfma_f32_16x16x32_bf16 v[188:191], a[120:123], a[184:187], v[188:191]
  buffer_store_dwordx4 v[32:35], v237, s[16:19], 0 offen offset:0 sc1
  v_mfma_f32_16x16x32_bf16 v[188:191], a[116:119], a[180:183], v[188:191]
  ds_read_b128 a[88:91], v243 offset:30720
  v_mfma_f32_16x16x32_bf16 v[188:191], a[112:115], a[176:179], v[188:191]
  s_waitcnt lgkmcnt(3)
  v_exp_f32 v169, v169
  v_mfma_f32_16x16x32_bf16 v[192:195], a[64:67], a[160:163], v[216:219]
  buffer_load_dwordx4 v234, s[28:31], s58 offen offset:2048 lds
  v_mfma_f32_16x16x32_bf16 v[192:195], a[68:71], a[164:167], v[192:195]
  s_add_u32 m0, s62, 3072
  ds_read_b128 a[92:95], v243 offset:31744
  v_cvt_pk_bf16_f32 v168, v168, v169
  v_mfma_f32_16x16x32_bf16 v[192:195], a[72:75], a[168:171], v[192:195]
  s_add_u32 s58, s58, 20480
  v_exp_f32 v170, v170
  v_mfma_f32_16x16x32_bf16 v[192:195], a[76:79], a[172:175], v[192:195]
  ds_read_b128 a[96:99], v247 offset:0
  v_mfma_f32_16x16x32_bf16 v[200:203], a[76:79], a[188:191], v[220:223]
  ds_read_b128 a[100:103], v247 offset:8192
  v_mfma_f32_16x16x32_bf16 v[200:203], a[72:75], a[184:187], v[200:203]
  v_exp_f32 v171, v171
  v_mfma_f32_16x16x32_bf16 v[200:203], a[68:71], a[180:183], v[200:203]
  ds_read_b128 a[104:107], v247 offset:1024
  v_cvt_pk_bf16_f32 v169, v170, v171
  v_mfma_f32_16x16x32_bf16 v[200:203], a[64:67], a[176:179], v[200:203]
  s_waitcnt lgkmcnt(3)
  ds_read_b128 a[108:111], v247 offset:9216
  v_mfma_f32_16x16x32_bf16 v[196:199], a[80:83], a[160:163], v[216:219]
  v_exp_f32 v172, v172
  v_mfma_f32_16x16x32_bf16 v[196:199], a[84:87], a[164:167], v[196:199]
  buffer_store_dwordx4 v[40:43], v237, s[16:19], 0 offen offset:1024 sc1
  v_mfma_f32_16x16x32_bf16 v[196:199], a[88:91], a[168:171], v[196:199]
  buffer_load_dwordx4 v232, s[28:31], s58 offen offset:0 lds
  v_mfma_f32_16x16x32_bf16 v[196:199], a[92:95], a[172:175], v[196:199]
  v_exp_f32 v173, v173
  v_mfma_f32_16x16x32_bf16 v[204:207], a[92:95], a[188:191], v[220:223]
  ds_read_b128 a[112:115], v247 offset:2048
  v_cvt_pk_bf16_f32 v170, v172, v173
  v_mfma_f32_16x16x32_bf16 v[204:207], a[88:91], a[184:187], v[204:207]
  ds_read_b128 a[116:119], v247 offset:10240
  v_exp_f32 v174, v174
  v_mfma_f32_16x16x32_bf16 v[204:207], a[84:87], a[180:183], v[204:207]
  buffer_load_dwordx4 v233, s[28:31], s58 offen offset:1024 lds
  v_mfma_f32_16x16x32_bf16 v[204:207], a[80:83], a[176:179], v[204:207]
  s_waitcnt lgkmcnt(2)
  ds_read_b128 a[120:123], v247 offset:3072
  v_mfma_f32_16x16x32_bf16 v[64:67], a[96:99], v[144:147], v[64:67]
  v_exp_f32 v175, v175
  s_nop 0
  v_cvt_pk_bf16_f32 v171, v174, v175
  v_mfma_f32_16x16x32_bf16 v[64:67], a[100:103], v[160:163], v[64:67]
  ds_read_b128 a[124:127], v247 offset:11264
  v_mfma_f32_16x16x32_bf16 v[96:99], a[100:103], v[168:171], v[96:99]
  buffer_load_dwordx4 v234, s[28:31], s58 offen offset:2048 lds
  v_mfma_f32_16x16x32_bf16 v[96:99], a[96:99], v[152:155], v[96:99]
  s_add_u32 s58, s58, 20480
  buffer_store_dwordx4 v[48:51], v237, s[16:19], 0 offen offset:2048 sc1
  v_mfma_f32_16x16x32_bf16 v[68:71], a[104:107], v[144:147], v[68:71]
  ds_read_b128 a[64:67], v247 offset:4096
  v_mfma_f32_16x16x32_bf16 v[68:71], a[108:111], v[160:163], v[68:71]
  ds_read_b128 a[68:71], v247 offset:12288
  v_exp_f32 v176, v176
  v_mfma_f32_16x16x32_bf16 v[100:103], a[108:111], v[168:171], v[100:103]
  v_exp_f32 v177, v177
  v_mfma_f32_16x16x32_bf16 v[100:103], a[104:107], v[152:155], v[100:103]
  s_waitcnt lgkmcnt(2)
  buffer_load_dwordx4 a[208:211], v248, s[4:7], s59 offen sc1
  v_mfma_f32_16x16x32_bf16 v[72:75], a[112:115], v[144:147], v[72:75]
  ds_read_b128 a[72:75], v247 offset:5120
  v_cvt_pk_bf16_f32 v176, v176, v177
  v_mfma_f32_16x16x32_bf16 v[72:75], a[116:119], v[160:163], v[72:75]
  ds_read_b128 a[76:79], v247 offset:13312
  v_exp_f32 v178, v178
  v_mfma_f32_16x16x32_bf16 v[104:107], a[116:119], v[168:171], v[104:107]
  buffer_load_dwordx4 a[212:215], v248, s[20:23], s59 offen sc1
  v_mfma_f32_16x16x32_bf16 v[104:107], a[112:115], v[152:155], v[104:107]
  v_exp_f32 v179, v179
  v_mfma_f32_16x16x32_bf16 v[76:79], a[120:123], v[144:147], v[76:79]
  ds_read_b128 a[80:83], v247 offset:6144
  v_cvt_pk_bf16_f32 v177, v178, v179
  v_mfma_f32_16x16x32_bf16 v[76:79], a[124:127], v[160:163], v[76:79]
  ds_read_b128 a[84:87], v247 offset:14336
  v_exp_f32 v180, v180
  v_mfma_f32_16x16x32_bf16 v[108:111], a[124:127], v[168:171], v[108:111]
  buffer_store_dwordx4 v[56:59], v237, s[16:19], 0 offen offset:3072 sc1
  v_mfma_f32_16x16x32_bf16 v[108:111], a[120:123], v[152:155], v[108:111]
  s_waitcnt lgkmcnt(2)
  buffer_load_dwordx4 a[216:219], v248, s[36:39], s59 offen sc1
  v_mfma_f32_16x16x32_bf16 v[80:83], a[64:67], v[144:147], v[80:83]
  ds_read_b128 a[88:91], v247 offset:7168
  v_exp_f32 v181, v181
  v_mfma_f32_16x16x32_bf16 v[80:83], a[68:71], v[160:163], v[80:83]
  ds_read_b128 a[92:95], v247 offset:15360
  v_cvt_pk_bf16_f32 v178, v180, v181
  v_mfma_f32_16x16x32_bf16 v[112:115], a[68:71], v[168:171], v[112:115]
  v_exp_f32 v182, v182
  v_mfma_f32_16x16x32_bf16 v[112:115], a[64:67], v[152:155], v[112:115]
  buffer_load_dwordx4 a[220:223], v248, s[40:43], s59 offen sc1
  v_mfma_f32_16x16x32_bf16 v[84:87], a[72:75], v[144:147], v[84:87]
  s_add_u32 s59, s59, 1024
  v_exp_f32 v183, v183
  v_mfma_f32_16x16x32_bf16 v[84:87], a[76:79], v[160:163], v[84:87]
  v_exp_f32 v184, v184
  v_cvt_pk_bf16_f32 v179, v182, v183
  v_mfma_f32_16x16x32_bf16 v[116:119], a[76:79], v[168:171], v[116:119]
  v_xor_b32 v243, 0x8000, v243
  v_exp_f32 v185, v185
  v_mfma_f32_16x16x32_bf16 v[116:119], a[72:75], v[152:155], v[116:119]
  s_waitcnt vmcnt(18) lgkmcnt(0)
  s_barrier
  v_mfma_f32_16x16x32_bf16 v[88:91], a[80:83], v[144:147], v[88:91]
  s_mov_b32 m0, s53
  v_exp_f32 v186, v186
  v_cvt_pk_bf16_f32 v184, v184, v185
  v_mfma_f32_16x16x32_bf16 v[88:91], a[84:87], v[160:163], v[88:91]
  v_exp_f32 v187, v187
  v_mfma_f32_16x16x32_bf16 v[120:123], a[84:87], v[168:171], v[120:123]
  ds_read_b128 a[96:99], v243 offset:0
  v_cvt_pk_bf16_f32 v185, v186, v187
  v_mfma_f32_16x16x32_bf16 v[120:123], a[80:83], v[152:155], v[120:123]
  ds_read_b128 a[100:103], v243 offset:1024
  v_mfma_f32_16x16x32_bf16 v[92:95], a[88:91], v[144:147], v[92:95]
  ds_read_b128 a[104:107], v243 offset:2048
  v_exp_f32 v188, v188
  v_mfma_f32_16x16x32_bf16 v[92:95], a[92:95], v[160:163], v[92:95]
  buffer_load_dwordx4 v244, s[12:15], s55 offen offset:0 sc1 lds
  v_mfma_f32_16x16x32_bf16 v[124:127], a[92:95], v[168:171], v[124:127]
  ds_read_b128 a[108:111], v243 offset:3072
  v_exp_f32 v189, v189
  v_mfma_f32_16x16x32_bf16 v[124:127], a[88:91], v[152:155], v[124:127]
  ds_read_b128 a[112:115], v243 offset:4096
  v_cvt_pk_bf16_f32 v186, v188, v189
  v_mfma_f32_16x16x32_bf16 v[136:139], a[232:235], v[144:147], v[136:139]
  v_exp_f32 v190, v190
  v_mfma_f32_16x16x32_bf16 v[136:139], a[232:235], v[160:163], v[136:139]
  buffer_load_dwordx4 v244, s[12:15], s55 offen offset:1024 sc1 lds
  v_mfma_f32_16x16x32_bf16 v[140:143], a[232:235], v[168:171], v[140:143]
  ds_read_b128 a[116:119], v243 offset:5120
  v_exp_f32 v191, v191
  v_mfma_f32_16x16x32_bf16 v[140:143], a[232:235], v[152:155], v[140:143]
  s_waitcnt lgkmcnt(2)
  buffer_load_dwordx4 v244, s[12:15], s55 offen offset:2048 sc1 lds
  v_mfma_f32_16x16x32_bf16 v[144:147], a[96:99], a[160:163], v[216:219]
  ds_read_b128 a[120:123], v243 offset:6144
  v_cvt_pk_bf16_f32 v187, v190, v191
  v_mfma_f32_16x16x32_bf16 v[144:147], a[100:103], a[164:167], v[144:147]
  v_exp_f32 v192, v192
  v_mfma_f32_16x16x32_bf16 v[144:147], a[104:107], a[168:171], v[144:147]
  ds_read_b128 a[124:127], v243 offset:7168
  v_exp_f32 v193, v193
  v_mfma_f32_16x16x32_bf16 v[144:147], a[108:111], a[172:175], v[144:147]
  buffer_load_dwordx4 v244, s[12:15], s55 offen offset:3072 sc1 lds
  v_mfma_f32_16x16x32_bf16 v[152:155], a[108:111], a[188:191], v[220:223]
  s_add_u32 m0, s52, 65536
  ds_read_b128 a[64:67], v243 offset:8192
  v_cvt_pk_bf16_f32 v192, v192, v193
  v_mfma_f32_16x16x32_bf16 v[152:155], a[104:107], a[184:187], v[152:155]
  v_exp_f32 v194, v194
  v_mfma_f32_16x16x32_bf16 v[152:155], a[100:103], a[180:183], v[152:155]
  ds_read_b128 a[68:71], v243 offset:9216
  v_exp_f32 v195, v195
  v_mfma_f32_16x16x32_bf16 v[152:155], a[96:99], a[176:179], v[152:155]
  s_waitcnt lgkmcnt(2)
  ds_read_b128 a[72:75], v243 offset:10240
  v_cvt_pk_bf16_f32 v193, v194, v195
  v_mfma_f32_16x16x32_bf16 v[148:151], a[112:115], a[160:163], v[216:219]
  v_exp_f32 v196, v196
  v_mfma_f32_16x16x32_bf16 v[148:151], a[116:119], a[164:167], v[148:151]
  buffer_load_dwordx4 v250, s[12:15], s55 offen offset:0 sc1 lds
  v_mfma_f32_16x16x32_bf16 v[148:151], a[120:123], a[168:171], v[148:151]
  ds_read_b128 a[76:79], v243 offset:11264
  v_exp_f32 v197, v197
  v_mfma_f32_16x16x32_bf16 v[148:151], a[124:127], a[172:175], v[148:151]
  ds_read_b128 a[80:83], v243 offset:12288
  v_cvt_pk_bf16_f32 v194, v196, v197
  v_mfma_f32_16x16x32_bf16 v[156:159], a[124:127], a[188:191], v[220:223]
  v_exp_f32 v198, v198
  v_mfma_f32_16x16x32_bf16 v[156:159], a[120:123], a[184:187], v[156:159]
  buffer_load_dwordx4 v250, s[12:15], s55 offen offset:1024 sc1 lds
  v_mfma_f32_16x16x32_bf16 v[156:159], a[116:119], a[180:183], v[156:159]
  ds_read_b128 a[84:87], v243 offset:13312
  v_exp_f32 v199, v199
  v_mfma_f32_16x16x32_bf16 v[156:159], a[112:115], a[176:179], v[156:159]
  s_waitcnt lgkmcnt(2)
  ds_read_b128 a[88:91], v243 offset:14336
  v_cvt_pk_bf16_f32 v195, v198, v199
  v_mfma_f32_16x16x32_bf16 v[160:163], a[64:67], a[160:163], v[216:219]
  v_exp_f32 v200, v200
  v_mfma_f32_16x16x32_bf16 v[160:163], a[68:71], a[164:167], v[160:163]
  buffer_load_dwordx4 v250, s[12:15], s55 offen offset:2048 sc1 lds
  v_mfma_f32_16x16x32_bf16 v[160:163], a[72:75], a[168:171], v[160:163]
  ds_read_b128 a[92:95], v243 offset:15360
  v_exp_f32 v201, v201
  v_mfma_f32_16x16x32_bf16 v[160:163], a[76:79], a[172:175], v[160:163]
  buffer_load_dwordx4 v250, s[12:15], s55 offen offset:3072 sc1 lds
  v_mfma_f32_16x16x32_bf16 v[168:171], a[76:79], a[188:191], v[220:223]
  s_mov_b32 m0, s52
  ds_read_b128 a[96:99], v247 offset:16384
  v_cvt_pk_bf16_f32 v200, v200, v201
  v_mfma_f32_16x16x32_bf16 v[168:171], a[72:75], a[184:187], v[168:171]
  ds_read_b128 a[100:103], v247 offset:24576
  v_exp_f32 v202, v202
  v_mfma_f32_16x16x32_bf16 v[168:171], a[68:71], a[180:183], v[168:171]
  v_exp_f32 v203, v203
  v_mfma_f32_16x16x32_bf16 v[168:171], a[64:67], a[176:179], v[168:171]
  s_waitcnt lgkmcnt(2)
  ds_read_b128 a[104:107], v247 offset:17408
  v_cvt_pk_bf16_f32 v201, v202, v203
  v_mfma_f32_16x16x32_bf16 v[164:167], a[80:83], a[160:163], v[216:219]
  ds_read_b128 a[108:111], v247 offset:25600
  v_exp_f32 v204, v204
  v_mfma_f32_16x16x32_bf16 v[164:167], a[84:87], a[164:167], v[164:167]
  buffer_load_dwordx4 v250, s[8:11], s55 offen offset:0 sc1 lds
  v_mfma_f32_16x16x32_bf16 v[164:167], a[88:91], a[168:171], v[164:167]
  v_exp_f32 v205, v205
  v_mfma_f32_16x16x32_bf16 v[164:167], a[92:95], a[172:175], v[164:167]
  ds_read_b128 a[112:115], v247 offset:18432
  v_cvt_pk_bf16_f32 v202, v204, v205
  v_mfma_f32_16x16x32_bf16 v[172:175], a[92:95], a[188:191], v[220:223]
  ds_read_b128 a[116:119], v247 offset:26624
  v_exp_f32 v206, v206
  v_mfma_f32_16x16x32_bf16 v[172:175], a[88:91], a[184:187], v[172:175]
  buffer_load_dwordx4 v250, s[8:11], s55 offen offset:1024 sc1 lds
  v_mfma_f32_16x16x32_bf16 v[172:175], a[84:87], a[180:183], v[172:175]
  v_exp_f32 v207, v207
  v_mfma_f32_16x16x32_bf16 v[172:175], a[80:83], a[176:179], v[172:175]
  s_waitcnt lgkmcnt(2)
  ds_read_b128 a[120:123], v247 offset:19456
  v_cvt_pk_bf16_f32 v203, v206, v207
  v_mfma_f32_16x16x32_bf16 v[64:67], a[96:99], v[176:179], v[64:67]
  ds_read_b128 a[124:127], v247 offset:27648
  v_mfma_f32_16x16x32_bf16 v[64:67], a[100:103], v[192:195], v[64:67]
  buffer_load_dwordx4 v250, s[8:11], s55 offen offset:2048 sc1 lds
  v_mfma_f32_16x16x32_bf16 v[96:99], a[100:103], v[200:203], v[96:99]
  v_exp_f32 v144, v144
  v_mfma_f32_16x16x32_bf16 v[96:99], a[96:99], v[184:187], v[96:99]
  buffer_load_dwordx4 v250, s[8:11], s55 offen offset:3072 sc1 lds
  v_mfma_f32_16x16x32_bf16 v[68:71], a[104:107], v[176:179], v[68:71]
  s_add_u32 m0, s52, 16384
  ds_read_b128 a[64:67], v247 offset:20480
  v_exp_f32 v145, v145
  v_mfma_f32_16x16x32_bf16 v[68:71], a[108:111], v[192:195], v[68:71]
  ds_read_b128 a[68:71], v247 offset:28672
  v_cvt_pk_bf16_f32 v144, v144, v145
  v_mfma_f32_16x16x32_bf16 v[100:103], a[108:111], v[200:203], v[100:103]
  v_exp_f32 v146, v146
  v_mfma_f32_16x16x32_bf16 v[100:103], a[104:107], v[184:187], v[100:103]
  s_waitcnt lgkmcnt(2)
  ds_read_b128 a[72:75], v247 offset:21504
  v_mfma_f32_16x16x32_bf16 v[72:75], a[112:115], v[176:179], v[72:75]
  ds_read_b128 a[76:79], v247 offset:29696
  v_mfma_f32_16x16x32_bf16 v[72:75], a[116:119], v[192:195], v[72:75]
  buffer_load_dwordx4 v251, s[8:11], s55 offen offset:0 sc1 lds
  v_mfma_f32_16x16x32_bf16 v[104:107], a[116:119], v[200:203], v[104:107]
  v_exp_f32 v147, v147
  v_mfma_f32_16x16x32_bf16 v[104:107], a[112:115], v[184:187], v[104:107]
  ds_read_b128 a[80:83], v247 offset:22528
  v_cvt_pk_bf16_f32 v145, v146, v147
  v_mfma_f32_16x16x32_bf16 v[76:79], a[120:123], v[176:179], v[76:79]
  ds_read_b128 a[84:87], v247 offset:30720
  v_mfma_f32_16x16x32_bf16 v[76:79], a[124:127], v[192:195], v[76:79]
  buffer_load_dwordx4 v251, s[8:11], s55 offen offset:1024 sc1 lds
  v_mfma_f32_16x16x32_bf16 v[108:111], a[124:127], v[200:203], v[108:111]
  v_exp_f32 v148, v148
  v_mfma_f32_16x16x32_bf16 v[108:111], a[120:123], v[184:187], v[108:111]
  s_waitcnt lgkmcnt(2)
  ds_read_b128 a[88:91], v247 offset:23552
  v_mfma_f32_16x16x32_bf16 v[80:83], a[64:67], v[176:179], v[80:83]
  ds_read_b128 a[92:95], v247 offset:31744
  v_xor_b32 v247, 0x8000, v247
  v_mfma_f32_16x16x32_bf16 v[80:83], a[68:71], v[192:195], v[80:83]
  v_exp_f32 v149, v149
  v_mfma_f32_16x16x32_bf16 v[112:115], a[68:71], v[200:203], v[112:115]
  buffer_load_dwordx4 v251, s[8:11], s55 offen offset:2048 sc1 lds
  v_cvt_pk_bf16_f32 v146, v148, v149
  v_mfma_f32_16x16x32_bf16 v[112:115], a[64:67], v[184:187], v[112:115]
  v_exp_f32 v150, v150
  v_mfma_f32_16x16x32_bf16 v[84:87], a[72:75], v[176:179], v[84:87]
  buffer_load_dwordx4 v251, s[8:11], s55 offen offset:3072 sc1 lds
  v_mfma_f32_16x16x32_bf16 v[84:87], a[76:79], v[192:195], v[84:87]
  s_add_u32 s55, s55, 32768
  v_exp_f32 v151, v151
  v_mfma_f32_16x16x32_bf16 v[116:119], a[76:79], v[200:203], v[116:119]
  s_xor_b64 s[52:53], s[52:53], s[76:77]
  ds_read_b128 a[96:99], v243 offset:16384
  v_cvt_pk_bf16_f32 v147, v150, v151
  v_mfma_f32_16x16x32_bf16 v[116:119], a[72:75], v[184:187], v[116:119]
  s_waitcnt lgkmcnt(1)
  v_exp_f32 v152, v152
  v_mfma_f32_16x16x32_bf16 v[88:91], a[80:83], v[176:179], v[88:91]
  ds_read_b128 a[100:103], v243 offset:17408
  v_mfma_f32_16x16x32_bf16 v[88:91], a[84:87], v[192:195], v[88:91]
  ds_read_b128 a[104:107], v243 offset:18432
  v_mfma_f32_16x16x32_bf16 v[120:123], a[84:87], v[200:203], v[120:123]
  v_exp_f32 v153, v153
  v_mfma_f32_16x16x32_bf16 v[120:123], a[80:83], v[184:187], v[120:123]
  ds_read_b128 a[108:111], v243 offset:19456
  v_cvt_pk_bf16_f32 v152, v152, v153
  v_mfma_f32_16x16x32_bf16 v[92:95], a[88:91], v[176:179], v[92:95]
  v_exp_f32 v154, v154
  v_mfma_f32_16x16x32_bf16 v[92:95], a[92:95], v[192:195], v[92:95]
  ds_read_b128 a[112:115], v243 offset:20480
  v_mfma_f32_16x16x32_bf16 v[124:127], a[92:95], v[200:203], v[124:127]
  ds_read_b128 a[116:119], v243 offset:21504
  v_mfma_f32_16x16x32_bf16 v[124:127], a[88:91], v[184:187], v[124:127]
  v_exp_f32 v155, v155
  v_mfma_f32_16x16x32_bf16 v[136:139], a[232:235], v[176:179], v[136:139]
  ds_read_b128 a[120:123], v243 offset:22528
  v_cvt_pk_bf16_f32 v153, v154, v155
  v_mfma_f32_16x16x32_bf16 v[136:139], a[232:235], v[192:195], v[136:139]
  ds_read_b128 a[124:127], v243 offset:23552
  v_mfma_f32_16x16x32_bf16 v[140:143], a[232:235], v[200:203], v[140:143]
  v_mfma_f32_16x16x32_bf16 v[140:143], a[232:235], v[184:187], v[140:143]
  s_cmp_eq_u32 s45, 6
  s_cbranch_scc1 recurrent_scan__compressed_kv_cla__dense_activation_silu__prompt_kernel_sx
recurrent_scan__compressed_kv_cla__dense_activation_silu__prompt_kernel_ss:
  s_waitcnt lgkmcnt(4)
  v_mfma_f32_16x16x32_bf16 v[176:179], a[96:99], a[160:163], v[216:219]
  s_waitcnt vmcnt(16)
  ds_read_b64_tr_b16 a[224:225], v235 offset:0
  v_mfma_f32_16x16x32_bf16 v[176:179], a[100:103], a[164:167], v[176:179]
  v_exp_f32 v156, v156
  v_mfma_f32_16x16x32_bf16 v[176:179], a[104:107], a[168:171], v[176:179]
  ds_read_b64_tr_b16 a[226:227], v235 offset:3072
  v_mfma_f32_16x16x32_bf16 v[176:179], a[108:111], a[172:175], v[176:179]
  ds_read_b64_tr_b16 a[228:229], v246 offset:32
  v_mfma_f32_16x16x32_bf16 v[184:187], a[108:111], a[188:191], v[220:223]
  ds_read_b64_tr_b16 a[230:231], v246 offset:3104
  v_mfma_f32_16x16x32_bf16 v[184:187], a[104:107], a[184:187], v[184:187]
  v_exp_f32 v157, v157
  v_mfma_f32_16x16x32_bf16 v[184:187], a[100:103], a[180:183], v[184:187]
  ds_read_b64_tr_b16 a[236:237], v235 offset:64
  v_cvt_pk_bf16_f32 v154, v156, v157
  v_mfma_f32_16x16x32_bf16 v[184:187], a[96:99], a[176:179], v[184:187]
  s_waitcnt lgkmcnt(1)
  ds_read_b64_tr_b16 a[238:239], v235 offset:3136
  v_mfma_f32_16x16x32_bf16 a[0:3], a[224:227], a[208:211], a[0:3]
  v_exp_f32 v158, v158
  v_mfma_f32_16x16x32_bf16 a[20:23], a[224:227], a[212:215], a[20:23]
  ds_read_b64_tr_b16 a[240:241], v246 offset:96
  v_mfma_f32_16x16x32_bf16 a[40:43], a[224:227], a[216:219], a[40:43]
  ds_read_b64_tr_b16 a[242:243], v246 offset:3168
  v_mfma_f32_16x16x32_bf16 a[60:63], a[224:227], a[220:223], a[60:63]
  v_exp_f32 v159, v159
  v_mfma_f32_16x16x32_bf16 a[192:195], a[228:231], a[220:223], a[192:195]
  ds_read_b64_tr_b16 a[244:245], v235 offset:128
  v_cvt_pk_bf16_f32 v155, v158, v159
  v_mfma_f32_16x16x32_bf16 a[44:47], a[228:231], a[216:219], a[44:47]
  ds_read_b64_tr_b16 a[246:247], v235 offset:3200
  v_mfma_f32_16x16x32_bf16 a[24:27], a[228:231], a[212:215], a[24:27]
  v_exp_f32 v160, v160
  v_mfma_f32_16x16x32_bf16 a[4:7], a[228:231], a[208:211], a[4:7]
  s_waitcnt lgkmcnt(2)
  v_exp_f32 v161, v161
  v_mfma_f32_16x16x32_bf16 a[8:11], a[236:239], a[208:211], a[8:11]
  v_cvt_pk_bf16_f32 v160, v160, v161
  v_mfma_f32_16x16x32_bf16 a[28:31], a[236:239], a[212:215], a[28:31]
  v_exp_f32 v162, v162
  v_mfma_f32_16x16x32_bf16 a[48:51], a[236:239], a[216:219], a[48:51]
  v_exp_f32 v163, v163
  v_mfma_f32_16x16x32_bf16 a[196:199], a[236:239], a[220:223], a[196:199]
  ds_read_b128 a[64:67], v243 offset:24576
  v_cvt_pk_bf16_f32 v161, v162, v163
  v_mfma_f32_16x16x32_bf16 a[200:203], a[240:243], a[220:223], a[200:203]
  v_exp_f32 v164, v164
  v_mfma_f32_16x16x32_bf16 a[52:55], a[240:243], a[216:219], a[52:55]
  ds_read_b128 a[68:71], v243 offset:25600
  v_mfma_f32_16x16x32_bf16 a[32:35], a[240:243], a[212:215], a[32:35]
  v_exp_f32 v165, v165
  v_mfma_f32_16x16x32_bf16 a[12:15], a[240:243], a[208:211], a[12:15]
  s_waitcnt lgkmcnt(2)
  ds_read_b128 a[72:75], v243 offset:26624
  v_cvt_pk_bf16_f32 v162, v164, v165
  v_mfma_f32_16x16x32_bf16 a[16:19], a[244:247], a[208:211], a[16:19]
  s_mov_b32 m0, s62
  v_exp_f32 v166, v166
  v_mfma_f32_16x16x32_bf16 a[36:39], a[244:247], a[212:215], a[36:39]
  ds_read_b128 a[76:79], v243 offset:27648
  v_mfma_f32_16x16x32_bf16 a[56:59], a[244:247], a[216:219], a[56:59]
  buffer_load_dwordx4 v232, s[28:31], s58 offen offset:0 lds
  v_mfma_f32_16x16x32_bf16 a[204:207], a[244:247], a[220:223], a[204:207]
  ds_read_b128 a[80:83], v243 offset:28672
  v_mfma_f32_16x16x32_bf16 v[180:183], a[112:115], a[160:163], v[216:219]
  v_exp_f32 v167, v167
  v_mfma_f32_16x16x32_bf16 v[180:183], a[116:119], a[164:167], v[180:183]
  ds_read_b128 a[84:87], v243 offset:29696
  v_cvt_pk_bf16_f32 v163, v166, v167
  v_mfma_f32_16x16x32_bf16 v[180:183], a[120:123], a[168:171], v[180:183]
  buffer_load_dwordx4 v233, s[28:31], s58 offen offset:1024 lds
  v_mfma_f32_16x16x32_bf16 v[180:183], a[124:127], a[172:175], v[180:183]
  v_exp_f32 v168, v168
  v_mfma_f32_16x16x32_bf16 v[188:191], a[124:127], a[188:191], v[220:223]
  ds_read_b128 a[88:91], v243 offset:30720
  v_mfma_f32_16x16x32_bf16 v[188:191], a[120:123], a[184:187], v[188:191]
  v_exp_f32 v169, v169
  v_mfma_f32_16x16x32_bf16 v[188:191], a[116:119], a[180:183], v[188:191]
  buffer_load_dwordx4 v234, s[28:31], s58 offen offset:2048 lds
  v_mfma_f32_16x16x32_bf16 v[188:191], a[112:115], a[176:179], v[188:191]
  s_waitcnt lgkmcnt(3)
  ds_read_b128 a[92:95], v243 offset:31744
  v_cvt_pk_bf16_f32 v168, v168, v169
  v_mfma_f32_16x16x32_bf16 v[192:195], a[64:67], a[160:163], v[216:219]
  s_add_u32 m0, s62, 3072
  v_exp_f32 v170, v170
  v_mfma_f32_16x16x32_bf16 v[192:195], a[68:71], a[164:167], v[192:195]
  s_add_u32 s58, s58, 20480
  ds_read_b128 a[96:99], v247 offset:0
  v_mfma_f32_16x16x32_bf16 v[192:195], a[72:75], a[168:171], v[192:195]
  ds_read_b128 a[100:103], v247 offset:8192
  v_mfma_f32_16x16x32_bf16 v[192:195], a[76:79], a[172:175], v[192:195]
  v_exp_f32 v171, v171
  v_mfma_f32_16x16x32_bf16 v[200:203], a[76:79], a[188:191], v[220:223]
  ds_read_b128 a[104:107], v247 offset:1024
  v_cvt_pk_bf16_f32 v169, v170, v171
  v_mfma_f32_16x16x32_bf16 v[200:203], a[72:75], a[184:187], v[200:203]
  ds_read_b128 a[108:111], v247 offset:9216
  v_mfma_f32_16x16x32_bf16 v[200:203], a[68:71], a[180:183], v[200:203]
  v_exp_f32 v172, v172
  v_mfma_f32_16x16x32_bf16 v[200:203], a[64:67], a[176:179], v[200:203]
  s_waitcnt lgkmcnt(4)
  buffer_load_dwordx4 v232, s[28:31], s58 offen offset:0 lds
  v_mfma_f32_16x16x32_bf16 v[196:199], a[80:83], a[160:163], v[216:219]
  v_exp_f32 v173, v173
  v_mfma_f32_16x16x32_bf16 v[196:199], a[84:87], a[164:167], v[196:199]
  ds_read_b128 a[112:115], v247 offset:2048
  v_cvt_pk_bf16_f32 v170, v172, v173
  v_mfma_f32_16x16x32_bf16 v[196:199], a[88:91], a[168:171], v[196:199]
  ds_read_b128 a[116:119], v247 offset:10240
  v_mfma_f32_16x16x32_bf16 v[196:199], a[92:95], a[172:175], v[196:199]
  buffer_load_dwordx4 v233, s[28:31], s58 offen offset:1024 lds
  v_mfma_f32_16x16x32_bf16 v[204:207], a[92:95], a[188:191], v[220:223]
  v_exp_f32 v174, v174
  v_mfma_f32_16x16x32_bf16 v[204:207], a[88:91], a[184:187], v[204:207]
  ds_read_b128 a[120:123], v247 offset:3072
  v_mfma_f32_16x16x32_bf16 v[204:207], a[84:87], a[180:183], v[204:207]
  ds_read_b128 a[124:127], v247 offset:11264
  v_mfma_f32_16x16x32_bf16 v[204:207], a[80:83], a[176:179], v[204:207]
  s_waitcnt lgkmcnt(4)
  v_exp_f32 v175, v175
  v_mfma_f32_16x16x32_bf16 v[64:67], a[96:99], v[144:147], v[64:67]
  ds_read_b128 a[64:67], v247 offset:4096
  v_cvt_pk_bf16_f32 v171, v174, v175
  v_mfma_f32_16x16x32_bf16 v[64:67], a[100:103], v[160:163], v[64:67]
  buffer_load_dwordx4 v234, s[28:31], s58 offen offset:2048 lds
  v_mfma_f32_16x16x32_bf16 v[96:99], a[100:103], v[168:171], v[96:99]
  s_add_u32 s58, s58, 20480
  ds_read_b128 a[68:71], v247 offset:12288
  v_mfma_f32_16x16x32_bf16 v[96:99], a[96:99], v[152:155], v[96:99]
  v_exp_f32 v176, v176
  v_mfma_f32_16x16x32_bf16 v[68:71], a[104:107], v[144:147], v[68:71]
  v_exp_f32 v177, v177
  v_mfma_f32_16x16x32_bf16 v[68:71], a[108:111], v[160:163], v[68:71]
  buffer_load_dwordx4 a[208:211], v248, s[4:7], s59 offen sc1
  v_mfma_f32_16x16x32_bf16 v[100:103], a[108:111], v[168:171], v[100:103]
  ds_read_b128 a[72:75], v247 offset:5120
  v_cvt_pk_bf16_f32 v176, v176, v177
  v_mfma_f32_16x16x32_bf16 v[100:103], a[104:107], v[152:155], v[100:103]
  s_waitcnt lgkmcnt(3)
  ds_read_b128 a[76:79], v247 offset:13312
  v_mfma_f32_16x16x32_bf16 v[72:75], a[112:115], v[144:147], v[72:75]
  v_exp_f32 v178, v178
  v_mfma_f32_16x16x32_bf16 v[72:75], a[116:119], v[160:163], v[72:75]
  buffer_load_dwordx4 a[212:215], v248, s[20:23], s59 offen sc1
  v_mfma_f32_16x16x32_bf16 v[104:107], a[116:119], v[168:171], v[104:107]
  v_exp_f32 v179, v179
  v_mfma_f32_16x16x32_bf16 v[104:107], a[112:115], v[152:155], v[104:107]
  ds_read_b128 a[80:83], v247 offset:6144
  v_cvt_pk_bf16_f32 v177, v178, v179
  v_mfma_f32_16x16x32_bf16 v[76:79], a[120:123], v[144:147], v[76:79]
  ds_read_b128 a[84:87], v247 offset:14336
  v_exp_f32 v180, v180
  v_mfma_f32_16x16x32_bf16 v[76:79], a[124:127], v[160:163], v[76:79]
  buffer_load_dwordx4 a[216:219], v248, s[36:39], s59 offen sc1
  v_mfma_f32_16x16x32_bf16 v[108:111], a[124:127], v[168:171], v[108:111]
  v_exp_f32 v181, v181
  v_mfma_f32_16x16x32_bf16 v[108:111], a[120:123], v[152:155], v[108:111]
  s_waitcnt lgkmcnt(2)
  ds_read_b128 a[88:91], v247 offset:7168
  v_cvt_pk_bf16_f32 v178, v180, v181
  v_mfma_f32_16x16x32_bf16 v[80:83], a[64:67], v[144:147], v[80:83]
  ds_read_b128 a[92:95], v247 offset:15360
  v_exp_f32 v182, v182
  v_mfma_f32_16x16x32_bf16 v[80:83], a[68:71], v[160:163], v[80:83]
  buffer_load_dwordx4 a[220:223], v248, s[40:43], s59 offen sc1
  v_mfma_f32_16x16x32_bf16 v[112:115], a[68:71], v[168:171], v[112:115]
  s_add_u32 s59, s59, 1024
  v_exp_f32 v183, v183
  v_mfma_f32_16x16x32_bf16 v[112:115], a[64:67], v[152:155], v[112:115]
  v_exp_f32 v184, v184
  v_mfma_f32_16x16x32_bf16 v[84:87], a[72:75], v[144:147], v[84:87]
  v_xor_b32 v243, 0x8000, v243
  v_cvt_pk_bf16_f32 v179, v182, v183
  v_mfma_f32_16x16x32_bf16 v[84:87], a[76:79], v[160:163], v[84:87]
  v_exp_f32 v185, v185
  v_mfma_f32_16x16x32_bf16 v[116:119], a[76:79], v[168:171], v[116:119]
  v_exp_f32 v186, v186
  v_mfma_f32_16x16x32_bf16 v[116:119], a[72:75], v[152:155], v[116:119]
  s_waitcnt vmcnt(10) lgkmcnt(0)
  s_barrier
  v_mfma_f32_16x16x32_bf16 v[88:91], a[80:83], v[144:147], v[88:91]
  s_mov_b32 m0, s53
  ds_read_b128 a[96:99], v243 offset:0
  v_cvt_pk_bf16_f32 v184, v184, v185
  v_mfma_f32_16x16x32_bf16 v[88:91], a[84:87], v[160:163], v[88:91]
  v_exp_f32 v187, v187
  v_mfma_f32_16x16x32_bf16 v[120:123], a[84:87], v[168:171], v[120:123]
  ds_read_b128 a[100:103], v243 offset:1024
  v_cvt_pk_bf16_f32 v185, v186, v187
  v_mfma_f32_16x16x32_bf16 v[120:123], a[80:83], v[152:155], v[120:123]
  ds_read_b128 a[104:107], v243 offset:2048
  v_mfma_f32_16x16x32_bf16 v[92:95], a[88:91], v[144:147], v[92:95]
  v_exp_f32 v188, v188
  v_mfma_f32_16x16x32_bf16 v[92:95], a[92:95], v[160:163], v[92:95]
  buffer_load_dwordx4 v244, s[12:15], s55 offen offset:0 sc1 lds
  v_mfma_f32_16x16x32_bf16 v[124:127], a[92:95], v[168:171], v[124:127]
  ds_read_b128 a[108:111], v243 offset:3072
  v_exp_f32 v189, v189
  v_mfma_f32_16x16x32_bf16 v[124:127], a[88:91], v[152:155], v[124:127]
  ds_read_b128 a[112:115], v243 offset:4096
  v_cvt_pk_bf16_f32 v186, v188, v189
  v_mfma_f32_16x16x32_bf16 v[136:139], a[232:235], v[144:147], v[136:139]
  v_exp_f32 v190, v190
  v_mfma_f32_16x16x32_bf16 v[136:139], a[232:235], v[160:163], v[136:139]
  buffer_load_dwordx4 v244, s[12:15], s55 offen offset:1024 sc1 lds
  v_mfma_f32_16x16x32_bf16 v[140:143], a[232:235], v[168:171], v[140:143]
  ds_read_b128 a[116:119], v243 offset:5120
  v_exp_f32 v191, v191
  v_mfma_f32_16x16x32_bf16 v[140:143], a[232:235], v[152:155], v[140:143]
  s_waitcnt lgkmcnt(2)
  buffer_load_dwordx4 v244, s[12:15], s55 offen offset:2048 sc1 lds
  v_mfma_f32_16x16x32_bf16 v[144:147], a[96:99], a[160:163], v[216:219]
  ds_read_b128 a[120:123], v243 offset:6144
  v_cvt_pk_bf16_f32 v187, v190, v191
  v_mfma_f32_16x16x32_bf16 v[144:147], a[100:103], a[164:167], v[144:147]
  v_exp_f32 v192, v192
  v_mfma_f32_16x16x32_bf16 v[144:147], a[104:107], a[168:171], v[144:147]
  ds_read_b128 a[124:127], v243 offset:7168
  v_exp_f32 v193, v193
  v_mfma_f32_16x16x32_bf16 v[144:147], a[108:111], a[172:175], v[144:147]
  buffer_load_dwordx4 v244, s[12:15], s55 offen offset:3072 sc1 lds
  v_mfma_f32_16x16x32_bf16 v[152:155], a[108:111], a[188:191], v[220:223]
  s_add_u32 m0, s52, 65536
  ds_read_b128 a[64:67], v243 offset:8192
  v_cvt_pk_bf16_f32 v192, v192, v193
  v_mfma_f32_16x16x32_bf16 v[152:155], a[104:107], a[184:187], v[152:155]
  v_exp_f32 v194, v194
  v_mfma_f32_16x16x32_bf16 v[152:155], a[100:103], a[180:183], v[152:155]
  ds_read_b128 a[68:71], v243 offset:9216
  v_exp_f32 v195, v195
  v_mfma_f32_16x16x32_bf16 v[152:155], a[96:99], a[176:179], v[152:155]
  s_waitcnt lgkmcnt(2)
  ds_read_b128 a[72:75], v243 offset:10240
  v_cvt_pk_bf16_f32 v193, v194, v195
  v_mfma_f32_16x16x32_bf16 v[148:151], a[112:115], a[160:163], v[216:219]
  v_exp_f32 v196, v196
  v_mfma_f32_16x16x32_bf16 v[148:151], a[116:119], a[164:167], v[148:151]
  buffer_load_dwordx4 v250, s[12:15], s55 offen offset:0 sc1 lds
  v_mfma_f32_16x16x32_bf16 v[148:151], a[120:123], a[168:171], v[148:151]
  ds_read_b128 a[76:79], v243 offset:11264
  v_exp_f32 v197, v197
  v_mfma_f32_16x16x32_bf16 v[148:151], a[124:127], a[172:175], v[148:151]
  ds_read_b128 a[80:83], v243 offset:12288
  v_cvt_pk_bf16_f32 v194, v196, v197
  v_mfma_f32_16x16x32_bf16 v[156:159], a[124:127], a[188:191], v[220:223]
  v_exp_f32 v198, v198
  v_mfma_f32_16x16x32_bf16 v[156:159], a[120:123], a[184:187], v[156:159]
  buffer_load_dwordx4 v250, s[12:15], s55 offen offset:1024 sc1 lds
  v_mfma_f32_16x16x32_bf16 v[156:159], a[116:119], a[180:183], v[156:159]
  ds_read_b128 a[84:87], v243 offset:13312
  v_exp_f32 v199, v199
  v_mfma_f32_16x16x32_bf16 v[156:159], a[112:115], a[176:179], v[156:159]
  s_waitcnt lgkmcnt(2)
  ds_read_b128 a[88:91], v243 offset:14336
  v_cvt_pk_bf16_f32 v195, v198, v199
  v_mfma_f32_16x16x32_bf16 v[160:163], a[64:67], a[160:163], v[216:219]
  v_exp_f32 v200, v200
  v_mfma_f32_16x16x32_bf16 v[160:163], a[68:71], a[164:167], v[160:163]
  buffer_load_dwordx4 v250, s[12:15], s55 offen offset:2048 sc1 lds
  v_mfma_f32_16x16x32_bf16 v[160:163], a[72:75], a[168:171], v[160:163]
  ds_read_b128 a[92:95], v243 offset:15360
  v_exp_f32 v201, v201
  v_mfma_f32_16x16x32_bf16 v[160:163], a[76:79], a[172:175], v[160:163]
  buffer_load_dwordx4 v250, s[12:15], s55 offen offset:3072 sc1 lds
  v_mfma_f32_16x16x32_bf16 v[168:171], a[76:79], a[188:191], v[220:223]
  s_mov_b32 m0, s52
  ds_read_b128 a[96:99], v247 offset:16384
  v_cvt_pk_bf16_f32 v200, v200, v201
  v_mfma_f32_16x16x32_bf16 v[168:171], a[72:75], a[184:187], v[168:171]
  ds_read_b128 a[100:103], v247 offset:24576
  v_exp_f32 v202, v202
  v_mfma_f32_16x16x32_bf16 v[168:171], a[68:71], a[180:183], v[168:171]
  v_exp_f32 v203, v203
  v_mfma_f32_16x16x32_bf16 v[168:171], a[64:67], a[176:179], v[168:171]
  s_waitcnt lgkmcnt(2)
  ds_read_b128 a[104:107], v247 offset:17408
  v_cvt_pk_bf16_f32 v201, v202, v203
  v_mfma_f32_16x16x32_bf16 v[164:167], a[80:83], a[160:163], v[216:219]
  ds_read_b128 a[108:111], v247 offset:25600
  v_exp_f32 v204, v204
  v_mfma_f32_16x16x32_bf16 v[164:167], a[84:87], a[164:167], v[164:167]
  buffer_load_dwordx4 v250, s[8:11], s55 offen offset:0 sc1 lds
  v_mfma_f32_16x16x32_bf16 v[164:167], a[88:91], a[168:171], v[164:167]
  v_exp_f32 v205, v205
  v_mfma_f32_16x16x32_bf16 v[164:167], a[92:95], a[172:175], v[164:167]
  ds_read_b128 a[112:115], v247 offset:18432
  v_cvt_pk_bf16_f32 v202, v204, v205
  v_mfma_f32_16x16x32_bf16 v[172:175], a[92:95], a[188:191], v[220:223]
  ds_read_b128 a[116:119], v247 offset:26624
  v_exp_f32 v206, v206
  v_mfma_f32_16x16x32_bf16 v[172:175], a[88:91], a[184:187], v[172:175]
  buffer_load_dwordx4 v250, s[8:11], s55 offen offset:1024 sc1 lds
  v_mfma_f32_16x16x32_bf16 v[172:175], a[84:87], a[180:183], v[172:175]
  v_exp_f32 v207, v207
  v_mfma_f32_16x16x32_bf16 v[172:175], a[80:83], a[176:179], v[172:175]
  s_waitcnt lgkmcnt(2)
  ds_read_b128 a[120:123], v247 offset:19456
  v_cvt_pk_bf16_f32 v203, v206, v207
  v_mfma_f32_16x16x32_bf16 v[64:67], a[96:99], v[176:179], v[64:67]
  ds_read_b128 a[124:127], v247 offset:27648
  v_mfma_f32_16x16x32_bf16 v[64:67], a[100:103], v[192:195], v[64:67]
  buffer_load_dwordx4 v250, s[8:11], s55 offen offset:2048 sc1 lds
  v_mfma_f32_16x16x32_bf16 v[96:99], a[100:103], v[200:203], v[96:99]
  v_exp_f32 v144, v144
  v_mfma_f32_16x16x32_bf16 v[96:99], a[96:99], v[184:187], v[96:99]
  buffer_load_dwordx4 v250, s[8:11], s55 offen offset:3072 sc1 lds
  v_mfma_f32_16x16x32_bf16 v[68:71], a[104:107], v[176:179], v[68:71]
  s_add_u32 m0, s52, 16384
  ds_read_b128 a[64:67], v247 offset:20480
  v_exp_f32 v145, v145
  v_mfma_f32_16x16x32_bf16 v[68:71], a[108:111], v[192:195], v[68:71]
  ds_read_b128 a[68:71], v247 offset:28672
  v_cvt_pk_bf16_f32 v144, v144, v145
  v_mfma_f32_16x16x32_bf16 v[100:103], a[108:111], v[200:203], v[100:103]
  v_exp_f32 v146, v146
  v_mfma_f32_16x16x32_bf16 v[100:103], a[104:107], v[184:187], v[100:103]
  s_waitcnt lgkmcnt(2)
  ds_read_b128 a[72:75], v247 offset:21504
  v_mfma_f32_16x16x32_bf16 v[72:75], a[112:115], v[176:179], v[72:75]
  ds_read_b128 a[76:79], v247 offset:29696
  v_mfma_f32_16x16x32_bf16 v[72:75], a[116:119], v[192:195], v[72:75]
  buffer_load_dwordx4 v251, s[8:11], s55 offen offset:0 sc1 lds
  v_mfma_f32_16x16x32_bf16 v[104:107], a[116:119], v[200:203], v[104:107]
  v_exp_f32 v147, v147
  v_mfma_f32_16x16x32_bf16 v[104:107], a[112:115], v[184:187], v[104:107]
  ds_read_b128 a[80:83], v247 offset:22528
  v_cvt_pk_bf16_f32 v145, v146, v147
  v_mfma_f32_16x16x32_bf16 v[76:79], a[120:123], v[176:179], v[76:79]
  ds_read_b128 a[84:87], v247 offset:30720
  v_mfma_f32_16x16x32_bf16 v[76:79], a[124:127], v[192:195], v[76:79]
  buffer_load_dwordx4 v251, s[8:11], s55 offen offset:1024 sc1 lds
  v_mfma_f32_16x16x32_bf16 v[108:111], a[124:127], v[200:203], v[108:111]
  v_exp_f32 v148, v148
  v_mfma_f32_16x16x32_bf16 v[108:111], a[120:123], v[184:187], v[108:111]
  s_waitcnt lgkmcnt(2)
  ds_read_b128 a[88:91], v247 offset:23552
  v_mfma_f32_16x16x32_bf16 v[80:83], a[64:67], v[176:179], v[80:83]
  ds_read_b128 a[92:95], v247 offset:31744
  v_xor_b32 v247, 0x8000, v247
  v_mfma_f32_16x16x32_bf16 v[80:83], a[68:71], v[192:195], v[80:83]
  v_exp_f32 v149, v149
  v_mfma_f32_16x16x32_bf16 v[112:115], a[68:71], v[200:203], v[112:115]
  buffer_load_dwordx4 v251, s[8:11], s55 offen offset:2048 sc1 lds
  v_cvt_pk_bf16_f32 v146, v148, v149
  v_mfma_f32_16x16x32_bf16 v[112:115], a[64:67], v[184:187], v[112:115]
  v_exp_f32 v150, v150
  v_mfma_f32_16x16x32_bf16 v[84:87], a[72:75], v[176:179], v[84:87]
  buffer_load_dwordx4 v251, s[8:11], s55 offen offset:3072 sc1 lds
  v_mfma_f32_16x16x32_bf16 v[84:87], a[76:79], v[192:195], v[84:87]
  s_add_u32 s55, s55, 32768
  v_exp_f32 v151, v151
  v_mfma_f32_16x16x32_bf16 v[116:119], a[76:79], v[200:203], v[116:119]
  s_xor_b64 s[52:53], s[52:53], s[76:77]
  ds_read_b128 a[96:99], v243 offset:16384
  v_cvt_pk_bf16_f32 v147, v150, v151
  v_mfma_f32_16x16x32_bf16 v[116:119], a[72:75], v[184:187], v[116:119]
  s_waitcnt lgkmcnt(1)
  v_exp_f32 v152, v152
  v_mfma_f32_16x16x32_bf16 v[88:91], a[80:83], v[176:179], v[88:91]
  ds_read_b128 a[100:103], v243 offset:17408
  v_mfma_f32_16x16x32_bf16 v[88:91], a[84:87], v[192:195], v[88:91]
  ds_read_b128 a[104:107], v243 offset:18432
  v_mfma_f32_16x16x32_bf16 v[120:123], a[84:87], v[200:203], v[120:123]
  v_exp_f32 v153, v153
  v_mfma_f32_16x16x32_bf16 v[120:123], a[80:83], v[184:187], v[120:123]
  ds_read_b128 a[108:111], v243 offset:19456
  v_cvt_pk_bf16_f32 v152, v152, v153
  v_mfma_f32_16x16x32_bf16 v[92:95], a[88:91], v[176:179], v[92:95]
  v_exp_f32 v154, v154
  v_mfma_f32_16x16x32_bf16 v[92:95], a[92:95], v[192:195], v[92:95]
  ds_read_b128 a[112:115], v243 offset:20480
  v_mfma_f32_16x16x32_bf16 v[124:127], a[92:95], v[200:203], v[124:127]
  ds_read_b128 a[116:119], v243 offset:21504
  v_mfma_f32_16x16x32_bf16 v[124:127], a[88:91], v[184:187], v[124:127]
  v_exp_f32 v155, v155
  v_mfma_f32_16x16x32_bf16 v[136:139], a[232:235], v[176:179], v[136:139]
  s_sub_u32 s56, s56, 1
  ds_read_b128 a[120:123], v243 offset:22528
  v_cvt_pk_bf16_f32 v153, v154, v155
  v_mfma_f32_16x16x32_bf16 v[136:139], a[232:235], v[192:195], v[136:139]
  ds_read_b128 a[124:127], v243 offset:23552
  v_mfma_f32_16x16x32_bf16 v[140:143], a[232:235], v[200:203], v[140:143]
  v_mfma_f32_16x16x32_bf16 v[140:143], a[232:235], v[184:187], v[140:143]
  s_cbranch_scc0 recurrent_scan__compressed_kv_cla__dense_activation_silu__prompt_kernel_ss
recurrent_scan__compressed_kv_cla__dense_activation_silu__prompt_kernel_sx:
  s_waitcnt lgkmcnt(4)
  v_mfma_f32_16x16x32_bf16 v[176:179], a[96:99], a[160:163], v[216:219]
  s_waitcnt vmcnt(16)
  ds_read_b64_tr_b16 a[224:225], v235 offset:0
  v_mfma_f32_16x16x32_bf16 v[176:179], a[100:103], a[164:167], v[176:179]
  v_exp_f32 v156, v156
  v_mfma_f32_16x16x32_bf16 v[176:179], a[104:107], a[168:171], v[176:179]
  ds_read_b64_tr_b16 a[226:227], v235 offset:3072
  v_mfma_f32_16x16x32_bf16 v[176:179], a[108:111], a[172:175], v[176:179]
  ds_read_b64_tr_b16 a[228:229], v246 offset:32
  v_mfma_f32_16x16x32_bf16 v[184:187], a[108:111], a[188:191], v[220:223]
  ds_read_b64_tr_b16 a[230:231], v246 offset:3104
  v_mfma_f32_16x16x32_bf16 v[184:187], a[104:107], a[184:187], v[184:187]
  v_exp_f32 v157, v157
  v_mfma_f32_16x16x32_bf16 v[184:187], a[100:103], a[180:183], v[184:187]
  ds_read_b64_tr_b16 a[236:237], v235 offset:64
  v_cvt_pk_bf16_f32 v154, v156, v157
  v_mfma_f32_16x16x32_bf16 v[184:187], a[96:99], a[176:179], v[184:187]
  s_waitcnt lgkmcnt(1)
  ds_read_b64_tr_b16 a[238:239], v235 offset:3136
  v_mfma_f32_16x16x32_bf16 a[0:3], a[224:227], a[208:211], a[0:3]
  v_exp_f32 v158, v158
  v_mfma_f32_16x16x32_bf16 a[20:23], a[224:227], a[212:215], a[20:23]
  ds_read_b64_tr_b16 a[240:241], v246 offset:96
  v_mfma_f32_16x16x32_bf16 a[40:43], a[224:227], a[216:219], a[40:43]
  ds_read_b64_tr_b16 a[242:243], v246 offset:3168
  v_mfma_f32_16x16x32_bf16 a[60:63], a[224:227], a[220:223], a[60:63]
  v_exp_f32 v159, v159
  v_mfma_f32_16x16x32_bf16 a[192:195], a[228:231], a[220:223], a[192:195]
  ds_read_b64_tr_b16 a[244:245], v235 offset:128
  v_cvt_pk_bf16_f32 v155, v158, v159
  v_mfma_f32_16x16x32_bf16 a[44:47], a[228:231], a[216:219], a[44:47]
  ds_read_b64_tr_b16 a[246:247], v235 offset:3200
  v_mfma_f32_16x16x32_bf16 a[24:27], a[228:231], a[212:215], a[24:27]
  s_lshl_b32 s53, s47, 3
  v_exp_f32 v160, v160
  v_mfma_f32_16x16x32_bf16 a[4:7], a[228:231], a[208:211], a[4:7]
  s_waitcnt lgkmcnt(2)
  v_exp_f32 v161, v161
  v_mfma_f32_16x16x32_bf16 a[8:11], a[236:239], a[208:211], a[8:11]
  v_cvt_pk_bf16_f32 v160, v160, v161
  v_mfma_f32_16x16x32_bf16 a[28:31], a[236:239], a[212:215], a[28:31]
  v_exp_f32 v162, v162
  v_mfma_f32_16x16x32_bf16 a[48:51], a[236:239], a[216:219], a[48:51]
  s_add_u32 s53, s53, s45
  v_exp_f32 v163, v163
  v_mfma_f32_16x16x32_bf16 a[196:199], a[236:239], a[220:223], a[196:199]
  ds_read_b128 a[64:67], v243 offset:24576
  v_cvt_pk_bf16_f32 v161, v162, v163
  v_mfma_f32_16x16x32_bf16 a[200:203], a[240:243], a[220:223], a[200:203]
  v_exp_f32 v164, v164
  v_mfma_f32_16x16x32_bf16 a[52:55], a[240:243], a[216:219], a[52:55]
  ds_read_b128 a[68:71], v243 offset:25600
  v_mfma_f32_16x16x32_bf16 a[32:35], a[240:243], a[212:215], a[32:35]
  s_lshl_b32 s53, s53, 5
  v_exp_f32 v165, v165
  v_mfma_f32_16x16x32_bf16 a[12:15], a[240:243], a[208:211], a[12:15]
  s_waitcnt lgkmcnt(2)
  ds_read_b128 a[72:75], v243 offset:26624
  v_cvt_pk_bf16_f32 v162, v164, v165
  v_mfma_f32_16x16x32_bf16 a[16:19], a[244:247], a[208:211], a[16:19]
  v_exp_f32 v166, v166
  v_mfma_f32_16x16x32_bf16 a[36:39], a[244:247], a[212:215], a[36:39]
  ds_read_b128 a[76:79], v243 offset:27648
  v_mfma_f32_16x16x32_bf16 a[56:59], a[244:247], a[216:219], a[56:59]
  s_lshl_b32 s49, s46, 2
  ds_read_b128 a[80:83], v243 offset:28672
  v_mfma_f32_16x16x32_bf16 a[204:207], a[244:247], a[220:223], a[204:207]
  v_exp_f32 v167, v167
  v_mfma_f32_16x16x32_bf16 v[180:183], a[112:115], a[160:163], v[216:219]
  ds_read_b128 a[84:87], v243 offset:29696
  v_cvt_pk_bf16_f32 v163, v166, v167
  v_mfma_f32_16x16x32_bf16 v[180:183], a[116:119], a[164:167], v[180:183]
  v_exp_f32 v168, v168
  v_mfma_f32_16x16x32_bf16 v[180:183], a[120:123], a[168:171], v[180:183]
  s_add_u32 s53, s53, s49
  ds_read_b128 a[88:91], v243 offset:30720
  v_mfma_f32_16x16x32_bf16 v[180:183], a[124:127], a[172:175], v[180:183]
  v_exp_f32 v169, v169
  v_mfma_f32_16x16x32_bf16 v[188:191], a[124:127], a[188:191], v[220:223]
  ds_read_b128 a[92:95], v243 offset:31744
  v_cvt_pk_bf16_f32 v168, v168, v169
  v_mfma_f32_16x16x32_bf16 v[188:191], a[120:123], a[184:187], v[188:191]
  v_exp_f32 v170, v170
  v_mfma_f32_16x16x32_bf16 v[188:191], a[116:119], a[180:183], v[188:191]
  s_add_u32 s53, s53, s3
  ds_read_b128 a[96:99], v247 offset:0
  v_mfma_f32_16x16x32_bf16 v[188:191], a[112:115], a[176:179], v[188:191]
  s_waitcnt lgkmcnt(5)
  ds_read_b128 a[100:103], v247 offset:8192
  v_mfma_f32_16x16x32_bf16 v[192:195], a[64:67], a[160:163], v[216:219]
  v_exp_f32 v171, v171
  v_mfma_f32_16x16x32_bf16 v[192:195], a[68:71], a[164:167], v[192:195]
  ds_read_b128 a[104:107], v247 offset:1024
  v_cvt_pk_bf16_f32 v169, v170, v171
  v_mfma_f32_16x16x32_bf16 v[192:195], a[72:75], a[168:171], v[192:195]
  ds_read_b128 a[108:111], v247 offset:9216
  v_mfma_f32_16x16x32_bf16 v[192:195], a[76:79], a[172:175], v[192:195]
  s_lshl_b32 s53, s53, 2
  v_exp_f32 v172, v172
  v_mfma_f32_16x16x32_bf16 v[200:203], a[76:79], a[188:191], v[220:223]
  v_exp_f32 v173, v173
  v_mfma_f32_16x16x32_bf16 v[200:203], a[72:75], a[184:187], v[200:203]
  ds_read_b128 a[112:115], v247 offset:2048
  v_cvt_pk_bf16_f32 v170, v172, v173
  v_mfma_f32_16x16x32_bf16 v[200:203], a[68:71], a[180:183], v[200:203]
  ds_read_b128 a[116:119], v247 offset:10240
  v_mfma_f32_16x16x32_bf16 v[200:203], a[64:67], a[176:179], v[200:203]
  s_waitcnt lgkmcnt(6)
  v_exp_f32 v174, v174
  v_mfma_f32_16x16x32_bf16 v[196:199], a[80:83], a[160:163], v[216:219]
  s_add_u32 s53, s53, 8256
  v_exp_f32 v175, v175
  v_mfma_f32_16x16x32_bf16 v[196:199], a[84:87], a[164:167], v[196:199]
  ds_read_b128 a[120:123], v247 offset:3072
  v_cvt_pk_bf16_f32 v171, v174, v175
  v_mfma_f32_16x16x32_bf16 v[196:199], a[88:91], a[168:171], v[196:199]
  ds_read_b128 a[124:127], v247 offset:11264
  v_mfma_f32_16x16x32_bf16 v[196:199], a[92:95], a[172:175], v[196:199]
  v_exp_f32 v176, v176
  v_mfma_f32_16x16x32_bf16 v[204:207], a[92:95], a[188:191], v[220:223]
  v_exp_f32 v177, v177
  v_mfma_f32_16x16x32_bf16 v[204:207], a[88:91], a[184:187], v[204:207]
  ds_read_b128 a[64:67], v247 offset:4096
  v_cvt_pk_bf16_f32 v176, v176, v177
  v_mfma_f32_16x16x32_bf16 v[204:207], a[84:87], a[180:183], v[204:207]
  ds_read_b128 a[68:71], v247 offset:12288
  v_mfma_f32_16x16x32_bf16 v[204:207], a[80:83], a[176:179], v[204:207]
  s_waitcnt lgkmcnt(6)
  v_exp_f32 v178, v178
  v_mfma_f32_16x16x32_bf16 v[64:67], a[96:99], v[144:147], v[64:67]
  v_exp_f32 v179, v179
  v_mfma_f32_16x16x32_bf16 v[64:67], a[100:103], v[160:163], v[64:67]
  ds_read_b128 a[72:75], v247 offset:5120
  v_lshlrev_b32 v251, 22, v249
  v_mfma_f32_16x16x32_bf16 v[96:99], a[100:103], v[168:171], v[96:99]
  s_add_u32 s49, s53, s63
  ds_read_b128 a[76:79], v247 offset:13312
  v_cvt_pk_bf16_f32 v177, v178, v179
  v_mfma_f32_16x16x32_bf16 v[96:99], a[96:99], v[152:155], v[96:99]
  v_exp_f32 v180, v180
  v_mfma_f32_16x16x32_bf16 v[68:71], a[104:107], v[144:147], v[68:71]
  v_exp_f32 v181, v181
  v_mfma_f32_16x16x32_bf16 v[68:71], a[108:111], v[160:163], v[68:71]
  ds_read_b128 a[80:83], v247 offset:6144
  v_cvt_pk_bf16_f32 v178, v180, v181
  v_mfma_f32_16x16x32_bf16 v[100:103], a[108:111], v[168:171], v[100:103]
  ds_read_b128 a[84:87], v247 offset:14336
  v_mfma_f32_16x16x32_bf16 v[100:103], a[104:107], v[152:155], v[100:103]
  s_waitcnt lgkmcnt(6)
  v_exp_f32 v182, v182
  v_mfma_f32_16x16x32_bf16 v[72:75], a[112:115], v[144:147], v[72:75]
  v_exp_f32 v183, v183
  v_mfma_f32_16x16x32_bf16 v[72:75], a[116:119], v[160:163], v[72:75]
  ds_read_b128 a[88:91], v247 offset:7168
  v_mov_b32 v254, 1
  v_mfma_f32_16x16x32_bf16 v[104:107], a[116:119], v[168:171], v[104:107]
  ds_read_b128 a[92:95], v247 offset:15360
  v_cvt_pk_bf16_f32 v179, v182, v183
  v_mfma_f32_16x16x32_bf16 v[104:107], a[112:115], v[152:155], v[104:107]
  v_exp_f32 v184, v184
  v_mfma_f32_16x16x32_bf16 v[76:79], a[120:123], v[144:147], v[76:79]
  v_exp_f32 v185, v185
  v_mfma_f32_16x16x32_bf16 v[76:79], a[124:127], v[160:163], v[76:79]
  v_exp_f32 v186, v186
  v_mfma_f32_16x16x32_bf16 v[108:111], a[124:127], v[168:171], v[108:111]
  v_cvt_pk_bf16_f32 v184, v184, v185
  v_mfma_f32_16x16x32_bf16 v[108:111], a[120:123], v[152:155], v[108:111]
  s_waitcnt lgkmcnt(4)
  v_exp_f32 v187, v187
  v_mfma_f32_16x16x32_bf16 v[80:83], a[64:67], v[144:147], v[80:83]
  v_exp_f32 v188, v188
  v_mfma_f32_16x16x32_bf16 v[80:83], a[68:71], v[160:163], v[80:83]
  v_xor_b32 v243, 0x8000, v243
  v_cvt_pk_bf16_f32 v185, v186, v187
  v_mfma_f32_16x16x32_bf16 v[112:115], a[68:71], v[168:171], v[112:115]
  v_exp_f32 v189, v189
  v_mfma_f32_16x16x32_bf16 v[112:115], a[64:67], v[152:155], v[112:115]
  v_mfma_f32_16x16x32_bf16 v[84:87], a[72:75], v[144:147], v[84:87]
  v_exp_f32 v190, v190
  v_mfma_f32_16x16x32_bf16 v[84:87], a[76:79], v[160:163], v[84:87]
  v_cvt_pk_bf16_f32 v186, v188, v189
  v_mfma_f32_16x16x32_bf16 v[116:119], a[76:79], v[168:171], v[116:119]
  v_exp_f32 v191, v191
  v_mfma_f32_16x16x32_bf16 v[116:119], a[72:75], v[152:155], v[116:119]
  s_waitcnt vmcnt(0) lgkmcnt(0)
  s_barrier
  v_mfma_f32_16x16x32_bf16 v[88:91], a[80:83], v[144:147], v[88:91]
  ds_read_b128 a[96:99], v243 offset:0
  v_cmp_gt_i32 s[76:77], 0, v241
  v_mfma_f32_16x16x32_bf16 v[88:91], a[84:87], v[160:163], v[88:91]
  ds_read_b128 a[100:103], v243 offset:1024
  v_cmp_gt_i32 s[78:79], 1, v241
  v_mfma_f32_16x16x32_bf16 v[120:123], a[84:87], v[168:171], v[120:123]
  buffer_store_dword v254, v251, s[68:71], s49 offen sc1
  v_mfma_f32_16x16x32_bf16 v[120:123], a[80:83], v[152:155], v[120:123]
  s_and_b32 s48, s55, 0xffff
  ds_read_b128 a[104:107], v243 offset:2048
  v_cmp_gt_i32 s[80:81], 2, v241
  v_mfma_f32_16x16x32_bf16 v[92:95], a[88:91], v[144:147], v[92:95]
  v_cmp_gt_i32 s[82:83], 3, v241
  v_cndmask_b32 v224, v216, v240, s[76:77]
  v_cndmask_b32 v225, v217, v240, s[78:79]
  v_mfma_f32_16x16x32_bf16 v[92:95], a[92:95], v[160:163], v[92:95]
  v_cndmask_b32 v226, v218, v240, s[80:81]
  v_cndmask_b32 v227, v219, v240, s[82:83]
  v_mfma_f32_16x16x32_bf16 v[124:127], a[92:95], v[168:171], v[124:127]
  ds_read_b128 a[108:111], v243 offset:3072
  v_cvt_pk_bf16_f32 v187, v190, v191
  v_mfma_f32_16x16x32_bf16 v[124:127], a[88:91], v[152:155], v[124:127]
  s_add_u32 m0, s48, s60
  ds_read_b128 a[112:115], v243 offset:4096
  v_mfma_f32_16x16x32_bf16 v[136:139], a[232:235], v[144:147], v[136:139]
  ds_read_b128 a[116:119], v243 offset:5120
  v_cmp_gt_i32 s[76:77], 16, v241
  v_mfma_f32_16x16x32_bf16 v[136:139], a[232:235], v[160:163], v[136:139]
  ds_read_b128 a[120:123], v243 offset:6144
  v_cmp_gt_i32 s[78:79], 17, v241
  v_mfma_f32_16x16x32_bf16 v[140:143], a[232:235], v[168:171], v[140:143]
  v_exp_f32 v192, v192
  v_mfma_f32_16x16x32_bf16 v[140:143], a[232:235], v[152:155], v[140:143]
  s_waitcnt lgkmcnt(3)
  v_cmp_gt_i32 s[80:81], 18, v241
  v_cmp_gt_i32 s[82:83], 19, v241
  v_mfma_f32_16x16x32_bf16 v[144:147], a[96:99], a[160:163], v[224:227]
  v_cndmask_b32 v228, v216, v240, s[76:77]
  v_cndmask_b32 v229, v217, v240, s[78:79]
  v_cndmask_b32 v230, v218, v240, s[80:81]
  v_mfma_f32_16x16x32_bf16 v[144:147], a[100:103], a[164:167], v[144:147]
  ds_read_b128 a[124:127], v243 offset:7168
  v_cndmask_b32 v231, v219, v240, s[82:83]
  v_mfma_f32_16x16x32_bf16 v[144:147], a[104:107], a[168:171], v[144:147]
  v_exp_f32 v193, v193
  v_mfma_f32_16x16x32_bf16 v[144:147], a[108:111], a[172:175], v[144:147]
  ds_read_b128 a[64:67], v243 offset:8192
  v_cvt_pk_bf16_f32 v192, v192, v193
  v_mfma_f32_16x16x32_bf16 v[152:155], a[108:111], a[188:191], v[220:223]
  v_exp_f32 v194, v194
  v_mfma_f32_16x16x32_bf16 v[152:155], a[104:107], a[184:187], v[152:155]
  ds_read_b128 a[68:71], v243 offset:9216
  v_cmp_gt_i32 s[76:77], 32, v241
  v_mfma_f32_16x16x32_bf16 v[152:155], a[100:103], a[180:183], v[152:155]
  v_exp_f32 v195, v195
  v_mfma_f32_16x16x32_bf16 v[152:155], a[96:99], a[176:179], v[152:155]
  s_waitcnt lgkmcnt(2)
  ds_read_b128 a[72:75], v243 offset:10240
  v_cvt_pk_bf16_f32 v193, v194, v195
  v_mfma_f32_16x16x32_bf16 v[148:151], a[112:115], a[160:163], v[228:231]
  v_exp_f32 v196, v196
  v_cmp_gt_i32 s[78:79], 33, v241
  v_mfma_f32_16x16x32_bf16 v[148:151], a[116:119], a[164:167], v[148:151]
  v_cmp_gt_i32 s[80:81], 34, v241
  v_cmp_gt_i32 s[82:83], 35, v241
  v_cndmask_b32 v224, v216, v240, s[76:77]
  v_mfma_f32_16x16x32_bf16 v[148:151], a[120:123], a[168:171], v[148:151]
  v_cndmask_b32 v225, v217, v240, s[78:79]
  v_cndmask_b32 v226, v218, v240, s[80:81]
  v_cndmask_b32 v227, v219, v240, s[82:83]
  v_mfma_f32_16x16x32_bf16 v[148:151], a[124:127], a[172:175], v[148:151]
  ds_read_b128 a[76:79], v243 offset:11264
  v_exp_f32 v197, v197
  v_mfma_f32_16x16x32_bf16 v[156:159], a[124:127], a[188:191], v[220:223]
  buffer_load_dwordx4 v244, s[12:15], s55 offen offset:0 sc1 lds
  v_cvt_pk_bf16_f32 v194, v196, v197
  v_mfma_f32_16x16x32_bf16 v[156:159], a[120:123], a[184:187], v[156:159]
  ds_read_b128 a[80:83], v243 offset:12288
  v_cmp_gt_i32 s[76:77], 48, v241
  v_mfma_f32_16x16x32_bf16 v[156:159], a[116:119], a[180:183], v[156:159]
  ds_read_b128 a[84:87], v243 offset:13312
  v_exp_f32 v198, v198
  v_mfma_f32_16x16x32_bf16 v[156:159], a[112:115], a[176:179], v[156:159]
  s_waitcnt lgkmcnt(2)
  v_exp_f32 v199, v199
  v_mfma_f32_16x16x32_bf16 v[160:163], a[64:67], a[160:163], v[224:227]
  ds_read_b128 a[88:91], v243 offset:14336
  v_cvt_pk_bf16_f32 v195, v198, v199
  v_cmp_gt_i32 s[78:79], 49, v241
  v_mfma_f32_16x16x32_bf16 v[160:163], a[68:71], a[164:167], v[160:163]
  v_exp_f32 v200, v200
  v_cmp_gt_i32 s[80:81], 50, v241
  v_mfma_f32_16x16x32_bf16 v[160:163], a[72:75], a[168:171], v[160:163]
  v_cmp_gt_i32 s[82:83], 51, v241
  v_cndmask_b32 v228, v216, v240, s[76:77]
  v_cndmask_b32 v229, v217, v240, s[78:79]
  v_mfma_f32_16x16x32_bf16 v[160:163], a[76:79], a[172:175], v[160:163]
  ds_read_b128 a[92:95], v243 offset:15360
  v_cndmask_b32 v230, v218, v240, s[80:81]
  v_cndmask_b32 v231, v219, v240, s[82:83]
  v_mfma_f32_16x16x32_bf16 v[168:171], a[76:79], a[188:191], v[220:223]
  ds_read_b128 a[96:99], v247 offset:16384
  v_exp_f32 v201, v201
  v_mfma_f32_16x16x32_bf16 v[168:171], a[72:75], a[184:187], v[168:171]
  ds_read_b128 a[100:103], v247 offset:24576
  v_cvt_pk_bf16_f32 v200, v200, v201
  v_mfma_f32_16x16x32_bf16 v[168:171], a[68:71], a[180:183], v[168:171]
  v_exp_f32 v202, v202
  v_mfma_f32_16x16x32_bf16 v[168:171], a[64:67], a[176:179], v[168:171]
  s_waitcnt lgkmcnt(2)
  v_exp_f32 v203, v203
  v_mfma_f32_16x16x32_bf16 v[164:167], a[80:83], a[160:163], v[228:231]
  buffer_load_dwordx4 v244, s[12:15], s55 offen offset:1024 sc1 lds
  v_cvt_pk_bf16_f32 v201, v202, v203
  v_mfma_f32_16x16x32_bf16 v[164:167], a[84:87], a[164:167], v[164:167]
  ds_read_b128 a[104:107], v247 offset:17408
  v_exp_f32 v204, v204
  v_mfma_f32_16x16x32_bf16 v[164:167], a[88:91], a[168:171], v[164:167]
  ds_read_b128 a[108:111], v247 offset:25600
  v_exp_f32 v205, v205
  v_mfma_f32_16x16x32_bf16 v[164:167], a[92:95], a[172:175], v[164:167]
  ds_read_b128 a[112:115], v247 offset:18432
  v_cvt_pk_bf16_f32 v202, v204, v205
  v_mfma_f32_16x16x32_bf16 v[172:175], a[92:95], a[188:191], v[220:223]
  ds_read_b128 a[116:119], v247 offset:26624
  v_exp_f32 v206, v206
  v_mfma_f32_16x16x32_bf16 v[172:175], a[88:91], a[184:187], v[172:175]
  v_exp_f32 v207, v207
  v_mfma_f32_16x16x32_bf16 v[172:175], a[84:87], a[180:183], v[172:175]
  ds_read_b128 a[120:123], v247 offset:19456
  v_cvt_pk_bf16_f32 v203, v206, v207
  v_mfma_f32_16x16x32_bf16 v[172:175], a[80:83], a[176:179], v[172:175]
  s_waitcnt lgkmcnt(3)
  ds_read_b128 a[124:127], v247 offset:27648
  v_mfma_f32_16x16x32_bf16 v[64:67], a[96:99], v[176:179], v[64:67]
  buffer_load_dwordx4 v244, s[12:15], s55 offen offset:2048 sc1 lds
  v_mfma_f32_16x16x32_bf16 v[64:67], a[100:103], v[192:195], v[64:67]
  v_exp_f32 v144, v144
  v_mfma_f32_16x16x32_bf16 v[96:99], a[100:103], v[200:203], v[96:99]
  v_exp_f32 v145, v145
  v_mfma_f32_16x16x32_bf16 v[96:99], a[96:99], v[184:187], v[96:99]
  ds_read_b128 a[64:67], v247 offset:20480
  v_cvt_pk_bf16_f32 v144, v144, v145
  v_mfma_f32_16x16x32_bf16 v[68:71], a[104:107], v[176:179], v[68:71]
  ds_read_b128 a[68:71], v247 offset:28672
  v_exp_f32 v146, v146
  v_mfma_f32_16x16x32_bf16 v[68:71], a[108:111], v[192:195], v[68:71]
  v_exp_f32 v147, v147
  v_mfma_f32_16x16x32_bf16 v[100:103], a[108:111], v[200:203], v[100:103]
  v_exp_f32 v148, v148
  v_mfma_f32_16x16x32_bf16 v[100:103], a[104:107], v[184:187], v[100:103]
  s_waitcnt lgkmcnt(2)
  ds_read_b128 a[72:75], v247 offset:21504
  v_cvt_pk_bf16_f32 v145, v146, v147
  v_mfma_f32_16x16x32_bf16 v[72:75], a[112:115], v[176:179], v[72:75]
  ds_read_b128 a[76:79], v247 offset:29696
  v_mfma_f32_16x16x32_bf16 v[72:75], a[116:119], v[192:195], v[72:75]
  v_exp_f32 v149, v149
  v_mfma_f32_16x16x32_bf16 v[104:107], a[116:119], v[200:203], v[104:107]
  v_exp_f32 v150, v150
  v_mfma_f32_16x16x32_bf16 v[104:107], a[112:115], v[184:187], v[104:107]
  ds_read_b128 a[80:83], v247 offset:22528
  v_cvt_pk_bf16_f32 v146, v148, v149
  v_mfma_f32_16x16x32_bf16 v[76:79], a[120:123], v[176:179], v[76:79]
  buffer_load_dwordx4 v244, s[12:15], s55 offen offset:3072 sc1 lds
  v_mfma_f32_16x16x32_bf16 v[76:79], a[124:127], v[192:195], v[76:79]
  ds_read_b128 a[84:87], v247 offset:30720
  v_exp_f32 v151, v151
  v_mfma_f32_16x16x32_bf16 v[108:111], a[124:127], v[200:203], v[108:111]
  v_exp_f32 v152, v152
  v_cvt_pk_bf16_f32 v147, v150, v151
  v_mfma_f32_16x16x32_bf16 v[108:111], a[120:123], v[184:187], v[108:111]
  s_waitcnt lgkmcnt(2)
  v_exp_f32 v153, v153
  v_mfma_f32_16x16x32_bf16 v[80:83], a[64:67], v[176:179], v[80:83]
  s_add_u32 s55, s55, 16384
  ds_read_b128 a[88:91], v247 offset:23552
  v_cvt_pk_bf16_f32 v152, v152, v153
  v_mfma_f32_16x16x32_bf16 v[80:83], a[68:71], v[192:195], v[80:83]
  ds_read_b128 a[92:95], v247 offset:31744
  v_xor_b32 v247, 0x8000, v247
  v_mfma_f32_16x16x32_bf16 v[112:115], a[68:71], v[200:203], v[112:115]
  v_exp_f32 v154, v154
  v_mfma_f32_16x16x32_bf16 v[112:115], a[64:67], v[184:187], v[112:115]
  v_exp_f32 v155, v155
  v_mfma_f32_16x16x32_bf16 v[84:87], a[72:75], v[176:179], v[84:87]
  v_exp_f32 v156, v156
  v_cvt_pk_bf16_f32 v153, v154, v155
  v_mfma_f32_16x16x32_bf16 v[84:87], a[76:79], v[192:195], v[84:87]
  v_exp_f32 v157, v157
  v_mfma_f32_16x16x32_bf16 v[116:119], a[76:79], v[200:203], v[116:119]
  v_exp_f32 v158, v158
  v_cvt_pk_bf16_f32 v154, v156, v157
  v_mfma_f32_16x16x32_bf16 v[116:119], a[72:75], v[184:187], v[116:119]
  s_waitcnt lgkmcnt(0)
  v_exp_f32 v159, v159
  v_mfma_f32_16x16x32_bf16 v[88:91], a[80:83], v[176:179], v[88:91]
  ds_read_b128 a[96:99], v243 offset:16384
  v_cvt_pk_bf16_f32 v155, v158, v159
  v_mfma_f32_16x16x32_bf16 v[88:91], a[84:87], v[192:195], v[88:91]
  v_exp_f32 v160, v160
  v_mfma_f32_16x16x32_bf16 v[120:123], a[84:87], v[200:203], v[120:123]
  ds_read_b128 a[100:103], v243 offset:17408
  v_exp_f32 v161, v161
  v_mfma_f32_16x16x32_bf16 v[120:123], a[80:83], v[184:187], v[120:123]
  ds_read_b128 a[104:107], v243 offset:18432
  v_cvt_pk_bf16_f32 v160, v160, v161
  v_mfma_f32_16x16x32_bf16 v[92:95], a[88:91], v[176:179], v[92:95]
  v_exp_f32 v162, v162
  v_mfma_f32_16x16x32_bf16 v[92:95], a[92:95], v[192:195], v[92:95]
  v_exp_f32 v163, v163
  v_mfma_f32_16x16x32_bf16 v[124:127], a[92:95], v[200:203], v[124:127]
  ds_read_b128 a[108:111], v243 offset:19456
  v_cvt_pk_bf16_f32 v161, v162, v163
  v_mfma_f32_16x16x32_bf16 v[124:127], a[88:91], v[184:187], v[124:127]
  ds_read_b128 a[112:115], v243 offset:20480
  v_exp_f32 v164, v164
  v_mfma_f32_16x16x32_bf16 v[136:139], a[232:235], v[176:179], v[136:139]
  ds_read_b128 a[116:119], v243 offset:21504
  v_exp_f32 v165, v165
  v_mfma_f32_16x16x32_bf16 v[136:139], a[232:235], v[192:195], v[136:139]
  ds_read_b128 a[120:123], v243 offset:22528
  v_cvt_pk_bf16_f32 v162, v164, v165
  v_mfma_f32_16x16x32_bf16 v[140:143], a[232:235], v[200:203], v[140:143]
  ds_read_b128 a[124:127], v243 offset:23552
  v_exp_f32 v166, v166
  v_mfma_f32_16x16x32_bf16 v[140:143], a[232:235], v[184:187], v[140:143]
  v_exp_f32 v167, v167
  s_nop 0
  v_cvt_pk_bf16_f32 v163, v166, v167
recurrent_scan__compressed_kv_cla__dense_activation_silu__prompt_kernel_x:
  v_cmp_gt_i32 s[76:77], 0, v242
  v_cmp_gt_i32 s[78:79], 1, v242
  v_cmp_gt_i32 s[80:81], 2, v242
  v_cmp_gt_i32 s[82:83], 3, v242
  v_cndmask_b32 v224, v220, v240, s[76:77]
  v_cndmask_b32 v225, v221, v240, s[78:79]
  v_cndmask_b32 v226, v222, v240, s[80:81]
  v_cndmask_b32 v227, v223, v240, s[82:83]
  s_waitcnt lgkmcnt(4)
  s_nop 0
  v_mfma_f32_16x16x32_bf16 v[184:187], a[96:99], a[176:179], v[224:227]
  s_lshl_b32 s53, s47, 3
  ds_read_b128 a[64:67], v243 offset:24576
  v_cmp_gt_i32 s[76:77], 16, v242
  v_mfma_f32_16x16x32_bf16 v[184:187], a[100:103], a[180:183], v[184:187]
  s_add_u32 s53, s53, s45
  ds_read_b128 a[68:71], v243 offset:25600
  v_cmp_gt_i32 s[78:79], 17, v242
  v_mfma_f32_16x16x32_bf16 v[184:187], a[104:107], a[184:187], v[184:187]
  v_cmp_gt_i32 s[80:81], 18, v242
  v_cmp_gt_i32 s[82:83], 19, v242
  v_cndmask_b32 v228, v220, v240, s[76:77]
  v_cndmask_b32 v229, v221, v240, s[78:79]
  v_cndmask_b32 v230, v222, v240, s[80:81]
  v_cndmask_b32 v231, v223, v240, s[82:83]
  v_mfma_f32_16x16x32_bf16 v[184:187], a[108:111], a[188:191], v[184:187]
  s_waitcnt lgkmcnt(2)
  ds_read_b128 a[72:75], v243 offset:26624
  s_lshl_b32 s53, s53, 5
  v_mfma_f32_16x16x32_bf16 v[188:191], a[112:115], a[176:179], v[228:231]
  s_lshl_b32 s49, s46, 2
  ds_read_b128 a[76:79], v243 offset:27648
  v_cmp_gt_i32 s[76:77], 32, v242
  v_mfma_f32_16x16x32_bf16 v[188:191], a[116:119], a[180:183], v[188:191]
  s_add_u32 s53, s53, s49
  ds_read_b128 a[80:83], v243 offset:28672
  v_cmp_gt_i32 s[78:79], 33, v242
  v_mfma_f32_16x16x32_bf16 v[188:191], a[120:123], a[184:187], v[188:191]
  v_cmp_gt_i32 s[80:81], 34, v242
  v_cmp_gt_i32 s[82:83], 35, v242
  v_cndmask_b32 v224, v220, v240, s[76:77]
  v_cndmask_b32 v225, v221, v240, s[78:79]
  v_cndmask_b32 v226, v222, v240, s[80:81]
  v_cndmask_b32 v227, v223, v240, s[82:83]
  v_mfma_f32_16x16x32_bf16 v[188:191], a[124:127], a[188:191], v[188:191]
  s_waitcnt lgkmcnt(1)
  ds_read_b128 a[84:87], v243 offset:29696
  s_add_u32 s53, s53, s3
  v_mfma_f32_16x16x32_bf16 v[200:203], a[64:67], a[176:179], v[224:227]
  ds_read_b128 a[88:91], v243 offset:30720
  ds_read_b128 a[92:95], v243 offset:31744
  v_mfma_f32_16x16x32_bf16 v[200:203], a[68:71], a[180:183], v[200:203]
  s_lshl_b32 s53, s53, 2
  ds_read_b128 a[96:99], v247 offset:0
  v_exp_f32 v168, v168
  v_mfma_f32_16x16x32_bf16 v[200:203], a[72:75], a[184:187], v[200:203]
  v_cmp_gt_i32 s[76:77], 48, v242
  v_cmp_gt_i32 s[78:79], 49, v242
  v_cmp_gt_i32 s[80:81], 50, v242
  v_cmp_gt_i32 s[82:83], 51, v242
  v_cndmask_b32 v228, v220, v240, s[76:77]
  v_cndmask_b32 v229, v221, v240, s[78:79]
  v_cndmask_b32 v230, v222, v240, s[80:81]
  v_cndmask_b32 v231, v223, v240, s[82:83]
  v_mfma_f32_16x16x32_bf16 v[200:203], a[76:79], a[188:191], v[200:203]
  s_waitcnt lgkmcnt(1)
  ds_read_b128 a[100:103], v247 offset:8192
  v_exp_f32 v169, v169
  v_mfma_f32_16x16x32_bf16 v[204:207], a[80:83], a[176:179], v[228:231]
  ds_read_b128 a[104:107], v247 offset:1024
  ds_read_b128 a[108:111], v247 offset:9216
  v_mfma_f32_16x16x32_bf16 v[204:207], a[84:87], a[180:183], v[204:207]
  s_add_u32 s53, s53, 8256
  v_exp_f32 v170, v170
  v_cvt_pk_bf16_f32 v168, v168, v169
  v_mfma_f32_16x16x32_bf16 v[204:207], a[88:91], a[184:187], v[204:207]
  ds_read_b128 a[112:115], v247 offset:2048
  v_exp_f32 v171, v171
  v_mfma_f32_16x16x32_bf16 v[204:207], a[92:95], a[188:191], v[204:207]
  s_waitcnt lgkmcnt(1)
  v_exp_f32 v172, v172
  v_cvt_pk_bf16_f32 v169, v170, v171
  v_mfma_f32_16x16x32_bf16 v[64:67], a[96:99], v[144:147], v[64:67]
  v_exp_f32 v173, v173
  v_exp_f32 v174, v174
  v_exp_f32 v175, v175
  v_cvt_pk_bf16_f32 v170, v172, v173
  v_cvt_pk_bf16_f32 v171, v174, v175
  v_mfma_f32_16x16x32_bf16 v[64:67], a[100:103], v[160:163], v[64:67]
  ds_read_b128 a[116:119], v247 offset:10240
  v_lshlrev_b32 v251, 22, v249
  s_add_u32 s49, s53, s63
  v_mfma_f32_16x16x32_bf16 v[96:99], a[100:103], v[168:171], v[96:99]
  ds_read_b128 a[120:123], v247 offset:3072
  v_mov_b32 v254, 1
  v_accvgpr_read_b32 v232, a248
  v_mfma_f32_16x16x32_bf16 v[96:99], a[96:99], v[152:155], v[96:99]
  ds_read_b128 a[124:127], v247 offset:11264
  v_accvgpr_read_b32 v233, a249
  v_accvgpr_read_b32 v234, a250
  v_mfma_f32_16x16x32_bf16 v[68:71], a[104:107], v[144:147], v[68:71]
  ds_read_b128 a[64:67], v247 offset:4096
  v_accvgpr_read_b32 v235, a251
  v_mfma_f32_16x16x32_bf16 v[68:71], a[108:111], v[160:163], v[68:71]
  ds_read_b128 a[68:71], v247 offset:12288
  v_accvgpr_read_b32 v246, a252
  v_mfma_f32_16x16x32_bf16 v[100:103], a[108:111], v[168:171], v[100:103]
  s_add_u32 s51, s46, 0
  v_exp_f32 v184, v184
  v_mfma_f32_16x16x32_bf16 v[100:103], a[104:107], v[152:155], v[100:103]
  s_waitcnt lgkmcnt(2)
  s_and_b32 s51, s51, 3
  v_exp_f32 v185, v185
  v_mfma_f32_16x16x32_bf16 v[72:75], a[112:115], v[144:147], v[72:75]
  s_mul_i32 s51, s51, 163840
  ds_read_b128 a[72:75], v247 offset:5120
  v_cvt_pk_bf16_f32 v184, v184, v185
  v_mfma_f32_16x16x32_bf16 v[72:75], a[116:119], v[160:163], v[72:75]
  s_add_u32 m0, s61, 143360
  ds_read_b128 a[76:79], v247 offset:13312
  v_exp_f32 v186, v186
  v_mfma_f32_16x16x32_bf16 v[104:107], a[116:119], v[168:171], v[104:107]
  v_exp_f32 v187, v187
  v_mfma_f32_16x16x32_bf16 v[104:107], a[112:115], v[152:155], v[104:107]
  buffer_load_dwordx4 v232, s[24:27], s51 offen offset:0 lds
  v_mfma_f32_16x16x32_bf16 v[76:79], a[120:123], v[144:147], v[76:79]
  ds_read_b128 a[80:83], v247 offset:6144
  v_cvt_pk_bf16_f32 v185, v186, v187
  v_mfma_f32_16x16x32_bf16 v[76:79], a[124:127], v[160:163], v[76:79]
  ds_read_b128 a[84:87], v247 offset:14336
  v_exp_f32 v188, v188
  v_mfma_f32_16x16x32_bf16 v[108:111], a[124:127], v[168:171], v[108:111]
  buffer_load_dwordx4 v233, s[24:27], s51 offen offset:1024 lds
  v_mfma_f32_16x16x32_bf16 v[108:111], a[120:123], v[152:155], v[108:111]
  s_waitcnt lgkmcnt(2)
  v_exp_f32 v189, v189
  v_mfma_f32_16x16x32_bf16 v[80:83], a[64:67], v[144:147], v[80:83]
  buffer_load_dwordx4 v234, s[24:27], s51 offen offset:2048 lds
  v_cvt_pk_bf16_f32 v186, v188, v189
  v_mfma_f32_16x16x32_bf16 v[80:83], a[68:71], v[160:163], v[80:83]
  ds_read_b128 a[88:91], v247 offset:7168
  v_exp_f32 v190, v190
  v_mfma_f32_16x16x32_bf16 v[112:115], a[68:71], v[168:171], v[112:115]
  ds_read_b128 a[92:95], v247 offset:15360
  v_exp_f32 v191, v191
  v_mfma_f32_16x16x32_bf16 v[112:115], a[64:67], v[152:155], v[112:115]
  buffer_load_dwordx4 v235, s[24:27], s51 offen offset:3072 lds
  v_mfma_f32_16x16x32_bf16 v[84:87], a[72:75], v[144:147], v[84:87]
  s_add_u32 m0, s61, 147456
  v_cvt_pk_bf16_f32 v187, v190, v191
  v_mfma_f32_16x16x32_bf16 v[84:87], a[76:79], v[160:163], v[84:87]
  buffer_load_dwordx4 v246, s[24:27], s51 offen offset:0 lds
  v_mfma_f32_16x16x32_bf16 v[116:119], a[76:79], v[168:171], v[116:119]
  v_exp_f32 v200, v200
  v_mfma_f32_16x16x32_bf16 v[116:119], a[72:75], v[152:155], v[116:119]
  s_waitcnt vmcnt(5)
  s_barrier
  s_waitcnt lgkmcnt(0)
  v_mfma_f32_16x16x32_bf16 v[88:91], a[80:83], v[144:147], v[88:91]
  v_exp_f32 v201, v201
  v_mfma_f32_16x16x32_bf16 v[88:91], a[84:87], v[160:163], v[88:91]
  v_exp_f32 v202, v202
  v_cvt_pk_bf16_f32 v200, v200, v201
  v_mfma_f32_16x16x32_bf16 v[120:123], a[84:87], v[168:171], v[120:123]
  ds_read_b128 a[96:99], v247 offset:16384
  v_mfma_f32_16x16x32_bf16 v[120:123], a[80:83], v[152:155], v[120:123]
  ds_read_b128 a[100:103], v247 offset:24576
  v_exp_f32 v203, v203
  v_mfma_f32_16x16x32_bf16 v[92:95], a[88:91], v[144:147], v[92:95]
  ds_read_b128 a[104:107], v247 offset:17408
  v_cvt_pk_bf16_f32 v201, v202, v203
  v_mfma_f32_16x16x32_bf16 v[92:95], a[92:95], v[160:163], v[92:95]
  ds_read_b128 a[108:111], v247 offset:25600
  v_exp_f32 v204, v204
  v_mfma_f32_16x16x32_bf16 v[124:127], a[92:95], v[168:171], v[124:127]
  buffer_store_dword v254, v251, s[68:71], s49 offen sc1
  v_mfma_f32_16x16x32_bf16 v[124:127], a[88:91], v[152:155], v[124:127]
  s_add_u32 s51, s46, 0
  ds_read_b128 a[112:115], v247 offset:18432
  s_and_b32 s51, s51, 3
  v_mfma_f32_16x16x32_bf16 v[136:139], a[232:235], v[144:147], v[136:139]
  s_mul_i32 s51, s51, 163840
  ds_read_b128 a[116:119], v247 offset:26624
  s_add_u32 s51, s51, 81920
  v_mfma_f32_16x16x32_bf16 v[136:139], a[232:235], v[160:163], v[136:139]
  s_add_u32 m0, s61, 0
  ds_read_b128 a[120:123], v247 offset:19456
  v_exp_f32 v205, v205
  v_mfma_f32_16x16x32_bf16 v[140:143], a[232:235], v[168:171], v[140:143]
  ds_read_b128 a[124:127], v247 offset:27648
  v_cvt_pk_bf16_f32 v202, v204, v205
  v_mfma_f32_16x16x32_bf16 v[140:143], a[232:235], v[152:155], v[140:143]
  s_waitcnt lgkmcnt(4)
  v_exp_f32 v206, v206
  v_exp_f32 v207, v207
  s_nop 0
  v_cvt_pk_bf16_f32 v203, v206, v207
  v_mfma_f32_16x16x32_bf16 v[96:99], a[96:99], v[184:187], v[96:99]
  ds_read_b128 a[64:67], v247 offset:20480
  v_mfma_f32_16x16x32_bf16 v[96:99], a[100:103], v[200:203], v[96:99]
  ds_read_b128 a[68:71], v247 offset:28672
  v_mfma_f32_16x16x32_bf16 v[100:103], a[104:107], v[184:187], v[100:103]
  ds_read_b128 a[72:75], v247 offset:21504
  v_mfma_f32_16x16x32_bf16 v[100:103], a[108:111], v[200:203], v[100:103]
  s_waitcnt lgkmcnt(3)
  ds_read_b128 a[76:79], v247 offset:29696
  v_mfma_f32_16x16x32_bf16 v[104:107], a[112:115], v[184:187], v[104:107]
  ds_read_b128 a[80:83], v247 offset:22528
  v_mfma_f32_16x16x32_bf16 v[104:107], a[116:119], v[200:203], v[104:107]
  ds_read_b128 a[84:87], v247 offset:30720
  v_mfma_f32_16x16x32_bf16 v[108:111], a[120:123], v[184:187], v[108:111]
  buffer_load_dwordx4 v232, s[24:27], s51 offen offset:0 lds
  v_mfma_f32_16x16x32_bf16 v[108:111], a[124:127], v[200:203], v[108:111]
  s_waitcnt lgkmcnt(2)
  ds_read_b128 a[88:91], v247 offset:23552
  v_mfma_f32_16x16x32_bf16 v[112:115], a[64:67], v[184:187], v[112:115]
  ds_read_b128 a[92:95], v247 offset:31744
  v_mfma_f32_16x16x32_bf16 v[112:115], a[68:71], v[200:203], v[112:115]
  buffer_load_dwordx4 v233, s[24:27], s51 offen offset:1024 lds
  v_mfma_f32_16x16x32_bf16 v[116:119], a[72:75], v[184:187], v[116:119]
  buffer_load_dwordx4 v234, s[24:27], s51 offen offset:2048 lds
  v_mfma_f32_16x16x32_bf16 v[116:119], a[76:79], v[200:203], v[116:119]
  s_waitcnt lgkmcnt(0)
  buffer_load_dwordx4 v235, s[24:27], s51 offen offset:3072 lds
  v_mfma_f32_16x16x32_bf16 v[120:123], a[80:83], v[184:187], v[120:123]
  s_add_u32 m0, s61, 4096
  v_mfma_f32_16x16x32_bf16 v[120:123], a[84:87], v[200:203], v[120:123]
  buffer_load_dwordx4 v246, s[24:27], s51 offen offset:0 lds
  v_mfma_f32_16x16x32_bf16 v[124:127], a[88:91], v[184:187], v[124:127]
  v_mfma_f32_16x16x32_bf16 v[124:127], a[92:95], v[200:203], v[124:127]
  v_mfma_f32_16x16x32_bf16 v[140:143], a[232:235], v[184:187], v[140:143]
  v_mfma_f32_16x16x32_bf16 v[140:143], a[232:235], v[200:203], v[140:143]
  s_load_dwordx2 s[80:81], s[0:1], 0
  s_load_dwordx2 s[82:83], s[0:1], 72
  s_andn2_b32 s55, s53, 48
  v_and_b32 v252, 3, v249
  v_lshlrev_b32 v252, 4, v252
  buffer_load_dword v253, v252, s[68:71], s55 offen sc1
  s_mov_b32 s51, 0x21800000
  s_mov_b32 s52, 0x5f800000
  v_cmp_gt_f32 s[76:77], v136, s51
  v_cmp_lt_f32 s[78:79], v136, s52
  v_rcp_f32 v250, v136
  s_and_b64 s[86:87], s[86:87], s[76:77]
  s_and_b64 s[86:87], s[86:87], s[78:79]
  v_cmp_gt_f32 s[76:77], v140, s51
  v_cmp_lt_f32 s[78:79], v140, s52
  v_rcp_f32 v251, v140
  s_and_b64 s[86:87], s[86:87], s[76:77]
  s_and_b64 s[86:87], s[86:87], s[78:79]
  s_cmp_eq_u64 s[86:87], -1
  s_cbranch_scc0 recurrent_scan__compressed_kv_cla__dense_activation_silu__prompt_kernel_slow
  v_pk_mul_f32 v[64:65], v[64:65], v[250:251] op_sel_hi:[1,0]
  v_pk_mul_f32 v[66:67], v[66:67], v[250:251] op_sel_hi:[1,0]
  v_pk_mul_f32 v[68:69], v[68:69], v[250:251] op_sel_hi:[1,0]
  v_pk_mul_f32 v[70:71], v[70:71], v[250:251] op_sel_hi:[1,0]
  v_cvt_pk_bf16_f32 v64, v64, v65
  v_cvt_pk_bf16_f32 v65, v66, v67
  v_cvt_pk_bf16_f32 v66, v68, v69
  v_cvt_pk_bf16_f32 v67, v70, v71
  buffer_store_dwordx4 v[64:67], v238, s[16:19], 0 offen offset:0 sc1
  v_pk_mul_f32 v[72:73], v[72:73], v[250:251] op_sel_hi:[1,0]
  v_pk_mul_f32 v[74:75], v[74:75], v[250:251] op_sel_hi:[1,0]
  v_pk_mul_f32 v[76:77], v[76:77], v[250:251] op_sel_hi:[1,0]
  v_pk_mul_f32 v[78:79], v[78:79], v[250:251] op_sel_hi:[1,0]
  v_cvt_pk_bf16_f32 v72, v72, v73
  v_cvt_pk_bf16_f32 v73, v74, v75
  v_cvt_pk_bf16_f32 v74, v76, v77
  v_cvt_pk_bf16_f32 v75, v78, v79
  buffer_store_dwordx4 v[72:75], v238, s[16:19], 0 offen offset:1024 sc1
  v_pk_mul_f32 v[80:81], v[80:81], v[250:251] op_sel_hi:[1,0]
  v_pk_mul_f32 v[82:83], v[82:83], v[250:251] op_sel_hi:[1,0]
  v_pk_mul_f32 v[84:85], v[84:85], v[250:251] op_sel_hi:[1,0]
  v_pk_mul_f32 v[86:87], v[86:87], v[250:251] op_sel_hi:[1,0]
  v_cvt_pk_bf16_f32 v80, v80, v81
  v_cvt_pk_bf16_f32 v81, v82, v83
  v_cvt_pk_bf16_f32 v82, v84, v85
  v_cvt_pk_bf16_f32 v83, v86, v87
  buffer_store_dwordx4 v[80:83], v238, s[16:19], 0 offen offset:2048 sc1
  v_pk_mul_f32 v[88:89], v[88:89], v[250:251] op_sel_hi:[1,0]
  v_pk_mul_f32 v[90:91], v[90:91], v[250:251] op_sel_hi:[1,0]
  v_pk_mul_f32 v[92:93], v[92:93], v[250:251] op_sel_hi:[1,0]
  v_pk_mul_f32 v[94:95], v[94:95], v[250:251] op_sel_hi:[1,0]
  v_cvt_pk_bf16_f32 v88, v88, v89
  v_cvt_pk_bf16_f32 v89, v90, v91
  v_cvt_pk_bf16_f32 v90, v92, v93
  v_cvt_pk_bf16_f32 v91, v94, v95
  buffer_store_dwordx4 v[88:91], v238, s[16:19], 0 offen offset:3072 sc1
  v_pk_mul_f32 v[96:97], v[96:97], v[250:251] op_sel:[0,1] op_sel_hi:[1,1]
  v_pk_mul_f32 v[98:99], v[98:99], v[250:251] op_sel:[0,1] op_sel_hi:[1,1]
  v_pk_mul_f32 v[100:101], v[100:101], v[250:251] op_sel:[0,1] op_sel_hi:[1,1]
  v_pk_mul_f32 v[102:103], v[102:103], v[250:251] op_sel:[0,1] op_sel_hi:[1,1]
  v_cvt_pk_bf16_f32 v96, v96, v97
  v_cvt_pk_bf16_f32 v97, v98, v99
  v_cvt_pk_bf16_f32 v98, v100, v101
  v_cvt_pk_bf16_f32 v99, v102, v103
  buffer_store_dwordx4 v[96:99], v239, s[16:19], 0 offen offset:0 sc1
  v_pk_mul_f32 v[104:105], v[104:105], v[250:251] op_sel:[0,1] op_sel_hi:[1,1]
  v_pk_mul_f32 v[106:107], v[106:107], v[250:251] op_sel:[0,1] op_sel_hi:[1,1]
  v_pk_mul_f32 v[108:109], v[108:109], v[250:251] op_sel:[0,1] op_sel_hi:[1,1]
  v_pk_mul_f32 v[110:111], v[110:111], v[250:251] op_sel:[0,1] op_sel_hi:[1,1]
  v_cvt_pk_bf16_f32 v104, v104, v105
  v_cvt_pk_bf16_f32 v105, v106, v107
  v_cvt_pk_bf16_f32 v106, v108, v109
  v_cvt_pk_bf16_f32 v107, v110, v111
  buffer_store_dwordx4 v[104:107], v239, s[16:19], 0 offen offset:1024 sc1
  v_pk_mul_f32 v[112:113], v[112:113], v[250:251] op_sel:[0,1] op_sel_hi:[1,1]
  v_pk_mul_f32 v[114:115], v[114:115], v[250:251] op_sel:[0,1] op_sel_hi:[1,1]
  v_pk_mul_f32 v[116:117], v[116:117], v[250:251] op_sel:[0,1] op_sel_hi:[1,1]
  v_pk_mul_f32 v[118:119], v[118:119], v[250:251] op_sel:[0,1] op_sel_hi:[1,1]
  v_cvt_pk_bf16_f32 v112, v112, v113
  v_cvt_pk_bf16_f32 v113, v114, v115
  v_cvt_pk_bf16_f32 v114, v116, v117
  v_cvt_pk_bf16_f32 v115, v118, v119
  buffer_store_dwordx4 v[112:115], v239, s[16:19], 0 offen offset:2048 sc1
  v_pk_mul_f32 v[120:121], v[120:121], v[250:251] op_sel:[0,1] op_sel_hi:[1,1]
  v_pk_mul_f32 v[122:123], v[122:123], v[250:251] op_sel:[0,1] op_sel_hi:[1,1]
  v_pk_mul_f32 v[124:125], v[124:125], v[250:251] op_sel:[0,1] op_sel_hi:[1,1]
  v_pk_mul_f32 v[126:127], v[126:127], v[250:251] op_sel:[0,1] op_sel_hi:[1,1]
  v_cvt_pk_bf16_f32 v120, v120, v121
  v_cvt_pk_bf16_f32 v121, v122, v123
  v_cvt_pk_bf16_f32 v122, v124, v125
  v_cvt_pk_bf16_f32 v123, v126, v127
  buffer_store_dwordx4 v[120:123], v239, s[16:19], 0 offen offset:3072 sc1
recurrent_scan__compressed_kv_cla__dense_activation_silu__prompt_kernel_fin:
  v_lshrrev_b32 v250, 4, v249
  v_bfe_u32 v251, v249, 2, 2
  v_lshl_add_u32 v251, v250, 2, v251
  v_and_b32 v254, 3, v249
  v_lshlrev_b32 v254, 3, v254
  v_mul_u32_u24 v224, 320, v251
  v_add_u32 v224, v224, v254
  v_and_b32 v250, 1, v250
  v_lshlrev_b32 v250, 5, v250
  v_sub_u32 v225, v224, v250
  v_add_u32 v224, v224, v250
  v_add_u32 v226, 0x10000, v224
  v_add_u32 v227, 0x10000, v225
  v_add_u32 v228, 0x20000, v224
  v_add_u32 v229, 0x20000, v225
  s_waitcnt lgkmcnt(0)
  s_waitcnt vmcnt(9)
  s_barrier
  ds_read_b64_tr_b16 a[64:65], v228 offset:12288
  ds_read_b64_tr_b16 a[66:67], v228 offset:17408
  ds_read_b64_tr_b16 a[68:69], v228 offset:22528
  ds_read_b64_tr_b16 a[70:71], v228 offset:27648
  ds_read_b64_tr_b16 a[72:73], v224 offset:0
  ds_read_b64_tr_b16 a[74:75], v224 offset:5120
  ds_read_b64_tr_b16 a[76:77], v224 offset:10240
  ds_read_b64_tr_b16 a[78:79], v224 offset:15360
  s_waitcnt lgkmcnt(0)
  v_mfma_f32_16x16x32_bf16 v[4:7], a[64:67], v[0:3], 0
  ds_read_b64_tr_b16 a[80:81], v229 offset:12320
  v_mfma_f32_16x16x32_bf16 v[4:7], a[68:71], v[8:11], v[4:7]
  ds_read_b64_tr_b16 a[82:83], v229 offset:17440
  v_mfma_f32_16x16x32_bf16 v[4:7], a[72:75], v[16:19], v[4:7]
  s_lshl_b32 s56, s44, 20
  ds_read_b64_tr_b16 a[84:85], v229 offset:22560
  v_mfma_f32_16x16x32_bf16 v[4:7], a[76:79], v[24:27], v[4:7]
  ds_read_b64_tr_b16 a[86:87], v229 offset:27680
  s_add_u32 s36, s84, s56
  s_addc_u32 s37, s85, 0
  v_mfma_f32_16x16x32_bf16 v[84:87], a[76:79], v[56:59], 0
  ds_read_b64_tr_b16 a[88:89], v225 offset:32
  s_add_u32 s36, s36, 67108864
  s_addc_u32 s37, s37, 0
  v_mfma_f32_16x16x32_bf16 v[84:87], a[72:75], v[48:51], v[84:87]
  s_mov_b32 s38, 655360
  ds_read_b64_tr_b16 a[90:91], v225 offset:5152
  s_mov_b32 s39, 0x20000
  v_mfma_f32_16x16x32_bf16 v[84:87], a[68:71], v[40:43], v[84:87]
  ds_read_b64_tr_b16 a[92:93], v225 offset:10272
  s_add_u32 s20, s84, 67108864
  s_addc_u32 s21, s85, 0
  v_mfma_f32_16x16x32_bf16 v[84:87], a[64:67], v[32:35], v[84:87]
  ds_read_b64_tr_b16 a[94:95], v225 offset:15392
  s_waitcnt vmcnt(0)
  v_cmp_ne_u32 vcc, 1, v253
  s_cbranch_vccnz recurrent_scan__compressed_kv_cla__dense_activation_silu__prompt_kernel_spin2
recurrent_scan__compressed_kv_cla__dense_activation_silu__prompt_kernel_back2:
  v_mfma_f32_16x16x32_bf16 v[144:147], a[64:67], v[64:67], 0
  s_add_u32 s51, s46, 1
  s_and_b32 s51, s51, 3
  s_mul_i32 s51, s51, 163840
  v_mfma_f32_16x16x32_bf16 v[144:147], a[68:71], v[72:75], v[144:147]
  s_add_u32 m0, s61, 20480
  v_mfma_f32_16x16x32_bf16 v[144:147], a[72:75], v[80:83], v[144:147]
  s_mov_b32 s22, 33554432
  v_mfma_f32_16x16x32_bf16 v[144:147], a[76:79], v[88:91], v[144:147]
  s_mov_b32 s23, 0x20000
  v_mfma_f32_16x16x32_bf16 v[184:187], a[76:79], v[120:123], 0
  buffer_load_dwordx4 v232, s[24:27], s51 offen offset:0 lds
  v_mfma_f32_16x16x32_bf16 v[184:187], a[72:75], v[112:115], v[184:187]
  s_lshl_b32 s54, s47, 3
  ds_read_b64_tr_b16 a[96:97], v228 offset:12352
  v_mfma_f32_16x16x32_bf16 v[184:187], a[68:71], v[104:107], v[184:187]
  s_sub_u32 s49, 118, s54
  ds_read_b64_tr_b16 a[98:99], v228 offset:17472
  v_mfma_f32_16x16x32_bf16 v[184:187], a[64:67], v[96:99], v[184:187]
  s_waitcnt lgkmcnt(2)
  buffer_load_dwordx4 v233, s[24:27], s51 offen offset:1024 lds
  v_mfma_f32_16x16x32_bf16 v[12:15], a[80:83], v[0:3], 0
  ds_read_b64_tr_b16 a[100:101], v228 offset:22592
  s_cmp_lt_u32 s3, 2
  s_cselect_b32 s54, s54, s49
  v_mfma_f32_16x16x32_bf16 v[12:15], a[84:87], v[8:11], v[12:15]
  ds_read_b64_tr_b16 a[102:103], v228 offset:27712
  v_mfma_f32_16x16x32_bf16 v[12:15], a[88:91], v[16:19], v[12:15]
  ds_read_b64_tr_b16 a[104:105], v224 offset:64
  v_mfma_f32_16x16x32_bf16 v[12:15], a[92:95], v[24:27], v[12:15]
  s_add_u32 s54, s54, s3
  ds_read_b64_tr_b16 a[106:107], v224 offset:5184
  v_mfma_f32_16x16x32_bf16 v[92:95], a[92:95], v[56:59], 0
  s_lshl_b32 s49, s46, 1
  ds_read_b64_tr_b16 a[108:109], v224 offset:10304
  v_mfma_f32_16x16x32_bf16 v[92:95], a[88:91], v[48:51], v[92:95]
  ds_read_b64_tr_b16 a[110:111], v224 offset:15424
  v_mfma_f32_16x16x32_bf16 v[92:95], a[84:87], v[40:43], v[92:95]
  s_add_u32 s54, s54, s49
  buffer_load_dwordx4 v234, s[24:27], s51 offen offset:2048 lds
  v_mfma_f32_16x16x32_bf16 v[92:95], a[80:83], v[32:35], v[92:95]
  buffer_load_dwordx4 v235, s[24:27], s51 offen offset:3072 lds
  v_mfma_f32_16x16x32_bf16 v[148:151], a[80:83], v[64:67], 0
  s_add_u32 m0, s61, 24576
  s_mul_i32 s56, s54, 20480
  v_mfma_f32_16x16x32_bf16 v[148:151], a[84:87], v[72:75], v[148:151]
  s_mul_i32 s49, s45, 160
  v_mfma_f32_16x16x32_bf16 v[148:151], a[88:91], v[80:83], v[148:151]
  v_mfma_f32_16x16x32_bf16 v[148:151], a[92:95], v[88:91], v[148:151]
  s_add_u32 s56, s56, s49
  buffer_load_dwordx4 v246, s[24:27], s51 offen offset:0 lds
  v_mfma_f32_16x16x32_bf16 v[188:191], a[92:95], v[120:123], 0
  s_add_u32 s51, s46, 1
  s_and_b32 s51, s51, 3
  s_mul_i32 s51, s51, 163840
  v_mfma_f32_16x16x32_bf16 v[188:191], a[88:91], v[112:115], v[188:191]
  ds_read_b64_tr_b16 a[64:65], v229 offset:12384
  s_add_u32 s12, s82, s56
  s_addc_u32 s13, s83, 0
  v_mfma_f32_16x16x32_bf16 v[188:191], a[84:87], v[104:107], v[188:191]
  s_add_u32 s51, s51, 81920
  ds_read_b64_tr_b16 a[66:67], v229 offset:17504
  v_mfma_f32_16x16x32_bf16 v[188:191], a[80:83], v[96:99], v[188:191]
  s_waitcnt lgkmcnt(2)
  ds_read_b64_tr_b16 a[68:69], v229 offset:22624
  s_add_u32 m0, s61, 40960
  v_mfma_f32_16x16x32_bf16 v[20:23], a[96:99], v[0:3], 0
  s_mov_b32 s14, 19360
  ds_read_b64_tr_b16 a[70:71], v229 offset:27744
  v_mfma_f32_16x16x32_bf16 v[20:23], a[100:103], v[8:11], v[20:23]
  s_mov_b32 s15, 0x20000
  ds_read_b64_tr_b16 a[72:73], v225 offset:96
  v_mfma_f32_16x16x32_bf16 v[20:23], a[104:107], v[16:19], v[20:23]
  s_andn2_b32 s56, s56, 63
  ds_read_b64_tr_b16 a[74:75], v225 offset:5216
  v_mfma_f32_16x16x32_bf16 v[20:23], a[108:111], v[24:27], v[20:23]
  ds_read_b64_tr_b16 a[76:77], v225 offset:10336
  v_mfma_f32_16x16x32_bf16 v[100:103], a[108:111], v[56:59], 0
  ds_read_b64_tr_b16 a[78:79], v225 offset:15456
  s_add_u32 s8, s80, s56
  s_addc_u32 s9, s81, 0
  v_mfma_f32_16x16x32_bf16 v[100:103], a[104:107], v[48:51], v[100:103]
  v_mfma_f32_16x16x32_bf16 v[100:103], a[100:103], v[40:43], v[100:103]
  v_mfma_f32_16x16x32_bf16 v[100:103], a[96:99], v[32:35], v[100:103]
  s_mov_b32 s10, 19392
  buffer_load_dwordx4 v232, s[24:27], s51 offen offset:0 lds
  v_mfma_f32_16x16x32_bf16 v[152:155], a[96:99], v[64:67], 0
  v_mfma_f32_16x16x32_bf16 v[152:155], a[100:103], v[72:75], v[152:155]
  s_mov_b32 s11, 0x20000
  v_mfma_f32_16x16x32_bf16 v[152:155], a[104:107], v[80:83], v[152:155]
  s_lshr_b32 s56, s88, 3
  buffer_load_dwordx4 v233, s[24:27], s51 offen offset:1024 lds
  v_mfma_f32_16x16x32_bf16 v[152:155], a[108:111], v[88:91], v[152:155]
  v_mfma_f32_16x16x32_bf16 v[192:195], a[108:111], v[120:123], 0
  s_lshl_b32 s56, s56, 2
  v_mfma_f32_16x16x32_bf16 v[192:195], a[104:107], v[112:115], v[192:195]
  s_add_u32 s56, s56, s3
  buffer_load_dwordx4 v234, s[24:27], s51 offen offset:2048 lds
  v_mfma_f32_16x16x32_bf16 v[192:195], a[100:103], v[104:107], v[192:195]
  ds_read_b64_tr_b16 a[80:81], v228 offset:12416
  v_mfma_f32_16x16x32_bf16 v[192:195], a[96:99], v[96:99], v[192:195]
  s_waitcnt lgkmcnt(1)
  ds_read_b64_tr_b16 a[82:83], v228 offset:17536
  s_lshl_b32 s56, s56, 11
  v_mfma_f32_16x16x32_bf16 v[28:31], a[64:67], v[0:3], 0
  s_add_u32 s56, s56, 524288
  ds_read_b64_tr_b16 a[84:85], v228 offset:22656
  v_mfma_f32_16x16x32_bf16 v[28:31], a[68:71], v[8:11], v[28:31]
  ds_read_b64_tr_b16 a[86:87], v228 offset:27776
  v_mfma_f32_16x16x32_bf16 v[28:31], a[72:75], v[16:19], v[28:31]
  ds_read_b64_tr_b16 a[88:89], v224 offset:128
  v_mfma_f32_16x16x32_bf16 v[28:31], a[76:79], v[24:27], v[28:31]
  ds_read_b64_tr_b16 a[90:91], v224 offset:5248
  v_mfma_f32_16x16x32_bf16 v[108:111], a[76:79], v[56:59], 0
  ds_read_b64_tr_b16 a[92:93], v224 offset:10368
  v_mfma_f32_16x16x32_bf16 v[108:111], a[72:75], v[48:51], v[108:111]
  ds_read_b64_tr_b16 a[94:95], v224 offset:15488
  v_mfma_f32_16x16x32_bf16 v[108:111], a[68:71], v[40:43], v[108:111]
  buffer_load_dwordx4 v235, s[24:27], s51 offen offset:3072 lds
  v_mfma_f32_16x16x32_bf16 v[108:111], a[64:67], v[32:35], v[108:111]
  s_add_u32 m0, s61, 45056
  v_mfma_f32_16x16x32_bf16 v[156:159], a[64:67], v[64:67], 0
  buffer_load_dwordx4 v246, s[24:27], s51 offen offset:0 lds
  v_mfma_f32_16x16x32_bf16 v[156:159], a[68:71], v[72:75], v[156:159]
  s_add_u32 s52, s46, 1
  s_and_b32 s52, s52, 3
  v_add_u32 v244, s56, v248
  v_mfma_f32_16x16x32_bf16 v[156:159], a[72:75], v[80:83], v[156:159]
  s_lshl_b32 s52, s52, 12
  s_lshr_b32 s56, s90, 3
  s_lshl_b32 s56, s56, 2
  v_mfma_f32_16x16x32_bf16 v[156:159], a[76:79], v[88:91], v[156:159]
  s_add_u32 s56, s56, s3
  s_lshl_b32 s56, s56, 11
  s_add_u32 s56, s56, 524288
  v_mfma_f32_16x16x32_bf16 v[196:199], a[76:79], v[120:123], 0
  v_mfma_f32_16x16x32_bf16 v[196:199], a[72:75], v[112:115], v[196:199]
  ds_read_b64_tr_b16 a[96:97], v229 offset:12448
  v_mfma_f32_16x16x32_bf16 v[196:199], a[68:71], v[104:107], v[196:199]
  buffer_load_dwordx4 a[208:211], v236, s[32:35], s52 offen offset:0 sc1
  v_mfma_f32_16x16x32_bf16 v[196:199], a[64:67], v[96:99], v[196:199]
  s_waitcnt lgkmcnt(1)
  ds_read_b64_tr_b16 a[98:99], v229 offset:17568
  v_mfma_f32_16x16x32_bf16 v[36:39], a[80:83], v[0:3], 0
  ds_read_b64_tr_b16 a[100:101], v229 offset:22688
  v_mfma_f32_16x16x32_bf16 v[36:39], a[84:87], v[8:11], v[36:39]
  ds_read_b64_tr_b16 a[102:103], v229 offset:27808
  v_add_u32 v245, s56, v248
  v_mfma_f32_16x16x32_bf16 v[36:39], a[88:91], v[16:19], v[36:39]
  ds_read_b64_tr_b16 a[104:105], v225 offset:160
  v_mfma_f32_16x16x32_bf16 v[36:39], a[92:95], v[24:27], v[36:39]
  ds_read_b64_tr_b16 a[106:107], v225 offset:5280
  v_and_b32 v250, 15, v249
  v_mfma_f32_16x16x32_bf16 v[116:119], a[92:95], v[56:59], 0
  ds_read_b64_tr_b16 a[108:109], v225 offset:10400
  v_mul_u32_u24 v230, 192, v250
  v_mfma_f32_16x16x32_bf16 v[116:119], a[88:91], v[48:51], v[116:119]
  ds_read_b64_tr_b16 a[110:111], v225 offset:15520
  v_mfma_f32_16x16x32_bf16 v[116:119], a[84:87], v[40:43], v[116:119]
  buffer_load_dwordx4 a[212:215], v237, s[32:35], s52 offen offset:0 sc1
  v_mfma_f32_16x16x32_bf16 v[116:119], a[80:83], v[32:35], v[116:119]
  buffer_load_dwordx4 a[216:219], v236, s[32:35], s52 offen offset:1024 sc1
  v_mfma_f32_16x16x32_bf16 v[160:163], a[80:83], v[64:67], 0
  v_lshrrev_b32 v251, 4, v249
  v_lshl_add_u32 v230, v251, 3, v230
  v_mfma_f32_16x16x32_bf16 v[160:163], a[84:87], v[72:75], v[160:163]
  buffer_load_dwordx4 a[220:223], v237, s[32:35], s52 offen offset:1024 sc1
  v_mfma_f32_16x16x32_bf16 v[160:163], a[88:91], v[80:83], v[160:163]
  v_lshlrev_b32 v251, 2, v251
  v_mfma_f32_16x16x32_bf16 v[160:163], a[92:95], v[88:91], v[160:163]
  buffer_load_dwordx4 a[224:227], v236, s[32:35], s52 offen offset:2048 sc1
  v_mfma_f32_16x16x32_bf16 v[200:203], a[92:95], v[120:123], 0
  v_sub_u32 v250, v250, v251
  s_add_u32 s50, s50, 65536
  v_mfma_f32_16x16x32_bf16 v[200:203], a[88:91], v[112:115], v[200:203]
  ds_read_b64_tr_b16 a[64:65], v228 offset:12480
  v_mfma_f32_16x16x32_bf16 v[200:203], a[84:87], v[104:107], v[200:203]
  buffer_load_dwordx4 a[228:231], v237, s[32:35], s52 offen offset:2048 sc1
  v_mfma_f32_16x16x32_bf16 v[200:203], a[80:83], v[96:99], v[200:203]
  s_waitcnt lgkmcnt(1)
  v_add_u32 v230, s50, v230
  s_lshr_b32 s56, s45, 1
  v_mfma_f32_16x16x32_bf16 v[44:47], a[96:99], v[0:3], 0
  s_lshl_b32 s56, s56, 20
  ds_read_b64_tr_b16 a[66:67], v228 offset:17600
  s_and_b32 s49, s45, 1
  v_mfma_f32_16x16x32_bf16 v[44:47], a[100:103], v[8:11], v[44:47]
  s_lshl_b32 s55, s49, 11
  ds_read_b64_tr_b16 a[68:69], v228 offset:22720
  s_add_u32 s55, s55, s56
  v_mfma_f32_16x16x32_bf16 v[44:47], a[104:107], v[16:19], v[44:47]
  s_lshl_b32 s49, s49, 10
  ds_read_b64_tr_b16 a[70:71], v228 offset:27840
  v_mfma_f32_16x16x32_bf16 v[44:47], a[108:111], v[24:27], v[44:47]
  s_add_u32 s56, s56, s49
  ds_read_b64_tr_b16 a[72:73], v224 offset:192
  v_mfma_f32_16x16x32_bf16 v[124:127], a[108:111], v[56:59], 0
  s_lshl_b32 s49, s54, 12
  ds_read_b64_tr_b16 a[74:75], v224 offset:5312
  v_mfma_f32_16x16x32_bf16 v[124:127], a[104:107], v[48:51], v[124:127]
  ds_read_b64_tr_b16 a[76:77], v224 offset:10432
  v_mfma_f32_16x16x32_bf16 v[124:127], a[100:103], v[40:43], v[124:127]
  s_add_u32 s55, s55, s49
  ds_read_b64_tr_b16 a[78:79], v224 offset:15552
  v_mfma_f32_16x16x32_bf16 v[124:127], a[96:99], v[32:35], v[124:127]
  buffer_load_dwordx4 a[236:239], v236, s[32:35], s52 offen offset:3072 sc1
  v_mfma_f32_16x16x32_bf16 v[164:167], a[96:99], v[64:67], 0
  buffer_load_dwordx4 a[240:243], v237, s[32:35], s52 offen offset:3072 sc1
  v_mfma_f32_16x16x32_bf16 v[164:167], a[100:103], v[72:75], v[164:167]
  s_add_u32 s51, s46, 2
  s_and_b32 s51, s51, 3
  s_mul_i32 s51, s51, 163840
  v_mfma_f32_16x16x32_bf16 v[164:167], a[104:107], v[80:83], v[164:167]
  s_add_u32 m0, s61, 61440
  v_mfma_f32_16x16x32_bf16 v[164:167], a[108:111], v[88:91], v[164:167]
  v_mfma_f32_16x16x32_bf16 v[204:207], a[108:111], v[120:123], 0
  v_mfma_f32_16x16x32_bf16 v[204:207], a[104:107], v[112:115], v[204:207]
  v_add_u32 v240, s55, v248
  s_lshr_b32 s49, s54, 3
  v_mfma_f32_16x16x32_bf16 v[204:207], a[100:103], v[104:107], v[204:207]
  s_lshl_b32 s49, s49, 13
  ds_read_b64_tr_b16 a[80:81], v229 offset:12512
  s_add_u32 s56, s56, s49
  v_mfma_f32_16x16x32_bf16 v[204:207], a[96:99], v[96:99], v[204:207]
  s_waitcnt lgkmcnt(1)
  buffer_load_dwordx4 v232, s[24:27], s51 offen offset:0 lds
  v_mfma_f32_16x16x32_bf16 v[52:55], a[64:67], v[0:3], 0
  s_and_b32 s55, s54, 7
  ds_read_b64_tr_b16 a[82:83], v229 offset:17632
  s_sub_u32 s49, 7, s55
  v_mfma_f32_16x16x32_bf16 v[52:55], a[68:71], v[8:11], v[52:55]
  s_min_u32 s49, s49, s55
  ds_read_b64_tr_b16 a[84:85], v229 offset:22752
  v_mfma_f32_16x16x32_bf16 v[52:55], a[72:75], v[16:19], v[52:55]
  s_lshl_b32 s49, s49, 11
  ds_read_b64_tr_b16 a[86:87], v229 offset:27872
  v_mfma_f32_16x16x32_bf16 v[52:55], a[76:79], v[24:27], v[52:55]
  ds_read_b64_tr_b16 a[88:89], v225 offset:224
  v_mfma_f32_16x16x32_bf16 v[128:131], a[76:79], v[56:59], 0
  s_add_u32 s56, s56, s49
  ds_read_b64_tr_b16 a[90:91], v225 offset:5344
  v_mfma_f32_16x16x32_bf16 v[128:131], a[72:75], v[48:51], v[128:131]
  s_lshr_b32 s55, s55, 2
  ds_read_b64_tr_b16 a[92:93], v225 offset:10464
  v_mfma_f32_16x16x32_bf16 v[128:131], a[68:71], v[40:43], v[128:131]
  ds_read_b64_tr_b16 a[94:95], v225 offset:15584
  v_mfma_f32_16x16x32_bf16 v[128:131], a[64:67], v[32:35], v[128:131]
  s_lshl_b32 s55, s55, 3
  buffer_load_dwordx4 v233, s[24:27], s51 offen offset:1024 lds
  v_mfma_f32_16x16x32_bf16 v[168:171], a[64:67], v[64:67], 0
  buffer_load_dwordx4 v234, s[24:27], s51 offen offset:2048 lds
  v_mfma_f32_16x16x32_bf16 v[168:171], a[68:71], v[72:75], v[168:171]
  s_add_u32 s56, s56, s55
  buffer_load_dwordx4 v235, s[24:27], s51 offen offset:3072 lds
  v_mfma_f32_16x16x32_bf16 v[168:171], a[72:75], v[80:83], v[168:171]
  s_add_u32 m0, s61, 65536
  s_add_u32 s56, s56, 524288
  v_mfma_f32_16x16x32_bf16 v[168:171], a[76:79], v[88:91], v[168:171]
  v_mfma_f32_16x16x32_bf16 v[208:211], a[76:79], v[120:123], 0
  v_mfma_f32_16x16x32_bf16 v[208:211], a[72:75], v[112:115], v[208:211]
  ds_read_b64_tr_b16 a[96:97], v228 offset:12544
  v_mfma_f32_16x16x32_bf16 v[208:211], a[68:71], v[104:107], v[208:211]
  buffer_load_dwordx4 v246, s[24:27], s51 offen offset:0 lds
  v_mfma_f32_16x16x32_bf16 v[208:211], a[64:67], v[96:99], v[208:211]
  s_waitcnt lgkmcnt(1)
  ds_read_b64_tr_b16 a[98:99], v228 offset:17664
  s_add_u32 s51, s46, 2
  v_mfma_f32_16x16x32_bf16 v[60:63], a[80:83], v[0:3], 0
  s_and_b32 s51, s51, 3
  ds_read_b64_tr_b16 a[100:101], v228 offset:22784
  s_mul_i32 s51, s51, 163840
  v_mfma_f32_16x16x32_bf16 v[60:63], a[84:87], v[8:11], v[60:63]
  s_add_u32 s51, s51, 81920
  ds_read_b64_tr_b16 a[102:103], v228 offset:27904
  v_mfma_f32_16x16x32_bf16 v[60:63], a[88:91], v[16:19], v[60:63]
  s_add_u32 m0, s61, 81920
  ds_read_b64_tr_b16 a[104:105], v224 offset:256
  v_add_u32 v241, s56, v248
  v_mfma_f32_16x16x32_bf16 v[60:63], a[92:95], v[24:27], v[60:63]
  s_mul_i32 s56, s3, 15360
  ds_read_b64_tr_b16 a[106:107], v224 offset:5376
  v_mfma_f32_16x16x32_bf16 v[132:135], a[92:95], v[56:59], 0
  ds_read_b64_tr_b16 a[108:109], v224 offset:10496
  v_mfma_f32_16x16x32_bf16 v[132:135], a[88:91], v[48:51], v[132:135]
  ds_read_b64_tr_b16 a[110:111], v224 offset:15616
  v_add_u32 v231, s56, v248
  v_mfma_f32_16x16x32_bf16 v[132:135], a[84:87], v[40:43], v[132:135]
  s_sub_u32 s56, s3, 1
  s_and_b32 s56, s56, 3
  s_mul_i32 s56, s56, 15360
  v_mfma_f32_16x16x32_bf16 v[132:135], a[80:83], v[32:35], v[132:135]
  v_mfma_f32_16x16x32_bf16 v[172:175], a[80:83], v[64:67], 0
  v_mfma_f32_16x16x32_bf16 v[172:175], a[84:87], v[72:75], v[172:175]
  buffer_load_dwordx4 v232, s[24:27], s51 offen offset:0 lds
  v_mfma_f32_16x16x32_bf16 v[172:175], a[88:91], v[80:83], v[172:175]
  v_mfma_f32_16x16x32_bf16 v[172:175], a[92:95], v[88:91], v[172:175]
  v_add_u32 v242, s56, v248
  s_sub_u32 s56, s3, 2
  v_mfma_f32_16x16x32_bf16 v[212:215], a[92:95], v[120:123], 0
  s_and_b32 s56, s56, 3
  s_mul_i32 s56, s56, 15360
  v_mfma_f32_16x16x32_bf16 v[212:215], a[88:91], v[112:115], v[212:215]
  buffer_load_dwordx4 v233, s[24:27], s51 offen offset:1024 lds
  v_mfma_f32_16x16x32_bf16 v[212:215], a[84:87], v[104:107], v[212:215]
  ds_read_b64_tr_b16 a[64:65], v229 offset:12576
  v_mfma_f32_16x16x32_bf16 v[212:215], a[80:83], v[96:99], v[212:215]
  s_waitcnt lgkmcnt(1)
  ds_read_b64_tr_b16 a[66:67], v229 offset:17696
  v_mfma_f32_16x16x32_bf16 v[68:71], a[96:99], v[0:3], 0
  buffer_load_dwordx4 v234, s[24:27], s51 offen offset:2048 lds
  v_mfma_f32_16x16x32_bf16 v[68:71], a[100:103], v[8:11], v[68:71]
  ds_read_b64_tr_b16 a[68:69], v229 offset:22816
  v_add_u32 v243, s56, v248
  v_mfma_f32_16x16x32_bf16 v[68:71], a[104:107], v[16:19], v[68:71]
  s_sub_u32 s56, s3, 3
  ds_read_b64_tr_b16 a[70:71], v229 offset:27936
  s_and_b32 s56, s56, 3
  v_mfma_f32_16x16x32_bf16 v[68:71], a[108:111], v[24:27], v[68:71]
  s_mul_i32 s56, s56, 15360
  ds_read_b64_tr_b16 a[72:73], v225 offset:288
  v_mfma_f32_16x16x32_bf16 v[136:139], a[108:111], v[56:59], 0
  ds_read_b64_tr_b16 a[74:75], v225 offset:5408
  v_mfma_f32_16x16x32_bf16 v[136:139], a[104:107], v[48:51], v[136:139]
  ds_read_b64_tr_b16 a[76:77], v225 offset:10528
  v_mfma_f32_16x16x32_bf16 v[136:139], a[100:103], v[40:43], v[136:139]
  ds_read_b64_tr_b16 a[78:79], v225 offset:15648
  v_mfma_f32_16x16x32_bf16 v[136:139], a[96:99], v[32:35], v[136:139]
  buffer_load_dwordx4 v235, s[24:27], s51 offen offset:3072 lds
  v_mfma_f32_16x16x32_bf16 v[176:179], a[96:99], v[64:67], 0
  s_add_u32 m0, s61, 86016
  v_add_u32 v247, s56, v248
  s_lshl_b32 s55, s47, 2
  v_mfma_f32_16x16x32_bf16 v[176:179], a[100:103], v[72:75], v[176:179]
  s_lshr_b32 s49, s45, 1
  buffer_load_dwordx4 v246, s[24:27], s51 offen offset:0 lds
  v_mfma_f32_16x16x32_bf16 v[176:179], a[104:107], v[80:83], v[176:179]
  s_add_u32 s55, s55, s49
  s_lshl_b32 s55, s55, 7
  s_lshr_b32 s49, s3, 1
  v_mfma_f32_16x16x32_bf16 v[176:179], a[108:111], v[88:91], v[176:179]
  s_lshl_b32 s49, s49, 6
  v_mfma_f32_16x16x32_bf16 v[216:219], a[108:111], v[120:123], 0
  s_add_u32 s55, s55, s49
  v_mfma_f32_16x16x32_bf16 v[216:219], a[104:107], v[112:115], v[216:219]
  v_mfma_f32_16x16x32_bf16 v[216:219], a[100:103], v[104:107], v[216:219]
  s_add_u32 s55, s55, 0x4000
  v_mfma_f32_16x16x32_bf16 v[216:219], a[96:99], v[96:99], v[216:219]
  s_waitcnt lgkmcnt(0)
  v_mfma_f32_16x16x32_bf16 v[76:79], a[64:67], v[0:3], 0
  v_mfma_f32_16x16x32_bf16 v[76:79], a[68:71], v[8:11], v[76:79]
  v_mfma_f32_16x16x32_bf16 v[76:79], a[72:75], v[16:19], v[76:79]
  v_mfma_f32_16x16x32_bf16 v[76:79], a[76:79], v[24:27], v[76:79]
  s_waitcnt vmcnt(18)
  s_barrier
  ds_read_b64_tr_b16 a[80:81], v224 offset:20480
  v_mfma_f32_16x16x32_bf16 v[140:143], a[76:79], v[56:59], 0
  s_lshl_b32 s53, s47, 3
  ds_read_b64_tr_b16 a[82:83], v224 offset:25600
  s_add_u32 s53, s53, s45
  v_mfma_f32_16x16x32_bf16 v[140:143], a[72:75], v[48:51], v[140:143]
  s_lshl_b32 s53, s53, 5
  ds_read_b64_tr_b16 a[84:85], v224 offset:30720
  s_add_u32 s53, s53, s46
  v_mfma_f32_16x16x32_bf16 v[140:143], a[68:71], v[40:43], v[140:143]
  s_lshl_b32 s53, s53, 2
  ds_read_b64_tr_b16 a[86:87], v224 offset:35840
  s_add_u32 s53, s53, 8192
  v_mfma_f32_16x16x32_bf16 v[140:143], a[64:67], v[32:35], v[140:143]
  ds_read_b64_tr_b16 a[88:89], v224 offset:40960
  v_mfma_f32_16x16x32_bf16 v[180:183], a[64:67], v[64:67], 0
  ds_read_b64_tr_b16 a[90:91], v224 offset:46080
  v_mov_b32 v254, 1
  v_mfma_f32_16x16x32_bf16 v[180:183], a[68:71], v[72:75], v[180:183]
  ds_read_b64_tr_b16 a[92:93], v224 offset:51200
  v_mfma_f32_16x16x32_bf16 v[180:183], a[72:75], v[80:83], v[180:183]
  ds_read_b64_tr_b16 a[94:95], v224 offset:56320
  v_mfma_f32_16x16x32_bf16 v[180:183], a[76:79], v[88:91], v[180:183]
  buffer_store_dword v254, v255, s[68:71], s53 offen sc1
  v_mfma_f32_16x16x32_bf16 v[220:223], a[76:79], v[120:123], 0
  ds_read_b64_tr_b16 a[96:97], v225 offset:20512
  v_mfma_f32_16x16x32_bf16 v[220:223], a[72:75], v[112:115], v[220:223]
  ds_read_b64_tr_b16 a[98:99], v225 offset:25632
  v_mfma_f32_16x16x32_bf16 v[220:223], a[68:71], v[104:107], v[220:223]
  ds_read_b64_tr_b16 a[100:101], v225 offset:30752
  v_mfma_f32_16x16x32_bf16 v[220:223], a[64:67], v[96:99], v[220:223]
  s_waitcnt vmcnt(11) lgkmcnt(3)
  ds_read_b64_tr_b16 a[102:103], v225 offset:35872
  s_add_u32 s52, s46, 2
  v_mfma_f32_16x16x32_bf16 v[4:7], a[80:83], a[208:211], v[4:7]
  s_and_b32 s52, s52, 3
  ds_read_b64_tr_b16 a[104:105], v225 offset:40992
  s_lshl_b32 s52, s52, 12
  v_mfma_f32_16x16x32_bf16 v[4:7], a[84:87], a[216:219], v[4:7]
  ds_read_b64_tr_b16 a[106:107], v225 offset:46112
  v_mfma_f32_16x16x32_bf16 v[4:7], a[88:91], a[224:227], v[4:7]
  ds_read_b64_tr_b16 a[108:109], v225 offset:51232
  v_mfma_f32_16x16x32_bf16 v[4:7], a[92:95], a[236:239], v[4:7]
  ds_read_b64_tr_b16 a[110:111], v225 offset:56352
  v_mfma_f32_16x16x32_bf16 v[84:87], a[92:95], a[240:243], v[84:87]
  ds_read_b64_tr_b16 a[64:65], v224 offset:20544
  v_mfma_f32_16x16x32_bf16 v[84:87], a[88:91], a[228:231], v[84:87]
  ds_read_b64_tr_b16 a[66:67], v224 offset:25664
  v_mfma_f32_16x16x32_bf16 v[84:87], a[84:87], a[220:223], v[84:87]
  ds_read_b64_tr_b16 a[68:69], v224 offset:30784
  v_mfma_f32_16x16x32_bf16 v[84:87], a[80:83], a[212:215], v[84:87]
  s_waitcnt lgkmcnt(3)
  ds_read_b64_tr_b16 a[70:71], v224 offset:35904
  v_mfma_f32_16x16x32_bf16 v[12:15], a[96:99], a[208:211], v[12:15]
  ds_read_b64_tr_b16 a[72:73], v224 offset:41024
  v_mfma_f32_16x16x32_bf16 v[12:15], a[100:103], a[216:219], v[12:15]
  ds_read_b64_tr_b16 a[74:75], v224 offset:46144
  v_mfma_f32_16x16x32_bf16 v[12:15], a[104:107], a[224:227], v[12:15]
  ds_read_b64_tr_b16 a[76:77], v224 offset:51264
  v_mfma_f32_16x16x32_bf16 v[12:15], a[108:111], a[236:239], v[12:15]
  ds_read_b64_tr_b16 a[78:79], v224 offset:56384
  v_mfma_f32_16x16x32_bf16 v[92:95], a[108:111], a[240:243], v[92:95]
  buffer_load_dwordx4 v[0:3], v236, s[32:35], s52 offen offset:0 sc1
  v_mfma_f32_16x16x32_bf16 v[92:95], a[104:107], a[228:231], v[92:95]
  ds_read_b64_tr_b16 a[80:81], v225 offset:20576
  v_mfma_f32_16x16x32_bf16 v[92:95], a[100:103], a[220:223], v[92:95]
  ds_read_b64_tr_b16 a[82:83], v225 offset:25696
  v_mfma_f32_16x16x32_bf16 v[92:95], a[96:99], a[212:215], v[92:95]
  s_waitcnt lgkmcnt(2)
  ds_read_b64_tr_b16 a[84:85], v225 offset:30816
  v_mfma_f32_16x16x32_bf16 v[20:23], a[64:67], a[208:211], v[20:23]
  ds_read_b64_tr_b16 a[86:87], v225 offset:35936
  v_mfma_f32_16x16x32_bf16 v[20:23], a[68:71], a[216:219], v[20:23]
  ds_read_b64_tr_b16 a[88:89], v225 offset:41056
  v_mfma_f32_16x16x32_bf16 v[20:23], a[72:75], a[224:227], v[20:23]
  ds_read_b64_tr_b16 a[90:91], v225 offset:46176
  v_mfma_f32_16x16x32_bf16 v[20:23], a[76:79], a[236:239], v[20:23]
  ds_read_b64_tr_b16 a[92:93], v225 offset:51296
  ds_read_b64_tr_b16 a[94:95], v225 offset:56416
  v_mfma_f32_16x16x32_bf16 v[100:103], a[76:79], a[240:243], v[100:103]
  buffer_load_dwordx4 v[32:35], v237, s[32:35], s52 offen offset:0 sc1
  v_mfma_f32_16x16x32_bf16 v[100:103], a[72:75], a[228:231], v[100:103]
  buffer_load_dwordx4 v[8:11], v236, s[32:35], s52 offen offset:1024 sc1
  v_mfma_f32_16x16x32_bf16 v[100:103], a[68:71], a[220:223], v[100:103]
  ds_read_b64_tr_b16 a[96:97], v224 offset:20608
  v_mfma_f32_16x16x32_bf16 v[100:103], a[64:67], a[212:215], v[100:103]
  s_waitcnt lgkmcnt(1)
  ds_read_b64_tr_b16 a[98:99], v224 offset:25728
  v_mfma_f32_16x16x32_bf16 v[28:31], a[80:83], a[208:211], v[28:31]
  ds_read_b64_tr_b16 a[100:101], v224 offset:30848
  v_mfma_f32_16x16x32_bf16 v[28:31], a[84:87], a[216:219], v[28:31]
  ds_read_b64_tr_b16 a[102:103], v224 offset:35968
  v_mfma_f32_16x16x32_bf16 v[28:31], a[88:91], a[224:227], v[28:31]
  ds_read_b64_tr_b16 a[104:105], v224 offset:41088
  v_mfma_f32_16x16x32_bf16 v[28:31], a[92:95], a[236:239], v[28:31]
  ds_read_b64_tr_b16 a[106:107], v224 offset:46208
  ds_read_b64_tr_b16 a[108:109], v224 offset:51328
  ds_read_b64_tr_b16 a[110:111], v224 offset:56448
  v_mfma_f32_16x16x32_bf16 v[108:111], a[92:95], a[240:243], v[108:111]
  buffer_load_dwordx4 v[40:43], v237, s[32:35], s52 offen offset:1024 sc1
  v_mfma_f32_16x16x32_bf16 v[108:111], a[88:91], a[228:231], v[108:111]
  buffer_load_dwordx4 v[16:19], v236, s[32:35], s52 offen offset:2048 sc1
  v_mfma_f32_16x16x32_bf16 v[108:111], a[84:87], a[220:223], v[108:111]
  ds_read_b64_tr_b16 a[64:65], v225 offset:20640
  v_mfma_f32_16x16x32_bf16 v[108:111], a[80:83], a[212:215], v[108:111]
  s_waitcnt lgkmcnt(1)
  ds_read_b64_tr_b16 a[66:67], v225 offset:25760
  v_mfma_f32_16x16x32_bf16 v[36:39], a[96:99], a[208:211], v[36:39]
  ds_read_b64_tr_b16 a[68:69], v225 offset:30880
  v_mfma_f32_16x16x32_bf16 v[36:39], a[100:103], a[216:219], v[36:39]
  ds_read_b64_tr_b16 a[70:71], v225 offset:36000
  v_mfma_f32_16x16x32_bf16 v[36:39], a[104:107], a[224:227], v[36:39]
  ds_read_b64_tr_b16 a[72:73], v225 offset:41120
  v_mfma_f32_16x16x32_bf16 v[36:39], a[108:111], a[236:239], v[36:39]
  ds_read_b64_tr_b16 a[74:75], v225 offset:46240
  ds_read_b64_tr_b16 a[76:77], v225 offset:51360
  ds_read_b64_tr_b16 a[78:79], v225 offset:56480
  v_mfma_f32_16x16x32_bf16 v[116:119], a[108:111], a[240:243], v[116:119]
  buffer_load_dwordx4 v[48:51], v237, s[32:35], s52 offen offset:2048 sc1
  v_mfma_f32_16x16x32_bf16 v[116:119], a[104:107], a[228:231], v[116:119]
  buffer_load_dwordx4 v[24:27], v236, s[32:35], s52 offen offset:3072 sc1
  v_mfma_f32_16x16x32_bf16 v[116:119], a[100:103], a[220:223], v[116:119]
  ds_read_b64_tr_b16 a[80:81], v224 offset:20672
  v_mfma_f32_16x16x32_bf16 v[116:119], a[96:99], a[212:215], v[116:119]
  s_waitcnt lgkmcnt(1)
  ds_read_b64_tr_b16 a[82:83], v224 offset:25792
  v_mfma_f32_16x16x32_bf16 v[44:47], a[64:67], a[208:211], v[44:47]
  ds_read_b64_tr_b16 a[84:85], v224 offset:30912
  v_mfma_f32_16x16x32_bf16 v[44:47], a[68:71], a[216:219], v[44:47]
  ds_read_b64_tr_b16 a[86:87], v224 offset:36032
  v_mfma_f32_16x16x32_bf16 v[44:47], a[72:75], a[224:227], v[44:47]
  ds_read_b64_tr_b16 a[88:89], v224 offset:41152
  v_mfma_f32_16x16x32_bf16 v[44:47], a[76:79], a[236:239], v[44:47]
  ds_read_b64_tr_b16 a[90:91], v224 offset:46272
  ds_read_b64_tr_b16 a[92:93], v224 offset:51392
  ds_read_b64_tr_b16 a[94:95], v224 offset:56512
  v_mfma_f32_16x16x32_bf16 v[124:127], a[76:79], a[240:243], v[124:127]
  buffer_load_dwordx4 v[56:59], v237, s[32:35], s52 offen offset:3072 sc1
  s_add_u32 s51, s46, 3
  v_mfma_f32_16x16x32_bf16 v[124:127], a[72:75], a[228:231], v[124:127]
  s_and_b32 s51, s51, 3
  ds_read_b64_tr_b16 a[96:97], v225 offset:20704
  s_mul_i32 s51, s51, 163840
  v_mfma_f32_16x16x32_bf16 v[124:127], a[68:71], a[220:223], v[124:127]
  s_add_u32 m0, s61, 102400
  ds_read_b64_tr_b16 a[98:99], v225 offset:25824
  v_mfma_f32_16x16x32_bf16 v[124:127], a[64:67], a[212:215], v[124:127]
  s_waitcnt lgkmcnt(2)
  ds_read_b64_tr_b16 a[100:101], v225 offset:30944
  v_mfma_f32_16x16x32_bf16 v[52:55], a[80:83], a[208:211], v[52:55]
  ds_read_b64_tr_b16 a[102:103], v225 offset:36064
  v_mfma_f32_16x16x32_bf16 v[52:55], a[84:87], a[216:219], v[52:55]
  ds_read_b64_tr_b16 a[104:105], v225 offset:41184
  v_mfma_f32_16x16x32_bf16 v[52:55], a[88:91], a[224:227], v[52:55]
  ds_read_b64_tr_b16 a[106:107], v225 offset:46304
  v_mfma_f32_16x16x32_bf16 v[52:55], a[92:95], a[236:239], v[52:55]
  ds_read_b64_tr_b16 a[108:109], v225 offset:51424
  ds_read_b64_tr_b16 a[110:111], v225 offset:56544
  v_mfma_f32_16x16x32_bf16 v[128:131], a[92:95], a[240:243], v[128:131]
  buffer_load_dwordx4 v232, s[24:27], s51 offen offset:0 lds
  v_mfma_f32_16x16x32_bf16 v[128:131], a[88:91], a[228:231], v[128:131]
  ds_read_b64_tr_b16 a[64:65], v224 offset:20736
  v_mfma_f32_16x16x32_bf16 v[128:131], a[84:87], a[220:223], v[128:131]
  ds_read_b64_tr_b16 a[66:67], v224 offset:25856
  v_mfma_f32_16x16x32_bf16 v[128:131], a[80:83], a[212:215], v[128:131]
  s_waitcnt lgkmcnt(2)
  ds_read_b64_tr_b16 a[68:69], v224 offset:30976
  v_mfma_f32_16x16x32_bf16 v[60:63], a[96:99], a[208:211], v[60:63]
  ds_read_b64_tr_b16 a[70:71], v224 offset:36096
  v_mfma_f32_16x16x32_bf16 v[60:63], a[100:103], a[216:219], v[60:63]
  ds_read_b64_tr_b16 a[72:73], v224 offset:41216
  v_mfma_f32_16x16x32_bf16 v[60:63], a[104:107], a[224:227], v[60:63]
  ds_read_b64_tr_b16 a[74:75], v224 offset:46336
  v_mfma_f32_16x16x32_bf16 v[60:63], a[108:111], a[236:239], v[60:63]
  ds_read_b64_tr_b16 a[76:77], v224 offset:51456
  ds_read_b64_tr_b16 a[78:79], v224 offset:56576
  v_mfma_f32_16x16x32_bf16 v[132:135], a[108:111], a[240:243], v[132:135]
  buffer_load_dwordx4 v233, s[24:27], s51 offen offset:1024 lds
  v_mfma_f32_16x16x32_bf16 v[132:135], a[104:107], a[228:231], v[132:135]
  buffer_load_dwordx4 v234, s[24:27], s51 offen offset:2048 lds
  v_mfma_f32_16x16x32_bf16 v[132:135], a[100:103], a[220:223], v[132:135]
  ds_read_b64_tr_b16 a[80:81], v225 offset:20768
  v_mfma_f32_16x16x32_bf16 v[132:135], a[96:99], a[212:215], v[132:135]
  s_waitcnt lgkmcnt(1)
  ds_read_b64_tr_b16 a[82:83], v225 offset:25888
  v_mfma_f32_16x16x32_bf16 v[68:71], a[64:67], a[208:211], v[68:71]
  ds_read_b64_tr_b16 a[84:85], v225 offset:31008
  v_mfma_f32_16x16x32_bf16 v[68:71], a[68:71], a[216:219], v[68:71]
  buffer_load_dwordx4 v235, s[24:27], s51 offen offset:3072 lds
  s_add_u32 m0, s61, 106496
  s_nop 0
  buffer_load_dwordx4 v246, s[24:27], s51 offen offset:0 lds
  v_mfma_f32_16x16x32_bf16 v[68:71], a[72:75], a[224:227], v[68:71]
  s_andn2_b32 s53, s53, 15
  ds_read_b64_tr_b16 a[86:87], v225 offset:36128
  v_mfma_f32_16x16x32_bf16 v[68:71], a[76:79], a[236:239], v[68:71]
  s_waitcnt vmcnt(14)
  s_barrier
  ds_read_b64_tr_b16 a[88:89], v225 offset:41248
  ds_read_b64_tr_b16 a[90:91], v225 offset:46368
  ds_read_b64_tr_b16 a[92:93], v225 offset:51488
  ds_read_b64_tr_b16 a[94:95], v225 offset:56608
  v_mfma_f32_16x16x32_bf16 v[136:139], a[76:79], a[240:243], v[136:139]
  ds_read_b64_tr_b16 a[96:97], v224 offset:61440
  v_mfma_f32_16x16x32_bf16 v[136:139], a[72:75], a[228:231], v[136:139]
  ds_read_b64_tr_b16 a[98:99], v226 offset:1024
  v_mfma_f32_16x16x32_bf16 v[136:139], a[68:71], a[220:223], v[136:139]
  ds_read_b64_tr_b16 a[100:101], v226 offset:6144
  v_mfma_f32_16x16x32_bf16 v[136:139], a[64:67], a[212:215], v[136:139]
  s_waitcnt lgkmcnt(3)
  ds_read_b64_tr_b16 a[102:103], v226 offset:11264
  v_lshrrev_b32 v252, 2, v252
  v_mfma_f32_16x16x32_bf16 v[76:79], a[80:83], a[208:211], v[76:79]
  ds_read_b64_tr_b16 a[104:105], v226 offset:16384
  v_mfma_f32_16x16x32_bf16 v[76:79], a[84:87], a[216:219], v[76:79]
  ds_read_b64_tr_b16 a[106:107], v226 offset:21504
  v_mfma_f32_16x16x32_bf16 v[76:79], a[88:91], a[224:227], v[76:79]
  ds_read_b64_tr_b16 a[108:109], v226 offset:26624
  v_mfma_f32_16x16x32_bf16 v[76:79], a[92:95], a[236:239], v[76:79]
  ds_read_b64_tr_b16 a[110:111], v226 offset:31744
  v_mfma_f32_16x16x32_bf16 v[140:143], a[92:95], a[240:243], v[140:143]
  buffer_load_dword v253, v252, s[68:71], s53 offen sc1
  v_mfma_f32_16x16x32_bf16 v[140:143], a[88:91], a[228:231], v[140:143]
  s_add_u32 s51, s46, 3
  ds_read_b64_tr_b16 a[64:65], v225 offset:61472
  s_and_b32 s51, s51, 3
  v_mfma_f32_16x16x32_bf16 v[140:143], a[84:87], a[220:223], v[140:143]
  s_mul_i32 s51, s51, 163840
  ds_read_b64_tr_b16 a[66:67], v227 offset:1056
  s_add_u32 s51, s51, 81920
  v_mfma_f32_16x16x32_bf16 v[140:143], a[80:83], a[212:215], v[140:143]
  s_waitcnt vmcnt(6) lgkmcnt(2)
  ds_read_b64_tr_b16 a[68:69], v227 offset:6176
  s_add_u32 m0, s61, 122880
  v_mfma_f32_16x16x32_bf16 v[4:7], a[96:99], v[0:3], v[4:7]
  ds_read_b64_tr_b16 a[70:71], v227 offset:11296
  v_mfma_f32_16x16x32_bf16 v[4:7], a[100:103], v[8:11], v[4:7]
  ds_read_b64_tr_b16 a[72:73], v227 offset:16416
  v_mfma_f32_16x16x32_bf16 v[4:7], a[104:107], v[16:19], v[4:7]
  ds_read_b64_tr_b16 a[74:75], v227 offset:21536
  v_mfma_f32_16x16x32_bf16 v[4:7], a[108:111], v[24:27], v[4:7]
  ds_read_b64_tr_b16 a[76:77], v227 offset:26656
  ds_read_b64_tr_b16 a[78:79], v227 offset:31776
  v_mfma_f32_16x16x32_bf16 v[84:87], a[108:111], v[56:59], v[84:87]
  ds_read_b64_tr_b16 a[80:81], v224 offset:61504
  v_mfma_f32_16x16x32_bf16 v[84:87], a[104:107], v[48:51], v[84:87]
  ds_read_b64_tr_b16 a[82:83], v226 offset:1088
  v_mfma_f32_16x16x32_bf16 v[84:87], a[100:103], v[40:43], v[84:87]
  ds_read_b64_tr_b16 a[84:85], v226 offset:6208
  v_mfma_f32_16x16x32_bf16 v[84:87], a[96:99], v[32:35], v[84:87]
  s_waitcnt lgkmcnt(3)
  ds_read_b64_tr_b16 a[86:87], v226 offset:11328
  v_mfma_f32_16x16x32_bf16 v[12:15], a[64:67], v[0:3], v[12:15]
  ds_read_b64_tr_b16 a[88:89], v226 offset:16448
  v_mfma_f32_16x16x32_bf16 v[12:15], a[68:71], v[8:11], v[12:15]
  ds_read_b64_tr_b16 a[90:91], v226 offset:21568
  v_mfma_f32_16x16x32_bf16 v[12:15], a[72:75], v[16:19], v[12:15]
  ds_read_b64_tr_b16 a[92:93], v226 offset:26688
  v_mfma_f32_16x16x32_bf16 v[12:15], a[76:79], v[24:27], v[12:15]
  ds_read_b64_tr_b16 a[94:95], v226 offset:31808
  v_mfma_f32_16x16x32_bf16 v[92:95], a[76:79], v[56:59], v[92:95]
  buffer_load_dwordx4 v232, s[24:27], s51 offen offset:0 lds
  v_mfma_f32_16x16x32_bf16 v[92:95], a[72:75], v[48:51], v[92:95]
  buffer_load_dwordx4 v233, s[24:27], s51 offen offset:1024 lds
  v_mfma_f32_16x16x32_bf16 v[92:95], a[68:71], v[40:43], v[92:95]
  ds_read_b64_tr_b16 a[96:97], v225 offset:61536
  v_mfma_f32_16x16x32_bf16 v[92:95], a[64:67], v[32:35], v[92:95]
  s_waitcnt lgkmcnt(1)
  ds_read_b64_tr_b16 a[98:99], v227 offset:1120
  v_mfma_f32_16x16x32_bf16 v[20:23], a[80:83], v[0:3], v[20:23]
  ds_read_b64_tr_b16 a[100:101], v227 offset:6240
  v_mfma_f32_16x16x32_bf16 v[20:23], a[84:87], v[8:11], v[20:23]
  ds_read_b64_tr_b16 a[102:103], v227 offset:11360
  v_mfma_f32_16x16x32_bf16 v[20:23], a[88:91], v[16:19], v[20:23]
  ds_read_b64_tr_b16 a[104:105], v227 offset:16480
  v_mfma_f32_16x16x32_bf16 v[20:23], a[92:95], v[24:27], v[20:23]
  ds_read_b64_tr_b16 a[106:107], v227 offset:21600
  ds_read_b64_tr_b16 a[108:109], v227 offset:26720
  ds_read_b64_tr_b16 a[110:111], v227 offset:31840
  v_mfma_f32_16x16x32_bf16 v[100:103], a[92:95], v[56:59], v[100:103]
  buffer_load_dwordx4 v234, s[24:27], s51 offen offset:2048 lds
  v_mfma_f32_16x16x32_bf16 v[100:103], a[88:91], v[48:51], v[100:103]
  buffer_load_dwordx4 v235, s[24:27], s51 offen offset:3072 lds
  s_add_u32 m0, s61, 126976
  v_mfma_f32_16x16x32_bf16 v[100:103], a[84:87], v[40:43], v[100:103]
  buffer_load_dwordx4 v246, s[24:27], s51 offen offset:0 lds
  s_add_u32 s52, s46, 3
  v_mfma_f32_16x16x32_bf16 v[100:103], a[80:83], v[32:35], v[100:103]
  s_waitcnt lgkmcnt(0)
  ds_read_b64_tr_b16 a[64:65], v224 offset:61568
  s_and_b32 s52, s52, 3
  s_lshl_b32 s52, s52, 12
  v_mfma_f32_16x16x32_bf16 v[28:31], a[96:99], v[0:3], v[28:31]
  buffer_load_dwordx4 a[208:211], v236, s[32:35], s52 offen offset:0 sc1
  v_mfma_f32_16x16x32_bf16 v[28:31], a[100:103], v[8:11], v[28:31]
  buffer_load_dwordx4 a[212:215], v237, s[32:35], s52 offen offset:0 sc1
  v_mfma_f32_16x16x32_bf16 v[28:31], a[104:107], v[16:19], v[28:31]
  ds_read_b64_tr_b16 a[66:67], v226 offset:1152
  v_mfma_f32_16x16x32_bf16 v[28:31], a[108:111], v[24:27], v[28:31]
  ds_read_b64_tr_b16 a[68:69], v226 offset:6272
  ds_read_b64_tr_b16 a[70:71], v226 offset:11392
  ds_read_b64_tr_b16 a[72:73], v226 offset:16512
  ds_read_b64_tr_b16 a[74:75], v226 offset:21632
  ds_read_b64_tr_b16 a[76:77], v226 offset:26752
  ds_read_b64_tr_b16 a[78:79], v226 offset:31872
  v_mfma_f32_16x16x32_bf16 v[108:111], a[108:111], v[56:59], v[108:111]
  buffer_load_dwordx4 a[216:219], v236, s[32:35], s52 offen offset:1024 sc1
  v_mfma_f32_16x16x32_bf16 v[108:111], a[104:107], v[48:51], v[108:111]
  buffer_load_dwordx4 a[220:223], v237, s[32:35], s52 offen offset:1024 sc1
  v_mfma_f32_16x16x32_bf16 v[108:111], a[100:103], v[40:43], v[108:111]
  ds_read_b64_tr_b16 a[80:81], v225 offset:61600
  v_mfma_f32_16x16x32_bf16 v[108:111], a[96:99], v[32:35], v[108:111]
  s_waitcnt lgkmcnt(1)
  ds_read_b64_tr_b16 a[82:83], v227 offset:1184
  v_mfma_f32_16x16x32_bf16 v[36:39], a[64:67], v[0:3], v[36:39]
  ds_read_b64_tr_b16 a[84:85], v227 offset:6304
  v_mfma_f32_16x16x32_bf16 v[36:39], a[68:71], v[8:11], v[36:39]
  ds_read_b64_tr_b16 a[86:87], v227 offset:11424
  v_mfma_f32_16x16x32_bf16 v[36:39], a[72:75], v[16:19], v[36:39]
  ds_read_b64_tr_b16 a[88:89], v227 offset:16544
  v_mfma_f32_16x16x32_bf16 v[36:39], a[76:79], v[24:27], v[36:39]
  ds_read_b64_tr_b16 a[90:91], v227 offset:21664
  ds_read_b64_tr_b16 a[92:93], v227 offset:26784
  ds_read_b64_tr_b16 a[94:95], v227 offset:31904
  v_mfma_f32_16x16x32_bf16 v[116:119], a[76:79], v[56:59], v[116:119]
  buffer_load_dwordx4 a[224:227], v236, s[32:35], s52 offen offset:2048 sc1
  v_mfma_f32_16x16x32_bf16 v[116:119], a[72:75], v[48:51], v[116:119]
  ds_read_b64_tr_b16 a[96:97], v224 offset:61632
  v_mfma_f32_16x16x32_bf16 v[116:119], a[68:71], v[40:43], v[116:119]
  ds_read_b64_tr_b16 a[98:99], v226 offset:1216
  v_mfma_f32_16x16x32_bf16 v[116:119], a[64:67], v[32:35], v[116:119]
  s_waitcnt lgkmcnt(2)
  ds_read_b64_tr_b16 a[100:101], v226 offset:6336
  v_mfma_f32_16x16x32_bf16 v[44:47], a[80:83], v[0:3], v[44:47]
  ds_read_b64_tr_b16 a[102:103], v226 offset:11456
  v_mfma_f32_16x16x32_bf16 v[44:47], a[84:87], v[8:11], v[44:47]
  ds_read_b64_tr_b16 a[104:105], v226 offset:16576
  v_mfma_f32_16x16x32_bf16 v[44:47], a[88:91], v[16:19], v[44:47]
  ds_read_b64_tr_b16 a[106:107], v226 offset:21696
  v_mfma_f32_16x16x32_bf16 v[44:47], a[92:95], v[24:27], v[44:47]
  ds_read_b64_tr_b16 a[108:109], v226 offset:26816
  ds_read_b64_tr_b16 a[110:111], v226 offset:31936
  v_mfma_f32_16x16x32_bf16 v[124:127], a[92:95], v[56:59], v[124:127]
  buffer_load_dwordx4 a[228:231], v237, s[32:35], s52 offen offset:2048 sc1
  v_mfma_f32_16x16x32_bf16 v[124:127], a[88:91], v[48:51], v[124:127]
  buffer_load_dwordx4 a[236:239], v236, s[32:35], s52 offen offset:3072 sc1
  v_mfma_f32_16x16x32_bf16 v[124:127], a[84:87], v[40:43], v[124:127]
  ds_read_b64_tr_b16 a[64:65], v225 offset:61664
  v_mfma_f32_16x16x32_bf16 v[124:127], a[80:83], v[32:35], v[124:127]
  s_waitcnt lgkmcnt(1)
  ds_read_b64_tr_b16 a[66:67], v227 offset:1248
  v_mfma_f32_16x16x32_bf16 v[52:55], a[96:99], v[0:3], v[52:55]
  ds_read_b64_tr_b16 a[68:69], v227 offset:6368
  v_mfma_f32_16x16x32_bf16 v[52:55], a[100:103], v[8:11], v[52:55]
  ds_read_b64_tr_b16 a[70:71], v227 offset:11488
  v_mfma_f32_16x16x32_bf16 v[52:55], a[104:107], v[16:19], v[52:55]
  ds_read_b64_tr_b16 a[72:73], v227 offset:16608
  v_mfma_f32_16x16x32_bf16 v[52:55], a[108:111], v[24:27], v[52:55]
  ds_read_b64_tr_b16 a[74:75], v227 offset:21728
  ds_read_b64_tr_b16 a[76:77], v227 offset:26848
  ds_read_b64_tr_b16 a[78:79], v227 offset:31968
  v_mfma_f32_16x16x32_bf16 v[128:131], a[108:111], v[56:59], v[128:131]
  buffer_load_dwordx4 a[240:243], v237, s[32:35], s52 offen offset:3072 sc1
  v_mfma_f32_16x16x32_bf16 v[128:131], a[104:107], v[48:51], v[128:131]
  ds_read_b64_tr_b16 a[80:81], v224 offset:61696
  v_mfma_f32_16x16x32_bf16 v[128:131], a[100:103], v[40:43], v[128:131]
  ds_read_b64_tr_b16 a[82:83], v226 offset:1280
  v_mfma_f32_16x16x32_bf16 v[128:131], a[96:99], v[32:35], v[128:131]
  s_waitcnt lgkmcnt(2)
  ds_read_b64_tr_b16 a[84:85], v226 offset:6400
  s_waitcnt vmcnt(13)
  v_cmp_ne_u32 vcc, 1, v253
  s_cbranch_vccnz recurrent_scan__compressed_kv_cla__dense_activation_silu__prompt_kernel_spin5
recurrent_scan__compressed_kv_cla__dense_activation_silu__prompt_kernel_back5:
  v_mfma_f32_16x16x32_bf16 v[60:63], a[64:67], v[0:3], v[60:63]
  s_add_u32 s52, s46, 1
  ds_read_b64_tr_b16 a[86:87], v226 offset:11520
  s_and_b32 s52, s52, 3
  v_mfma_f32_16x16x32_bf16 v[60:63], a[68:71], v[8:11], v[60:63]
  s_lshl_b32 s52, s52, 12
  ds_read_b64_tr_b16 a[88:89], v226 offset:16640
  v_mfma_f32_16x16x32_bf16 v[60:63], a[72:75], v[16:19], v[60:63]
  ds_read_b64_tr_b16 a[90:91], v226 offset:21760
  v_mfma_f32_16x16x32_bf16 v[60:63], a[76:79], v[24:27], v[60:63]
  ds_read_b64_tr_b16 a[92:93], v226 offset:26880
  ds_read_b64_tr_b16 a[94:95], v226 offset:32000
  v_mfma_f32_16x16x32_bf16 v[132:135], a[76:79], v[56:59], v[132:135]
  ds_read_b64_tr_b16 a[96:97], v225 offset:61728
  v_mfma_f32_16x16x32_bf16 v[132:135], a[72:75], v[48:51], v[132:135]
  ds_read_b64_tr_b16 a[98:99], v227 offset:1312
  v_mfma_f32_16x16x32_bf16 v[132:135], a[68:71], v[40:43], v[132:135]
  ds_read_b64_tr_b16 a[100:101], v227 offset:6432
  v_mfma_f32_16x16x32_bf16 v[132:135], a[64:67], v[32:35], v[132:135]
  s_waitcnt lgkmcnt(3)
  ds_read_b64_tr_b16 a[102:103], v227 offset:11552
  v_mfma_f32_16x16x32_bf16 v[68:71], a[80:83], v[0:3], v[68:71]
  ds_read_b64_tr_b16 a[104:105], v227 offset:16672
  v_mfma_f32_16x16x32_bf16 v[68:71], a[84:87], v[8:11], v[68:71]
  ds_read_b64_tr_b16 a[106:107], v227 offset:21792
  v_mfma_f32_16x16x32_bf16 v[68:71], a[88:91], v[16:19], v[68:71]
  ds_read_b64_tr_b16 a[108:109], v227 offset:26912
  v_mfma_f32_16x16x32_bf16 v[68:71], a[92:95], v[24:27], v[68:71]
  s_waitcnt vmcnt(8)
  s_barrier
  ds_read_b64_tr_b16 a[110:111], v227 offset:32032
  v_mfma_f32_16x16x32_bf16 v[136:139], a[92:95], v[56:59], v[136:139]
  s_lshl_b32 s56, s88, 12
  buffer_load_dwordx4 a[112:115], v238, s[32:35], s52 offen offset:0 sc1
  v_mfma_f32_16x16x32_bf16 v[136:139], a[88:91], v[48:51], v[136:139]
  buffer_load_dwordx4 a[116:119], v239, s[32:35], s52 offen offset:0 sc1
  v_mfma_f32_16x16x32_bf16 v[136:139], a[84:87], v[40:43], v[136:139]
  buffer_load_dwordx4 a[120:123], v238, s[32:35], s52 offen offset:1024 sc1
  v_mfma_f32_16x16x32_bf16 v[136:139], a[80:83], v[32:35], v[136:139]
  s_waitcnt lgkmcnt(0)
  buffer_load_dwordx4 a[124:127], v239, s[32:35], s52 offen offset:1024 sc1
  v_mfma_f32_16x16x32_bf16 v[76:79], a[96:99], v[0:3], v[76:79]
  ds_read_b64_tr_b16 a[64:65], v226 offset:36864
  v_mfma_f32_16x16x32_bf16 v[76:79], a[100:103], v[8:11], v[76:79]
  ds_read_b64_tr_b16 a[66:67], v226 offset:41984
  v_mfma_f32_16x16x32_bf16 v[76:79], a[104:107], v[16:19], v[76:79]
  ds_read_b64_tr_b16 a[68:69], v226 offset:47104
  v_mfma_f32_16x16x32_bf16 v[76:79], a[108:111], v[24:27], v[76:79]
  ds_read_b64_tr_b16 a[70:71], v226 offset:52224
  ds_read_b64_tr_b16 a[72:73], v226 offset:57344
  ds_read_b64_tr_b16 a[74:75], v226 offset:62464
  ds_read_b64_tr_b16 a[76:77], v228 offset:2048
  ds_read_b64_tr_b16 a[78:79], v228 offset:7168
  v_mfma_f32_16x16x32_bf16 v[140:143], a[108:111], v[56:59], v[140:143]
  buffer_load_dwordx4 a[128:131], v238, s[32:35], s52 offen offset:2048 sc1
  v_mfma_f32_16x16x32_bf16 v[140:143], a[104:107], v[48:51], v[140:143]
  ds_read_b64_tr_b16 a[80:81], v227 offset:36896
  v_add_u32 v236, s56, v248
  v_mfma_f32_16x16x32_bf16 v[140:143], a[100:103], v[40:43], v[140:143]
  ds_read_b64_tr_b16 a[82:83], v227 offset:42016
  v_mfma_f32_16x16x32_bf16 v[140:143], a[96:99], v[32:35], v[140:143]
  s_waitcnt vmcnt(5) lgkmcnt(2)
  ds_read_b64_tr_b16 a[84:85], v227 offset:47136
  s_lshl_b32 s56, s89, 12
  v_mfma_f32_16x16x32_bf16 v[4:7], a[64:67], a[208:211], v[4:7]
  ds_read_b64_tr_b16 a[86:87], v227 offset:52256
  v_mfma_f32_16x16x32_bf16 v[4:7], a[68:71], a[216:219], v[4:7]
  ds_read_b64_tr_b16 a[88:89], v227 offset:57376
  v_mfma_f32_16x16x32_bf16 v[4:7], a[72:75], a[224:227], v[4:7]
  ds_read_b64_tr_b16 a[90:91], v227 offset:62496
  v_mfma_f32_16x16x32_bf16 v[4:7], a[76:79], a[236:239], v[4:7]
  ds_read_b64_tr_b16 a[92:93], v229 offset:2080
  ds_read_b64_tr_b16 a[94:95], v229 offset:7200
  v_mfma_f32_16x16x32_bf16 v[84:87], a[76:79], a[240:243], v[84:87]
  buffer_load_dwordx4 a[132:135], v239, s[32:35], s52 offen offset:2048 sc1
  v_mfma_f32_16x16x32_bf16 v[84:87], a[72:75], a[228:231], v[84:87]
  buffer_load_dwordx4 a[136:139], v238, s[32:35], s52 offen offset:3072 sc1
  v_mfma_f32_16x16x32_bf16 v[84:87], a[68:71], a[220:223], v[84:87]
  buffer_load_dwordx4 a[140:143], v239, s[32:35], s52 offen offset:3072 sc1
  s_add_u32 s52, s46, 2
  v_mfma_f32_16x16x32_bf16 v[84:87], a[64:67], a[212:215], v[84:87]
  s_waitcnt lgkmcnt(0)
  ds_read_b64_tr_b16 a[96:97], v226 offset:36928
  s_and_b32 s52, s52, 3
  v_mfma_f32_16x16x32_bf16 v[12:15], a[80:83], a[208:211], v[12:15]
  s_lshl_b32 s52, s52, 12
  ds_read_b64_tr_b16 a[98:99], v226 offset:42048
  v_mfma_f32_16x16x32_bf16 v[12:15], a[84:87], a[216:219], v[12:15]
  ds_read_b64_tr_b16 a[100:101], v226 offset:47168
  v_mfma_f32_16x16x32_bf16 v[12:15], a[88:91], a[224:227], v[12:15]
  ds_read_b64_tr_b16 a[102:103], v226 offset:52288
  v_mfma_f32_16x16x32_bf16 v[12:15], a[92:95], a[236:239], v[12:15]
  ds_read_b64_tr_b16 a[104:105], v226 offset:57408
  ds_read_b64_tr_b16 a[106:107], v226 offset:62528
  ds_read_b64_tr_b16 a[108:109], v228 offset:2112
  ds_read_b64_tr_b16 a[110:111], v228 offset:7232
  v_mfma_f32_16x16x32_bf16 v[92:95], a[92:95], a[240:243], v[92:95]
  buffer_load_dwordx4 a[144:147], v238, s[32:35], s52 offen offset:0 sc1
  v_mfma_f32_16x16x32_bf16 v[92:95], a[88:91], a[228:231], v[92:95]
  ds_read_b64_tr_b16 a[64:65], v227 offset:36960
  v_add_u32 v237, s56, v248
  v_mfma_f32_16x16x32_bf16 v[92:95], a[84:87], a[220:223], v[92:95]
  ds_read_b64_tr_b16 a[66:67], v227 offset:42080
  v_mfma_f32_16x16x32_bf16 v[92:95], a[80:83], a[212:215], v[92:95]
  s_waitcnt lgkmcnt(2)
  ds_read_b64_tr_b16 a[68:69], v227 offset:47200
  v_mfma_f32_16x16x32_bf16 v[20:23], a[96:99], a[208:211], v[20:23]
  ds_read_b64_tr_b16 a[70:71], v227 offset:52320
  v_mfma_f32_16x16x32_bf16 v[20:23], a[100:103], a[216:219], v[20:23]
  ds_read_b64_tr_b16 a[72:73], v227 offset:57440
  v_mfma_f32_16x16x32_bf16 v[20:23], a[104:107], a[224:227], v[20:23]
  ds_read_b64_tr_b16 a[74:75], v227 offset:62560
  v_mfma_f32_16x16x32_bf16 v[20:23], a[108:111], a[236:239], v[20:23]
  ds_read_b64_tr_b16 a[76:77], v229 offset:2144
  ds_read_b64_tr_b16 a[78:79], v229 offset:7264
  v_mfma_f32_16x16x32_bf16 v[100:103], a[108:111], a[240:243], v[100:103]
  buffer_load_dwordx4 a[148:151], v239, s[32:35], s52 offen offset:0 sc1
  v_mfma_f32_16x16x32_bf16 v[100:103], a[104:107], a[228:231], v[100:103]
  buffer_load_dwordx4 a[152:155], v238, s[32:35], s52 offen offset:1024 sc1
  v_mfma_f32_16x16x32_bf16 v[100:103], a[100:103], a[220:223], v[100:103]
  buffer_load_dwordx4 a[156:159], v239, s[32:35], s52 offen offset:1024 sc1
  v_mfma_f32_16x16x32_bf16 v[100:103], a[96:99], a[212:215], v[100:103]
  s_waitcnt lgkmcnt(0)
  ds_read_b64_tr_b16 a[80:81], v226 offset:36992
  v_mfma_f32_16x16x32_bf16 v[28:31], a[64:67], a[208:211], v[28:31]
  ds_read_b64_tr_b16 a[82:83], v226 offset:42112
  v_mfma_f32_16x16x32_bf16 v[28:31], a[68:71], a[216:219], v[28:31]
  ds_read_b64_tr_b16 a[84:85], v226 offset:47232
  v_mfma_f32_16x16x32_bf16 v[28:31], a[72:75], a[224:227], v[28:31]
  ds_read_b64_tr_b16 a[86:87], v226 offset:52352
  v_mfma_f32_16x16x32_bf16 v[28:31], a[76:79], a[236:239], v[28:31]
  ds_read_b64_tr_b16 a[88:89], v226 offset:57472
  ds_read_b64_tr_b16 a[90:91], v226 offset:62592
  ds_read_b64_tr_b16 a[92:93], v228 offset:2176
  ds_read_b64_tr_b16 a[94:95], v228 offset:7296
  v_mfma_f32_16x16x32_bf16 v[108:111], a[76:79], a[240:243], v[108:111]
  buffer_load_dwordx4 a[160:163], v238, s[32:35], s52 offen offset:2048 sc1
  v_mfma_f32_16x16x32_bf16 v[108:111], a[72:75], a[228:231], v[108:111]
  buffer_load_dwordx4 a[164:167], v239, s[32:35], s52 offen offset:2048 sc1
  v_mfma_f32_16x16x32_bf16 v[108:111], a[68:71], a[220:223], v[108:111]
  ds_read_b64_tr_b16 a[96:97], v227 offset:37024
  v_mfma_f32_16x16x32_bf16 v[108:111], a[64:67], a[212:215], v[108:111]
  s_waitcnt lgkmcnt(1)
  ds_read_b64_tr_b16 a[98:99], v227 offset:42144
  v_mfma_f32_16x16x32_bf16 v[36:39], a[80:83], a[208:211], v[36:39]
  ds_read_b64_tr_b16 a[100:101], v227 offset:47264
  v_mfma_f32_16x16x32_bf16 v[36:39], a[84:87], a[216:219], v[36:39]
  ds_read_b64_tr_b16 a[102:103], v227 offset:52384
  v_mfma_f32_16x16x32_bf16 v[36:39], a[88:91], a[224:227], v[36:39]
  ds_read_b64_tr_b16 a[104:105], v227 offset:57504
  v_mfma_f32_16x16x32_bf16 v[36:39], a[92:95], a[236:239], v[36:39]
  ds_read_b64_tr_b16 a[106:107], v227 offset:62624
  ds_read_b64_tr_b16 a[108:109], v229 offset:2208
  ds_read_b64_tr_b16 a[110:111], v229 offset:7328
  v_mfma_f32_16x16x32_bf16 v[116:119], a[92:95], a[240:243], v[116:119]
  buffer_load_dwordx4 a[168:171], v238, s[32:35], s52 offen offset:3072 sc1
  v_mfma_f32_16x16x32_bf16 v[116:119], a[88:91], a[228:231], v[116:119]
  buffer_load_dwordx4 a[172:175], v239, s[32:35], s52 offen offset:3072 sc1
  s_add_u32 s52, s46, 3
  v_mfma_f32_16x16x32_bf16 v[116:119], a[84:87], a[220:223], v[116:119]
  s_and_b32 s52, s52, 3
  ds_read_b64_tr_b16 a[64:65], v226 offset:37056
  s_lshl_b32 s52, s52, 12
  v_mfma_f32_16x16x32_bf16 v[116:119], a[80:83], a[212:215], v[116:119]
  s_waitcnt lgkmcnt(1)
  ds_read_b64_tr_b16 a[66:67], v226 offset:42176
  v_mfma_f32_16x16x32_bf16 v[44:47], a[96:99], a[208:211], v[44:47]
  ds_read_b64_tr_b16 a[68:69], v226 offset:47296
  v_mfma_f32_16x16x32_bf16 v[44:47], a[100:103], a[216:219], v[44:47]
  ds_read_b64_tr_b16 a[70:71], v226 offset:52416
  v_mfma_f32_16x16x32_bf16 v[44:47], a[104:107], a[224:227], v[44:47]
  ds_read_b64_tr_b16 a[72:73], v226 offset:57536
  v_mfma_f32_16x16x32_bf16 v[44:47], a[108:111], a[236:239], v[44:47]
  ds_read_b64_tr_b16 a[74:75], v226 offset:62656
  ds_read_b64_tr_b16 a[76:77], v228 offset:2240
  ds_read_b64_tr_b16 a[78:79], v228 offset:7360
  v_mfma_f32_16x16x32_bf16 v[124:127], a[108:111], a[240:243], v[124:127]
  buffer_load_dwordx4 a[176:179], v238, s[32:35], s52 offen offset:0 sc1
  v_mfma_f32_16x16x32_bf16 v[124:127], a[104:107], a[228:231], v[124:127]
  buffer_load_dwordx4 a[180:183], v239, s[32:35], s52 offen offset:0 sc1
  v_mfma_f32_16x16x32_bf16 v[124:127], a[100:103], a[220:223], v[124:127]
  ds_read_b64_tr_b16 a[80:81], v227 offset:37088
  v_mfma_f32_16x16x32_bf16 v[124:127], a[96:99], a[212:215], v[124:127]
  s_waitcnt lgkmcnt(1)
  ds_read_b64_tr_b16 a[82:83], v227 offset:42208
  v_mfma_f32_16x16x32_bf16 v[52:55], a[64:67], a[208:211], v[52:55]
  ds_read_b64_tr_b16 a[84:85], v227 offset:47328
  v_mfma_f32_16x16x32_bf16 v[52:55], a[68:71], a[216:219], v[52:55]
  ds_read_b64_tr_b16 a[86:87], v227 offset:52448
  v_mfma_f32_16x16x32_bf16 v[52:55], a[72:75], a[224:227], v[52:55]
  ds_read_b64_tr_b16 a[88:89], v227 offset:57568
  v_mfma_f32_16x16x32_bf16 v[52:55], a[76:79], a[236:239], v[52:55]
  ds_read_b64_tr_b16 a[90:91], v227 offset:62688
  ds_read_b64_tr_b16 a[92:93], v229 offset:2272
  ds_read_b64_tr_b16 a[94:95], v229 offset:7392
  v_mfma_f32_16x16x32_bf16 v[128:131], a[76:79], a[240:243], v[128:131]
  buffer_load_dwordx4 a[184:187], v238, s[32:35], s52 offen offset:1024 sc1
  v_mfma_f32_16x16x32_bf16 v[128:131], a[72:75], a[228:231], v[128:131]
  buffer_load_dwordx4 a[188:191], v239, s[32:35], s52 offen offset:1024 sc1
  v_mfma_f32_16x16x32_bf16 v[128:131], a[68:71], a[220:223], v[128:131]
  buffer_load_dwordx4 a[232:235], v238, s[32:35], s52 offen offset:2048 sc1
  v_mfma_f32_16x16x32_bf16 v[128:131], a[64:67], a[212:215], v[128:131]
  s_waitcnt lgkmcnt(0)
  ds_read_b64_tr_b16 a[96:97], v226 offset:37120
  v_mfma_f32_16x16x32_bf16 v[60:63], a[80:83], a[208:211], v[60:63]
  ds_read_b64_tr_b16 a[98:99], v226 offset:42240
  v_mfma_f32_16x16x32_bf16 v[60:63], a[84:87], a[216:219], v[60:63]
  ds_read_b64_tr_b16 a[100:101], v226 offset:47360
  v_mfma_f32_16x16x32_bf16 v[60:63], a[88:91], a[224:227], v[60:63]
  ds_read_b64_tr_b16 a[102:103], v226 offset:52480
  v_mfma_f32_16x16x32_bf16 v[60:63], a[92:95], a[236:239], v[60:63]
  ds_read_b64_tr_b16 a[104:105], v226 offset:57600
  ds_read_b64_tr_b16 a[106:107], v226 offset:62720
  ds_read_b64_tr_b16 a[108:109], v228 offset:2304
  ds_read_b64_tr_b16 a[110:111], v228 offset:7424
  v_mfma_f32_16x16x32_bf16 v[132:135], a[92:95], a[240:243], v[132:135]
  buffer_load_dwordx4 a[244:247], v239, s[32:35], s52 offen offset:2048 sc1
  v_mfma_f32_16x16x32_bf16 v[132:135], a[88:91], a[228:231], v[132:135]
  buffer_load_dwordx4 a[248:251], v238, s[32:35], s52 offen offset:3072 sc1
  v_mfma_f32_16x16x32_bf16 v[132:135], a[84:87], a[220:223], v[132:135]
  buffer_load_dwordx4 a[252:255], v239, s[32:35], s52 offen offset:3072 sc1
  v_mfma_f32_16x16x32_bf16 v[132:135], a[80:83], a[212:215], v[132:135]
  s_waitcnt lgkmcnt(0)
  ds_read_b64_tr_b16 a[64:65], v227 offset:37152
  v_lshrrev_b32 v253, 1, v249
  v_mfma_f32_16x16x32_bf16 v[68:71], a[96:99], a[208:211], v[68:71]
  ds_read_b64_tr_b16 a[66:67], v227 offset:42272
  v_min_u32 v253, 15, v253
  v_mfma_f32_16x16x32_bf16 v[68:71], a[100:103], a[216:219], v[68:71]
  ds_read_b64_tr_b16 a[68:69], v227 offset:47392
  v_mul_u32_u24 v253, 1280, v253
  v_mfma_f32_16x16x32_bf16 v[68:71], a[104:107], a[224:227], v[68:71]
  ds_read_b64_tr_b16 a[70:71], v227 offset:52512
  v_and_b32 v252, 1, v249
  v_mfma_f32_16x16x32_bf16 v[68:71], a[108:111], a[236:239], v[68:71]
  ds_read_b64_tr_b16 a[72:73], v227 offset:57632
  ds_read_b64_tr_b16 a[74:75], v227 offset:62752
  ds_read_b64_tr_b16 a[76:77], v229 offset:2336
  ds_read_b64_tr_b16 a[78:79], v229 offset:7456
  v_mfma_f32_16x16x32_bf16 v[136:139], a[108:111], a[240:243], v[136:139]
  ds_read_b64_tr_b16 a[80:81], v224 offset:20480
  v_lshl_add_u32 v252, v252, 7, v253
  v_mfma_f32_16x16x32_bf16 v[136:139], a[104:107], a[228:231], v[136:139]
  ds_read_b64_tr_b16 a[82:83], v224 offset:25600
  v_mfma_f32_16x16x32_bf16 v[136:139], a[100:103], a[220:223], v[136:139]
  ds_read_b64_tr_b16 a[84:85], v224 offset:30720
  v_mfma_f32_16x16x32_bf16 v[136:139], a[96:99], a[212:215], v[136:139]
  s_waitcnt lgkmcnt(3)
  ds_read_b64_tr_b16 a[86:87], v224 offset:35840
  v_mfma_f32_16x16x32_bf16 v[76:79], a[64:67], a[208:211], v[76:79]
  ds_read_b64_tr_b16 a[88:89], v224 offset:40960
  v_mfma_f32_16x16x32_bf16 v[76:79], a[68:71], a[216:219], v[76:79]
  ds_read_b64_tr_b16 a[90:91], v224 offset:46080
  v_mfma_f32_16x16x32_bf16 v[76:79], a[72:75], a[224:227], v[76:79]
  ds_read_b64_tr_b16 a[92:93], v224 offset:51200
  v_mfma_f32_16x16x32_bf16 v[76:79], a[76:79], a[236:239], v[76:79]
  ds_read_b64_tr_b16 a[94:95], v224 offset:56320
  v_mfma_f32_16x16x32_bf16 v[140:143], a[76:79], a[240:243], v[140:143]
  s_lshl_b32 s56, s90, 12
  buffer_load_dword v253, v252, s[8:11], 0 offen
  v_mfma_f32_16x16x32_bf16 v[140:143], a[72:75], a[228:231], v[140:143]
  ds_read_b64_tr_b16 a[96:97], v225 offset:20512
  v_mfma_f32_16x16x32_bf16 v[140:143], a[68:71], a[220:223], v[140:143]
  ds_read_b64_tr_b16 a[98:99], v225 offset:25632
  v_mfma_f32_16x16x32_bf16 v[140:143], a[64:67], a[212:215], v[140:143]
  s_waitcnt vmcnt(17) lgkmcnt(2)
  ds_read_b64_tr_b16 a[100:101], v225 offset:30752
  v_mfma_f32_16x16x32_bf16 v[144:147], a[80:83], a[112:115], v[144:147]
  ds_read_b64_tr_b16 a[102:103], v225 offset:35872
  v_mfma_f32_16x16x32_bf16 v[144:147], a[84:87], a[120:123], v[144:147]
  ds_read_b64_tr_b16 a[104:105], v225 offset:40992
  v_mfma_f32_16x16x32_bf16 v[144:147], a[88:91], a[128:131], v[144:147]
  ds_read_b64_tr_b16 a[106:107], v225 offset:46112
  v_mfma_f32_16x16x32_bf16 v[144:147], a[92:95], a[136:139], v[144:147]
  ds_read_b64_tr_b16 a[108:109], v225 offset:51232
  ds_read_b64_tr_b16 a[110:111], v225 offset:56352
  v_mfma_f32_16x16x32_bf16 v[184:187], a[92:95], a[140:143], v[184:187]
  ds_read_b64_tr_b16 a[64:65], v224 offset:61440
  v_mfma_f32_16x16x32_bf16 v[184:187], a[88:91], a[132:135], v[184:187]
  ds_read_b64_tr_b16 a[66:67], v226 offset:1024
  v_mfma_f32_16x16x32_bf16 v[184:187], a[84:87], a[124:127], v[184:187]
  ds_read_b64_tr_b16 a[68:69], v226 offset:6144
  v_cvt_pk_bf16_f32 v4, v4, v5
  v_mfma_f32_16x16x32_bf16 v[184:187], a[80:83], a[116:119], v[184:187]
  s_waitcnt lgkmcnt(3)
  ds_read_b64_tr_b16 a[70:71], v226 offset:11264
  v_cvt_pk_bf16_f32 v5, v6, v7
  v_mfma_f32_16x16x32_bf16 v[148:151], a[96:99], a[112:115], v[148:151]
  ds_read_b64_tr_b16 a[72:73], v226 offset:16384
  v_mfma_f32_16x16x32_bf16 v[148:151], a[100:103], a[120:123], v[148:151]
  ds_read_b64_tr_b16 a[74:75], v226 offset:21504
  v_cvt_pk_bf16_f32 v6, v12, v13
  v_mfma_f32_16x16x32_bf16 v[148:151], a[104:107], a[128:131], v[148:151]
  ds_read_b64_tr_b16 a[76:77], v226 offset:26624
  v_add_u32 v238, s56, v248
  v_mfma_f32_16x16x32_bf16 v[148:151], a[108:111], a[136:139], v[148:151]
  s_lshl_b32 s56, s91, 12
  ds_read_b64_tr_b16 a[78:79], v226 offset:31744
  v_cvt_pk_bf16_f32 v7, v14, v15
  v_mfma_f32_16x16x32_bf16 v[188:191], a[108:111], a[140:143], v[188:191]
  ds_read_b64_tr_b16 a[80:81], v225 offset:61472
  v_mfma_f32_16x16x32_bf16 v[188:191], a[104:107], a[132:135], v[188:191]
  ds_read_b64_tr_b16 a[82:83], v227 offset:1056
  v_mfma_f32_16x16x32_bf16 v[188:191], a[100:103], a[124:127], v[188:191]
  ds_read_b64_tr_b16 a[84:85], v227 offset:6176
  v_mfma_f32_16x16x32_bf16 v[188:191], a[96:99], a[116:119], v[188:191]
  s_waitcnt vmcnt(9) lgkmcnt(3)
  ds_read_b64_tr_b16 a[86:87], v227 offset:11296
  v_mfma_f32_16x16x32_bf16 v[144:147], a[64:67], a[144:147], v[144:147]
  ds_read_b64_tr_b16 a[88:89], v227 offset:16416
  v_mfma_f32_16x16x32_bf16 v[144:147], a[68:71], a[152:155], v[144:147]
  ds_read_b64_tr_b16 a[90:91], v227 offset:21536
  v_mfma_f32_16x16x32_bf16 v[144:147], a[72:75], a[160:163], v[144:147]
  ds_read_b64_tr_b16 a[92:93], v227 offset:26656
  v_mfma_f32_16x16x32_bf16 v[144:147], a[76:79], a[168:171], v[144:147]
  ds_read_b64_tr_b16 a[94:95], v227 offset:31776
  v_mfma_f32_16x16x32_bf16 v[184:187], a[76:79], a[172:175], v[184:187]
  buffer_store_dwordx4 v[4:7], v236, s[36:39], 0 offen offset:0 sc1
  v_cvt_pk_bf16_f32 v20, v20, v21
  v_mfma_f32_16x16x32_bf16 v[184:187], a[72:75], a[164:167], v[184:187]
  ds_read_b64_tr_b16 a[96:97], v226 offset:36864
  v_cvt_pk_bf16_f32 v21, v22, v23
  v_cvt_pk_bf16_f32 v22, v28, v29
  v_mfma_f32_16x16x32_bf16 v[184:187], a[68:71], a[156:159], v[184:187]
  ds_read_b64_tr_b16 a[98:99], v226 offset:41984
  v_cvt_pk_bf16_f32 v23, v30, v31
  v_mfma_f32_16x16x32_bf16 v[184:187], a[64:67], a[148:151], v[184:187]
  s_waitcnt lgkmcnt(2)
  ds_read_b64_tr_b16 a[100:101], v226 offset:47104
  v_add_u32 v239, s56, v248
  v_mfma_f32_16x16x32_bf16 v[148:151], a[80:83], a[144:147], v[148:151]
  ds_read_b64_tr_b16 a[102:103], v226 offset:52224
  v_mfma_f32_16x16x32_bf16 v[148:151], a[84:87], a[152:155], v[148:151]
  ds_read_b64_tr_b16 a[104:105], v226 offset:57344
  v_mfma_f32_16x16x32_bf16 v[148:151], a[88:91], a[160:163], v[148:151]
  ds_read_b64_tr_b16 a[106:107], v226 offset:62464
  v_mfma_f32_16x16x32_bf16 v[148:151], a[92:95], a[168:171], v[148:151]
  ds_read_b64_tr_b16 a[108:109], v228 offset:2048
  ds_read_b64_tr_b16 a[110:111], v228 offset:7168
  v_mfma_f32_16x16x32_bf16 v[188:191], a[92:95], a[172:175], v[188:191]
  buffer_store_dwordx4 v[20:23], v236, s[36:39], 0 offen offset:1024 sc1
  v_cvt_pk_bf16_f32 v84, v84, v85
  v_mfma_f32_16x16x32_bf16 v[188:191], a[88:91], a[164:167], v[188:191]
  ds_read_b64_tr_b16 a[64:65], v227 offset:36896
  v_cvt_pk_bf16_f32 v85, v86, v87
  v_mfma_f32_16x16x32_bf16 v[188:191], a[84:87], a[156:159], v[188:191]
  ds_read_b64_tr_b16 a[66:67], v227 offset:42016
  v_cvt_pk_bf16_f32 v86, v92, v93
  v_mfma_f32_16x16x32_bf16 v[188:191], a[80:83], a[148:151], v[188:191]
  s_waitcnt vmcnt(3) lgkmcnt(2)
  ds_read_b64_tr_b16 a[68:69], v227 offset:47136
  v_cvt_pk_bf16_f32 v87, v94, v95
  v_mfma_f32_16x16x32_bf16 v[144:147], a[96:99], a[176:179], v[144:147]
  ds_read_b64_tr_b16 a[70:71], v227 offset:52256
  v_mfma_f32_16x16x32_bf16 v[144:147], a[100:103], a[184:187], v[144:147]
  ds_read_b64_tr_b16 a[72:73], v227 offset:57376
  v_mfma_f32_16x16x32_bf16 v[144:147], a[104:107], a[232:235], v[144:147]
  ds_read_b64_tr_b16 a[74:75], v227 offset:62496
  v_mfma_f32_16x16x32_bf16 v[144:147], a[108:111], a[248:251], v[144:147]
  ds_read_b64_tr_b16 a[76:77], v229 offset:2080
  ds_read_b64_tr_b16 a[78:79], v229 offset:7200
  v_mfma_f32_16x16x32_bf16 v[184:187], a[108:111], a[252:255], v[184:187]
  buffer_store_dwordx4 v[84:87], v237, s[36:39], 0 offen offset:0 sc1
  v_mfma_f32_16x16x32_bf16 v[184:187], a[104:107], a[244:247], v[184:187]
  ds_read_b64_tr_b16 a[80:81], v224 offset:20544
  v_cvt_pk_bf16_f32 v100, v100, v101
  v_mfma_f32_16x16x32_bf16 v[184:187], a[100:103], a[188:191], v[184:187]
  ds_read_b64_tr_b16 a[82:83], v224 offset:25664
  v_cvt_pk_bf16_f32 v101, v102, v103
  v_mfma_f32_16x16x32_bf16 v[184:187], a[96:99], a[180:183], v[184:187]
  s_waitcnt lgkmcnt(2)
  ds_read_b64_tr_b16 a[84:85], v224 offset:30784
  v_cvt_pk_bf16_f32 v102, v108, v109
  v_mfma_f32_16x16x32_bf16 v[148:151], a[64:67], a[176:179], v[148:151]
  ds_read_b64_tr_b16 a[86:87], v224 offset:35904
  v_cvt_pk_bf16_f32 v103, v110, v111
  v_mfma_f32_16x16x32_bf16 v[148:151], a[68:71], a[184:187], v[148:151]
  ds_read_b64_tr_b16 a[88:89], v224 offset:41024
  v_mfma_f32_16x16x32_bf16 v[148:151], a[72:75], a[232:235], v[148:151]
  ds_read_b64_tr_b16 a[90:91], v224 offset:46144
  v_mfma_f32_16x16x32_bf16 v[148:151], a[76:79], a[248:251], v[148:151]
  ds_read_b64_tr_b16 a[92:93], v224 offset:51264
  ds_read_b64_tr_b16 a[94:95], v224 offset:56384
  v_mfma_f32_16x16x32_bf16 v[188:191], a[76:79], a[252:255], v[188:191]
  buffer_store_dwordx4 v[100:103], v237, s[36:39], 0 offen offset:1024 sc1
  v_mfma_f32_16x16x32_bf16 v[188:191], a[72:75], a[244:247], v[188:191]
  ds_read_b64_tr_b16 a[96:97], v225 offset:20576
  v_cvt_pk_bf16_f32 v36, v36, v37
  v_mfma_f32_16x16x32_bf16 v[188:191], a[68:71], a[188:191], v[188:191]
  ds_read_b64_tr_b16 a[98:99], v225 offset:25696
  v_cvt_pk_bf16_f32 v37, v38, v39
  v_mfma_f32_16x16x32_bf16 v[188:191], a[64:67], a[180:183], v[188:191]
  s_waitcnt lgkmcnt(2)
  ds_read_b64_tr_b16 a[100:101], v225 offset:30816
  v_cvt_pk_bf16_f32 v38, v116, v117
  v_mfma_f32_16x16x32_bf16 v[152:155], a[80:83], a[112:115], v[152:155]
  ds_read_b64_tr_b16 a[102:103], v225 offset:35936
  v_cvt_pk_bf16_f32 v39, v118, v119
  v_mfma_f32_16x16x32_bf16 v[152:155], a[84:87], a[120:123], v[152:155]
  ds_read_b64_tr_b16 a[104:105], v225 offset:41056
  v_mfma_f32_16x16x32_bf16 v[152:155], a[88:91], a[128:131], v[152:155]
  ds_read_b64_tr_b16 a[106:107], v225 offset:46176
  v_mfma_f32_16x16x32_bf16 v[152:155], a[92:95], a[136:139], v[152:155]
  ds_read_b64_tr_b16 a[108:109], v225 offset:51296
  ds_read_b64_tr_b16 a[110:111], v225 offset:56416
  v_mfma_f32_16x16x32_bf16 v[192:195], a[92:95], a[140:143], v[192:195]
  ds_read_b64_tr_b16 a[64:65], v224 offset:61504
  v_mfma_f32_16x16x32_bf16 v[192:195], a[88:91], a[132:135], v[192:195]
  ds_read_b64_tr_b16 a[66:67], v226 offset:1088
  v_mfma_f32_16x16x32_bf16 v[192:195], a[84:87], a[124:127], v[192:195]
  ds_read_b64_tr_b16 a[68:69], v226 offset:6208
  v_mfma_f32_16x16x32_bf16 v[192:195], a[80:83], a[116:119], v[192:195]
  s_waitcnt lgkmcnt(3)
  ds_read_b64_tr_b16 a[70:71], v226 offset:11328
  v_mfma_f32_16x16x32_bf16 v[156:159], a[96:99], a[112:115], v[156:159]
  ds_read_b64_tr_b16 a[72:73], v226 offset:16448
  v_mfma_f32_16x16x32_bf16 v[156:159], a[100:103], a[120:123], v[156:159]
  ds_read_b64_tr_b16 a[74:75], v226 offset:21568
  v_mfma_f32_16x16x32_bf16 v[156:159], a[104:107], a[128:131], v[156:159]
  ds_read_b64_tr_b16 a[76:77], v226 offset:26688
  v_mfma_f32_16x16x32_bf16 v[156:159], a[108:111], a[136:139], v[156:159]
  ds_read_b64_tr_b16 a[78:79], v226 offset:31808
  v_mfma_f32_16x16x32_bf16 v[196:199], a[108:111], a[140:143], v[196:199]
  buffer_store_dwordx4 v[36:39], v244, s[36:39], 0 offen offset:0 sc1
  v_cvt_pk_bf16_f32 v44, v44, v45
  v_mfma_f32_16x16x32_bf16 v[196:199], a[104:107], a[132:135], v[196:199]
  ds_read_b64_tr_b16 a[80:81], v225 offset:61536
  v_cvt_pk_bf16_f32 v45, v46, v47
  v_cvt_pk_bf16_f32 v46, v52, v53
  v_mfma_f32_16x16x32_bf16 v[196:199], a[100:103], a[124:127], v[196:199]
  ds_read_b64_tr_b16 a[82:83], v227 offset:1120
  v_cvt_pk_bf16_f32 v47, v54, v55
  v_mfma_f32_16x16x32_bf16 v[196:199], a[96:99], a[116:119], v[196:199]
  s_waitcnt lgkmcnt(2)
  ds_read_b64_tr_b16 a[84:85], v227 offset:6240
  v_mfma_f32_16x16x32_bf16 v[152:155], a[64:67], a[144:147], v[152:155]
  ds_read_b64_tr_b16 a[86:87], v227 offset:11360
  v_mfma_f32_16x16x32_bf16 v[152:155], a[68:71], a[152:155], v[152:155]
  ds_read_b64_tr_b16 a[88:89], v227 offset:16480
  v_mfma_f32_16x16x32_bf16 v[152:155], a[72:75], a[160:163], v[152:155]
  ds_read_b64_tr_b16 a[90:91], v227 offset:21600
  v_mfma_f32_16x16x32_bf16 v[152:155], a[76:79], a[168:171], v[152:155]
  ds_read_b64_tr_b16 a[92:93], v227 offset:26720
  ds_read_b64_tr_b16 a[94:95], v227 offset:31840
  v_mfma_f32_16x16x32_bf16 v[192:195], a[76:79], a[172:175], v[192:195]
  buffer_store_dwordx4 v[44:47], v236, s[36:39], 0 offen offset:2048 sc1
  v_cvt_pk_bf16_f32 v60, v60, v61
  v_mfma_f32_16x16x32_bf16 v[192:195], a[72:75], a[164:167], v[192:195]
  ds_read_b64_tr_b16 a[96:97], v226 offset:36928
  v_cvt_pk_bf16_f32 v61, v62, v63
  v_cvt_pk_bf16_f32 v62, v68, v69
  v_mfma_f32_16x16x32_bf16 v[192:195], a[68:71], a[156:159], v[192:195]
  ds_read_b64_tr_b16 a[98:99], v226 offset:42048
  v_cvt_pk_bf16_f32 v63, v70, v71
  v_mfma_f32_16x16x32_bf16 v[192:195], a[64:67], a[148:151], v[192:195]
  s_waitcnt lgkmcnt(2)
  ds_read_b64_tr_b16 a[100:101], v226 offset:47168
  v_mfma_f32_16x16x32_bf16 v[156:159], a[80:83], a[144:147], v[156:159]
  ds_read_b64_tr_b16 a[102:103], v226 offset:52288
  v_mfma_f32_16x16x32_bf16 v[156:159], a[84:87], a[152:155], v[156:159]
  ds_read_b64_tr_b16 a[104:105], v226 offset:57408
  v_mfma_f32_16x16x32_bf16 v[156:159], a[88:91], a[160:163], v[156:159]
  ds_read_b64_tr_b16 a[106:107], v226 offset:62528
  v_mfma_f32_16x16x32_bf16 v[156:159], a[92:95], a[168:171], v[156:159]
  ds_read_b64_tr_b16 a[108:109], v228 offset:2112
  ds_read_b64_tr_b16 a[110:111], v228 offset:7232
  v_mfma_f32_16x16x32_bf16 v[196:199], a[92:95], a[172:175], v[196:199]
  buffer_store_dwordx4 v[60:63], v236, s[36:39], 0 offen offset:3072 sc1
  v_cvt_pk_bf16_f32 v124, v124, v125
  v_mfma_f32_16x16x32_bf16 v[196:199], a[88:91], a[164:167], v[196:199]
  ds_read_b64_tr_b16 a[64:65], v227 offset:36960
  v_cvt_pk_bf16_f32 v125, v126, v127
  v_cvt_pk_bf16_f32 v126, v128, v129
  v_mfma_f32_16x16x32_bf16 v[196:199], a[84:87], a[156:159], v[196:199]
  ds_read_b64_tr_b16 a[66:67], v227 offset:42080
  v_cvt_pk_bf16_f32 v127, v130, v131
  v_mfma_f32_16x16x32_bf16 v[196:199], a[80:83], a[148:151], v[196:199]
  s_waitcnt lgkmcnt(2)
  ds_read_b64_tr_b16 a[68:69], v227 offset:47200
  v_mfma_f32_16x16x32_bf16 v[152:155], a[96:99], a[176:179], v[152:155]
  ds_read_b64_tr_b16 a[70:71], v227 offset:52320
  v_mfma_f32_16x16x32_bf16 v[152:155], a[100:103], a[184:187], v[152:155]
  ds_read_b64_tr_b16 a[72:73], v227 offset:57440
  v_mfma_f32_16x16x32_bf16 v[152:155], a[104:107], a[232:235], v[152:155]
  ds_read_b64_tr_b16 a[74:75], v227 offset:62560
  v_mfma_f32_16x16x32_bf16 v[152:155], a[108:111], a[248:251], v[152:155]
  ds_read_b64_tr_b16 a[76:77], v229 offset:2144
  ds_read_b64_tr_b16 a[78:79], v229 offset:7264
  v_mfma_f32_16x16x32_bf16 v[192:195], a[108:111], a[252:255], v[192:195]
  buffer_store_dwordx4 v[124:127], v237, s[36:39], 0 offen offset:2048 sc1
  v_cvt_pk_bf16_f32 v132, v132, v133
  v_mfma_f32_16x16x32_bf16 v[192:195], a[104:107], a[244:247], v[192:195]
  ds_read_b64_tr_b16 a[80:81], v225 offset:20640
  v_cvt_pk_bf16_f32 v133, v134, v135
  v_mfma_f32_16x16x32_bf16 v[192:195], a[100:103], a[188:191], v[192:195]
  ds_read_b64_tr_b16 a[82:83], v225 offset:25760
  v_cvt_pk_bf16_f32 v134, v136, v137
  v_mfma_f32_16x16x32_bf16 v[192:195], a[96:99], a[180:183], v[192:195]
  s_waitcnt lgkmcnt(2)
  ds_read_b64_tr_b16 a[84:85], v225 offset:30880
  v_cvt_pk_bf16_f32 v135, v138, v139
  v_mfma_f32_16x16x32_bf16 v[156:159], a[64:67], a[176:179], v[156:159]
  ds_read_b64_tr_b16 a[86:87], v225 offset:36000
  v_mfma_f32_16x16x32_bf16 v[156:159], a[68:71], a[184:187], v[156:159]
  ds_read_b64_tr_b16 a[88:89], v225 offset:41120
  v_mfma_f32_16x16x32_bf16 v[156:159], a[72:75], a[232:235], v[156:159]
  ds_read_b64_tr_b16 a[90:91], v225 offset:46240
  v_mfma_f32_16x16x32_bf16 v[156:159], a[76:79], a[248:251], v[156:159]
  ds_read_b64_tr_b16 a[92:93], v225 offset:51360
  ds_read_b64_tr_b16 a[94:95], v225 offset:56480
  v_mfma_f32_16x16x32_bf16 v[196:199], a[76:79], a[252:255], v[196:199]
  buffer_store_dwordx4 v[132:135], v237, s[36:39], 0 offen offset:3072 sc1
  v_mfma_f32_16x16x32_bf16 v[196:199], a[72:75], a[244:247], v[196:199]
  ds_read_b64_tr_b16 a[96:97], v224 offset:20672
  v_cvt_pk_bf16_f32 v76, v76, v77
  v_mfma_f32_16x16x32_bf16 v[196:199], a[68:71], a[188:191], v[196:199]
  ds_read_b64_tr_b16 a[98:99], v224 offset:25792
  v_cvt_pk_bf16_f32 v77, v78, v79
  v_mfma_f32_16x16x32_bf16 v[196:199], a[64:67], a[180:183], v[196:199]
  s_waitcnt lgkmcnt(2)
  ds_read_b64_tr_b16 a[100:101], v224 offset:30912
  v_cvt_pk_bf16_f32 v78, v140, v141
  v_mfma_f32_16x16x32_bf16 v[164:167], a[80:83], a[112:115], v[164:167]
  ds_read_b64_tr_b16 a[102:103], v224 offset:36032
  v_cvt_pk_bf16_f32 v79, v142, v143
  v_mfma_f32_16x16x32_bf16 v[164:167], a[84:87], a[120:123], v[164:167]
  ds_read_b64_tr_b16 a[104:105], v224 offset:41152
  v_mfma_f32_16x16x32_bf16 v[164:167], a[88:91], a[128:131], v[164:167]
  ds_read_b64_tr_b16 a[106:107], v224 offset:46272
  v_mfma_f32_16x16x32_bf16 v[164:167], a[92:95], a[136:139], v[164:167]
  ds_read_b64_tr_b16 a[108:109], v224 offset:51392
  ds_read_b64_tr_b16 a[110:111], v224 offset:56512
  v_mfma_f32_16x16x32_bf16 v[204:207], a[92:95], a[140:143], v[204:207]
  buffer_store_dwordx4 v[76:79], v244, s[36:39], 0 offen offset:1024 sc1
  v_mfma_f32_16x16x32_bf16 v[204:207], a[88:91], a[132:135], v[204:207]
  ds_read_b64_tr_b16 a[64:65], v225 offset:61600
  v_cvt_pk_bf16_f32 v144, v144, v145
  v_mfma_f32_16x16x32_bf16 v[204:207], a[84:87], a[124:127], v[204:207]
  ds_read_b64_tr_b16 a[66:67], v227 offset:1184
  v_mfma_f32_16x16x32_bf16 v[204:207], a[80:83], a[116:119], v[204:207]
  s_waitcnt lgkmcnt(2)
  ds_read_b64_tr_b16 a[68:69], v227 offset:6304
  v_cvt_pk_bf16_f32 v145, v146, v147
  v_mfma_f32_16x16x32_bf16 v[168:171], a[96:99], a[112:115], v[168:171]
  ds_read_b64_tr_b16 a[70:71], v227 offset:11424
  v_mfma_f32_16x16x32_bf16 v[168:171], a[100:103], a[120:123], v[168:171]
  ds_read_b64_tr_b16 a[72:73], v227 offset:16544
  v_mfma_f32_16x16x32_bf16 v[168:171], a[104:107], a[128:131], v[168:171]
  ds_read_b64_tr_b16 a[74:75], v227 offset:21664
  v_cvt_pk_bf16_f32 v146, v148, v149
  v_mfma_f32_16x16x32_bf16 v[168:171], a[108:111], a[136:139], v[168:171]
  ds_read_b64_tr_b16 a[76:77], v227 offset:26784
  ds_read_b64_tr_b16 a[78:79], v227 offset:31904
  v_mfma_f32_16x16x32_bf16 v[208:211], a[108:111], a[140:143], v[208:211]
  ds_read_b64_tr_b16 a[80:81], v224 offset:61632
  v_mfma_f32_16x16x32_bf16 v[208:211], a[104:107], a[132:135], v[208:211]
  ds_read_b64_tr_b16 a[82:83], v226 offset:1216
  v_cvt_pk_bf16_f32 v147, v150, v151
  v_mfma_f32_16x16x32_bf16 v[208:211], a[100:103], a[124:127], v[208:211]
  ds_read_b64_tr_b16 a[84:85], v226 offset:6336
  v_mfma_f32_16x16x32_bf16 v[208:211], a[96:99], a[116:119], v[208:211]
  s_waitcnt lgkmcnt(3)
  ds_read_b64_tr_b16 a[86:87], v226 offset:11456
  v_mfma_f32_16x16x32_bf16 v[164:167], a[64:67], a[144:147], v[164:167]
  ds_read_b64_tr_b16 a[88:89], v226 offset:16576
  v_mfma_f32_16x16x32_bf16 v[164:167], a[68:71], a[152:155], v[164:167]
  ds_read_b64_tr_b16 a[90:91], v226 offset:21696
  v_mfma_f32_16x16x32_bf16 v[164:167], a[72:75], a[160:163], v[164:167]
  ds_read_b64_tr_b16 a[92:93], v226 offset:26816
  v_mfma_f32_16x16x32_bf16 v[164:167], a[76:79], a[168:171], v[164:167]
  ds_read_b64_tr_b16 a[94:95], v226 offset:31936
  v_mfma_f32_16x16x32_bf16 v[204:207], a[76:79], a[172:175], v[204:207]
  buffer_store_dwordx4 v[144:147], v238, s[36:39], 0 offen offset:0 sc1
  v_mfma_f32_16x16x32_bf16 v[204:207], a[72:75], a[164:167], v[204:207]
  ds_read_b64_tr_b16 a[96:97], v227 offset:37024
  v_mfma_f32_16x16x32_bf16 v[204:207], a[68:71], a[156:159], v[204:207]
  ds_read_b64_tr_b16 a[98:99], v227 offset:42144
  v_cvt_pk_bf16_f32 v184, v184, v185
  v_mfma_f32_16x16x32_bf16 v[204:207], a[64:67], a[148:151], v[204:207]
  s_waitcnt lgkmcnt(2)
  ds_read_b64_tr_b16 a[100:101], v227 offset:47264
  v_mfma_f32_16x16x32_bf16 v[168:171], a[80:83], a[144:147], v[168:171]
  ds_read_b64_tr_b16 a[102:103], v227 offset:52384
  v_mfma_f32_16x16x32_bf16 v[168:171], a[84:87], a[152:155], v[168:171]
  ds_read_b64_tr_b16 a[104:105], v227 offset:57504
  v_cvt_pk_bf16_f32 v185, v186, v187
  v_mfma_f32_16x16x32_bf16 v[168:171], a[88:91], a[160:163], v[168:171]
  ds_read_b64_tr_b16 a[106:107], v227 offset:62624
  v_mfma_f32_16x16x32_bf16 v[168:171], a[92:95], a[168:171], v[168:171]
  ds_read_b64_tr_b16 a[108:109], v229 offset:2208
  ds_read_b64_tr_b16 a[110:111], v229 offset:7328
  v_mfma_f32_16x16x32_bf16 v[208:211], a[92:95], a[172:175], v[208:211]
  ds_read_b64_tr_b16 a[64:65], v226 offset:37056
  v_cvt_pk_bf16_f32 v186, v188, v189
  v_mfma_f32_16x16x32_bf16 v[208:211], a[88:91], a[164:167], v[208:211]
  ds_read_b64_tr_b16 a[66:67], v226 offset:42176
  v_mfma_f32_16x16x32_bf16 v[208:211], a[84:87], a[156:159], v[208:211]
  ds_read_b64_tr_b16 a[68:69], v226 offset:47296
  v_mfma_f32_16x16x32_bf16 v[208:211], a[80:83], a[148:151], v[208:211]
  s_waitcnt lgkmcnt(3)
  ds_read_b64_tr_b16 a[70:71], v226 offset:52416
  v_cvt_pk_bf16_f32 v187, v190, v191
  v_mfma_f32_16x16x32_bf16 v[164:167], a[96:99], a[176:179], v[164:167]
  ds_read_b64_tr_b16 a[72:73], v226 offset:57536
  v_mfma_f32_16x16x32_bf16 v[164:167], a[100:103], a[184:187], v[164:167]
  ds_read_b64_tr_b16 a[74:75], v226 offset:62656
  v_mfma_f32_16x16x32_bf16 v[164:167], a[104:107], a[232:235], v[164:167]
  ds_read_b64_tr_b16 a[76:77], v228 offset:2240
  v_mfma_f32_16x16x32_bf16 v[164:167], a[108:111], a[248:251], v[164:167]
  ds_read_b64_tr_b16 a[78:79], v228 offset:7360
  v_mfma_f32_16x16x32_bf16 v[204:207], a[108:111], a[252:255], v[204:207]
  ds_read_b64_tr_b16 a[80:81], v225 offset:20704
  v_mfma_f32_16x16x32_bf16 v[204:207], a[104:107], a[244:247], v[204:207]
  ds_read_b64_tr_b16 a[82:83], v225 offset:25824
  v_mfma_f32_16x16x32_bf16 v[204:207], a[100:103], a[188:191], v[204:207]
  ds_read_b64_tr_b16 a[84:85], v225 offset:30944
  v_mfma_f32_16x16x32_bf16 v[204:207], a[96:99], a[180:183], v[204:207]
  s_waitcnt lgkmcnt(3)
  ds_read_b64_tr_b16 a[86:87], v225 offset:36064
  v_mfma_f32_16x16x32_bf16 v[168:171], a[64:67], a[176:179], v[168:171]
  ds_read_b64_tr_b16 a[88:89], v225 offset:41184
  v_mfma_f32_16x16x32_bf16 v[168:171], a[68:71], a[184:187], v[168:171]
  ds_read_b64_tr_b16 a[90:91], v225 offset:46304
  v_mfma_f32_16x16x32_bf16 v[168:171], a[72:75], a[232:235], v[168:171]
  ds_read_b64_tr_b16 a[92:93], v225 offset:51424
  v_mfma_f32_16x16x32_bf16 v[168:171], a[76:79], a[248:251], v[168:171]
  ds_read_b64_tr_b16 a[94:95], v225 offset:56544
  v_mfma_f32_16x16x32_bf16 v[208:211], a[76:79], a[252:255], v[208:211]
  buffer_store_dwordx4 v[184:187], v239, s[36:39], 0 offen offset:0 sc1
  v_cvt_pk_bf16_f32 v152, v152, v153
  v_mfma_f32_16x16x32_bf16 v[208:211], a[72:75], a[244:247], v[208:211]
  ds_read_b64_tr_b16 a[96:97], v224 offset:20736
  v_cvt_pk_bf16_f32 v153, v154, v155
  v_mfma_f32_16x16x32_bf16 v[208:211], a[68:71], a[188:191], v[208:211]
  ds_read_b64_tr_b16 a[98:99], v224 offset:25856
  v_cvt_pk_bf16_f32 v154, v156, v157
  v_mfma_f32_16x16x32_bf16 v[208:211], a[64:67], a[180:183], v[208:211]
  s_waitcnt lgkmcnt(2)
  ds_read_b64_tr_b16 a[100:101], v224 offset:30976
  v_mfma_f32_16x16x32_bf16 v[172:175], a[80:83], a[112:115], v[172:175]
  ds_read_b64_tr_b16 a[102:103], v224 offset:36096
  v_mfma_f32_16x16x32_bf16 v[172:175], a[84:87], a[120:123], v[172:175]
  ds_read_b64_tr_b16 a[104:105], v224 offset:41216
  v_cvt_pk_bf16_f32 v155, v158, v159
  v_mfma_f32_16x16x32_bf16 v[172:175], a[88:91], a[128:131], v[172:175]
  ds_read_b64_tr_b16 a[106:107], v224 offset:46336
  v_mfma_f32_16x16x32_bf16 v[172:175], a[92:95], a[136:139], v[172:175]
  ds_read_b64_tr_b16 a[108:109], v224 offset:51456
  ds_read_b64_tr_b16 a[110:111], v224 offset:56576
  v_mfma_f32_16x16x32_bf16 v[212:215], a[92:95], a[140:143], v[212:215]
  ds_read_b64_tr_b16 a[64:65], v225 offset:61664
  v_mfma_f32_16x16x32_bf16 v[212:215], a[88:91], a[132:135], v[212:215]
  ds_read_b64_tr_b16 a[66:67], v227 offset:1248
  v_mfma_f32_16x16x32_bf16 v[212:215], a[84:87], a[124:127], v[212:215]
  ds_read_b64_tr_b16 a[68:69], v227 offset:6368
  v_mfma_f32_16x16x32_bf16 v[212:215], a[80:83], a[116:119], v[212:215]
  s_waitcnt lgkmcnt(3)
  ds_read_b64_tr_b16 a[70:71], v227 offset:11488
  v_mfma_f32_16x16x32_bf16 v[176:179], a[96:99], a[112:115], v[176:179]
  ds_read_b64_tr_b16 a[72:73], v227 offset:16608
  v_mfma_f32_16x16x32_bf16 v[176:179], a[100:103], a[120:123], v[176:179]
  ds_read_b64_tr_b16 a[74:75], v227 offset:21728
  v_mfma_f32_16x16x32_bf16 v[176:179], a[104:107], a[128:131], v[176:179]
  ds_read_b64_tr_b16 a[76:77], v227 offset:26848
  v_mfma_f32_16x16x32_bf16 v[176:179], a[108:111], a[136:139], v[176:179]
  ds_read_b64_tr_b16 a[78:79], v227 offset:31968
  v_mfma_f32_16x16x32_bf16 v[216:219], a[108:111], a[140:143], v[216:219]
  buffer_store_dwordx4 v[152:155], v238, s[36:39], 0 offen offset:1024 sc1
  v_mfma_f32_16x16x32_bf16 v[216:219], a[104:107], a[132:135], v[216:219]
  ds_read_b64_tr_b16 a[80:81], v224 offset:61696
  v_cvt_pk_bf16_f32 v192, v192, v193
  v_mfma_f32_16x16x32_bf16 v[216:219], a[100:103], a[124:127], v[216:219]
  ds_read_b64_tr_b16 a[82:83], v226 offset:1280
  v_cvt_pk_bf16_f32 v193, v194, v195
  v_mfma_f32_16x16x32_bf16 v[216:219], a[96:99], a[116:119], v[216:219]
  s_waitcnt lgkmcnt(2)
  ds_read_b64_tr_b16 a[84:85], v226 offset:6400
  v_mfma_f32_16x16x32_bf16 v[172:175], a[64:67], a[144:147], v[172:175]
  ds_read_b64_tr_b16 a[86:87], v226 offset:11520
  v_cvt_pk_bf16_f32 v194, v196, v197
  v_mfma_f32_16x16x32_bf16 v[172:175], a[68:71], a[152:155], v[172:175]
  ds_read_b64_tr_b16 a[88:89], v226 offset:16640
  v_mfma_f32_16x16x32_bf16 v[172:175], a[72:75], a[160:163], v[172:175]
  ds_read_b64_tr_b16 a[90:91], v226 offset:21760
  v_mfma_f32_16x16x32_bf16 v[172:175], a[76:79], a[168:171], v[172:175]
  ds_read_b64_tr_b16 a[92:93], v226 offset:26880
  ds_read_b64_tr_b16 a[94:95], v226 offset:32000
  v_mfma_f32_16x16x32_bf16 v[212:215], a[76:79], a[172:175], v[212:215]
  ds_read_b64_tr_b16 a[96:97], v227 offset:37088
  v_cvt_pk_bf16_f32 v195, v198, v199
  v_mfma_f32_16x16x32_bf16 v[212:215], a[72:75], a[164:167], v[212:215]
  ds_read_b64_tr_b16 a[98:99], v227 offset:42208
  v_mfma_f32_16x16x32_bf16 v[212:215], a[68:71], a[156:159], v[212:215]
  ds_read_b64_tr_b16 a[100:101], v227 offset:47328
  v_mfma_f32_16x16x32_bf16 v[212:215], a[64:67], a[148:151], v[212:215]
  s_waitcnt lgkmcnt(3)
  ds_read_b64_tr_b16 a[102:103], v227 offset:52448
  v_mfma_f32_16x16x32_bf16 v[176:179], a[80:83], a[144:147], v[176:179]
  ds_read_b64_tr_b16 a[104:105], v227 offset:57568
  v_mfma_f32_16x16x32_bf16 v[176:179], a[84:87], a[152:155], v[176:179]
  ds_read_b64_tr_b16 a[106:107], v227 offset:62688
  v_mfma_f32_16x16x32_bf16 v[176:179], a[88:91], a[160:163], v[176:179]
  ds_read_b64_tr_b16 a[108:109], v229 offset:2272
  v_mfma_f32_16x16x32_bf16 v[176:179], a[92:95], a[168:171], v[176:179]
  ds_read_b64_tr_b16 a[110:111], v229 offset:7392
  v_mfma_f32_16x16x32_bf16 v[216:219], a[92:95], a[172:175], v[216:219]
  buffer_store_dwordx4 v[192:195], v239, s[36:39], 0 offen offset:1024 sc1
  v_mfma_f32_16x16x32_bf16 v[216:219], a[88:91], a[164:167], v[216:219]
  ds_read_b64_tr_b16 a[64:65], v226 offset:37120
  v_cvt_pk_bf16_f32 v164, v164, v165
  v_mfma_f32_16x16x32_bf16 v[216:219], a[84:87], a[156:159], v[216:219]
  ds_read_b64_tr_b16 a[66:67], v226 offset:42240
  v_cvt_pk_bf16_f32 v165, v166, v167
  v_mfma_f32_16x16x32_bf16 v[216:219], a[80:83], a[148:151], v[216:219]
  s_waitcnt lgkmcnt(2)
  ds_read_b64_tr_b16 a[68:69], v226 offset:47360
  v_mfma_f32_16x16x32_bf16 v[172:175], a[96:99], a[176:179], v[172:175]
  ds_read_b64_tr_b16 a[70:71], v226 offset:52480
  v_mfma_f32_16x16x32_bf16 v[172:175], a[100:103], a[184:187], v[172:175]
  ds_read_b64_tr_b16 a[72:73], v226 offset:57600
  v_cvt_pk_bf16_f32 v166, v168, v169
  v_mfma_f32_16x16x32_bf16 v[172:175], a[104:107], a[232:235], v[172:175]
  ds_read_b64_tr_b16 a[74:75], v226 offset:62720
  v_mfma_f32_16x16x32_bf16 v[172:175], a[108:111], a[248:251], v[172:175]
  ds_read_b64_tr_b16 a[76:77], v228 offset:2304
  ds_read_b64_tr_b16 a[78:79], v228 offset:7424
  v_mfma_f32_16x16x32_bf16 v[212:215], a[108:111], a[252:255], v[212:215]
  ds_read_b64_tr_b16 a[80:81], v224 offset:20608
  v_cvt_pk_bf16_f32 v167, v170, v171
  v_mfma_f32_16x16x32_bf16 v[212:215], a[104:107], a[244:247], v[212:215]
  ds_read_b64_tr_b16 a[82:83], v224 offset:25728
  v_mfma_f32_16x16x32_bf16 v[212:215], a[100:103], a[188:191], v[212:215]
  ds_read_b64_tr_b16 a[84:85], v224 offset:30848
  v_mfma_f32_16x16x32_bf16 v[212:215], a[96:99], a[180:183], v[212:215]
  s_waitcnt lgkmcnt(3)
  ds_read_b64_tr_b16 a[86:87], v224 offset:35968
  v_mfma_f32_16x16x32_bf16 v[176:179], a[64:67], a[176:179], v[176:179]
  ds_read_b64_tr_b16 a[88:89], v224 offset:41088
  v_mfma_f32_16x16x32_bf16 v[176:179], a[68:71], a[184:187], v[176:179]
  ds_read_b64_tr_b16 a[90:91], v224 offset:46208
  v_mfma_f32_16x16x32_bf16 v[176:179], a[72:75], a[232:235], v[176:179]
  ds_read_b64_tr_b16 a[92:93], v224 offset:51328
  v_mfma_f32_16x16x32_bf16 v[176:179], a[76:79], a[248:251], v[176:179]
  ds_read_b64_tr_b16 a[94:95], v224 offset:56448
  v_mfma_f32_16x16x32_bf16 v[216:219], a[76:79], a[252:255], v[216:219]
  buffer_store_dwordx4 v[164:167], v238, s[36:39], 0 offen offset:2048 sc1
  v_mfma_f32_16x16x32_bf16 v[216:219], a[72:75], a[244:247], v[216:219]
  ds_read_b64_tr_b16 a[96:97], v225 offset:20768
  v_cvt_pk_bf16_f32 v204, v204, v205
  v_mfma_f32_16x16x32_bf16 v[216:219], a[68:71], a[188:191], v[216:219]
  ds_read_b64_tr_b16 a[98:99], v225 offset:25888
  v_cvt_pk_bf16_f32 v205, v206, v207
  v_mfma_f32_16x16x32_bf16 v[216:219], a[64:67], a[180:183], v[216:219]
  s_waitcnt lgkmcnt(2)
  ds_read_b64_tr_b16 a[100:101], v225 offset:31008
  v_mfma_f32_16x16x32_bf16 v[160:163], a[80:83], a[112:115], v[160:163]
  ds_read_b64_tr_b16 a[102:103], v225 offset:36128
  v_mfma_f32_16x16x32_bf16 v[160:163], a[84:87], a[120:123], v[160:163]
  ds_read_b64_tr_b16 a[104:105], v225 offset:41248
  v_cvt_pk_bf16_f32 v206, v208, v209
  v_mfma_f32_16x16x32_bf16 v[160:163], a[88:91], a[128:131], v[160:163]
  ds_read_b64_tr_b16 a[106:107], v225 offset:46368
  v_mfma_f32_16x16x32_bf16 v[160:163], a[92:95], a[136:139], v[160:163]
  ds_read_b64_tr_b16 a[108:109], v225 offset:51488
  ds_read_b64_tr_b16 a[110:111], v225 offset:56608
  v_mfma_f32_16x16x32_bf16 v[200:203], a[92:95], a[140:143], v[200:203]
  ds_read_b64_tr_b16 a[64:65], v224 offset:61568
  v_cvt_pk_bf16_f32 v207, v210, v211
  v_mfma_f32_16x16x32_bf16 v[200:203], a[88:91], a[132:135], v[200:203]
  ds_read_b64_tr_b16 a[66:67], v226 offset:1152
  v_mfma_f32_16x16x32_bf16 v[200:203], a[84:87], a[124:127], v[200:203]
  ds_read_b64_tr_b16 a[68:69], v226 offset:6272
  v_mfma_f32_16x16x32_bf16 v[200:203], a[80:83], a[116:119], v[200:203]
  s_waitcnt lgkmcnt(3)
  ds_read_b64_tr_b16 a[70:71], v226 offset:11392
  v_mfma_f32_16x16x32_bf16 v[180:183], a[96:99], a[112:115], v[180:183]
  ds_read_b64_tr_b16 a[72:73], v226 offset:16512
  v_mfma_f32_16x16x32_bf16 v[180:183], a[100:103], a[120:123], v[180:183]
  ds_read_b64_tr_b16 a[74:75], v226 offset:21632
  v_mfma_f32_16x16x32_bf16 v[180:183], a[104:107], a[128:131], v[180:183]
  ds_read_b64_tr_b16 a[76:77], v226 offset:26752
  v_mfma_f32_16x16x32_bf16 v[180:183], a[108:111], a[136:139], v[180:183]
  ds_read_b64_tr_b16 a[78:79], v226 offset:31872
  v_mfma_f32_16x16x32_bf16 v[220:223], a[108:111], a[140:143], v[220:223]
  buffer_store_dwordx4 v[204:207], v239, s[36:39], 0 offen offset:2048 sc1
  v_mfma_f32_16x16x32_bf16 v[220:223], a[104:107], a[132:135], v[220:223]
  ds_read_b64_tr_b16 a[80:81], v225 offset:61728
  v_cvt_pk_bf16_f32 v172, v172, v173
  v_mfma_f32_16x16x32_bf16 v[220:223], a[100:103], a[124:127], v[220:223]
  ds_read_b64_tr_b16 a[82:83], v227 offset:1312
  v_cvt_pk_bf16_f32 v173, v174, v175
  v_mfma_f32_16x16x32_bf16 v[220:223], a[96:99], a[116:119], v[220:223]
  s_waitcnt lgkmcnt(2)
  ds_read_b64_tr_b16 a[84:85], v227 offset:6432
  v_mfma_f32_16x16x32_bf16 v[160:163], a[64:67], a[144:147], v[160:163]
  ds_read_b64_tr_b16 a[86:87], v227 offset:11552
  v_mfma_f32_16x16x32_bf16 v[160:163], a[68:71], a[152:155], v[160:163]
  ds_read_b64_tr_b16 a[88:89], v227 offset:16672
  v_cvt_pk_bf16_f32 v174, v176, v177
  v_mfma_f32_16x16x32_bf16 v[160:163], a[72:75], a[160:163], v[160:163]
  ds_read_b64_tr_b16 a[90:91], v227 offset:21792
  v_mfma_f32_16x16x32_bf16 v[160:163], a[76:79], a[168:171], v[160:163]
  ds_read_b64_tr_b16 a[92:93], v227 offset:26912
  ds_read_b64_tr_b16 a[94:95], v227 offset:32032
  v_mfma_f32_16x16x32_bf16 v[200:203], a[76:79], a[172:175], v[200:203]
  ds_read_b64_tr_b16 a[96:97], v226 offset:36992
  v_cvt_pk_bf16_f32 v175, v178, v179
  v_mfma_f32_16x16x32_bf16 v[200:203], a[72:75], a[164:167], v[200:203]
  ds_read_b64_tr_b16 a[98:99], v226 offset:42112
  v_mfma_f32_16x16x32_bf16 v[200:203], a[68:71], a[156:159], v[200:203]
  ds_read_b64_tr_b16 a[100:101], v226 offset:47232
  v_mfma_f32_16x16x32_bf16 v[200:203], a[64:67], a[148:151], v[200:203]
  s_waitcnt lgkmcnt(3)
  ds_read_b64_tr_b16 a[102:103], v226 offset:52352
  v_mfma_f32_16x16x32_bf16 v[180:183], a[80:83], a[144:147], v[180:183]
  ds_read_b64_tr_b16 a[104:105], v226 offset:57472
  v_mfma_f32_16x16x32_bf16 v[180:183], a[84:87], a[152:155], v[180:183]
  ds_read_b64_tr_b16 a[106:107], v226 offset:62592
  v_mfma_f32_16x16x32_bf16 v[180:183], a[88:91], a[160:163], v[180:183]
  ds_read_b64_tr_b16 a[108:109], v228 offset:2176
  v_mfma_f32_16x16x32_bf16 v[180:183], a[92:95], a[168:171], v[180:183]
  s_waitcnt vmcnt(6)
  s_barrier
  ds_read_b64_tr_b16 a[110:111], v228 offset:7296
  v_mfma_f32_16x16x32_bf16 v[220:223], a[92:95], a[172:175], v[220:223]
  s_lshl_b32 s53, s45, 2
  buffer_store_dwordx4 v[172:175], v238, s[36:39], 0 offen offset:3072 sc1
  v_mfma_f32_16x16x32_bf16 v[220:223], a[88:91], a[164:167], v[220:223]
  s_add_u32 s53, s53, s46
  ds_read_b64_tr_b16 a[64:65], v227 offset:37152
  v_cvt_pk_bf16_f32 v212, v212, v213
  v_mfma_f32_16x16x32_bf16 v[220:223], a[84:87], a[156:159], v[220:223]
  s_lshl_b32 s53, s53, 5
  ds_read_b64_tr_b16 a[66:67], v227 offset:42272
  v_cvt_pk_bf16_f32 v213, v214, v215
  v_mfma_f32_16x16x32_bf16 v[220:223], a[80:83], a[148:151], v[220:223]
  s_waitcnt lgkmcnt(2)
  ds_read_b64_tr_b16 a[68:69], v227 offset:47392
  s_add_u32 s53, s53, s47
  v_mfma_f32_16x16x32_bf16 v[160:163], a[96:99], a[176:179], v[160:163]
  s_lshl_b32 s53, s53, 2
  ds_read_b64_tr_b16 a[70:71], v227 offset:52512
  s_add_u32 s53, s53, 16384
  v_mfma_f32_16x16x32_bf16 v[160:163], a[100:103], a[184:187], v[160:163]
  ds_read_b64_tr_b16 a[72:73], v227 offset:57632
  v_mov_b32 v254, 1
  v_mfma_f32_16x16x32_bf16 v[160:163], a[104:107], a[232:235], v[160:163]
  ds_read_b64_tr_b16 a[74:75], v227 offset:62752
  v_cvt_pk_bf16_f32 v214, v216, v217
  v_mfma_f32_16x16x32_bf16 v[160:163], a[108:111], a[248:251], v[160:163]
  ds_read_b64_tr_b16 a[76:77], v229 offset:2336
  ds_read_b64_tr_b16 a[78:79], v229 offset:7456
  v_mfma_f32_16x16x32_bf16 v[200:203], a[108:111], a[252:255], v[200:203]
  buffer_store_dword v254, v255, s[68:71], s53 offen sc1
  v_mfma_f32_16x16x32_bf16 v[200:203], a[104:107], a[244:247], v[200:203]
  v_cvt_pk_bf16_f32 v215, v218, v219
  v_mfma_f32_16x16x32_bf16 v[200:203], a[100:103], a[188:191], v[200:203]
  buffer_store_dwordx4 v[212:215], v239, s[36:39], 0 offen offset:3072 sc1
  v_mfma_f32_16x16x32_bf16 v[200:203], a[96:99], a[180:183], v[200:203]
  s_waitcnt lgkmcnt(0)
  v_mfma_f32_16x16x32_bf16 v[180:183], a[64:67], a[176:179], v[180:183]
  v_mfma_f32_16x16x32_bf16 v[180:183], a[68:71], a[184:187], v[180:183]
  v_mfma_f32_16x16x32_bf16 v[180:183], a[72:75], a[232:235], v[180:183]
  v_mfma_f32_16x16x32_bf16 v[180:183], a[76:79], a[248:251], v[180:183]
  v_mfma_f32_16x16x32_bf16 v[220:223], a[76:79], a[252:255], v[220:223]
  v_mfma_f32_16x16x32_bf16 v[220:223], a[72:75], a[244:247], v[220:223]
  v_mfma_f32_16x16x32_bf16 v[220:223], a[68:71], a[188:191], v[220:223]
  v_mfma_f32_16x16x32_bf16 v[220:223], a[64:67], a[180:183], v[220:223]
  v_cvt_pk_bf16_f32 v160, v160, v161
  v_cvt_pk_bf16_f32 v161, v162, v163
  v_cvt_pk_bf16_f32 v162, v200, v201
  v_cvt_pk_bf16_f32 v163, v202, v203
  buffer_store_dwordx4 v[160:163], v245, s[36:39], 0 offen offset:0 sc1
  v_cvt_pk_bf16_f32 v180, v180, v181
  v_cvt_pk_bf16_f32 v181, v182, v183
  s_nop 0
  v_cvt_pk_bf16_f32 v182, v220, v221
  v_cvt_pk_bf16_f32 v183, v222, v223
  buffer_store_dwordx4 v[180:183], v245, s[36:39], 0 offen offset:1024 sc1
  s_barrier
  ds_write_b128 v231, a[20:23] offset:0
  ds_write_b128 v231, a[24:27] offset:1024
  ds_write_b128 v231, a[28:31] offset:2048
  ds_write_b128 v231, a[32:35] offset:3072
  ds_write_b128 v231, a[36:39] offset:4096
  ds_write_b128 v231, a[40:43] offset:5120
  ds_write_b128 v231, a[44:47] offset:6144
  ds_write_b128 v231, a[48:51] offset:7168
  ds_write_b128 v231, a[52:55] offset:8192
  ds_write_b128 v231, a[56:59] offset:9216
  ds_write_b128 v231, a[60:63] offset:10240
  ds_write_b128 v231, a[192:195] offset:11264
  ds_write_b128 v231, a[196:199] offset:12288
  ds_write_b128 v231, a[200:203] offset:13312
  ds_write_b128 v231, a[204:207] offset:14336
  v_accvgpr_read_b32 v32, a0
  v_accvgpr_read_b32 v33, a1
  v_accvgpr_read_b32 v34, a2
  v_accvgpr_read_b32 v35, a3
  v_accvgpr_read_b32 v36, a4
  v_accvgpr_read_b32 v37, a5
  v_accvgpr_read_b32 v38, a6
  v_accvgpr_read_b32 v39, a7
  v_accvgpr_read_b32 v40, a8
  v_accvgpr_read_b32 v41, a9
  v_accvgpr_read_b32 v42, a10
  v_accvgpr_read_b32 v43, a11
  v_accvgpr_read_b32 v44, a12
  v_accvgpr_read_b32 v45, a13
  v_accvgpr_read_b32 v46, a14
  v_accvgpr_read_b32 v47, a15
  v_accvgpr_read_b32 v48, a16
  v_accvgpr_read_b32 v49, a17
  v_accvgpr_read_b32 v50, a18
  v_accvgpr_read_b32 v51, a19
  v_add_u32 v251, 0, v249
  v_mul_u32_u24 v252, 5462, v251
  v_lshrrev_b32 v252, 16, v252
  v_mul_u32_u24 v253, 12, v252
  v_sub_u32 v251, v251, v253
  v_mul_u32_u24 v252, 1280, v252
  v_lshl_add_u32 v120, v251, 4, v252
  v_add_u32 v251, 64, v249
  v_mul_u32_u24 v252, 5462, v251
  v_lshrrev_b32 v252, 16, v252
  v_mul_u32_u24 v253, 12, v252
  v_sub_u32 v251, v251, v253
  v_mul_u32_u24 v252, 1280, v252
  v_lshl_add_u32 v121, v251, 4, v252
  v_add_u32 v251, 128, v249
  v_mul_u32_u24 v252, 5462, v251
  v_lshrrev_b32 v252, 16, v252
  v_mul_u32_u24 v253, 12, v252
  v_sub_u32 v251, v251, v253
  v_mul_u32_u24 v252, 1280, v252
  v_lshl_add_u32 v122, v251, 4, v252
  v_subrev_u32 v121, 1024, v121
  v_subrev_u32 v122, 2048, v122
  s_mov_b32 m0, s50
  s_lshl_b32 s53, s45, 2
  s_add_u32 s53, s53, s46
  s_lshl_b32 s53, s53, 5
  s_add_u32 s53, s53, s47
  s_lshl_b32 s53, s53, 2
  s_add_u32 s53, s53, 16384
  s_add_u32 s53, s53, 64
  s_waitcnt lgkmcnt(0)
  s_waitcnt vmcnt(0)
  s_barrier
  v_mov_b32 v254, 1
  buffer_store_dword v254, v255, s[68:71], s53 offen sc1
  buffer_load_dwordx4 v120, s[8:11], 0 offen offset:0 lds
  buffer_load_dwordx4 v121, s[8:11], 0 offen offset:1024 lds
  buffer_load_dwordx4 v122, s[8:11], 0 offen offset:2048 lds
  ds_read_b128 v[52:55], v242 offset:0
  ds_read_b128 v[56:59], v242 offset:1024
  ds_read_b128 v[60:63], v242 offset:2048
  ds_read_b128 v[64:67], v242 offset:3072
  ds_read_b128 v[68:71], v242 offset:4096
  ds_read_b128 v[72:75], v243 offset:5120
  ds_read_b128 v[76:79], v243 offset:6144
  ds_read_b128 v[80:83], v243 offset:7168
  ds_read_b128 v[84:87], v243 offset:8192
  ds_read_b128 v[88:91], v243 offset:9216
  ds_read_b128 v[92:95], v247 offset:10240
  ds_read_b128 v[96:99], v247 offset:11264
  ds_read_b128 v[100:103], v247 offset:12288
  ds_read_b128 v[104:107], v247 offset:13312
  ds_read_b128 v[108:111], v247 offset:14336
  v_mov_b32 v112, 0
  v_mov_b32 v113, 0
  v_mov_b32 v118, 0
  v_mov_b32 v119, 0
  v_mov_b32 v251, 0x3f80
  v_mov_b32 v254, 0x3f800000
  v_cmp_eq_u32 vcc, 0, v250
  s_nop 1
  v_cndmask_b32 v114, v112, v251, vcc
  v_cmp_eq_u32 vcc, 1, v250
  s_nop 1
  v_cndmask_b32 v114, v114, v254, vcc
  v_mov_b32 v116, v114
  v_cmp_eq_u32 vcc, 2, v250
  s_nop 1
  v_cndmask_b32 v115, v112, v251, vcc
  v_cmp_eq_u32 vcc, 3, v250
  s_nop 1
  v_cndmask_b32 v115, v115, v254, vcc
  v_mov_b32 v117, v115
  v_add_u32 v251, 0, v249
  v_mul_u32_u24 v252, 6554, v251
  v_lshrrev_b32 v252, 16, v252
  v_mul_u32_u24 v253, 10, v252
  v_sub_u32 v251, v251, v253
  v_mul_u32_u24 v252, 1280, v252
  v_lshl_add_u32 v123, v251, 4, v252
  v_add_u32 v251, 64, v249
  v_mul_u32_u24 v252, 6554, v251
  v_lshrrev_b32 v252, 16, v252
  v_mul_u32_u24 v253, 10, v252
  v_sub_u32 v251, v251, v253
  v_mul_u32_u24 v252, 1280, v252
  v_lshl_add_u32 v124, v251, 4, v252
  v_add_u32 v251, 128, v249
  v_mul_u32_u24 v252, 6554, v251
  v_lshrrev_b32 v252, 16, v252
  v_mul_u32_u24 v253, 10, v252
  v_sub_u32 v251, v251, v253
  v_mul_u32_u24 v252, 1280, v252
  v_lshl_add_u32 v125, v251, 4, v252
  s_waitcnt lgkmcnt(14)
  v_pk_add_f32 v[32:33], v[32:33], v[52:53]
  v_pk_add_f32 v[34:35], v[34:35], v[54:55]
  s_waitcnt lgkmcnt(13)
  v_pk_add_f32 v[36:37], v[36:37], v[56:57]
  v_pk_add_f32 v[38:39], v[38:39], v[58:59]
  s_waitcnt lgkmcnt(12)
  v_pk_add_f32 v[40:41], v[40:41], v[60:61]
  v_pk_add_f32 v[42:43], v[42:43], v[62:63]
  s_waitcnt lgkmcnt(11)
  v_pk_add_f32 v[44:45], v[44:45], v[64:65]
  v_pk_add_f32 v[46:47], v[46:47], v[66:67]
  s_waitcnt lgkmcnt(10)
  v_pk_add_f32 v[48:49], v[48:49], v[68:69]
  v_pk_add_f32 v[50:51], v[50:51], v[70:71]
  s_waitcnt lgkmcnt(9)
  v_pk_add_f32 v[32:33], v[32:33], v[72:73]
  v_pk_add_f32 v[34:35], v[34:35], v[74:75]
  s_waitcnt lgkmcnt(8)
  v_pk_add_f32 v[36:37], v[36:37], v[76:77]
  v_pk_add_f32 v[38:39], v[38:39], v[78:79]
  s_waitcnt lgkmcnt(7)
  v_pk_add_f32 v[40:41], v[40:41], v[80:81]
  v_pk_add_f32 v[42:43], v[42:43], v[82:83]
  s_waitcnt lgkmcnt(6)
  v_pk_add_f32 v[44:45], v[44:45], v[84:85]
  v_pk_add_f32 v[46:47], v[46:47], v[86:87]
  s_waitcnt lgkmcnt(5)
  v_pk_add_f32 v[48:49], v[48:49], v[88:89]
  v_pk_add_f32 v[50:51], v[50:51], v[90:91]
  s_waitcnt lgkmcnt(4)
  v_pk_add_f32 v[32:33], v[32:33], v[92:93]
  v_pk_add_f32 v[34:35], v[34:35], v[94:95]
  s_waitcnt lgkmcnt(3)
  v_pk_add_f32 v[36:37], v[36:37], v[96:97]
  v_pk_add_f32 v[38:39], v[38:39], v[98:99]
  s_waitcnt lgkmcnt(2)
  v_pk_add_f32 v[40:41], v[40:41], v[100:101]
  v_pk_add_f32 v[42:43], v[42:43], v[102:103]
  s_waitcnt lgkmcnt(1)
  v_pk_add_f32 v[44:45], v[44:45], v[104:105]
  v_pk_add_f32 v[46:47], v[46:47], v[106:107]
  s_waitcnt lgkmcnt(0)
  v_pk_add_f32 v[48:49], v[48:49], v[108:109]
  v_pk_add_f32 v[50:51], v[50:51], v[110:111]
  v_mov_b32 v126, 0xc13504f3
  v_mov_b32 v127, 0x40faf233
  s_and_b32 s48, s45, 1
  s_lshl_b32 s48, s48, 5
  v_add_u32 v251, s48, v230
  v_and_b32 v252, 7, v249
  v_lshlrev_b32 v252, 2, v252
  v_pk_mul_f32 v[52:53], v[32:33], v[126:127] op_sel_hi:[1,0]
  v_pk_mul_f32 v[54:55], v[34:35], v[126:127] op_sel_hi:[1,0]
  v_pk_mul_f32 v[56:57], v[36:37], v[126:127] op_sel_hi:[1,0]
  v_pk_mul_f32 v[58:59], v[38:39], v[126:127] op_sel_hi:[1,0]
  v_pk_mul_f32 v[60:61], v[40:41], v[126:127] op_sel_hi:[1,0]
  v_pk_mul_f32 v[62:63], v[42:43], v[126:127] op_sel_hi:[1,0]
  v_pk_mul_f32 v[64:65], v[44:45], v[126:127] op_sel_hi:[1,0]
  v_pk_mul_f32 v[66:67], v[46:47], v[126:127] op_sel_hi:[1,0]
  v_pk_mul_f32 v[68:69], v[48:49], v[126:127] op_sel_hi:[1,0]
  v_pk_mul_f32 v[70:71], v[50:51], v[126:127] op_sel_hi:[1,0]
  v_exp_f32 v52, v52
  v_exp_f32 v53, v53
  v_exp_f32 v54, v54
  v_exp_f32 v55, v55
  v_exp_f32 v56, v56
  v_exp_f32 v57, v57
  v_exp_f32 v58, v58
  v_exp_f32 v59, v59
  v_exp_f32 v60, v60
  v_exp_f32 v61, v61
  v_exp_f32 v62, v62
  v_exp_f32 v63, v63
  v_exp_f32 v64, v64
  v_exp_f32 v65, v65
  v_exp_f32 v66, v66
  v_exp_f32 v67, v67
  v_exp_f32 v68, v68
  v_exp_f32 v69, v69
  v_exp_f32 v70, v70
  v_exp_f32 v71, v71
  buffer_load_dword v253, v252, s[68:71], s55 offen sc1
  s_waitcnt vmcnt(1)
  ds_read_b64 v[0:1], v251 offset:0
  ds_read_b64 v[2:3], v251 offset:32
  ds_read_b64 v[4:5], v251 offset:64
  ds_read_b64 v[6:7], v251 offset:96
  ds_read_b64 v[8:9], v251 offset:128
  v_add_f32 v52, 1.0, v52
  v_add_f32 v53, 1.0, v53
  v_add_f32 v54, 1.0, v54
  v_add_f32 v55, 1.0, v55
  v_add_f32 v56, 1.0, v56
  v_add_f32 v57, 1.0, v57
  v_add_f32 v58, 1.0, v58
  v_add_f32 v59, 1.0, v59
  v_add_f32 v60, 1.0, v60
  v_add_f32 v61, 1.0, v61
  v_add_f32 v62, 1.0, v62
  v_add_f32 v63, 1.0, v63
  v_add_f32 v64, 1.0, v64
  v_add_f32 v65, 1.0, v65
  v_add_f32 v66, 1.0, v66
  v_add_f32 v67, 1.0, v67
  v_add_f32 v68, 1.0, v68
  v_add_f32 v69, 1.0, v69
  v_add_f32 v70, 1.0, v70
  v_add_f32 v71, 1.0, v71
  v_rcp_f32 v52, v52
  v_rcp_f32 v53, v53
  v_rcp_f32 v54, v54
  v_rcp_f32 v55, v55
  v_rcp_f32 v56, v56
  v_rcp_f32 v57, v57
  v_rcp_f32 v58, v58
  v_rcp_f32 v59, v59
  v_rcp_f32 v60, v60
  v_rcp_f32 v61, v61
  v_rcp_f32 v62, v62
  v_rcp_f32 v63, v63
  v_rcp_f32 v64, v64
  v_rcp_f32 v65, v65
  v_rcp_f32 v66, v66
  v_rcp_f32 v67, v67
  v_rcp_f32 v68, v68
  v_rcp_f32 v69, v69
  v_rcp_f32 v70, v70
  v_rcp_f32 v71, v71
  v_pk_mul_f32 v[32:33], v[32:33], v[126:127] op_sel:[0,1] op_sel_hi:[1,1]
  v_pk_mul_f32 v[34:35], v[34:35], v[126:127] op_sel:[0,1] op_sel_hi:[1,1]
  v_pk_mul_f32 v[36:37], v[36:37], v[126:127] op_sel:[0,1] op_sel_hi:[1,1]
  v_pk_mul_f32 v[38:39], v[38:39], v[126:127] op_sel:[0,1] op_sel_hi:[1,1]
  v_pk_mul_f32 v[40:41], v[40:41], v[126:127] op_sel:[0,1] op_sel_hi:[1,1]
  v_pk_mul_f32 v[42:43], v[42:43], v[126:127] op_sel:[0,1] op_sel_hi:[1,1]
  v_pk_mul_f32 v[44:45], v[44:45], v[126:127] op_sel:[0,1] op_sel_hi:[1,1]
  v_pk_mul_f32 v[46:47], v[46:47], v[126:127] op_sel:[0,1] op_sel_hi:[1,1]
  v_pk_mul_f32 v[48:49], v[48:49], v[126:127] op_sel:[0,1] op_sel_hi:[1,1]
  v_pk_mul_f32 v[50:51], v[50:51], v[126:127] op_sel:[0,1] op_sel_hi:[1,1]
  v_pk_mul_f32 v[32:33], v[32:33], v[52:53]
  v_pk_mul_f32 v[34:35], v[34:35], v[54:55]
  v_pk_mul_f32 v[36:37], v[36:37], v[56:57]
  v_pk_mul_f32 v[38:39], v[38:39], v[58:59]
  v_pk_mul_f32 v[40:41], v[40:41], v[60:61]
  v_pk_mul_f32 v[42:43], v[42:43], v[62:63]
  v_pk_mul_f32 v[44:45], v[44:45], v[64:65]
  v_pk_mul_f32 v[46:47], v[46:47], v[66:67]
  v_pk_mul_f32 v[48:49], v[48:49], v[68:69]
  v_pk_mul_f32 v[50:51], v[50:51], v[70:71]
  s_waitcnt lgkmcnt(4)
  v_lshlrev_b32 v128, 16, v0
  v_and_b32 v129, 0xffff0000, v0
  v_lshlrev_b32 v130, 16, v1
  v_and_b32 v131, 0xffff0000, v1
  s_waitcnt lgkmcnt(3)
  v_lshlrev_b32 v132, 16, v2
  v_and_b32 v133, 0xffff0000, v2
  v_lshlrev_b32 v134, 16, v3
  v_and_b32 v135, 0xffff0000, v3
  s_waitcnt lgkmcnt(2)
  v_lshlrev_b32 v136, 16, v4
  v_and_b32 v137, 0xffff0000, v4
  v_lshlrev_b32 v138, 16, v5
  v_and_b32 v139, 0xffff0000, v5
  s_waitcnt lgkmcnt(1)
  v_lshlrev_b32 v140, 16, v6
  v_and_b32 v141, 0xffff0000, v6
  v_lshlrev_b32 v142, 16, v7
  v_and_b32 v143, 0xffff0000, v7
  s_waitcnt lgkmcnt(0)
  v_lshlrev_b32 v144, 16, v8
  v_and_b32 v145, 0xffff0000, v8
  v_lshlrev_b32 v146, 16, v9
  v_and_b32 v147, 0xffff0000, v9
  v_and_b32 v251, 15, v249
  v_lshlrev_b32 v251, 5, v251
  v_sub_u32 v230, v230, v251
  v_add_u32 v251, s50, v248
  s_waitcnt vmcnt(0)
  v_cmp_ne_u32 vcc, 1, v253
  s_cbranch_vccnz recurrent_scan__compressed_kv_cla__dense_activation_silu__prompt_kernel_spin6
recurrent_scan__compressed_kv_cla__dense_activation_silu__prompt_kernel_back6:
  s_mov_b32 s49, 0
  buffer_load_dwordx4 a[64:67], v240, s[20:23], s49 offen offset:0 sc1
  buffer_load_dwordx4 a[68:71], v240, s[20:23], s49 offen offset:1024 sc1
  buffer_load_dwordx2 a[128:129], v241, s[20:23], s49 offen sc1
  s_mov_b32 s49, 4194304
  buffer_load_dwordx4 a[72:75], v240, s[20:23], s49 offen offset:0 sc1
  buffer_load_dwordx4 a[76:79], v240, s[20:23], s49 offen offset:1024 sc1
  buffer_load_dwordx2 a[130:131], v241, s[20:23], s49 offen sc1
  s_mov_b32 s49, 8388608
  buffer_load_dwordx4 a[80:83], v240, s[20:23], s49 offen offset:0 sc1
  buffer_load_dwordx4 a[84:87], v240, s[20:23], s49 offen offset:1024 sc1
  buffer_load_dwordx2 a[132:133], v241, s[20:23], s49 offen sc1
  s_mov_b32 s49, 12582912
  buffer_load_dwordx4 a[88:91], v240, s[20:23], s49 offen offset:0 sc1
  buffer_load_dwordx4 a[92:95], v240, s[20:23], s49 offen offset:1024 sc1
  buffer_load_dwordx2 a[134:135], v241, s[20:23], s49 offen sc1
  s_mov_b32 s49, 16777216
  buffer_load_dwordx4 a[96:99], v240, s[20:23], s49 offen offset:0 sc1
  buffer_load_dwordx4 a[100:103], v240, s[20:23], s49 offen offset:1024 sc1
  buffer_load_dwordx2 a[136:137], v241, s[20:23], s49 offen sc1
  s_mov_b32 s49, 20971520
  buffer_load_dwordx4 a[104:107], v240, s[20:23], s49 offen offset:0 sc1
  buffer_load_dwordx4 a[108:111], v240, s[20:23], s49 offen offset:1024 sc1
  buffer_load_dwordx2 a[138:139], v241, s[20:23], s49 offen sc1
  s_mov_b32 s49, 25165824
  buffer_load_dwordx4 a[112:115], v240, s[20:23], s49 offen offset:0 sc1
  buffer_load_dwordx4 a[116:119], v240, s[20:23], s49 offen offset:1024 sc1
  buffer_load_dwordx2 a[140:141], v241, s[20:23], s49 offen sc1
  s_mov_b32 s49, 29360128
  buffer_load_dwordx4 a[120:123], v240, s[20:23], s49 offen offset:0 sc1
  buffer_load_dwordx4 a[124:127], v240, s[20:23], s49 offen offset:1024 sc1
  buffer_load_dwordx2 a[142:143], v241, s[20:23], s49 offen sc1
  s_waitcnt vmcnt(23)
  v_mfma_f32_16x16x32_bf16 v[148:151], v[116:119], a[64:67], 0
  v_mfma_f32_16x16x32_bf16 v[152:155], v[112:115], a[64:67], 0
  s_waitcnt vmcnt(22)
  v_mfma_f32_16x16x32_bf16 v[156:159], v[116:119], a[68:71], 0
  v_mfma_f32_16x16x32_bf16 v[160:163], v[112:115], a[68:71], 0
  s_waitcnt vmcnt(20)
  v_mfma_f32_16x16x32_bf16 v[148:151], v[116:119], a[72:75], v[148:151]
  v_mfma_f32_16x16x32_bf16 v[152:155], v[112:115], a[72:75], v[152:155]
  s_waitcnt vmcnt(19)
  v_mfma_f32_16x16x32_bf16 v[156:159], v[116:119], a[76:79], v[156:159]
  v_mfma_f32_16x16x32_bf16 v[160:163], v[112:115], a[76:79], v[160:163]
  s_waitcnt vmcnt(18)
  v_mfma_f32_16x16x32_bf16 v[164:167], v[114:117], a[128:131], 0
  s_waitcnt vmcnt(17)
  v_mfma_f32_16x16x32_bf16 v[148:151], v[116:119], a[80:83], v[148:151]
  v_mfma_f32_16x16x32_bf16 v[152:155], v[112:115], a[80:83], v[152:155]
  s_waitcnt vmcnt(16)
  v_mfma_f32_16x16x32_bf16 v[156:159], v[116:119], a[84:87], v[156:159]
  v_mfma_f32_16x16x32_bf16 v[160:163], v[112:115], a[84:87], v[160:163]
  s_waitcnt vmcnt(14)
  v_mfma_f32_16x16x32_bf16 v[148:151], v[116:119], a[88:91], v[148:151]
  v_mfma_f32_16x16x32_bf16 v[152:155], v[112:115], a[88:91], v[152:155]
  s_waitcnt vmcnt(13)
  v_mfma_f32_16x16x32_bf16 v[156:159], v[116:119], a[92:95], v[156:159]
  v_mfma_f32_16x16x32_bf16 v[160:163], v[112:115], a[92:95], v[160:163]
  s_waitcnt vmcnt(12)
  v_mfma_f32_16x16x32_bf16 v[164:167], v[114:117], a[132:135], v[164:167]
  s_waitcnt vmcnt(11)
  v_mfma_f32_16x16x32_bf16 v[148:151], v[116:119], a[96:99], v[148:151]
  v_mfma_f32_16x16x32_bf16 v[152:155], v[112:115], a[96:99], v[152:155]
  s_waitcnt vmcnt(10)
  v_mfma_f32_16x16x32_bf16 v[156:159], v[116:119], a[100:103], v[156:159]
  v_mfma_f32_16x16x32_bf16 v[160:163], v[112:115], a[100:103], v[160:163]
  s_waitcnt vmcnt(8)
  v_mfma_f32_16x16x32_bf16 v[148:151], v[116:119], a[104:107], v[148:151]
  v_mfma_f32_16x16x32_bf16 v[152:155], v[112:115], a[104:107], v[152:155]
  s_waitcnt vmcnt(7)
  v_mfma_f32_16x16x32_bf16 v[156:159], v[116:119], a[108:111], v[156:159]
  v_mfma_f32_16x16x32_bf16 v[160:163], v[112:115], a[108:111], v[160:163]
  s_waitcnt vmcnt(6)
  v_mfma_f32_16x16x32_bf16 v[164:167], v[114:117], a[136:139], v[164:167]
  s_waitcnt vmcnt(5)
  v_mfma_f32_16x16x32_bf16 v[148:151], v[116:119], a[112:115], v[148:151]
  v_mfma_f32_16x16x32_bf16 v[152:155], v[112:115], a[112:115], v[152:155]
  s_waitcnt vmcnt(4)
  v_mfma_f32_16x16x32_bf16 v[156:159], v[116:119], a[116:119], v[156:159]
  v_mfma_f32_16x16x32_bf16 v[160:163], v[112:115], a[116:119], v[160:163]
  s_waitcnt vmcnt(2)
  v_mfma_f32_16x16x32_bf16 v[148:151], v[116:119], a[120:123], v[148:151]
  v_mfma_f32_16x16x32_bf16 v[152:155], v[112:115], a[120:123], v[152:155]
  s_waitcnt vmcnt(1)
  v_mfma_f32_16x16x32_bf16 v[156:159], v[116:119], a[124:127], v[156:159]
  v_mfma_f32_16x16x32_bf16 v[160:163], v[112:115], a[124:127], v[160:163]
  s_waitcnt vmcnt(0)
  v_mfma_f32_16x16x32_bf16 v[164:167], v[114:117], a[140:143], v[164:167]
  s_nop 1
  v_fmac_f32 v128, v148, v32
  v_fmac_f32 v129, v149, v33
  v_fmac_f32 v130, v150, v34
  v_fmac_f32 v131, v151, v35
  v_cvt_pk_bf16_f32 v0, v128, v129
  v_cvt_pk_bf16_f32 v1, v130, v131
  ds_write_b64 v230, v[0:1] offset:0
  v_fmac_f32 v132, v152, v36
  v_fmac_f32 v133, v153, v37
  v_fmac_f32 v134, v154, v38
  v_fmac_f32 v135, v155, v39
  v_cvt_pk_bf16_f32 v2, v132, v133
  v_cvt_pk_bf16_f32 v3, v134, v135
  ds_write_b64 v230, v[2:3] offset:32
  v_fmac_f32 v136, v156, v40
  v_fmac_f32 v137, v157, v41
  v_fmac_f32 v138, v158, v42
  v_fmac_f32 v139, v159, v43
  v_cvt_pk_bf16_f32 v4, v136, v137
  v_cvt_pk_bf16_f32 v5, v138, v139
  ds_write_b64 v230, v[4:5] offset:64
  v_fmac_f32 v140, v160, v44
  v_fmac_f32 v141, v161, v45
  v_fmac_f32 v142, v162, v46
  v_fmac_f32 v143, v163, v47
  v_cvt_pk_bf16_f32 v6, v140, v141
  v_cvt_pk_bf16_f32 v7, v142, v143
  ds_write_b64 v230, v[6:7] offset:96
  v_fmac_f32 v144, v164, v48
  v_fmac_f32 v145, v165, v49
  v_fmac_f32 v146, v166, v50
  v_fmac_f32 v147, v167, v51
  v_cvt_pk_bf16_f32 v8, v144, v145
  v_cvt_pk_bf16_f32 v9, v146, v147
  ds_write_b64 v230, v[8:9] offset:128
  s_waitcnt lgkmcnt(0)
  ds_read_b128 v[12:15], v251 offset:0
  ds_read_b128 v[16:19], v251 offset:1024
  ds_read_b128 v[20:23], v251 offset:2048
  s_waitcnt lgkmcnt(2)
  buffer_store_dwordx4 v[12:15], v123, s[12:15], 0 offen
  s_waitcnt lgkmcnt(1)
  buffer_store_dwordx4 v[16:19], v124, s[12:15], 0 offen
  s_waitcnt lgkmcnt(0)
  buffer_store_dwordx4 v[20:23], v125, s[12:15], 0 offen
recurrent_scan__compressed_kv_cla__dense_activation_silu__prompt_kernel_end:
  s_endpgm
recurrent_scan__compressed_kv_cla__dense_activation_silu__prompt_kernel_slow:
  v_mov_b32 v0, 0
  v_mov_b32 v1, 0
  v_mov_b32 v2, 0
  v_mov_b32 v3, 0
  v_mov_b32 v4, 0
  v_mov_b32 v5, 0
  v_mov_b32 v6, 0
  v_mov_b32 v7, 0
  v_mov_b32 v8, 0
  v_mov_b32 v9, 0
  v_mov_b32 v10, 0
  v_mov_b32 v11, 0
  v_mov_b32 v12, 0
  v_mov_b32 v13, 0
  v_mov_b32 v14, 0
  v_mov_b32 v15, 0
  v_mov_b32 v16, 0
  v_mov_b32 v17, 0
  v_mov_b32 v18, 0
  v_mov_b32 v19, 0
  v_mov_b32 v20, 0
  v_mov_b32 v21, 0
  v_mov_b32 v22, 0
  v_mov_b32 v23, 0
  v_mov_b32 v24, 0
  v_mov_b32 v25, 0
  v_mov_b32 v26, 0
  v_mov_b32 v27, 0
  v_mov_b32 v28, 0
  v_mov_b32 v29, 0
  v_mov_b32 v30, 0
  v_mov_b32 v31, 0
  v_mov_b32 v32, 0
  v_mov_b32 v33, 0
  v_mov_b32 v34, 0
  v_mov_b32 v35, 0
  v_mov_b32 v36, 0
  v_mov_b32 v37, 0
  v_mov_b32 v38, 0
  v_mov_b32 v39, 0
  v_mov_b32 v40, 0
  v_mov_b32 v41, 0
  v_mov_b32 v42, 0
  v_mov_b32 v43, 0
  v_mov_b32 v44, 0
  v_mov_b32 v45, 0
  v_mov_b32 v46, 0
  v_mov_b32 v47, 0
  v_mov_b32 v48, 0
  v_mov_b32 v49, 0
  v_mov_b32 v50, 0
  v_mov_b32 v51, 0
  v_mov_b32 v52, 0
  v_mov_b32 v53, 0
  v_mov_b32 v54, 0
  v_mov_b32 v55, 0
  v_mov_b32 v56, 0
  v_mov_b32 v57, 0
  v_mov_b32 v58, 0
  v_mov_b32 v59, 0
  v_mov_b32 v60, 0
  v_mov_b32 v61, 0
  v_mov_b32 v62, 0
  v_mov_b32 v63, 0
  v_mov_b32 v64, 0
  v_mov_b32 v65, 0
  v_mov_b32 v66, 0
  v_mov_b32 v67, 0
  v_mov_b32 v68, 0
  v_mov_b32 v69, 0
  v_mov_b32 v70, 0
  v_mov_b32 v71, 0
  v_mov_b32 v72, 0
  v_mov_b32 v73, 0
  v_mov_b32 v74, 0
  v_mov_b32 v75, 0
  v_mov_b32 v76, 0
  v_mov_b32 v77, 0
  v_mov_b32 v78, 0
  v_mov_b32 v79, 0
  v_mov_b32 v80, 0
  v_mov_b32 v81, 0
  v_mov_b32 v82, 0
  v_mov_b32 v83, 0
  v_mov_b32 v84, 0
  v_mov_b32 v85, 0
  v_mov_b32 v86, 0
  v_mov_b32 v87, 0
  v_mov_b32 v88, 0
  v_mov_b32 v89, 0
  v_mov_b32 v90, 0
  v_mov_b32 v91, 0
  v_mov_b32 v92, 0
  v_mov_b32 v93, 0
  v_mov_b32 v94, 0
  v_mov_b32 v95, 0
  v_mov_b32 v96, 0
  v_mov_b32 v97, 0
  v_mov_b32 v98, 0
  v_mov_b32 v99, 0
  v_mov_b32 v100, 0
  v_mov_b32 v101, 0
  v_mov_b32 v102, 0
  v_mov_b32 v103, 0
  v_mov_b32 v104, 0
  v_mov_b32 v105, 0
  v_mov_b32 v106, 0
  v_mov_b32 v107, 0
  v_mov_b32 v108, 0
  v_mov_b32 v109, 0
  v_mov_b32 v110, 0
  v_mov_b32 v111, 0
  v_mov_b32 v112, 0
  v_mov_b32 v113, 0
  v_mov_b32 v114, 0
  v_mov_b32 v115, 0
  v_mov_b32 v116, 0
  v_mov_b32 v117, 0
  v_mov_b32 v118, 0
  v_mov_b32 v119, 0
  v_mov_b32 v120, 0
  v_mov_b32 v121, 0
  v_mov_b32 v122, 0
  v_mov_b32 v123, 0
  v_mov_b32 v124, 0
  v_mov_b32 v125, 0
  v_mov_b32 v126, 0
  v_mov_b32 v127, 0
  v_mov_b32 v128, 0
  v_mov_b32 v129, 0
  v_mov_b32 v130, 0
  v_mov_b32 v131, 0
  v_mov_b32 v132, 0
  v_mov_b32 v133, 0
  v_mov_b32 v134, 0
  v_mov_b32 v135, 0
  v_mov_b32 v136, 0
  v_mov_b32 v137, 0
  v_mov_b32 v138, 0
  v_mov_b32 v139, 0
  v_mov_b32 v140, 0
  v_mov_b32 v141, 0
  v_mov_b32 v142, 0
  v_mov_b32 v143, 0
  v_lshrrev_b32 v250, 4, v249
  v_lshlrev_b32 v250, 2, v250
  v_and_b32 v251, 15, v249
  v_sub_u32 v251, v251, v250
  v_add_u32 v224, 4096, v248
  s_lshl_b32 s48, s88, 4
  v_add_u32 v212, s48, v251
  v_mov_b32 v208, v240
  s_lshl_b32 s48, s89, 4
  v_add_u32 v213, s48, v251
  v_mov_b32 v209, v240
  s_lshl_b32 s48, s90, 4
  v_add_u32 v214, s48, v251
  v_mov_b32 v210, v240
  s_lshl_b32 s48, s91, 4
  v_add_u32 v215, s48, v251
  v_mov_b32 v211, v240
  s_mov_b32 s54, 0
  s_waitcnt vmcnt(0) lgkmcnt(0)
recurrent_scan__compressed_kv_cla__dense_activation_silu__prompt_kernel_sl:
  buffer_load_dwordx4 a[64:67], v248, s[8:11], s54 offen offset:0 sc1
  buffer_load_dwordx4 a[68:71], v248, s[8:11], s54 offen offset:1024 sc1
  buffer_load_dwordx4 a[72:75], v248, s[8:11], s54 offen offset:2048 sc1
  buffer_load_dwordx4 a[76:79], v248, s[8:11], s54 offen offset:3072 sc1
  buffer_load_dwordx4 a[80:83], v224, s[8:11], s54 offen offset:0 sc1
  buffer_load_dwordx4 a[84:87], v224, s[8:11], s54 offen offset:1024 sc1
  buffer_load_dwordx4 a[88:91], v224, s[8:11], s54 offen offset:2048 sc1
  buffer_load_dwordx4 a[92:95], v224, s[8:11], s54 offen offset:3072 sc1
  buffer_load_dwordx4 a[96:99], v248, s[12:15], s54 offen offset:0 sc1
  buffer_load_dwordx4 a[100:103], v248, s[12:15], s54 offen offset:1024 sc1
  buffer_load_dwordx4 a[104:107], v248, s[12:15], s54 offen offset:2048 sc1
  buffer_load_dwordx4 a[108:111], v248, s[12:15], s54 offen offset:3072 sc1
  buffer_load_dwordx4 a[112:115], v224, s[12:15], s54 offen offset:0 sc1
  buffer_load_dwordx4 a[116:119], v224, s[12:15], s54 offen offset:1024 sc1
  buffer_load_dwordx4 a[120:123], v224, s[12:15], s54 offen offset:2048 sc1
  buffer_load_dwordx4 a[124:127], v224, s[12:15], s54 offen offset:3072 sc1
  s_waitcnt vmcnt(15)
  v_mfma_f32_16x16x32_bf16 v[144:147], a[64:67], a[128:131], 0
  v_mfma_f32_16x16x32_bf16 v[152:155], a[64:67], a[144:147], 0
  v_mfma_f32_16x16x32_bf16 v[160:163], a[64:67], a[160:163], 0
  v_mfma_f32_16x16x32_bf16 v[168:171], a[64:67], a[176:179], 0
  s_waitcnt vmcnt(14)
  v_mfma_f32_16x16x32_bf16 v[144:147], a[68:71], a[132:135], v[144:147]
  v_mfma_f32_16x16x32_bf16 v[152:155], a[68:71], a[148:151], v[152:155]
  v_mfma_f32_16x16x32_bf16 v[160:163], a[68:71], a[164:167], v[160:163]
  v_mfma_f32_16x16x32_bf16 v[168:171], a[68:71], a[180:183], v[168:171]
  s_waitcnt vmcnt(13)
  v_mfma_f32_16x16x32_bf16 v[144:147], a[72:75], a[136:139], v[144:147]
  v_mfma_f32_16x16x32_bf16 v[152:155], a[72:75], a[152:155], v[152:155]
  v_mfma_f32_16x16x32_bf16 v[160:163], a[72:75], a[168:171], v[160:163]
  v_mfma_f32_16x16x32_bf16 v[168:171], a[72:75], a[184:187], v[168:171]
  s_waitcnt vmcnt(12)
  v_mfma_f32_16x16x32_bf16 v[144:147], a[76:79], a[140:143], v[144:147]
  v_mfma_f32_16x16x32_bf16 v[152:155], a[76:79], a[156:159], v[152:155]
  v_mfma_f32_16x16x32_bf16 v[160:163], a[76:79], a[172:175], v[160:163]
  v_mfma_f32_16x16x32_bf16 v[168:171], a[76:79], a[188:191], v[168:171]
  s_waitcnt vmcnt(11)
  v_mfma_f32_16x16x32_bf16 v[148:151], a[80:83], a[128:131], 0
  v_mfma_f32_16x16x32_bf16 v[156:159], a[80:83], a[144:147], 0
  v_mfma_f32_16x16x32_bf16 v[164:167], a[80:83], a[160:163], 0
  v_mfma_f32_16x16x32_bf16 v[172:175], a[80:83], a[176:179], 0
  s_waitcnt vmcnt(10)
  v_mfma_f32_16x16x32_bf16 v[148:151], a[84:87], a[132:135], v[148:151]
  v_mfma_f32_16x16x32_bf16 v[156:159], a[84:87], a[148:151], v[156:159]
  v_mfma_f32_16x16x32_bf16 v[164:167], a[84:87], a[164:167], v[164:167]
  v_mfma_f32_16x16x32_bf16 v[172:175], a[84:87], a[180:183], v[172:175]
  s_waitcnt vmcnt(9)
  v_mfma_f32_16x16x32_bf16 v[148:151], a[88:91], a[136:139], v[148:151]
  v_mfma_f32_16x16x32_bf16 v[156:159], a[88:91], a[152:155], v[156:159]
  v_mfma_f32_16x16x32_bf16 v[164:167], a[88:91], a[168:171], v[164:167]
  v_mfma_f32_16x16x32_bf16 v[172:175], a[88:91], a[184:187], v[172:175]
  s_waitcnt vmcnt(8)
  v_mfma_f32_16x16x32_bf16 v[148:151], a[92:95], a[140:143], v[148:151]
  v_mfma_f32_16x16x32_bf16 v[156:159], a[92:95], a[156:159], v[156:159]
  v_mfma_f32_16x16x32_bf16 v[164:167], a[92:95], a[172:175], v[164:167]
  v_mfma_f32_16x16x32_bf16 v[172:175], a[92:95], a[188:191], v[172:175]
  v_cmp_gt_i32 vcc, 0, v212
  s_nop 1
  v_cndmask_b32 v144, v144, v240, vcc
  v_cmp_gt_i32 vcc, 1, v212
  s_nop 1
  v_cndmask_b32 v145, v145, v240, vcc
  v_cmp_gt_i32 vcc, 2, v212
  s_nop 1
  v_cndmask_b32 v146, v146, v240, vcc
  v_cmp_gt_i32 vcc, 3, v212
  s_nop 1
  v_cndmask_b32 v147, v147, v240, vcc
  v_cmp_gt_i32 vcc, 16, v212
  s_nop 1
  v_cndmask_b32 v148, v148, v240, vcc
  v_cmp_gt_i32 vcc, 17, v212
  s_nop 1
  v_cndmask_b32 v149, v149, v240, vcc
  v_cmp_gt_i32 vcc, 18, v212
  s_nop 1
  v_cndmask_b32 v150, v150, v240, vcc
  v_cmp_gt_i32 vcc, 19, v212
  s_nop 1
  v_cndmask_b32 v151, v151, v240, vcc
  v_max3_f32 v216, v144, v145, v146
  v_max3_f32 v216, v216, v147, v148
  v_max3_f32 v216, v216, v149, v150
  v_max3_f32 v216, v216, v151, v208
  v_mov_b32 v220, v216
  s_nop 1
  v_permlane16_swap_b32 v220, v216
  v_max_f32 v216, v216, v220
  v_mov_b32 v220, v216
  s_nop 1
  v_permlane32_swap_b32 v220, v216
  v_max_f32 v216, v216, v220
  v_sub_f32 v220, v208, v216
  v_mov_b32 v208, v216
  v_exp_f32 v216, v220
  v_sub_f32 v144, v144, v208
  v_exp_f32 v144, v144
  v_sub_f32 v145, v145, v208
  v_exp_f32 v145, v145
  v_sub_f32 v146, v146, v208
  v_exp_f32 v146, v146
  v_sub_f32 v147, v147, v208
  v_exp_f32 v147, v147
  v_sub_f32 v148, v148, v208
  v_exp_f32 v148, v148
  v_sub_f32 v149, v149, v208
  v_exp_f32 v149, v149
  v_sub_f32 v150, v150, v208
  v_exp_f32 v150, v150
  v_sub_f32 v151, v151, v208
  v_exp_f32 v151, v151
  v_mul_f32 v0, v0, v216
  v_mul_f32 v1, v1, v216
  v_mul_f32 v2, v2, v216
  v_mul_f32 v3, v3, v216
  v_mul_f32 v4, v4, v216
  v_mul_f32 v5, v5, v216
  v_mul_f32 v6, v6, v216
  v_mul_f32 v7, v7, v216
  v_mul_f32 v8, v8, v216
  v_mul_f32 v9, v9, v216
  v_mul_f32 v10, v10, v216
  v_mul_f32 v11, v11, v216
  v_mul_f32 v12, v12, v216
  v_mul_f32 v13, v13, v216
  v_mul_f32 v14, v14, v216
  v_mul_f32 v15, v15, v216
  v_mul_f32 v16, v16, v216
  v_mul_f32 v17, v17, v216
  v_mul_f32 v18, v18, v216
  v_mul_f32 v19, v19, v216
  v_mul_f32 v20, v20, v216
  v_mul_f32 v21, v21, v216
  v_mul_f32 v22, v22, v216
  v_mul_f32 v23, v23, v216
  v_mul_f32 v24, v24, v216
  v_mul_f32 v25, v25, v216
  v_mul_f32 v26, v26, v216
  v_mul_f32 v27, v27, v216
  v_mul_f32 v28, v28, v216
  v_mul_f32 v29, v29, v216
  v_mul_f32 v30, v30, v216
  v_mul_f32 v31, v31, v216
  v_mul_f32 v128, v128, v216
  v_mul_f32 v129, v129, v216
  v_mul_f32 v130, v130, v216
  v_mul_f32 v131, v131, v216
  v_cvt_pk_bf16_f32 v144, v144, v145
  v_cvt_pk_bf16_f32 v145, v146, v147
  v_cvt_pk_bf16_f32 v146, v148, v149
  v_cvt_pk_bf16_f32 v147, v150, v151
  v_subrev_u32 v212, 32, v212
  v_cmp_gt_i32 vcc, 0, v213
  s_nop 1
  v_cndmask_b32 v152, v152, v240, vcc
  v_cmp_gt_i32 vcc, 1, v213
  s_nop 1
  v_cndmask_b32 v153, v153, v240, vcc
  v_cmp_gt_i32 vcc, 2, v213
  s_nop 1
  v_cndmask_b32 v154, v154, v240, vcc
  v_cmp_gt_i32 vcc, 3, v213
  s_nop 1
  v_cndmask_b32 v155, v155, v240, vcc
  v_cmp_gt_i32 vcc, 16, v213
  s_nop 1
  v_cndmask_b32 v156, v156, v240, vcc
  v_cmp_gt_i32 vcc, 17, v213
  s_nop 1
  v_cndmask_b32 v157, v157, v240, vcc
  v_cmp_gt_i32 vcc, 18, v213
  s_nop 1
  v_cndmask_b32 v158, v158, v240, vcc
  v_cmp_gt_i32 vcc, 19, v213
  s_nop 1
  v_cndmask_b32 v159, v159, v240, vcc
  v_max3_f32 v217, v152, v153, v154
  v_max3_f32 v217, v217, v155, v156
  v_max3_f32 v217, v217, v157, v158
  v_max3_f32 v217, v217, v159, v209
  v_mov_b32 v221, v217
  s_nop 1
  v_permlane16_swap_b32 v221, v217
  v_max_f32 v217, v217, v221
  v_mov_b32 v221, v217
  s_nop 1
  v_permlane32_swap_b32 v221, v217
  v_max_f32 v217, v217, v221
  v_sub_f32 v221, v209, v217
  v_mov_b32 v209, v217
  v_exp_f32 v217, v221
  v_sub_f32 v152, v152, v209
  v_exp_f32 v152, v152
  v_sub_f32 v153, v153, v209
  v_exp_f32 v153, v153
  v_sub_f32 v154, v154, v209
  v_exp_f32 v154, v154
  v_sub_f32 v155, v155, v209
  v_exp_f32 v155, v155
  v_sub_f32 v156, v156, v209
  v_exp_f32 v156, v156
  v_sub_f32 v157, v157, v209
  v_exp_f32 v157, v157
  v_sub_f32 v158, v158, v209
  v_exp_f32 v158, v158
  v_sub_f32 v159, v159, v209
  v_exp_f32 v159, v159
  v_mul_f32 v32, v32, v217
  v_mul_f32 v33, v33, v217
  v_mul_f32 v34, v34, v217
  v_mul_f32 v35, v35, v217
  v_mul_f32 v36, v36, v217
  v_mul_f32 v37, v37, v217
  v_mul_f32 v38, v38, v217
  v_mul_f32 v39, v39, v217
  v_mul_f32 v40, v40, v217
  v_mul_f32 v41, v41, v217
  v_mul_f32 v42, v42, v217
  v_mul_f32 v43, v43, v217
  v_mul_f32 v44, v44, v217
  v_mul_f32 v45, v45, v217
  v_mul_f32 v46, v46, v217
  v_mul_f32 v47, v47, v217
  v_mul_f32 v48, v48, v217
  v_mul_f32 v49, v49, v217
  v_mul_f32 v50, v50, v217
  v_mul_f32 v51, v51, v217
  v_mul_f32 v52, v52, v217
  v_mul_f32 v53, v53, v217
  v_mul_f32 v54, v54, v217
  v_mul_f32 v55, v55, v217
  v_mul_f32 v56, v56, v217
  v_mul_f32 v57, v57, v217
  v_mul_f32 v58, v58, v217
  v_mul_f32 v59, v59, v217
  v_mul_f32 v60, v60, v217
  v_mul_f32 v61, v61, v217
  v_mul_f32 v62, v62, v217
  v_mul_f32 v63, v63, v217
  v_mul_f32 v132, v132, v217
  v_mul_f32 v133, v133, v217
  v_mul_f32 v134, v134, v217
  v_mul_f32 v135, v135, v217
  v_cvt_pk_bf16_f32 v152, v152, v153
  v_cvt_pk_bf16_f32 v153, v154, v155
  v_cvt_pk_bf16_f32 v154, v156, v157
  v_cvt_pk_bf16_f32 v155, v158, v159
  v_subrev_u32 v213, 32, v213
  v_cmp_gt_i32 vcc, 0, v214
  s_nop 1
  v_cndmask_b32 v160, v160, v240, vcc
  v_cmp_gt_i32 vcc, 1, v214
  s_nop 1
  v_cndmask_b32 v161, v161, v240, vcc
  v_cmp_gt_i32 vcc, 2, v214
  s_nop 1
  v_cndmask_b32 v162, v162, v240, vcc
  v_cmp_gt_i32 vcc, 3, v214
  s_nop 1
  v_cndmask_b32 v163, v163, v240, vcc
  v_cmp_gt_i32 vcc, 16, v214
  s_nop 1
  v_cndmask_b32 v164, v164, v240, vcc
  v_cmp_gt_i32 vcc, 17, v214
  s_nop 1
  v_cndmask_b32 v165, v165, v240, vcc
  v_cmp_gt_i32 vcc, 18, v214
  s_nop 1
  v_cndmask_b32 v166, v166, v240, vcc
  v_cmp_gt_i32 vcc, 19, v214
  s_nop 1
  v_cndmask_b32 v167, v167, v240, vcc
  v_max3_f32 v218, v160, v161, v162
  v_max3_f32 v218, v218, v163, v164
  v_max3_f32 v218, v218, v165, v166
  v_max3_f32 v218, v218, v167, v210
  v_mov_b32 v222, v218
  s_nop 1
  v_permlane16_swap_b32 v222, v218
  v_max_f32 v218, v218, v222
  v_mov_b32 v222, v218
  s_nop 1
  v_permlane32_swap_b32 v222, v218
  v_max_f32 v218, v218, v222
  v_sub_f32 v222, v210, v218
  v_mov_b32 v210, v218
  v_exp_f32 v218, v222
  v_sub_f32 v160, v160, v210
  v_exp_f32 v160, v160
  v_sub_f32 v161, v161, v210
  v_exp_f32 v161, v161
  v_sub_f32 v162, v162, v210
  v_exp_f32 v162, v162
  v_sub_f32 v163, v163, v210
  v_exp_f32 v163, v163
  v_sub_f32 v164, v164, v210
  v_exp_f32 v164, v164
  v_sub_f32 v165, v165, v210
  v_exp_f32 v165, v165
  v_sub_f32 v166, v166, v210
  v_exp_f32 v166, v166
  v_sub_f32 v167, v167, v210
  v_exp_f32 v167, v167
  v_mul_f32 v64, v64, v218
  v_mul_f32 v65, v65, v218
  v_mul_f32 v66, v66, v218
  v_mul_f32 v67, v67, v218
  v_mul_f32 v68, v68, v218
  v_mul_f32 v69, v69, v218
  v_mul_f32 v70, v70, v218
  v_mul_f32 v71, v71, v218
  v_mul_f32 v72, v72, v218
  v_mul_f32 v73, v73, v218
  v_mul_f32 v74, v74, v218
  v_mul_f32 v75, v75, v218
  v_mul_f32 v76, v76, v218
  v_mul_f32 v77, v77, v218
  v_mul_f32 v78, v78, v218
  v_mul_f32 v79, v79, v218
  v_mul_f32 v80, v80, v218
  v_mul_f32 v81, v81, v218
  v_mul_f32 v82, v82, v218
  v_mul_f32 v83, v83, v218
  v_mul_f32 v84, v84, v218
  v_mul_f32 v85, v85, v218
  v_mul_f32 v86, v86, v218
  v_mul_f32 v87, v87, v218
  v_mul_f32 v88, v88, v218
  v_mul_f32 v89, v89, v218
  v_mul_f32 v90, v90, v218
  v_mul_f32 v91, v91, v218
  v_mul_f32 v92, v92, v218
  v_mul_f32 v93, v93, v218
  v_mul_f32 v94, v94, v218
  v_mul_f32 v95, v95, v218
  v_mul_f32 v136, v136, v218
  v_mul_f32 v137, v137, v218
  v_mul_f32 v138, v138, v218
  v_mul_f32 v139, v139, v218
  v_cvt_pk_bf16_f32 v160, v160, v161
  v_cvt_pk_bf16_f32 v161, v162, v163
  v_cvt_pk_bf16_f32 v162, v164, v165
  v_cvt_pk_bf16_f32 v163, v166, v167
  v_subrev_u32 v214, 32, v214
  v_cmp_gt_i32 vcc, 0, v215
  s_nop 1
  v_cndmask_b32 v168, v168, v240, vcc
  v_cmp_gt_i32 vcc, 1, v215
  s_nop 1
  v_cndmask_b32 v169, v169, v240, vcc
  v_cmp_gt_i32 vcc, 2, v215
  s_nop 1
  v_cndmask_b32 v170, v170, v240, vcc
  v_cmp_gt_i32 vcc, 3, v215
  s_nop 1
  v_cndmask_b32 v171, v171, v240, vcc
  v_cmp_gt_i32 vcc, 16, v215
  s_nop 1
  v_cndmask_b32 v172, v172, v240, vcc
  v_cmp_gt_i32 vcc, 17, v215
  s_nop 1
  v_cndmask_b32 v173, v173, v240, vcc
  v_cmp_gt_i32 vcc, 18, v215
  s_nop 1
  v_cndmask_b32 v174, v174, v240, vcc
  v_cmp_gt_i32 vcc, 19, v215
  s_nop 1
  v_cndmask_b32 v175, v175, v240, vcc
  v_max3_f32 v219, v168, v169, v170
  v_max3_f32 v219, v219, v171, v172
  v_max3_f32 v219, v219, v173, v174
  v_max3_f32 v219, v219, v175, v211
  v_mov_b32 v223, v219
  s_nop 1
  v_permlane16_swap_b32 v223, v219
  v_max_f32 v219, v219, v223
  v_mov_b32 v223, v219
  s_nop 1
  v_permlane32_swap_b32 v223, v219
  v_max_f32 v219, v219, v223
  v_sub_f32 v223, v211, v219
  v_mov_b32 v211, v219
  v_exp_f32 v219, v223
  v_sub_f32 v168, v168, v211
  v_exp_f32 v168, v168
  v_sub_f32 v169, v169, v211
  v_exp_f32 v169, v169
  v_sub_f32 v170, v170, v211
  v_exp_f32 v170, v170
  v_sub_f32 v171, v171, v211
  v_exp_f32 v171, v171
  v_sub_f32 v172, v172, v211
  v_exp_f32 v172, v172
  v_sub_f32 v173, v173, v211
  v_exp_f32 v173, v173
  v_sub_f32 v174, v174, v211
  v_exp_f32 v174, v174
  v_sub_f32 v175, v175, v211
  v_exp_f32 v175, v175
  v_mul_f32 v96, v96, v219
  v_mul_f32 v97, v97, v219
  v_mul_f32 v98, v98, v219
  v_mul_f32 v99, v99, v219
  v_mul_f32 v100, v100, v219
  v_mul_f32 v101, v101, v219
  v_mul_f32 v102, v102, v219
  v_mul_f32 v103, v103, v219
  v_mul_f32 v104, v104, v219
  v_mul_f32 v105, v105, v219
  v_mul_f32 v106, v106, v219
  v_mul_f32 v107, v107, v219
  v_mul_f32 v108, v108, v219
  v_mul_f32 v109, v109, v219
  v_mul_f32 v110, v110, v219
  v_mul_f32 v111, v111, v219
  v_mul_f32 v112, v112, v219
  v_mul_f32 v113, v113, v219
  v_mul_f32 v114, v114, v219
  v_mul_f32 v115, v115, v219
  v_mul_f32 v116, v116, v219
  v_mul_f32 v117, v117, v219
  v_mul_f32 v118, v118, v219
  v_mul_f32 v119, v119, v219
  v_mul_f32 v120, v120, v219
  v_mul_f32 v121, v121, v219
  v_mul_f32 v122, v122, v219
  v_mul_f32 v123, v123, v219
  v_mul_f32 v124, v124, v219
  v_mul_f32 v125, v125, v219
  v_mul_f32 v126, v126, v219
  v_mul_f32 v127, v127, v219
  v_mul_f32 v140, v140, v219
  v_mul_f32 v141, v141, v219
  v_mul_f32 v142, v142, v219
  v_mul_f32 v143, v143, v219
  v_cvt_pk_bf16_f32 v168, v168, v169
  v_cvt_pk_bf16_f32 v169, v170, v171
  v_cvt_pk_bf16_f32 v170, v172, v173
  v_cvt_pk_bf16_f32 v171, v174, v175
  v_subrev_u32 v215, 32, v215
  s_waitcnt vmcnt(7)
  v_mfma_f32_16x16x32_bf16 v[0:3], a[96:99], v[144:147], v[0:3]
  v_mfma_f32_16x16x32_bf16 v[32:35], a[96:99], v[152:155], v[32:35]
  v_mfma_f32_16x16x32_bf16 v[64:67], a[96:99], v[160:163], v[64:67]
  v_mfma_f32_16x16x32_bf16 v[96:99], a[96:99], v[168:171], v[96:99]
  s_waitcnt vmcnt(6)
  v_mfma_f32_16x16x32_bf16 v[4:7], a[100:103], v[144:147], v[4:7]
  v_mfma_f32_16x16x32_bf16 v[36:39], a[100:103], v[152:155], v[36:39]
  v_mfma_f32_16x16x32_bf16 v[68:71], a[100:103], v[160:163], v[68:71]
  v_mfma_f32_16x16x32_bf16 v[100:103], a[100:103], v[168:171], v[100:103]
  s_waitcnt vmcnt(5)
  v_mfma_f32_16x16x32_bf16 v[8:11], a[104:107], v[144:147], v[8:11]
  v_mfma_f32_16x16x32_bf16 v[40:43], a[104:107], v[152:155], v[40:43]
  v_mfma_f32_16x16x32_bf16 v[72:75], a[104:107], v[160:163], v[72:75]
  v_mfma_f32_16x16x32_bf16 v[104:107], a[104:107], v[168:171], v[104:107]
  s_waitcnt vmcnt(4)
  v_mfma_f32_16x16x32_bf16 v[12:15], a[108:111], v[144:147], v[12:15]
  v_mfma_f32_16x16x32_bf16 v[44:47], a[108:111], v[152:155], v[44:47]
  v_mfma_f32_16x16x32_bf16 v[76:79], a[108:111], v[160:163], v[76:79]
  v_mfma_f32_16x16x32_bf16 v[108:111], a[108:111], v[168:171], v[108:111]
  s_waitcnt vmcnt(3)
  v_mfma_f32_16x16x32_bf16 v[16:19], a[112:115], v[144:147], v[16:19]
  v_mfma_f32_16x16x32_bf16 v[48:51], a[112:115], v[152:155], v[48:51]
  v_mfma_f32_16x16x32_bf16 v[80:83], a[112:115], v[160:163], v[80:83]
  v_mfma_f32_16x16x32_bf16 v[112:115], a[112:115], v[168:171], v[112:115]
  s_waitcnt vmcnt(2)
  v_mfma_f32_16x16x32_bf16 v[20:23], a[116:119], v[144:147], v[20:23]
  v_mfma_f32_16x16x32_bf16 v[52:55], a[116:119], v[152:155], v[52:55]
  v_mfma_f32_16x16x32_bf16 v[84:87], a[116:119], v[160:163], v[84:87]
  v_mfma_f32_16x16x32_bf16 v[116:119], a[116:119], v[168:171], v[116:119]
  s_waitcnt vmcnt(1)
  v_mfma_f32_16x16x32_bf16 v[24:27], a[120:123], v[144:147], v[24:27]
  v_mfma_f32_16x16x32_bf16 v[56:59], a[120:123], v[152:155], v[56:59]
  v_mfma_f32_16x16x32_bf16 v[88:91], a[120:123], v[160:163], v[88:91]
  v_mfma_f32_16x16x32_bf16 v[120:123], a[120:123], v[168:171], v[120:123]
  s_waitcnt vmcnt(0)
  v_mfma_f32_16x16x32_bf16 v[28:31], a[124:127], v[144:147], v[28:31]
  v_mfma_f32_16x16x32_bf16 v[60:63], a[124:127], v[152:155], v[60:63]
  v_mfma_f32_16x16x32_bf16 v[92:95], a[124:127], v[160:163], v[92:95]
  v_mfma_f32_16x16x32_bf16 v[124:127], a[124:127], v[168:171], v[124:127]
  v_mfma_f32_16x16x32_bf16 v[128:131], a[232:235], v[144:147], v[128:131]
  v_mfma_f32_16x16x32_bf16 v[132:135], a[232:235], v[152:155], v[132:135]
  v_mfma_f32_16x16x32_bf16 v[136:139], a[232:235], v[160:163], v[136:139]
  v_mfma_f32_16x16x32_bf16 v[140:143], a[232:235], v[168:171], v[140:143]
  s_add_u32 s54, s54, 8192
  s_cmp_lt_u32 s54, s10
  s_cbranch_scc1 recurrent_scan__compressed_kv_cla__dense_activation_silu__prompt_kernel_sl
  s_nop 3
  v_rcp_f32 v250, v136
  v_rcp_f32 v251, v140
  s_nop 0
  v_pk_mul_f32 v[64:65], v[64:65], v[250:251] op_sel_hi:[1,0]
  v_pk_mul_f32 v[66:67], v[66:67], v[250:251] op_sel_hi:[1,0]
  v_pk_mul_f32 v[68:69], v[68:69], v[250:251] op_sel_hi:[1,0]
  v_pk_mul_f32 v[70:71], v[70:71], v[250:251] op_sel_hi:[1,0]
  v_cvt_pk_bf16_f32 v64, v64, v65
  v_cvt_pk_bf16_f32 v65, v66, v67
  v_cvt_pk_bf16_f32 v66, v68, v69
  v_cvt_pk_bf16_f32 v67, v70, v71
  buffer_store_dwordx4 v[64:67], v238, s[16:19], 0 offen offset:0 sc1
  v_pk_mul_f32 v[72:73], v[72:73], v[250:251] op_sel_hi:[1,0]
  v_pk_mul_f32 v[74:75], v[74:75], v[250:251] op_sel_hi:[1,0]
  v_pk_mul_f32 v[76:77], v[76:77], v[250:251] op_sel_hi:[1,0]
  v_pk_mul_f32 v[78:79], v[78:79], v[250:251] op_sel_hi:[1,0]
  v_cvt_pk_bf16_f32 v72, v72, v73
  v_cvt_pk_bf16_f32 v73, v74, v75
  v_cvt_pk_bf16_f32 v74, v76, v77
  v_cvt_pk_bf16_f32 v75, v78, v79
  buffer_store_dwordx4 v[72:75], v238, s[16:19], 0 offen offset:1024 sc1
  v_pk_mul_f32 v[80:81], v[80:81], v[250:251] op_sel_hi:[1,0]
  v_pk_mul_f32 v[82:83], v[82:83], v[250:251] op_sel_hi:[1,0]
  v_pk_mul_f32 v[84:85], v[84:85], v[250:251] op_sel_hi:[1,0]
  v_pk_mul_f32 v[86:87], v[86:87], v[250:251] op_sel_hi:[1,0]
  v_cvt_pk_bf16_f32 v80, v80, v81
  v_cvt_pk_bf16_f32 v81, v82, v83
  v_cvt_pk_bf16_f32 v82, v84, v85
  v_cvt_pk_bf16_f32 v83, v86, v87
  buffer_store_dwordx4 v[80:83], v238, s[16:19], 0 offen offset:2048 sc1
  v_pk_mul_f32 v[88:89], v[88:89], v[250:251] op_sel_hi:[1,0]
  v_pk_mul_f32 v[90:91], v[90:91], v[250:251] op_sel_hi:[1,0]
  v_pk_mul_f32 v[92:93], v[92:93], v[250:251] op_sel_hi:[1,0]
  v_pk_mul_f32 v[94:95], v[94:95], v[250:251] op_sel_hi:[1,0]
  v_cvt_pk_bf16_f32 v88, v88, v89
  v_cvt_pk_bf16_f32 v89, v90, v91
  v_cvt_pk_bf16_f32 v90, v92, v93
  v_cvt_pk_bf16_f32 v91, v94, v95
  buffer_store_dwordx4 v[88:91], v238, s[16:19], 0 offen offset:3072 sc1
  v_pk_mul_f32 v[96:97], v[96:97], v[250:251] op_sel:[0,1] op_sel_hi:[1,1]
  v_pk_mul_f32 v[98:99], v[98:99], v[250:251] op_sel:[0,1] op_sel_hi:[1,1]
  v_pk_mul_f32 v[100:101], v[100:101], v[250:251] op_sel:[0,1] op_sel_hi:[1,1]
  v_pk_mul_f32 v[102:103], v[102:103], v[250:251] op_sel:[0,1] op_sel_hi:[1,1]
  v_cvt_pk_bf16_f32 v96, v96, v97
  v_cvt_pk_bf16_f32 v97, v98, v99
  v_cvt_pk_bf16_f32 v98, v100, v101
  v_cvt_pk_bf16_f32 v99, v102, v103
  buffer_store_dwordx4 v[96:99], v239, s[16:19], 0 offen offset:0 sc1
  v_pk_mul_f32 v[104:105], v[104:105], v[250:251] op_sel:[0,1] op_sel_hi:[1,1]
  v_pk_mul_f32 v[106:107], v[106:107], v[250:251] op_sel:[0,1] op_sel_hi:[1,1]
  v_pk_mul_f32 v[108:109], v[108:109], v[250:251] op_sel:[0,1] op_sel_hi:[1,1]
  v_pk_mul_f32 v[110:111], v[110:111], v[250:251] op_sel:[0,1] op_sel_hi:[1,1]
  v_cvt_pk_bf16_f32 v104, v104, v105
  v_cvt_pk_bf16_f32 v105, v106, v107
  v_cvt_pk_bf16_f32 v106, v108, v109
  v_cvt_pk_bf16_f32 v107, v110, v111
  buffer_store_dwordx4 v[104:107], v239, s[16:19], 0 offen offset:1024 sc1
  v_pk_mul_f32 v[112:113], v[112:113], v[250:251] op_sel:[0,1] op_sel_hi:[1,1]
  v_pk_mul_f32 v[114:115], v[114:115], v[250:251] op_sel:[0,1] op_sel_hi:[1,1]
  v_pk_mul_f32 v[116:117], v[116:117], v[250:251] op_sel:[0,1] op_sel_hi:[1,1]
  v_pk_mul_f32 v[118:119], v[118:119], v[250:251] op_sel:[0,1] op_sel_hi:[1,1]
  v_cvt_pk_bf16_f32 v112, v112, v113
  v_cvt_pk_bf16_f32 v113, v114, v115
  v_cvt_pk_bf16_f32 v114, v116, v117
  v_cvt_pk_bf16_f32 v115, v118, v119
  buffer_store_dwordx4 v[112:115], v239, s[16:19], 0 offen offset:2048 sc1
  v_pk_mul_f32 v[120:121], v[120:121], v[250:251] op_sel:[0,1] op_sel_hi:[1,1]
  v_pk_mul_f32 v[122:123], v[122:123], v[250:251] op_sel:[0,1] op_sel_hi:[1,1]
  v_pk_mul_f32 v[124:125], v[124:125], v[250:251] op_sel:[0,1] op_sel_hi:[1,1]
  v_pk_mul_f32 v[126:127], v[126:127], v[250:251] op_sel:[0,1] op_sel_hi:[1,1]
  v_cvt_pk_bf16_f32 v120, v120, v121
  v_cvt_pk_bf16_f32 v121, v122, v123
  v_cvt_pk_bf16_f32 v122, v124, v125
  v_cvt_pk_bf16_f32 v123, v126, v127
  buffer_store_dwordx4 v[120:123], v239, s[16:19], 0 offen offset:3072 sc1
  s_cmp_eq_u32 s63, 0
  s_cselect_b32 s56, 0, s18
  s_mov_b32 s54, s18
  s_mov_b32 s18, s56
  v_rcp_f32 v250, v128
  v_rcp_f32 v251, v132
  s_nop 0
  v_pk_mul_f32 v[0:1], v[0:1], v[250:251] op_sel_hi:[1,0]
  v_pk_mul_f32 v[2:3], v[2:3], v[250:251] op_sel_hi:[1,0]
  v_pk_mul_f32 v[4:5], v[4:5], v[250:251] op_sel_hi:[1,0]
  v_pk_mul_f32 v[6:7], v[6:7], v[250:251] op_sel_hi:[1,0]
  v_cvt_pk_bf16_f32 v0, v0, v1
  v_cvt_pk_bf16_f32 v1, v2, v3
  v_cvt_pk_bf16_f32 v2, v4, v5
  v_cvt_pk_bf16_f32 v3, v6, v7
  buffer_store_dwordx4 v[0:3], v236, s[16:19], 0 offen offset:0 sc1
  v_pk_mul_f32 v[8:9], v[8:9], v[250:251] op_sel_hi:[1,0]
  v_pk_mul_f32 v[10:11], v[10:11], v[250:251] op_sel_hi:[1,0]
  v_pk_mul_f32 v[12:13], v[12:13], v[250:251] op_sel_hi:[1,0]
  v_pk_mul_f32 v[14:15], v[14:15], v[250:251] op_sel_hi:[1,0]
  v_cvt_pk_bf16_f32 v8, v8, v9
  v_cvt_pk_bf16_f32 v9, v10, v11
  v_cvt_pk_bf16_f32 v10, v12, v13
  v_cvt_pk_bf16_f32 v11, v14, v15
  buffer_store_dwordx4 v[8:11], v236, s[16:19], 0 offen offset:1024 sc1
  v_pk_mul_f32 v[16:17], v[16:17], v[250:251] op_sel_hi:[1,0]
  v_pk_mul_f32 v[18:19], v[18:19], v[250:251] op_sel_hi:[1,0]
  v_pk_mul_f32 v[20:21], v[20:21], v[250:251] op_sel_hi:[1,0]
  v_pk_mul_f32 v[22:23], v[22:23], v[250:251] op_sel_hi:[1,0]
  v_cvt_pk_bf16_f32 v16, v16, v17
  v_cvt_pk_bf16_f32 v17, v18, v19
  v_cvt_pk_bf16_f32 v18, v20, v21
  v_cvt_pk_bf16_f32 v19, v22, v23
  buffer_store_dwordx4 v[16:19], v236, s[16:19], 0 offen offset:2048 sc1
  v_pk_mul_f32 v[24:25], v[24:25], v[250:251] op_sel_hi:[1,0]
  v_pk_mul_f32 v[26:27], v[26:27], v[250:251] op_sel_hi:[1,0]
  v_pk_mul_f32 v[28:29], v[28:29], v[250:251] op_sel_hi:[1,0]
  v_pk_mul_f32 v[30:31], v[30:31], v[250:251] op_sel_hi:[1,0]
  v_cvt_pk_bf16_f32 v24, v24, v25
  v_cvt_pk_bf16_f32 v25, v26, v27
  v_cvt_pk_bf16_f32 v26, v28, v29
  v_cvt_pk_bf16_f32 v27, v30, v31
  buffer_store_dwordx4 v[24:27], v236, s[16:19], 0 offen offset:3072 sc1
  v_pk_mul_f32 v[32:33], v[32:33], v[250:251] op_sel:[0,1] op_sel_hi:[1,1]
  v_pk_mul_f32 v[34:35], v[34:35], v[250:251] op_sel:[0,1] op_sel_hi:[1,1]
  v_pk_mul_f32 v[36:37], v[36:37], v[250:251] op_sel:[0,1] op_sel_hi:[1,1]
  v_pk_mul_f32 v[38:39], v[38:39], v[250:251] op_sel:[0,1] op_sel_hi:[1,1]
  v_cvt_pk_bf16_f32 v32, v32, v33
  v_cvt_pk_bf16_f32 v33, v34, v35
  v_cvt_pk_bf16_f32 v34, v36, v37
  v_cvt_pk_bf16_f32 v35, v38, v39
  buffer_store_dwordx4 v[32:35], v237, s[16:19], 0 offen offset:0 sc1
  v_pk_mul_f32 v[40:41], v[40:41], v[250:251] op_sel:[0,1] op_sel_hi:[1,1]
  v_pk_mul_f32 v[42:43], v[42:43], v[250:251] op_sel:[0,1] op_sel_hi:[1,1]
  v_pk_mul_f32 v[44:45], v[44:45], v[250:251] op_sel:[0,1] op_sel_hi:[1,1]
  v_pk_mul_f32 v[46:47], v[46:47], v[250:251] op_sel:[0,1] op_sel_hi:[1,1]
  v_cvt_pk_bf16_f32 v40, v40, v41
  v_cvt_pk_bf16_f32 v41, v42, v43
  v_cvt_pk_bf16_f32 v42, v44, v45
  v_cvt_pk_bf16_f32 v43, v46, v47
  buffer_store_dwordx4 v[40:43], v237, s[16:19], 0 offen offset:1024 sc1
  v_pk_mul_f32 v[48:49], v[48:49], v[250:251] op_sel:[0,1] op_sel_hi:[1,1]
  v_pk_mul_f32 v[50:51], v[50:51], v[250:251] op_sel:[0,1] op_sel_hi:[1,1]
  v_pk_mul_f32 v[52:53], v[52:53], v[250:251] op_sel:[0,1] op_sel_hi:[1,1]
  v_pk_mul_f32 v[54:55], v[54:55], v[250:251] op_sel:[0,1] op_sel_hi:[1,1]
  v_cvt_pk_bf16_f32 v48, v48, v49
  v_cvt_pk_bf16_f32 v49, v50, v51
  v_cvt_pk_bf16_f32 v50, v52, v53
  v_cvt_pk_bf16_f32 v51, v54, v55
  buffer_store_dwordx4 v[48:51], v237, s[16:19], 0 offen offset:2048 sc1
  v_pk_mul_f32 v[56:57], v[56:57], v[250:251] op_sel:[0,1] op_sel_hi:[1,1]
  v_pk_mul_f32 v[58:59], v[58:59], v[250:251] op_sel:[0,1] op_sel_hi:[1,1]
  v_pk_mul_f32 v[60:61], v[60:61], v[250:251] op_sel:[0,1] op_sel_hi:[1,1]
  v_pk_mul_f32 v[62:63], v[62:63], v[250:251] op_sel:[0,1] op_sel_hi:[1,1]
  v_cvt_pk_bf16_f32 v56, v56, v57
  v_cvt_pk_bf16_f32 v57, v58, v59
  v_cvt_pk_bf16_f32 v58, v60, v61
  v_cvt_pk_bf16_f32 v59, v62, v63
  buffer_store_dwordx4 v[56:59], v237, s[16:19], 0 offen offset:3072 sc1
  s_mov_b32 s18, s54
  s_waitcnt vmcnt(0)
  s_cmp_eq_u32 s63, 0
  s_cbranch_scc1 recurrent_scan__compressed_kv_cla__dense_activation_silu__prompt_kernel_slow2
  v_lshlrev_b32 v251, 22, v249
  v_mov_b32 v254, 1
  buffer_store_dword v254, v251, s[68:71], s53 offen sc1
recurrent_scan__compressed_kv_cla__dense_activation_silu__prompt_kernel_slow2:
  s_andn2_b32 s55, s53, 48
  v_and_b32 v252, 3, v249
  v_lshlrev_b32 v252, 4, v252
  buffer_load_dword v253, v252, s[68:71], s55 offen sc1
  s_branch recurrent_scan__compressed_kv_cla__dense_activation_silu__prompt_kernel_fin
recurrent_scan__compressed_kv_cla__dense_activation_silu__prompt_kernel_spin0:
  s_mov_b32 s101, 0
recurrent_scan__compressed_kv_cla__dense_activation_silu__prompt_kernel_spl0:
  buffer_load_dword v247, v243, s[72:75], 0 offen sc1
  s_waitcnt vmcnt(0)
  v_cmp_gt_u32 vcc, 0x80, v247
  s_cbranch_vccz recurrent_scan__compressed_kv_cla__dense_activation_silu__prompt_kernel_back0
  s_sleep 4
  s_add_u32 s101, s101, 1
  s_cmp_lt_u32 s101, 0x40000
  s_cbranch_scc1 recurrent_scan__compressed_kv_cla__dense_activation_silu__prompt_kernel_spl0
  s_endpgm
recurrent_scan__compressed_kv_cla__dense_activation_silu__prompt_kernel_spin1:
  s_mov_b32 s101, 0
recurrent_scan__compressed_kv_cla__dense_activation_silu__prompt_kernel_spl1:
  buffer_load_dword v247, v243, s[68:71], s53 offen sc1
  s_waitcnt vmcnt(0)
  v_cmp_ne_u32 vcc, 1, v247
  s_cbranch_vccz recurrent_scan__compressed_kv_cla__dense_activation_silu__prompt_kernel_back1
  s_sleep 4
  s_add_u32 s101, s101, 1
  s_cmp_lt_u32 s101, 0x40000
  s_cbranch_scc1 recurrent_scan__compressed_kv_cla__dense_activation_silu__prompt_kernel_spl1
  s_endpgm
recurrent_scan__compressed_kv_cla__dense_activation_silu__prompt_kernel_spin2:
  s_mov_b32 s101, 0
recurrent_scan__compressed_kv_cla__dense_activation_silu__prompt_kernel_spl2:
  buffer_load_dword v253, v252, s[68:71], s55 offen sc1
  s_waitcnt vmcnt(0)
  v_cmp_ne_u32 vcc, 1, v253
  s_cbranch_vccz recurrent_scan__compressed_kv_cla__dense_activation_silu__prompt_kernel_back2
  s_sleep 4
  s_add_u32 s101, s101, 1
  s_cmp_lt_u32 s101, 0x40000
  s_cbranch_scc1 recurrent_scan__compressed_kv_cla__dense_activation_silu__prompt_kernel_spl2
  s_endpgm
recurrent_scan__compressed_kv_cla__dense_activation_silu__prompt_kernel_spin3:
  s_mov_b32 s101, 0
recurrent_scan__compressed_kv_cla__dense_activation_silu__prompt_kernel_spl3:
  buffer_load_dword v253, v252, s[68:71], s51 offen sc1
  s_waitcnt vmcnt(0)
  v_cmp_ne_u32 vcc, 1, v253
  s_cbranch_vccz recurrent_scan__compressed_kv_cla__dense_activation_silu__prompt_kernel_back3
  s_sleep 4
  s_add_u32 s101, s101, 1
  s_cmp_lt_u32 s101, 0x40000
  s_cbranch_scc1 recurrent_scan__compressed_kv_cla__dense_activation_silu__prompt_kernel_spl3
  s_endpgm
recurrent_scan__compressed_kv_cla__dense_activation_silu__prompt_kernel_spin4:
  s_mov_b32 s101, 0
recurrent_scan__compressed_kv_cla__dense_activation_silu__prompt_kernel_spl4:
  buffer_load_dword v253, v252, s[68:71], s51 offen sc1
  s_waitcnt vmcnt(0)
  v_cmp_ne_u32 vcc, 1, v253
  s_cbranch_vccz recurrent_scan__compressed_kv_cla__dense_activation_silu__prompt_kernel_back4
  s_sleep 4
  s_add_u32 s101, s101, 1
  s_cmp_lt_u32 s101, 0x40000
  s_cbranch_scc1 recurrent_scan__compressed_kv_cla__dense_activation_silu__prompt_kernel_spl4
  s_endpgm
recurrent_scan__compressed_kv_cla__dense_activation_silu__prompt_kernel_spin5:
  s_mov_b32 s101, 0
recurrent_scan__compressed_kv_cla__dense_activation_silu__prompt_kernel_spl5:
  buffer_load_dword v253, v252, s[68:71], s53 offen sc1
  s_waitcnt vmcnt(0)
  v_cmp_ne_u32 vcc, 1, v253
  s_cbranch_vccz recurrent_scan__compressed_kv_cla__dense_activation_silu__prompt_kernel_back5
  s_sleep 4
  s_add_u32 s101, s101, 1
  s_cmp_lt_u32 s101, 0x40000
  s_cbranch_scc1 recurrent_scan__compressed_kv_cla__dense_activation_silu__prompt_kernel_spl5
  s_endpgm
recurrent_scan__compressed_kv_cla__dense_activation_silu__prompt_kernel_spin6:
  s_mov_b32 s101, 0
recurrent_scan__compressed_kv_cla__dense_activation_silu__prompt_kernel_spl6:
  buffer_load_dword v253, v252, s[68:71], s55 offen sc1
  s_waitcnt vmcnt(0)
  v_cmp_ne_u32 vcc, 1, v253
  s_cbranch_vccz recurrent_scan__compressed_kv_cla__dense_activation_silu__prompt_kernel_back6
  s_sleep 4
  s_add_u32 s101, s101, 1
  s_cmp_lt_u32 s101, 0x40000
  s_cbranch_scc1 recurrent_scan__compressed_kv_cla__dense_activation_silu__prompt_kernel_spl6
  s_endpgm
recurrent_scan__compressed_kv_cla__dense_activation_silu__prompt_kernel_last:
  s_endpgm
.section .rodata,"a"
.p2align 6
.amdhsa_kernel recurrent_scan__compressed_kv_cla__dense_activation_silu__prompt_kernel
  .amdhsa_next_free_vgpr 512
  .amdhsa_next_free_sgpr 102
  .amdhsa_accum_offset 256
  .amdhsa_group_segment_fixed_size 0
  .amdhsa_kernarg_size 96
  .amdhsa_user_sgpr_count 2
  .amdhsa_user_sgpr_kernarg_segment_ptr 1
  .amdhsa_system_sgpr_workgroup_id_x 1
.end_amdhsa_kernel
```
